```python
import torch

def _softmax(x, axis=-1):
    return torch.softmax(x, dim=axis)

def _gelu(x):
    return torch.nn.functional.gelu(x, approximate='tanh')

def _silu(x):
    return torch.nn.functional.silu(x)

def _sigmoid(x):
    return torch.sigmoid(x)

def _layernorm(x, axis=-1, eps=1e-05):
    m = x.mean(dim=axis, keepdim=True)
    v = x.var(dim=axis, keepdim=True, unbiased=False)
    return (x - m) / torch.sqrt(v + eps)

def _scatter_add(tgt, idx, src, axis=0):
    return tgt.clone().index_add_(axis, idx, src)

def _segment_sum(src, seg, n):
    out = torch.zeros((n,) + src.shape[1:], dtype=src.dtype)
    return out.index_add_(0, seg, src)

def _pad(x, pw):
    flat = tuple((v for pair in reversed(pw) for v in pair))
    return torch.nn.functional.pad(x, flat)
kernel_name = 'adaLN_cond__gqa_block_cached__moe_arch_mod__prompt'

def setup_inputs():

    _w = lambda a: (lambda t: t.to(torch.bfloat16) if t.is_floating_point() else t)(torch.as_tensor(a))

    def _A_setup():
        B, Sq, D = (1, 2048, 512)
        Hq, Hkv, Sk, Dh = (32, 32, 2048, 128)
        assert Hq % Hkv == 0, (Hq, Hkv)
        return {'x': _w((lambda *s: torch.randn(*s, dtype=torch.bfloat16) * 0.1)(B, Sq, D)), 'k_cache': _w((lambda *s: torch.randn(*s, dtype=torch.bfloat16) * 0.8)(B, Hkv, Sk, Dh)), 'v_cache': _w((lambda *s: torch.randn(*s, dtype=torch.bfloat16) * 0.8)(B, Hkv, Sk, Dh)), 'wq': _w((lambda *s: torch.randn(*s, dtype=torch.bfloat16) * 0.8)(D, Hq * Dh) * D ** (-0.5)), 'wo': _w((lambda *s: torch.randn(*s, dtype=torch.bfloat16) * 0.8)(Hq * Dh, D) * (Hq * Dh) ** (-0.5))}
    _A_in = _A_setup()

    def _B_setup():
        B, S, D, F, C = (1, 2048, 512, 1376, 1)
        return {'x': _w((lambda *s: torch.randn(*s, dtype=torch.bfloat16) * 0.1)(B, S, D)), 'w_r': _w((lambda *s: torch.randn(*s, dtype=torch.bfloat16) * 3.2)(D)), 'w_gate': _w((lambda *s: torch.randn(*s, dtype=torch.bfloat16) * 0.2)(D, F)), 'w_up': _w((lambda *s: torch.randn(*s, dtype=torch.bfloat16) * 0.2)(D, F)), 'w_down': _w((lambda *s: torch.randn(*s, dtype=torch.bfloat16) * 0.2)(F, D))}
    _B_in = _B_setup()
    return {'A_x': _A_in['x'], 'A_k_cache': _A_in['k_cache'], 'A_v_cache': _A_in['v_cache'], 'A_wq': _A_in['wq'], 'A_wo': _A_in['wo'], 'B_x': _B_in['x'], 'B_w_r': _B_in['w_r'], 'B_w_gate': _B_in['w_gate'], 'B_w_up': _B_in['w_up'], 'B_w_down': _B_in['w_down'], 'c': _w((lambda *s: torch.randn(*s, dtype=torch.bfloat16) * 0.2)(1, 512) * 8.0), 'w_mod': _w((lambda *s: torch.randn(*s, dtype=torch.bfloat16) * 0.2)(512, 6 * 512) * 512 ** (-0.5) * 8.0)}

def reference(A_x, A_k_cache, A_v_cache, A_wq, A_wo, B_x, B_w_r, B_w_gate, B_w_up, B_w_down, c, w_mod):

    def _A_ref(x, k_cache, v_cache, wq, wo):
        B, Sq, D = x.shape
        Hq, Dh = (32, 128)
        Hkv = k_cache.shape[1]
        rep = Hq // Hkv
        q = (lambda x, *d: x.permute(*d))((x @ wq).reshape(B, Sq, Hq, Dh), 0, 2, 1, 3)
        k = (lambda x, n, axis: torch.repeat_interleave(x, n, dim=axis))(k_cache, rep, axis=1)
        v = (lambda x, n, axis: torch.repeat_interleave(x, n, dim=axis))(v_cache, rep, axis=1)
        scores = torch.einsum('bhqd,bhkd->bhqk', q, k) * Dh ** (-0.5)
        p = _softmax(scores, axis=-1)
        o = torch.einsum('bhqk,bhkd->bhqd', p, v)
        return (lambda x, *d: x.permute(*d))(o, 0, 2, 1, 3).reshape(B, Sq, Hq * Dh) @ wo

    def _B_ref(x, w_r, w_gate, w_up, w_down):
        B, S, D = x.shape
        C = 1
        r = x @ w_r
        idx = torch.argsort(-r, axis=-1)[:, :C]
        idx_e = (lambda x, n, axis: torch.repeat_interleave(x, n, dim=axis))(idx.reshape(B, C, 1), D, axis=2)
        x_sel = (lambda x, i, axis: torch.take_along_dim(x, i, dim=axis))(x, idx_e, axis=1)
        g = _silu(x_sel @ w_gate)
        u = x_sel @ w_up
        y = g * u @ w_down
        r_sel = _sigmoid((lambda x, i, axis: torch.take_along_dim(x, i, dim=axis))(r, idx, axis=1))
        y = y * r_sel.reshape(B, C, 1)
        b_off = (torch.arange(B) * S).reshape(B, 1)
        flat_idx = (idx + b_off).reshape(B * C)
        zero = (x * 0.0).reshape(B * S, D)
        upd = _scatter_add(zero, flat_idx, y.reshape(B * C, D), axis=0)
        return x + upd.reshape(B, S, D)
    x = A_x
    mod = (_silu(c) @ w_mod).reshape(c.shape[0], 6, 1, -1)
    sa, ca, ga, sb, cb, gb = (mod[:, 0].clone(), mod[:, 1].clone(), mod[:, 2].clone(), mod[:, 3].clone(), mod[:, 4].clone(), mod[:, 5].clone())
    h = _layernorm(x, axis=-1) * (1 + ca) + sa
    x = x + ga * _A_ref(h, A_k_cache, A_v_cache, A_wq, A_wo)
    h = _layernorm(x, axis=-1) * (1 + cb) + sb
    x = x + gb * _B_ref(h, B_w_r, B_w_gate, B_w_up, B_w_down)
    return x
```

```asm
; @launch grid=(256,1,1) block=(256,1,1) lds=163840
.amdgcn_target "amdgcn-amd-amdhsa--gfx950"
.text
.p2align 12
.globl adaLN_cond__gqa_block_cached__moe_arch_mod__prompt_kernel
.p2align 8
.type adaLN_cond__gqa_block_cached__moe_arch_mod__prompt_kernel,@function
adaLN_cond__gqa_block_cached__moe_arch_mod__prompt_kernel:
s_cmp_ge_u32 s2, 256
s_cbranch_scc1 La_end
s_load_dwordx2 s[80:81], s[0:1], 0
s_load_dwordx2 s[96:97], s[0:1], 88
s_load_dwordx2 s[12:13], s[0:1], 80
s_load_dwordx2 s[16:17], s[0:1], 112
s_load_dwordx2 s[20:21], s[0:1], 24
s_load_dwordx2 s[88:89], s[0:1], 104
s_load_dwordx4 s[4:7], s[0:1], 8
s_load_dwordx2 s[84:85], s[0:1], 96
s_load_dwordx2 s[56:57], s[0:1], 56
s_load_dwordx2 s[92:93], s[0:1], 64
s_load_dwordx2 s[48:49], s[0:1], 72
v_and_b32 v248, 63, v0
v_lshrrev_b32 v192, 6, v0
s_and_b32 s34, s2, 7
s_lshr_b32 s35, s2, 3
v_readfirstlane_b32 s27, v192
s_getpc_b64 s[40:41]
Lh_pc:
s_lshl2_add_u32 s36, s35, s27
s_mul_i32 s36, s36, 640
v_lshl_add_u32 v1, v248, 7, s36
v_min_u32 v1, La_last-Lh_pc, v1
s_mov_b64 exec, 31
global_load_dword v215, v1, s[40:41]
s_mov_b64 exec, -1
s_mov_b32 s82, 0x200000
s_mov_b32 s83, 0x20000
s_mov_b32 s98, 0x300000
s_mov_b32 s99, 0x20000
s_mov_b32 s14, 0x400
s_mov_b32 s15, 0x20000
s_mov_b32 s18, 0x10000000
s_mov_b32 s19, 0x20000
v_and_b32 v6, 3, v0
v_lshrrev_b32 v7, 2, v248
v_lshlrev_b32 v8, 4, v7
v_lshl_add_u32 v8, v6, 10, v8
v_lshrrev_b32 v3, 3, v0
v_lshlrev_b32 v4, 1, v3
v_mul_u32_u24 v5, 6144, v3
v_and_b32 v2, 7, v0
v_lshl_add_u32 v5, v2, 4, v5
v_lshlrev_b32 v11, 1, v0
s_mov_b32 s62, s2
s_cmp_lt_u32 s2, 192
s_cselect_b32 s3, 1, 0
s_cmp_lt_u32 s2, 128
s_cselect_b32 s3, 2, s3
s_cbranch_scc0 Lh_l2
s_lshl2_add_u32 s36, s2, s27
s_lshl_b32 s36, s36, 12
s_waitcnt lgkmcnt(0)
buffer_load_dwordx4 v[16:19], v8, s[80:83], s36 offen offset:0
buffer_load_dwordx4 v[20:23], v8, s[80:83], s36 offen offset:256
buffer_load_dwordx4 v[24:27], v8, s[80:83], s36 offen offset:512
buffer_load_dwordx4 v[28:31], v8, s[80:83], s36 offen offset:768
s_branch Lh_l1
Lh_l2:
s_cmp_ge_u32 s2, 253
s_cbranch_scc0 Lh_l3
v_lshlrev_b32 v9, 4, v0
v_mov_b32 v12, -1
v_mov_b32 v13, -1
v_mov_b32 v14, -1
v_mov_b32 v15, -1
s_lshl_b32 s37, s2, 13
s_add_u32 s37, s37, 27262976
s_add_u32 s38, s37, 4096
s_waitcnt lgkmcnt(0)
buffer_store_dwordx4 v[12:15], v9, s[16:19], s37 offen sc1
buffer_store_dwordx4 v[12:15], v9, s[16:19], s38 offen sc1
Lh_l3:
s_waitcnt lgkmcnt(0)
s_cmp_eq_u32 s3, 1
s_cbranch_scc0 Lh_l1
s_bfe_u32 s36, s2, 0x20004
s_and_b32 s62, s2, 15
s_mul_i32 s37, s36, 786432
s_lshl_b32 s38, s62, 7
s_add_u32 s37, s37, s38
s_lshl4_add_u32 s62, s36, s62
s_lshl_b32 s36, s36, 8
buffer_load_ushort v96, v4, s[12:15], s36 offen offset:0
buffer_load_ushort v97, v4, s[12:15], s36 offen offset:64
buffer_load_ushort v98, v4, s[12:15], s36 offen offset:128
buffer_load_ushort v99, v4, s[12:15], s36 offen offset:192
buffer_load_dwordx4 v[64:67], v5, s[96:99], s37 offen
s_add_u32 s37, s37, 196608
buffer_load_dwordx4 v[68:71], v5, s[96:99], s37 offen
s_add_u32 s37, s37, 196608
buffer_load_dwordx4 v[72:75], v5, s[96:99], s37 offen
s_add_u32 s37, s37, 196608
buffer_load_dwordx4 v[76:79], v5, s[96:99], s37 offen
Lh_l1:
buffer_load_ushort v251, v11, s[12:15], 0 offen
buffer_load_ushort v252, v11, s[12:15], 0 offen offset:512
s_mov_b32 s22, 0x400000
s_mov_b32 s23, 0x20000
s_mov_b32 s90, 0x100
s_mov_b32 s91, 0x20000
s_bfe_u32 s28, s2, 0x20003
s_lshl2_add_u32 s28, s34, s28
s_lshr_b32 s29, s2, 5
s_mov_b32 s60, 1048576
v_lshlrev_b32 v255, 4, v248
v_lshrrev_b32 v192, 4, v248
v_and_b32 v193, 15, v248
s_lshl_b32 s36, s27, 16
s_lshl_b32 s37, s28, 8
s_add_u32 s36, s36, s37
v_lshlrev_b32 v194, 2, v192
v_xor_b32 v194, v194, v193
v_lshl_add_u32 v194, v194, 4, s36
v_lshl_add_u32 v245, v192, 13, v194
v_add_u32 v246, 31744, v245
s_lshl_b32 s26, s27, 11
s_mov_b32 s25, 0
s_lshl_b32 s36, s28, 19
s_add_u32 s8, s4, s36
s_addc_u32 s9, s5, 0
s_add_u32 s12, s6, s36
s_addc_u32 s13, s7, 0
s_mov_b32 s10, 0x80000
s_mov_b32 s11, 0x20000
s_mov_b32 s14, 0x80000
v_lshlrev_b32 v194, 8, v192
v_add_u32 v194, s26, v194
v_lshlrev_b32 v195, 1, v192
v_xor_b32 v195, v195, v193
v_lshl_add_u32 v228, v195, 4, v194
v_xor_b32 v229, 128, v228
s_and_b32 s36, s27, 1
s_lshl_b32 s36, s36, 3
v_or_b32 v195, s36, v192
v_xor_b32 v195, v195, v193
v_lshl_add_u32 v230, v195, 4, v194
v_xor_b32 v231, 64, v230
v_mov_b32 v196, 0
v_min_u32 v197, 2, v248
v_lshlrev_b32 v197, 2, v197
s_cmp_eq_u32 s3, 1
s_cbranch_scc1 Lh_c2
s_cmp_eq_u32 s3, 2
s_cbranch_scc0 Lh_idle
s_add_u32 m0, s26, 32768
s_and_b32 s25, s25, 0x3fffff
buffer_load_dwordx4 v245, s[20:23], s25 offen lds
buffer_load_dwordx4 v246, s[20:23], s25 offen offset:1024 lds
s_add_u32 s25, s25, 0x40000
s_add_u32 m0, s26, 40960
s_and_b32 s25, s25, 0x3fffff
buffer_load_dwordx4 v245, s[20:23], s25 offen lds
buffer_load_dwordx4 v246, s[20:23], s25 offen offset:1024 lds
s_add_u32 s25, s25, 0x40000
s_lshr_b32 s36, s62, 2
s_lshl_b32 s36, s36, 16
s_and_b32 s37, s62, 3
s_lshl4_add_u32 s37, s37, s27
s_lshl_b32 s37, s37, 6
s_add_u32 s36, s36, s37
v_lshlrev_b32 v10, 12, v192
v_and_b32 v11, 3, v7
v_lshl_add_u32 v10, v11, 8, v10
v_lshl_add_u32 v10, v6, 4, v10
s_waitcnt vmcnt(6)
v_lshlrev_b32 v32, 16, v16
v_and_b32 v33, 0xffff0000, v16
v_lshlrev_b32 v34, 16, v17
v_and_b32 v35, 0xffff0000, v17
v_lshlrev_b32 v36, 16, v18
v_and_b32 v37, 0xffff0000, v18
v_lshlrev_b32 v38, 16, v19
v_and_b32 v39, 0xffff0000, v19
v_lshlrev_b32 v40, 16, v20
v_and_b32 v41, 0xffff0000, v20
v_lshlrev_b32 v42, 16, v21
v_and_b32 v43, 0xffff0000, v21
v_lshlrev_b32 v44, 16, v22
v_and_b32 v45, 0xffff0000, v22
v_lshlrev_b32 v46, 16, v23
v_and_b32 v47, 0xffff0000, v23
v_lshlrev_b32 v48, 16, v24
v_and_b32 v49, 0xffff0000, v24
v_lshlrev_b32 v50, 16, v25
v_and_b32 v51, 0xffff0000, v25
v_lshlrev_b32 v52, 16, v26
v_and_b32 v53, 0xffff0000, v26
v_lshlrev_b32 v54, 16, v27
v_and_b32 v55, 0xffff0000, v27
v_lshlrev_b32 v56, 16, v28
v_and_b32 v57, 0xffff0000, v28
v_lshlrev_b32 v58, 16, v29
v_and_b32 v59, 0xffff0000, v29
v_lshlrev_b32 v60, 16, v30
v_and_b32 v61, 0xffff0000, v30
v_lshlrev_b32 v62, 16, v31
v_and_b32 v63, 0xffff0000, v31
v_pk_add_f32 v[64:65], v[32:33], v[34:35]
v_pk_mul_f32 v[66:67], v[32:33], v[32:33]
v_pk_fma_f32 v[66:67], v[34:35], v[34:35], v[66:67]
v_pk_add_f32 v[64:65], v[64:65], v[36:37]
v_pk_fma_f32 v[66:67], v[36:37], v[36:37], v[66:67]
v_pk_add_f32 v[64:65], v[64:65], v[38:39]
v_pk_fma_f32 v[66:67], v[38:39], v[38:39], v[66:67]
v_pk_add_f32 v[64:65], v[64:65], v[40:41]
v_pk_fma_f32 v[66:67], v[40:41], v[40:41], v[66:67]
v_pk_add_f32 v[64:65], v[64:65], v[42:43]
v_pk_fma_f32 v[66:67], v[42:43], v[42:43], v[66:67]
v_pk_add_f32 v[64:65], v[64:65], v[44:45]
v_pk_fma_f32 v[66:67], v[44:45], v[44:45], v[66:67]
v_pk_add_f32 v[64:65], v[64:65], v[46:47]
v_pk_fma_f32 v[66:67], v[46:47], v[46:47], v[66:67]
v_pk_add_f32 v[64:65], v[64:65], v[48:49]
v_pk_fma_f32 v[66:67], v[48:49], v[48:49], v[66:67]
v_pk_add_f32 v[64:65], v[64:65], v[50:51]
v_pk_fma_f32 v[66:67], v[50:51], v[50:51], v[66:67]
v_pk_add_f32 v[64:65], v[64:65], v[52:53]
v_pk_fma_f32 v[66:67], v[52:53], v[52:53], v[66:67]
v_pk_add_f32 v[64:65], v[64:65], v[54:55]
v_pk_fma_f32 v[66:67], v[54:55], v[54:55], v[66:67]
v_pk_add_f32 v[64:65], v[64:65], v[56:57]
v_pk_fma_f32 v[66:67], v[56:57], v[56:57], v[66:67]
v_pk_add_f32 v[64:65], v[64:65], v[58:59]
v_pk_fma_f32 v[66:67], v[58:59], v[58:59], v[66:67]
v_pk_add_f32 v[64:65], v[64:65], v[60:61]
v_pk_fma_f32 v[66:67], v[60:61], v[60:61], v[66:67]
v_pk_add_f32 v[64:65], v[64:65], v[62:63]
v_pk_fma_f32 v[66:67], v[62:63], v[62:63], v[66:67]
v_add_f32 v64, v64, v65
v_add_f32 v65, v66, v67
s_nop 0
v_add_f32_dpp v64, v64, v64 row_ror:4 row_mask:0xf bank_mask:0xf
v_add_f32_dpp v65, v65, v65 row_ror:4 row_mask:0xf bank_mask:0xf
s_nop 0
v_add_f32_dpp v64, v64, v64 row_ror:8 row_mask:0xf bank_mask:0xf
v_add_f32_dpp v65, v65, v65 row_ror:8 row_mask:0xf bank_mask:0xf
s_nop 0
v_mov_b32 v66, v64
v_mov_b32 v67, v65
s_nop 0
v_permlane16_swap_b32 v64, v66
v_permlane16_swap_b32 v65, v67
v_add_f32 v64, v64, v66
v_add_f32 v65, v65, v67
s_nop 0
v_mov_b32 v66, v64
v_mov_b32 v67, v65
s_nop 0
v_permlane32_swap_b32 v64, v66
v_permlane32_swap_b32 v65, v67
v_add_f32 v64, v64, v66
v_add_f32 v65, v65, v67
v_mul_f32 v64, 0x3b000000, v64
v_mul_f32 v65, 0x3b000000, v65
v_fma_f32 v65, -v64, v64, v65
v_max_f32 v65, 0, v65
v_cvt_pk_bf16_f32 v65, v65, v65
v_lshlrev_b32 v65, 16, v65
v_add_f32 v65, 0x3727c5ac, v65
v_cvt_pk_bf16_f32 v65, v65, v65
v_lshlrev_b32 v65, 16, v65
v_sqrt_f32 v65, v65
v_cvt_pk_bf16_f32 v64, v64, v64
v_lshlrev_b32 v64, 16, v64
v_cvt_pk_bf16_f32 v65, v65, v65
v_lshlrev_b32 v65, 16, v65
v_rcp_f32 v66, v65
s_nop 0
v_mul_f32 v64, v64, v66
v_pk_fma_f32 v[32:33], v[32:33], v[66:67], v[64:65] op_sel_hi:[1,0,0] neg_lo:[0,0,1] neg_hi:[0,0,1]
v_pk_fma_f32 v[34:35], v[34:35], v[66:67], v[64:65] op_sel_hi:[1,0,0] neg_lo:[0,0,1] neg_hi:[0,0,1]
v_pk_fma_f32 v[36:37], v[36:37], v[66:67], v[64:65] op_sel_hi:[1,0,0] neg_lo:[0,0,1] neg_hi:[0,0,1]
v_pk_fma_f32 v[38:39], v[38:39], v[66:67], v[64:65] op_sel_hi:[1,0,0] neg_lo:[0,0,1] neg_hi:[0,0,1]
v_cvt_pk_f16_f32 v16, v32, v33
v_cvt_pk_f16_f32 v17, v34, v35
v_cvt_pk_f16_f32 v18, v36, v37
v_cvt_pk_f16_f32 v19, v38, v39
buffer_store_dwordx4 v[16:19], v10, s[16:19], s36 offen sc1
s_add_u32 s36, s36, 16384
v_pk_fma_f32 v[40:41], v[40:41], v[66:67], v[64:65] op_sel_hi:[1,0,0] neg_lo:[0,0,1] neg_hi:[0,0,1]
v_pk_fma_f32 v[42:43], v[42:43], v[66:67], v[64:65] op_sel_hi:[1,0,0] neg_lo:[0,0,1] neg_hi:[0,0,1]
v_pk_fma_f32 v[44:45], v[44:45], v[66:67], v[64:65] op_sel_hi:[1,0,0] neg_lo:[0,0,1] neg_hi:[0,0,1]
v_pk_fma_f32 v[46:47], v[46:47], v[66:67], v[64:65] op_sel_hi:[1,0,0] neg_lo:[0,0,1] neg_hi:[0,0,1]
v_cvt_pk_f16_f32 v20, v40, v41
v_cvt_pk_f16_f32 v21, v42, v43
v_cvt_pk_f16_f32 v22, v44, v45
v_cvt_pk_f16_f32 v23, v46, v47
buffer_store_dwordx4 v[20:23], v10, s[16:19], s36 offen sc1
s_add_u32 s36, s36, 16384
v_pk_fma_f32 v[48:49], v[48:49], v[66:67], v[64:65] op_sel_hi:[1,0,0] neg_lo:[0,0,1] neg_hi:[0,0,1]
v_pk_fma_f32 v[50:51], v[50:51], v[66:67], v[64:65] op_sel_hi:[1,0,0] neg_lo:[0,0,1] neg_hi:[0,0,1]
v_pk_fma_f32 v[52:53], v[52:53], v[66:67], v[64:65] op_sel_hi:[1,0,0] neg_lo:[0,0,1] neg_hi:[0,0,1]
v_pk_fma_f32 v[54:55], v[54:55], v[66:67], v[64:65] op_sel_hi:[1,0,0] neg_lo:[0,0,1] neg_hi:[0,0,1]
v_cvt_pk_f16_f32 v24, v48, v49
v_cvt_pk_f16_f32 v25, v50, v51
v_cvt_pk_f16_f32 v26, v52, v53
v_cvt_pk_f16_f32 v27, v54, v55
buffer_store_dwordx4 v[24:27], v10, s[16:19], s36 offen sc1
s_add_u32 s36, s36, 16384
v_pk_fma_f32 v[56:57], v[56:57], v[66:67], v[64:65] op_sel_hi:[1,0,0] neg_lo:[0,0,1] neg_hi:[0,0,1]
v_pk_fma_f32 v[58:59], v[58:59], v[66:67], v[64:65] op_sel_hi:[1,0,0] neg_lo:[0,0,1] neg_hi:[0,0,1]
v_pk_fma_f32 v[60:61], v[60:61], v[66:67], v[64:65] op_sel_hi:[1,0,0] neg_lo:[0,0,1] neg_hi:[0,0,1]
v_pk_fma_f32 v[62:63], v[62:63], v[66:67], v[64:65] op_sel_hi:[1,0,0] neg_lo:[0,0,1] neg_hi:[0,0,1]
v_cvt_pk_f16_f32 v28, v56, v57
v_cvt_pk_f16_f32 v29, v58, v59
v_cvt_pk_f16_f32 v30, v60, v61
v_cvt_pk_f16_f32 v31, v62, v63
buffer_store_dwordx4 v[28:31], v10, s[16:19], s36 offen sc1
buffer_load_dword v196, v197, s[88:91], 0 offen sc1
s_branch Lh_c1
Lh_idle:
s_cmp_ge_u32 s2, 253
s_cbranch_scc0 Lh_nj
s_waitcnt vmcnt(2)
s_barrier
s_lshl2_add_u32 s37, s2, 4294966284
v_mov_b32 v9, s37
s_mov_b64 exec, 1
s_cmp_eq_u32 s27, 0
s_cbranch_scc0 Lh_njb
buffer_store_dword v12, v9, s[88:91], 0 offen sc1
Lh_njb:
s_mov_b64 exec, -1
Lh_nj:
s_and_b32 s36, s29, 1
v_lshrrev_b32 v9, 1, v0
v_lshl_add_u32 v9, v9, 1, s36
v_lshlrev_b32 v9, 13, v9
v_and_b32 v10, 1, v0
v_lshl_add_u32 v9, v10, 7, v9
s_lshl_b32 s37, s28, 8
s_add_u32 s38, s37, 2097152
v_lshlrev_b32 v10, 7, v0
v_lshl_add_u32 v10, s36, 15, v10
s_waitcnt vmcnt(0)
s_add_u32 s37, s37, 524288
buffer_load_dword v215, v9, s[20:23], s37 offen
s_branch Lh_c1b
Lh_c2:
s_waitcnt vmcnt(6)
v_lshlrev_b32 v96, 16, v96
v_lshlrev_b32 v97, 16, v97
v_lshlrev_b32 v98, 16, v98
v_lshlrev_b32 v99, 16, v99
v_mul_f32 v104, 0xbfb8aa3b, v96
v_mul_f32 v105, 0xbfb8aa3b, v97
v_mul_f32 v106, 0xbfb8aa3b, v98
v_mul_f32 v107, 0xbfb8aa3b, v99
v_exp_f32 v104, v104
v_exp_f32 v105, v105
v_exp_f32 v106, v106
v_exp_f32 v107, v107
v_add_f32 v104, 1.0, v104
v_add_f32 v105, 1.0, v105
v_add_f32 v106, 1.0, v106
v_add_f32 v107, 1.0, v107
v_rcp_f32 v104, v104
v_rcp_f32 v105, v105
v_rcp_f32 v106, v106
v_rcp_f32 v107, v107
v_mul_f32 v96, v96, v104
v_mul_f32 v97, v97, v105
v_mul_f32 v98, v98, v106
v_mul_f32 v99, v99, v107
v_cvt_pk_bf16_f32 v96, v96, v96
v_lshlrev_b32 v96, 16, v96
v_cvt_pk_bf16_f32 v97, v97, v97
v_lshlrev_b32 v97, 16, v97
v_cvt_pk_bf16_f32 v98, v98, v98
v_lshlrev_b32 v98, 16, v98
v_cvt_pk_bf16_f32 v99, v99, v99
v_lshlrev_b32 v99, 16, v99
s_lshl_b32 s36, s27, 8
v_lshl_add_u32 v44, v2, 5, s36
v_lshl_add_u32 v44, v192, 3, v44
v_lshlrev_b32 v45, 2, v248
s_waitcnt vmcnt(5)
v_lshlrev_b32 v104, 16, v64
v_and_b32 v105, 0xffff0000, v64
v_lshlrev_b32 v106, 16, v65
v_and_b32 v107, 0xffff0000, v65
v_lshlrev_b32 v108, 16, v66
v_and_b32 v109, 0xffff0000, v66
v_lshlrev_b32 v110, 16, v67
v_and_b32 v111, 0xffff0000, v67
v_pk_mul_f32 v[48:49], v[104:105], v[96:97] op_sel_hi:[1,0]
v_pk_mul_f32 v[50:51], v[106:107], v[96:97] op_sel_hi:[1,0]
v_pk_mul_f32 v[52:53], v[108:109], v[96:97] op_sel_hi:[1,0]
v_pk_mul_f32 v[54:55], v[110:111], v[96:97] op_sel_hi:[1,0]
s_waitcnt vmcnt(4)
v_lshlrev_b32 v112, 16, v68
v_and_b32 v113, 0xffff0000, v68
v_lshlrev_b32 v114, 16, v69
v_and_b32 v115, 0xffff0000, v69
v_lshlrev_b32 v116, 16, v70
v_and_b32 v117, 0xffff0000, v70
v_lshlrev_b32 v118, 16, v71
v_and_b32 v119, 0xffff0000, v71
v_pk_fma_f32 v[48:49], v[112:113], v[96:97], v[48:49] op_sel:[0,1,0]
v_pk_fma_f32 v[50:51], v[114:115], v[96:97], v[50:51] op_sel:[0,1,0]
v_pk_fma_f32 v[52:53], v[116:117], v[96:97], v[52:53] op_sel:[0,1,0]
v_pk_fma_f32 v[54:55], v[118:119], v[96:97], v[54:55] op_sel:[0,1,0]
s_waitcnt vmcnt(3)
v_lshlrev_b32 v104, 16, v72
v_and_b32 v105, 0xffff0000, v72
v_lshlrev_b32 v106, 16, v73
v_and_b32 v107, 0xffff0000, v73
v_lshlrev_b32 v108, 16, v74
v_and_b32 v109, 0xffff0000, v74
v_lshlrev_b32 v110, 16, v75
v_and_b32 v111, 0xffff0000, v75
v_pk_fma_f32 v[48:49], v[104:105], v[98:99], v[48:49] op_sel_hi:[1,0,1]
v_pk_fma_f32 v[50:51], v[106:107], v[98:99], v[50:51] op_sel_hi:[1,0,1]
v_pk_fma_f32 v[52:53], v[108:109], v[98:99], v[52:53] op_sel_hi:[1,0,1]
v_pk_fma_f32 v[54:55], v[110:111], v[98:99], v[54:55] op_sel_hi:[1,0,1]
s_waitcnt vmcnt(2)
buffer_load_dword v196, v197, s[88:91], 0 offen sc1
s_cmp_eq_u32 s27, 0
s_cbranch_scc1 Lh_nc
s_add_u32 m0, s26, 32768
s_and_b32 s25, s25, 0x3fffff
buffer_load_dwordx4 v245, s[20:23], s25 offen lds
buffer_load_dwordx4 v246, s[20:23], s25 offen offset:1024 lds
s_add_u32 s25, s25, 0x40000
s_add_u32 m0, s26, 40960
s_and_b32 s25, s25, 0x3fffff
buffer_load_dwordx4 v245, s[20:23], s25 offen lds
buffer_load_dwordx4 v246, s[20:23], s25 offen offset:1024 lds
s_add_u32 s25, s25, 0x40000
Lh_nc:
v_lshlrev_b32 v112, 16, v76
v_and_b32 v113, 0xffff0000, v76
v_lshlrev_b32 v114, 16, v77
v_and_b32 v115, 0xffff0000, v77
v_lshlrev_b32 v116, 16, v78
v_and_b32 v117, 0xffff0000, v78
v_lshlrev_b32 v118, 16, v79
v_and_b32 v119, 0xffff0000, v79
v_pk_fma_f32 v[48:49], v[112:113], v[98:99], v[48:49] op_sel:[0,1,0]
v_pk_fma_f32 v[50:51], v[114:115], v[98:99], v[50:51] op_sel:[0,1,0]
v_pk_fma_f32 v[52:53], v[116:117], v[98:99], v[52:53] op_sel:[0,1,0]
v_pk_fma_f32 v[54:55], v[118:119], v[98:99], v[54:55] op_sel:[0,1,0]
s_nop 1
v_permlane32_swap_b32 v48, v52
v_permlane32_swap_b32 v49, v53
v_permlane32_swap_b32 v50, v54
v_permlane32_swap_b32 v51, v55
v_add_f32 v48, v48, v52
v_add_f32 v49, v49, v53
v_add_f32 v50, v50, v54
v_add_f32 v51, v51, v55
s_nop 1
v_permlane16_swap_b32 v48, v50
v_permlane16_swap_b32 v49, v51
v_add_f32 v48, v48, v50
v_add_f32 v49, v49, v51
s_nop 0
v_add_f32_dpp v48, v48, v48 row_ror:8 row_mask:0xf bank_mask:0xf
v_add_f32_dpp v49, v49, v49 row_ror:8 row_mask:0xf bank_mask:0xf
ds_write_b64 v44, v[48:49] offset:8192
s_lshl_b32 s39, s62, 8
s_add_u32 s39, s39, 29343744
s_waitcnt lgkmcnt(0)
s_barrier
s_cmp_eq_u32 s27, 0
s_cbranch_scc0 Lh_c1
ds_read_b32 v48, v45 offset:8192
ds_read_b32 v49, v45 offset:8448
ds_read_b32 v50, v45 offset:8704
ds_read_b32 v51, v45 offset:8960
s_waitcnt vmcnt(0)
v_cmp_eq_u32 vcc, 0, v196
s_cbranch_vccz Lh_j1ok
Lh_j1:
buffer_load_dword v196, v197, s[88:91], 0 offen sc1
s_sub_u32 s60, s60, 1
s_cbranch_scc1 La_end
s_waitcnt vmcnt(0) lgkmcnt(0)
v_cmp_eq_u32 vcc, 0, v196
s_cbranch_vccnz Lh_j1
Lh_j1ok:
s_waitcnt lgkmcnt(0)
v_add_f32 v48, v48, v49
v_add_f32 v50, v50, v51
v_add_f32 v48, v48, v50
v_min_u32 v48, -2, v48
buffer_store_dword v48, v45, s[16:19], s39 offen sc1
Lh_c1b:
s_add_u32 m0, s26, 32768
s_and_b32 s25, s25, 0x3fffff
buffer_load_dwordx4 v245, s[20:23], s25 offen lds
buffer_load_dwordx4 v246, s[20:23], s25 offen offset:1024 lds
s_add_u32 s25, s25, 0x40000
s_add_u32 m0, s26, 40960
s_and_b32 s25, s25, 0x3fffff
buffer_load_dwordx4 v245, s[20:23], s25 offen lds
buffer_load_dwordx4 v246, s[20:23], s25 offen offset:1024 lds
s_add_u32 s25, s25, 0x40000
Lh_c1:
s_lshl2_add_u32 s30, s29, s27
s_lshl_b32 s33, s30, 19
s_lshl_b32 s24, s30, 8
s_add_u32 s24, s24, 29335552
s_lshl_b32 s30, s30, 16
v_add_u32 v247, s30, v255
s_mov_b32 s30, 0
s_lshl_b32 s36, s28, 14
s_add_u32 s33, s33, s36
s_add_u32 s33, s33, 8388608
v_lshrrev_b32 v194, 3, v193
v_lshlrev_b32 v194, 12, v194
v_and_b32 v195, 7, v193
v_lshl_add_u32 v194, v195, 8, v194
v_add_u32 v194, 2048, v194
v_xor_b32 v195, v192, v193
v_lshl_add_u32 v216, v195, 4, v194
v_xor_b32 v217, 64, v216
v_xor_b32 v218, 128, v216
v_xor_b32 v219, 192, v216
v_lshrrev_b32 v194, 1, v193
v_lshrrev_b32 v195, 5, v248
v_cmp_eq_u32 vcc, v194, v195
v_mov_b32 v194, 0x3f803f80
v_lshlrev_b32 v244, 5, v192
v_bfe_u32 v195, v248, 2, 2
v_cndmask_b32 v232, 0, v194, vcc
v_mov_b32 v233, v232
v_mov_b32 v234, v232
v_mov_b32 v235, v232
v_lshl_add_u32 v194, v192, 3, v195
v_lshlrev_b32 v194, 8, v194
v_lshl_add_u32 v194, v195, 6, v194
v_lshl_add_u32 v194, v6, 4, v194
v_add_u32 v240, 32768, v194
v_xor_b32 v241, 64, v240
v_xor_b32 v242, 128, v240
v_xor_b32 v243, 192, v240
v_lshrrev_b32 v194, 3, v7
v_lshlrev_b32 v194, 12, v194
v_lshl_add_u32 v194, v6, 3, v194
v_and_b32 v195, 7, v7
v_lshl_add_u32 v194, v195, 8, v194
v_lshl_add_u32 v220, v195, 5, v194
v_xor_b32 v221, 32, v220
v_xor_b32 v222, 64, v220
v_xor_b32 v223, 96, v220
v_xor_b32 v224, 128, v220
v_xor_b32 v225, 160, v220
v_xor_b32 v226, 192, v220
v_xor_b32 v227, 224, v220
v_mov_b32 v236, 0xff800000
v_mov_b32 v237, 0xff800000
v_mov_b32 v238, 0xff800000
v_mov_b32 v239, 0xff800000
s_mov_b32 s32, 0
s_mov_b32 s86, 0x200000
s_mov_b32 s87, 0x20000
s_mov_b32 s100, s28
s_mov_b32 s101, s29
s_mov_b32 s37, s34
s_add_u32 s36, s37, 1
s_and_b32 s36, s36, 7
s_lshl2_add_u32 s36, s36, s27
s_lshl_b32 s40, s36, 14
s_add_u32 s36, s37, 2
s_and_b32 s36, s36, 7
s_lshl2_add_u32 s36, s36, s27
s_lshl_b32 s41, s36, 14
s_add_u32 s36, s37, 3
s_and_b32 s36, s36, 7
s_lshl2_add_u32 s36, s36, s27
s_lshl_b32 s42, s36, 14
s_add_u32 s36, s37, 4
s_and_b32 s36, s36, 7
s_lshl2_add_u32 s36, s36, s27
s_lshl_b32 s43, s36, 14
s_add_u32 s36, s37, 5
s_and_b32 s36, s36, 7
s_lshl2_add_u32 s36, s36, s27
s_lshl_b32 s44, s36, 14
s_add_u32 s36, s37, 6
s_and_b32 s36, s36, 7
s_lshl2_add_u32 s36, s36, s27
s_lshl_b32 s45, s36, 14
s_add_u32 s36, s37, 7
s_and_b32 s36, s36, 7
s_lshl2_add_u32 s36, s36, s27
s_lshl_b32 s46, s36, 14
s_add_u32 s36, s37, 8
s_and_b32 s36, s36, 7
s_lshl2_add_u32 s36, s36, s27
s_lshl_b32 s47, s36, 14
s_lshl_b32 s36, s101, 19
s_add_u32 s36, s36, 2097152
v_add_u32 v249, s36, v255
s_lshl_b32 s36, s100, 19
s_add_u32 s36, s36, 8388608
v_add_u32 v250, s36, v255
s_cmp_lt_u32 s35, 8
s_cselect_b64 s[4:5], s[56:57], s[92:93]
s_cmp_lt_u32 s35, 16
s_cselect_b64 s[4:5], s[4:5], s[48:49]
s_mov_b32 s6, 0x158000
s_mov_b32 s7, 0x20000
s_lshl2_add_u32 s36, s35, s27
s_and_b32 s37, s36, 31
v_lshl_add_u32 v253, s37, 4, v7
v_mul_u32_u24 v253, 2752, v253
v_lshlrev_b32 v254, 7, v6
v_min_u32 v254, 348, v254
s_mul_i32 s37, s34, 352
v_add3_u32 v253, v253, v254, s37
s_sub_u32 s37, s36, 64
s_lshl_b32 s37, s37, 16
s_lshl_b32 s38, s34, 7
s_add_u32 s37, s37, s38
v_lshl_add_u32 v254, v248, 10, s37
s_cmp_lt_u32 s35, 16
s_cselect_b64 vcc, 0, -1
v_cndmask_b32 v253, v253, v254, vcc
v_and_b32 v254, 3, v7
v_lshl_add_u32 v254, s36, 2, v254
v_mul_u32_u24 v254, 6144, v254
s_lshl_b32 s38, s34, 9
v_lshl_add_u32 v254, v6, 7, v254
v_add_u32 v254, s38, v254
s_mul_i32 s63, s34, 22
s_add_u32 s63, s63, s35
s_cmp_lt_u32 s63, 172
s_cselect_b32 s61, 1, 0
s_lshl3_add_u32 s36, s34, s35
s_sub_u32 s36, s36, 22
s_cmp_ge_u32 s35, 22
s_cselect_b32 s61, 2, s61
s_cselect_b32 s63, s36, s63
s_cselect_b64 s[56:57], s[48:49], s[56:57]
s_cselect_b64 s[92:93], s[48:49], s[92:93]
s_cmp_ge_u32 s35, 30
s_cselect_b32 s61, 0, s61
s_cmp_eq_u32 s61, 0
s_cselect_b32 s58, 0, 1409024
s_mov_b32 s94, s58
s_mov_b32 s59, 0x20000
s_mov_b32 s95, 0x20000
s_lshl_b32 s50, s27, 10
s_mov_b32 s37, 0
s_sub_u32 s37, s50, s37
v_add_u32 v200, s37, v255
v_and_b32 v200, 0x7ff, v200
s_cmp_lt_u32 s27, 2
s_cselect_b32 s38, 4096, 0
s_cselect_b32 s52, 0, 1.0
v_add_u32 v200, s38, v200
s_add_u32 s50, s50, 29343744
v_add_u32 v201, 8192, v255
s_add_u32 s51, s50, 4096
v_lshlrev_b32 v198, 6, v6
s_lshl_b32 s36, s62, 6
s_add_u32 s36, s36, 29335552
s_waitcnt vmcnt(0)
v_cmp_eq_u32 vcc, 0, v196
s_cbranch_vccz Lh_j0ok
Lh_j0:
buffer_load_dword v196, v197, s[88:91], 0 offen sc1
s_sub_u32 s60, s60, 1
s_cbranch_scc1 La_end
s_waitcnt vmcnt(0) lgkmcnt(0)
v_cmp_eq_u32 vcc, 0, v196
s_cbranch_vccnz Lh_j0
Lh_j0ok:
s_cmp_eq_u32 s3, 2
s_cbranch_scc0 Lh_c0
s_barrier
s_mov_b64 exec, 1
s_cmp_eq_u32 s27, 0
s_cbranch_scc0 Lh_c2b
buffer_store_dword v197, v197, s[16:19], s36 offen sc1
Lh_c2b:
s_mov_b64 exec, -1
s_branch Lh_c0
.p2align 12
Lh_c0:
s_add_u32 m0, s26, 49152
s_and_b32 s25, s25, 0x3fffff
buffer_load_dwordx4 v245, s[20:23], s25 offen lds
buffer_load_dwordx4 v246, s[20:23], s25 offen offset:1024 lds
s_add_u32 s25, s25, 0x40000
s_add_u32 m0, s26, 57344
s_and_b32 s25, s25, 0x3fffff
buffer_load_dwordx4 v245, s[20:23], s25 offen lds
buffer_load_dwordx4 v246, s[20:23], s25 offen offset:1024 lds
s_add_u32 s25, s25, 0x40000
s_add_u32 m0, s26, 65536
s_and_b32 s25, s25, 0x3fffff
buffer_load_dwordx4 v245, s[20:23], s25 offen lds
buffer_load_dwordx4 v246, s[20:23], s25 offen offset:1024 lds
s_add_u32 s25, s25, 0x40000
s_add_u32 m0, s26, 73728
s_and_b32 s25, s25, 0x3fffff
buffer_load_dwordx4 v245, s[20:23], s25 offen lds
buffer_load_dwordx4 v246, s[20:23], s25 offen offset:1024 lds
s_add_u32 s25, s25, 0x40000
v_lshlrev_b32 v251, 16, v251
v_lshlrev_b32 v252, 16, v252
v_mul_f32 v202, 0xbfb8aa3b, v251
v_mul_f32 v203, 0xbfb8aa3b, v252
v_exp_f32 v202, v202
v_exp_f32 v203, v203
v_add_f32 v202, 1.0, v202
v_add_f32 v203, 1.0, v203
v_rcp_f32 v202, v202
v_rcp_f32 v203, v203
v_mul_f32 v251, v251, v202
v_mul_f32 v252, v252, v203
v_cvt_pk_bf16_f32 v251, v251, v251
v_lshlrev_b32 v251, 16, v251
v_cvt_pk_bf16_f32 v252, v252, v252
v_lshlrev_b32 v252, 16, v252
buffer_load_dwordx4 v[64:67], v255, s[16:19], s50 offen sc1
buffer_load_dwordx4 v[68:71], v255, s[16:19], s51 offen sc1
buffer_load_dwordx4 v[72:75], v201, s[16:19], s50 offen sc1
buffer_load_dwordx4 v[76:79], v201, s[16:19], s51 offen sc1
s_mov_b64 exec, 0
s_cmp_eq_u32 s27, 0
s_cbranch_scc1 Lpad1
s_cmp_eq_u32 s27, 1
s_cbranch_scc1 Lpad2
s_cmp_eq_u32 s27, 2
s_cbranch_scc1 Lpad3
s_branch Lpad4
Lwalk0:
s_mov_b64 exec, -1
s_branch Lh_mod1
Lh_mod:
buffer_load_dwordx4 v[64:67], v255, s[16:19], s50 offen sc1
buffer_load_dwordx4 v[68:71], v255, s[16:19], s51 offen sc1
buffer_load_dwordx4 v[72:75], v201, s[16:19], s50 offen sc1
buffer_load_dwordx4 v[76:79], v201, s[16:19], s51 offen sc1
s_sub_u32 s60, s60, 1
s_cbranch_scc1 La_end
Lh_mod1:
s_waitcnt vmcnt(0)
v_max_u32 v196, v64, v65
v_max3_u32 v196, v196, v66, v67
v_max3_u32 v196, v196, v68, v69
v_max3_u32 v196, v196, v70, v71
v_max3_u32 v196, v196, v72, v73
v_max3_u32 v196, v196, v74, v75
v_max3_u32 v196, v196, v76, v77
v_max3_u32 v196, v196, v78, v79
v_cmp_eq_u32 vcc, -1, v196
s_cbranch_vccnz Lh_mod
buffer_load_dword v196, v198, s[16:19], s24 offen sc1
v_pk_add_f32 v[64:65], v[64:65], v[68:69]
v_pk_add_f32 v[72:73], v[72:73], v[76:77]
v_pk_add_f32 v[66:67], v[66:67], v[70:71]
v_pk_add_f32 v[74:75], v[74:75], v[78:79]
v_pk_add_f32 v[64:65], v[64:65], v[72:73]
v_pk_add_f32 v[66:67], v[66:67], v[74:75]
v_cvt_pk_bf16_f32 v68, v64, v65
v_cvt_pk_bf16_f32 v69, v66, v67
v_lshlrev_b32 v64, 16, v68
v_and_b32 v65, 0xffff0000, v68
v_lshlrev_b32 v66, 16, v69
v_and_b32 v67, 0xffff0000, v69
v_add_f32 v64, s52, v64
v_add_f32 v65, s52, v65
v_add_f32 v66, s52, v66
v_add_f32 v67, s52, v67
v_cvt_pk_bf16_f32 v68, v64, v65
v_cvt_pk_bf16_f32 v69, v66, v67
v_lshlrev_b32 v64, 16, v68
v_and_b32 v65, 0xffff0000, v68
v_lshlrev_b32 v66, 16, v69
v_and_b32 v67, 0xffff0000, v69
v_mul_f32 v64, 0x3e0293ee, v64
v_mul_f32 v65, 0x3e0293ee, v65
v_mul_f32 v66, 0x3e0293ee, v66
v_mul_f32 v67, 0x3e0293ee, v67
ds_write_b128 v200, v[64:67]
s_waitcnt lgkmcnt(0)
s_barrier
ds_read_b128 v[144:147], v244 offset:0
ds_read_b128 v[148:151], v244 offset:16
ds_read_b128 v[152:155], v244 offset:4096
ds_read_b128 v[156:159], v244 offset:4112
ds_read_b64_tr_b16 a[192:193], v240 offset:0
ds_read_b64_tr_b16 a[194:195], v240 offset:1024
ds_read_b64_tr_b16 a[196:197], v240 offset:8
ds_read_b64_tr_b16 a[198:199], v240 offset:1032
ds_read_b64_tr_b16 a[200:201], v241 offset:0
ds_read_b64_tr_b16 a[202:203], v241 offset:1024
ds_read_b64_tr_b16 a[204:205], v241 offset:8
ds_read_b64_tr_b16 a[206:207], v241 offset:1032
ds_read_b64_tr_b16 a[208:209], v242 offset:0
ds_read_b64_tr_b16 a[210:211], v242 offset:1024
ds_read_b64_tr_b16 a[212:213], v242 offset:8
ds_read_b64_tr_b16 a[214:215], v242 offset:1032
ds_read_b64_tr_b16 a[216:217], v243 offset:0
ds_read_b64_tr_b16 a[218:219], v243 offset:1024
ds_read_b64_tr_b16 a[220:221], v243 offset:8
ds_read_b64_tr_b16 a[222:223], v243 offset:1032
ds_read_b128 v[160:163], v244 offset:128
ds_read_b128 v[164:167], v244 offset:144
ds_read_b128 v[168:171], v244 offset:4224
ds_read_b128 v[172:175], v244 offset:4240
s_waitcnt vmcnt(0)
v_cmp_ne_u32 vcc, 0, v196
s_cbranch_vccz Lh_xfok
Lh_xf:
buffer_load_dword v196, v198, s[16:19], s24 offen sc1
s_sub_u32 s60, s60, 1
s_cbranch_scc1 La_end
s_waitcnt vmcnt(0)
v_cmp_ne_u32 vcc, 0, v196
s_cbranch_vccnz Lh_xf
Lh_xfok:
buffer_load_dwordx4 v[0:3], v247, s[16:19], s30 offen offset:0 sc1
buffer_load_dwordx4 v[4:7], v247, s[16:19], s30 offen offset:1024 sc1
buffer_load_dwordx4 v[8:11], v247, s[16:19], s30 offen offset:2048 sc1
buffer_load_dwordx4 v[12:15], v247, s[16:19], s30 offen offset:3072 sc1
s_add_u32 s30, s30, 4096
s_and_b32 s30, s30, 0xffff
buffer_load_dwordx4 v[16:19], v247, s[16:19], s30 offen offset:0 sc1
buffer_load_dwordx4 v[20:23], v247, s[16:19], s30 offen offset:1024 sc1
buffer_load_dwordx4 v[24:27], v247, s[16:19], s30 offen offset:2048 sc1
buffer_load_dwordx4 v[28:31], v247, s[16:19], s30 offen offset:3072 sc1
s_add_u32 s30, s30, 4096
s_and_b32 s30, s30, 0xffff
buffer_load_dwordx4 v[32:35], v247, s[16:19], s30 offen offset:0 sc1
buffer_load_dwordx4 v[36:39], v247, s[16:19], s30 offen offset:1024 sc1
buffer_load_dwordx4 v[40:43], v247, s[16:19], s30 offen offset:2048 sc1
buffer_load_dwordx4 v[44:47], v247, s[16:19], s30 offen offset:3072 sc1
s_add_u32 s30, s30, 4096
s_and_b32 s30, s30, 0xffff
buffer_load_dwordx4 v[48:51], v247, s[16:19], s30 offen offset:0 sc1
buffer_load_dwordx4 v[52:55], v247, s[16:19], s30 offen offset:1024 sc1
buffer_load_dwordx4 v[56:59], v247, s[16:19], s30 offen offset:2048 sc1
buffer_load_dwordx4 v[60:63], v247, s[16:19], s30 offen offset:3072 sc1
s_add_u32 s30, s30, 4096
s_and_b32 s30, s30, 0xffff
v_mov_b32 v202, -1
v_mov_b32 v203, -1
v_lshrrev_b32 v204, 1, v255
s_waitcnt vmcnt(15) lgkmcnt(0)
v_fma_mix_f32 v192, v0, v144, v152 op_sel_hi:[1,0,0]
v_fma_mix_f32 v193, v0, v145, v153 op_sel:[1,0,0] op_sel_hi:[1,0,0]
v_cvt_pk_bf16_f32 v128, v192, v193
v_fma_mix_f32 v194, v1, v146, v154 op_sel_hi:[1,0,0]
v_fma_mix_f32 v195, v1, v147, v155 op_sel:[1,0,0] op_sel_hi:[1,0,0]
v_cvt_pk_bf16_f32 v129, v194, v195
v_fma_mix_f32 v196, v2, v148, v156 op_sel_hi:[1,0,0]
v_fma_mix_f32 v197, v2, v149, v157 op_sel:[1,0,0] op_sel_hi:[1,0,0]
v_cvt_pk_bf16_f32 v130, v196, v197
v_fma_mix_f32 v198, v3, v150, v158 op_sel_hi:[1,0,0]
v_fma_mix_f32 v199, v3, v151, v159 op_sel:[1,0,0] op_sel_hi:[1,0,0]
v_cvt_pk_bf16_f32 v131, v198, v199
s_waitcnt vmcnt(14) lgkmcnt(0)
v_fma_mix_f32 v192, v4, v144, v152 op_sel_hi:[1,0,0]
v_fma_mix_f32 v193, v4, v145, v153 op_sel:[1,0,0] op_sel_hi:[1,0,0]
v_cvt_pk_bf16_f32 v132, v192, v193
v_fma_mix_f32 v194, v5, v146, v154 op_sel_hi:[1,0,0]
v_fma_mix_f32 v195, v5, v147, v155 op_sel:[1,0,0] op_sel_hi:[1,0,0]
v_cvt_pk_bf16_f32 v133, v194, v195
v_fma_mix_f32 v196, v6, v148, v156 op_sel_hi:[1,0,0]
v_fma_mix_f32 v197, v6, v149, v157 op_sel:[1,0,0] op_sel_hi:[1,0,0]
v_cvt_pk_bf16_f32 v134, v196, v197
v_fma_mix_f32 v198, v7, v150, v158 op_sel_hi:[1,0,0]
v_fma_mix_f32 v199, v7, v151, v159 op_sel:[1,0,0] op_sel_hi:[1,0,0]
v_cvt_pk_bf16_f32 v135, v198, v199
s_waitcnt vmcnt(13) lgkmcnt(0)
v_fma_mix_f32 v192, v8, v144, v152 op_sel_hi:[1,0,0]
v_fma_mix_f32 v193, v8, v145, v153 op_sel:[1,0,0] op_sel_hi:[1,0,0]
v_cvt_pk_bf16_f32 v136, v192, v193
v_fma_mix_f32 v194, v9, v146, v154 op_sel_hi:[1,0,0]
v_fma_mix_f32 v195, v9, v147, v155 op_sel:[1,0,0] op_sel_hi:[1,0,0]
v_cvt_pk_bf16_f32 v137, v194, v195
v_fma_mix_f32 v196, v10, v148, v156 op_sel_hi:[1,0,0]
v_fma_mix_f32 v197, v10, v149, v157 op_sel:[1,0,0] op_sel_hi:[1,0,0]
v_cvt_pk_bf16_f32 v138, v196, v197
v_fma_mix_f32 v198, v11, v150, v158 op_sel_hi:[1,0,0]
v_fma_mix_f32 v199, v11, v151, v159 op_sel:[1,0,0] op_sel_hi:[1,0,0]
v_cvt_pk_bf16_f32 v139, v198, v199
s_waitcnt vmcnt(12) lgkmcnt(0)
v_fma_mix_f32 v192, v12, v144, v152 op_sel_hi:[1,0,0]
v_fma_mix_f32 v193, v12, v145, v153 op_sel:[1,0,0] op_sel_hi:[1,0,0]
v_cvt_pk_bf16_f32 v140, v192, v193
v_fma_mix_f32 v194, v13, v146, v154 op_sel_hi:[1,0,0]
v_fma_mix_f32 v195, v13, v147, v155 op_sel:[1,0,0] op_sel_hi:[1,0,0]
v_cvt_pk_bf16_f32 v141, v194, v195
v_fma_mix_f32 v196, v14, v148, v156 op_sel_hi:[1,0,0]
v_fma_mix_f32 v197, v14, v149, v157 op_sel:[1,0,0] op_sel_hi:[1,0,0]
v_cvt_pk_bf16_f32 v142, v196, v197
v_fma_mix_f32 v198, v15, v150, v158 op_sel_hi:[1,0,0]
v_fma_mix_f32 v199, v15, v151, v159 op_sel:[1,0,0] op_sel_hi:[1,0,0]
v_cvt_pk_bf16_f32 v143, v198, v199
s_waitcnt vmcnt(8) lgkmcnt(0)
v_mfma_f32_16x16x32_bf16 a[0:3], a[192:195], v[128:131], 0
ds_read_b64_tr_b16 a[224:225], v240 offset:8192
v_fma_mix_f32 v192, v16, v160, v168 op_sel_hi:[1,0,0]
v_mfma_f32_16x16x32_bf16 a[32:35], a[192:195], v[132:135], 0
ds_read_b64_tr_b16 a[226:227], v240 offset:9216
v_fma_mix_f32 v193, v16, v161, v169 op_sel:[1,0,0] op_sel_hi:[1,0,0]
v_mfma_f32_16x16x32_bf16 v[64:67], a[192:195], v[136:139], 0
ds_read_b64_tr_b16 a[228:229], v240 offset:8200
v_cvt_pk_bf16_f32 v176, v192, v193
v_mfma_f32_16x16x32_bf16 v[96:99], a[192:195], v[140:143], 0
ds_read_b64_tr_b16 a[230:231], v240 offset:9224
v_fma_mix_f32 v194, v17, v162, v170 op_sel_hi:[1,0,0]
v_mfma_f32_16x16x32_bf16 a[4:7], a[196:199], v[128:131], 0
ds_read_b64_tr_b16 a[232:233], v241 offset:8192
v_fma_mix_f32 v195, v17, v163, v171 op_sel:[1,0,0] op_sel_hi:[1,0,0]
v_mfma_f32_16x16x32_bf16 a[36:39], a[196:199], v[132:135], 0
ds_read_b64_tr_b16 a[234:235], v241 offset:9216
v_cvt_pk_bf16_f32 v177, v194, v195
v_mfma_f32_16x16x32_bf16 v[68:71], a[196:199], v[136:139], 0
ds_read_b64_tr_b16 a[236:237], v241 offset:8200
v_fma_mix_f32 v196, v18, v164, v172 op_sel_hi:[1,0,0]
v_mfma_f32_16x16x32_bf16 v[100:103], a[196:199], v[140:143], 0
ds_read_b64_tr_b16 a[238:239], v241 offset:9224
v_fma_mix_f32 v197, v18, v165, v173 op_sel:[1,0,0] op_sel_hi:[1,0,0]
v_mfma_f32_16x16x32_bf16 a[8:11], a[200:203], v[128:131], 0
ds_read_b64_tr_b16 a[240:241], v242 offset:8192
v_cvt_pk_bf16_f32 v178, v196, v197
v_mfma_f32_16x16x32_bf16 a[40:43], a[200:203], v[132:135], 0
ds_read_b64_tr_b16 a[242:243], v242 offset:9216
v_fma_mix_f32 v198, v19, v166, v174 op_sel_hi:[1,0,0]
v_mfma_f32_16x16x32_bf16 v[72:75], a[200:203], v[136:139], 0
ds_read_b64_tr_b16 a[244:245], v242 offset:8200
v_fma_mix_f32 v199, v19, v167, v175 op_sel:[1,0,0] op_sel_hi:[1,0,0]
v_mfma_f32_16x16x32_bf16 v[104:107], a[200:203], v[140:143], 0
ds_read_b64_tr_b16 a[246:247], v242 offset:9224
v_cvt_pk_bf16_f32 v179, v198, v199
v_mfma_f32_16x16x32_bf16 a[12:15], a[204:207], v[128:131], 0
ds_read_b64_tr_b16 a[248:249], v243 offset:8192
v_fma_mix_f32 v192, v20, v160, v168 op_sel_hi:[1,0,0]
v_mfma_f32_16x16x32_bf16 a[44:47], a[204:207], v[132:135], 0
ds_read_b64_tr_b16 a[250:251], v243 offset:9216
v_fma_mix_f32 v193, v20, v161, v169 op_sel:[1,0,0] op_sel_hi:[1,0,0]
v_mfma_f32_16x16x32_bf16 v[76:79], a[204:207], v[136:139], 0
ds_read_b64_tr_b16 a[252:253], v243 offset:8200
v_cvt_pk_bf16_f32 v180, v192, v193
v_mfma_f32_16x16x32_bf16 v[108:111], a[204:207], v[140:143], 0
ds_read_b64_tr_b16 a[254:255], v243 offset:9224
v_fma_mix_f32 v194, v21, v162, v170 op_sel_hi:[1,0,0]
v_mfma_f32_16x16x32_bf16 a[16:19], a[208:211], v[128:131], 0
ds_read_b128 v[144:147], v244 offset:256
v_fma_mix_f32 v195, v21, v163, v171 op_sel:[1,0,0] op_sel_hi:[1,0,0]
v_mfma_f32_16x16x32_bf16 a[48:51], a[208:211], v[132:135], 0
ds_read_b128 v[148:151], v244 offset:272
buffer_load_dwordx4 v[0:3], v247, s[16:19], s30 offen offset:0 sc1
v_cvt_pk_bf16_f32 v181, v194, v195
v_mfma_f32_16x16x32_bf16 v[80:83], a[208:211], v[136:139], 0
ds_read_b128 v[152:155], v244 offset:4352
v_fma_mix_f32 v196, v22, v164, v172 op_sel_hi:[1,0,0]
v_mfma_f32_16x16x32_bf16 v[112:115], a[208:211], v[140:143], 0
ds_read_b128 v[156:159], v244 offset:4368
buffer_load_dwordx4 v[4:7], v247, s[16:19], s30 offen offset:1024 sc1
v_fma_mix_f32 v197, v22, v165, v173 op_sel:[1,0,0] op_sel_hi:[1,0,0]
v_mfma_f32_16x16x32_bf16 a[20:23], a[212:215], v[128:131], 0
v_cvt_pk_bf16_f32 v182, v196, v197
v_fma_mix_f32 v198, v23, v166, v174 op_sel_hi:[1,0,0]
v_mfma_f32_16x16x32_bf16 a[52:55], a[212:215], v[132:135], 0
buffer_load_dwordx4 v[8:11], v247, s[16:19], s30 offen offset:2048 sc1
v_fma_mix_f32 v199, v23, v167, v175 op_sel:[1,0,0] op_sel_hi:[1,0,0]
v_cvt_pk_bf16_f32 v183, v198, v199
v_mfma_f32_16x16x32_bf16 v[84:87], a[212:215], v[136:139], 0
v_fma_mix_f32 v192, v24, v160, v168 op_sel_hi:[1,0,0]
v_fma_mix_f32 v193, v24, v161, v169 op_sel:[1,0,0] op_sel_hi:[1,0,0]
v_mfma_f32_16x16x32_bf16 v[116:119], a[212:215], v[140:143], 0
buffer_load_dwordx4 v[12:15], v247, s[16:19], s30 offen offset:3072 sc1
v_cvt_pk_bf16_f32 v184, v192, v193
v_fma_mix_f32 v194, v25, v162, v170 op_sel_hi:[1,0,0]
v_mfma_f32_16x16x32_bf16 a[24:27], a[216:219], v[128:131], 0
s_add_u32 s30, s30, 4096
s_and_b32 s30, s30, 0xffff
s_add_u32 m0, s26, 81920
s_and_b32 s25, s25, 0x3fffff
v_fma_mix_f32 v195, v25, v163, v171 op_sel:[1,0,0] op_sel_hi:[1,0,0]
v_cvt_pk_bf16_f32 v185, v194, v195
v_mfma_f32_16x16x32_bf16 a[56:59], a[216:219], v[132:135], 0
buffer_load_dwordx4 v245, s[20:23], s25 offen lds
v_fma_mix_f32 v196, v26, v164, v172 op_sel_hi:[1,0,0]
v_fma_mix_f32 v197, v26, v165, v173 op_sel:[1,0,0] op_sel_hi:[1,0,0]
v_mfma_f32_16x16x32_bf16 v[88:91], a[216:219], v[136:139], 0
v_cvt_pk_bf16_f32 v186, v196, v197
v_fma_mix_f32 v198, v27, v166, v174 op_sel_hi:[1,0,0]
v_mfma_f32_16x16x32_bf16 v[120:123], a[216:219], v[140:143], 0
buffer_load_dwordx4 v246, s[20:23], s25 offen offset:1024 lds
v_fma_mix_f32 v199, v27, v167, v175 op_sel:[1,0,0] op_sel_hi:[1,0,0]
v_cvt_pk_bf16_f32 v187, v198, v199
v_mfma_f32_16x16x32_bf16 a[28:31], a[220:223], v[128:131], 0
s_add_u32 s25, s25, 0x40000
v_fma_mix_f32 v192, v28, v160, v168 op_sel_hi:[1,0,0]
v_fma_mix_f32 v193, v28, v161, v169 op_sel:[1,0,0] op_sel_hi:[1,0,0]
v_cvt_pk_bf16_f32 v188, v192, v193
v_mfma_f32_16x16x32_bf16 a[60:63], a[220:223], v[132:135], 0
v_fma_mix_f32 v194, v29, v162, v170 op_sel_hi:[1,0,0]
v_fma_mix_f32 v195, v29, v163, v171 op_sel:[1,0,0] op_sel_hi:[1,0,0]
v_cvt_pk_bf16_f32 v189, v194, v195
v_mfma_f32_16x16x32_bf16 v[92:95], a[220:223], v[136:139], 0
v_fma_mix_f32 v196, v30, v164, v172 op_sel_hi:[1,0,0]
v_fma_mix_f32 v197, v30, v165, v173 op_sel:[1,0,0] op_sel_hi:[1,0,0]
v_cvt_pk_bf16_f32 v190, v196, v197
v_mfma_f32_16x16x32_bf16 v[124:127], a[220:223], v[140:143], 0
v_fma_mix_f32 v198, v31, v166, v174 op_sel_hi:[1,0,0]
v_fma_mix_f32 v199, v31, v167, v175 op_sel:[1,0,0] op_sel_hi:[1,0,0]
v_cvt_pk_bf16_f32 v191, v198, v199
s_waitcnt vmcnt(10) lgkmcnt(0)
v_mfma_f32_16x16x32_bf16 a[0:3], a[224:227], v[176:179], a[0:3]
ds_read_b64_tr_b16 a[192:193], v240 offset:16384
v_fma_mix_f32 v192, v32, v144, v152 op_sel_hi:[1,0,0]
v_mfma_f32_16x16x32_bf16 a[32:35], a[224:227], v[180:183], a[32:35]
ds_read_b64_tr_b16 a[194:195], v240 offset:17408
v_fma_mix_f32 v193, v32, v145, v153 op_sel:[1,0,0] op_sel_hi:[1,0,0]
v_mfma_f32_16x16x32_bf16 v[64:67], a[224:227], v[184:187], v[64:67]
ds_read_b64_tr_b16 a[196:197], v240 offset:16392
v_cvt_pk_bf16_f32 v128, v192, v193
v_mfma_f32_16x16x32_bf16 v[96:99], a[224:227], v[188:191], v[96:99]
ds_read_b64_tr_b16 a[198:199], v240 offset:17416
v_fma_mix_f32 v194, v33, v146, v154 op_sel_hi:[1,0,0]
v_mfma_f32_16x16x32_bf16 a[4:7], a[228:231], v[176:179], a[4:7]
ds_read_b64_tr_b16 a[200:201], v241 offset:16384
v_fma_mix_f32 v195, v33, v147, v155 op_sel:[1,0,0] op_sel_hi:[1,0,0]
v_mfma_f32_16x16x32_bf16 a[36:39], a[228:231], v[180:183], a[36:39]
ds_read_b64_tr_b16 a[202:203], v241 offset:17408
v_cvt_pk_bf16_f32 v129, v194, v195
v_mfma_f32_16x16x32_bf16 v[68:71], a[228:231], v[184:187], v[68:71]
ds_read_b64_tr_b16 a[204:205], v241 offset:16392
v_fma_mix_f32 v196, v34, v148, v156 op_sel_hi:[1,0,0]
v_mfma_f32_16x16x32_bf16 v[100:103], a[228:231], v[188:191], v[100:103]
ds_read_b64_tr_b16 a[206:207], v241 offset:17416
v_fma_mix_f32 v197, v34, v149, v157 op_sel:[1,0,0] op_sel_hi:[1,0,0]
v_mfma_f32_16x16x32_bf16 a[8:11], a[232:235], v[176:179], a[8:11]
ds_read_b64_tr_b16 a[208:209], v242 offset:16384
v_cvt_pk_bf16_f32 v130, v196, v197
v_mfma_f32_16x16x32_bf16 a[40:43], a[232:235], v[180:183], a[40:43]
ds_read_b64_tr_b16 a[210:211], v242 offset:17408
v_fma_mix_f32 v198, v35, v150, v158 op_sel_hi:[1,0,0]
v_mfma_f32_16x16x32_bf16 v[72:75], a[232:235], v[184:187], v[72:75]
ds_read_b64_tr_b16 a[212:213], v242 offset:16392
v_fma_mix_f32 v199, v35, v151, v159 op_sel:[1,0,0] op_sel_hi:[1,0,0]
v_mfma_f32_16x16x32_bf16 v[104:107], a[232:235], v[188:191], v[104:107]
ds_read_b64_tr_b16 a[214:215], v242 offset:17416
v_cvt_pk_bf16_f32 v131, v198, v199
v_mfma_f32_16x16x32_bf16 a[12:15], a[236:239], v[176:179], a[12:15]
ds_read_b64_tr_b16 a[216:217], v243 offset:16384
v_fma_mix_f32 v192, v36, v144, v152 op_sel_hi:[1,0,0]
v_mfma_f32_16x16x32_bf16 a[44:47], a[236:239], v[180:183], a[44:47]
ds_read_b64_tr_b16 a[218:219], v243 offset:17408
v_fma_mix_f32 v193, v36, v145, v153 op_sel:[1,0,0] op_sel_hi:[1,0,0]
v_mfma_f32_16x16x32_bf16 v[76:79], a[236:239], v[184:187], v[76:79]
ds_read_b64_tr_b16 a[220:221], v243 offset:16392
v_cvt_pk_bf16_f32 v132, v192, v193
v_mfma_f32_16x16x32_bf16 v[108:111], a[236:239], v[188:191], v[108:111]
ds_read_b64_tr_b16 a[222:223], v243 offset:17416
v_fma_mix_f32 v194, v37, v146, v154 op_sel_hi:[1,0,0]
v_mfma_f32_16x16x32_bf16 a[16:19], a[240:243], v[176:179], a[16:19]
ds_read_b128 v[160:163], v244 offset:384
v_fma_mix_f32 v195, v37, v147, v155 op_sel:[1,0,0] op_sel_hi:[1,0,0]
v_mfma_f32_16x16x32_bf16 a[48:51], a[240:243], v[180:183], a[48:51]
ds_read_b128 v[164:167], v244 offset:400
buffer_load_dwordx4 v[16:19], v247, s[16:19], s30 offen offset:0 sc1
v_cvt_pk_bf16_f32 v133, v194, v195
v_mfma_f32_16x16x32_bf16 v[80:83], a[240:243], v[184:187], v[80:83]
ds_read_b128 v[168:171], v244 offset:4480
v_fma_mix_f32 v196, v38, v148, v156 op_sel_hi:[1,0,0]
v_mfma_f32_16x16x32_bf16 v[112:115], a[240:243], v[188:191], v[112:115]
ds_read_b128 v[172:175], v244 offset:4496
buffer_load_dwordx4 v[20:23], v247, s[16:19], s30 offen offset:1024 sc1
v_fma_mix_f32 v197, v38, v149, v157 op_sel:[1,0,0] op_sel_hi:[1,0,0]
v_mfma_f32_16x16x32_bf16 a[20:23], a[244:247], v[176:179], a[20:23]
v_cvt_pk_bf16_f32 v134, v196, v197
v_fma_mix_f32 v198, v39, v150, v158 op_sel_hi:[1,0,0]
v_mfma_f32_16x16x32_bf16 a[52:55], a[244:247], v[180:183], a[52:55]
buffer_load_dwordx4 v[24:27], v247, s[16:19], s30 offen offset:2048 sc1
v_fma_mix_f32 v199, v39, v151, v159 op_sel:[1,0,0] op_sel_hi:[1,0,0]
v_cvt_pk_bf16_f32 v135, v198, v199
v_mfma_f32_16x16x32_bf16 v[84:87], a[244:247], v[184:187], v[84:87]
v_fma_mix_f32 v192, v40, v144, v152 op_sel_hi:[1,0,0]
v_fma_mix_f32 v193, v40, v145, v153 op_sel:[1,0,0] op_sel_hi:[1,0,0]
v_mfma_f32_16x16x32_bf16 v[116:119], a[244:247], v[188:191], v[116:119]
buffer_load_dwordx4 v[28:31], v247, s[16:19], s30 offen offset:3072 sc1
v_cvt_pk_bf16_f32 v136, v192, v193
v_fma_mix_f32 v194, v41, v146, v154 op_sel_hi:[1,0,0]
v_mfma_f32_16x16x32_bf16 a[24:27], a[248:251], v[176:179], a[24:27]
s_add_u32 s30, s30, 4096
s_and_b32 s30, s30, 0xffff
s_add_u32 m0, s26, 90112
s_and_b32 s25, s25, 0x3fffff
v_fma_mix_f32 v195, v41, v147, v155 op_sel:[1,0,0] op_sel_hi:[1,0,0]
v_cvt_pk_bf16_f32 v137, v194, v195
v_mfma_f32_16x16x32_bf16 a[56:59], a[248:251], v[180:183], a[56:59]
buffer_load_dwordx4 v245, s[20:23], s25 offen lds
v_fma_mix_f32 v196, v42, v148, v156 op_sel_hi:[1,0,0]
v_fma_mix_f32 v197, v42, v149, v157 op_sel:[1,0,0] op_sel_hi:[1,0,0]
v_mfma_f32_16x16x32_bf16 v[88:91], a[248:251], v[184:187], v[88:91]
v_cvt_pk_bf16_f32 v138, v196, v197
v_fma_mix_f32 v198, v43, v150, v158 op_sel_hi:[1,0,0]
v_mfma_f32_16x16x32_bf16 v[120:123], a[248:251], v[188:191], v[120:123]
buffer_load_dwordx4 v246, s[20:23], s25 offen offset:1024 lds
v_fma_mix_f32 v199, v43, v151, v159 op_sel:[1,0,0] op_sel_hi:[1,0,0]
v_cvt_pk_bf16_f32 v139, v198, v199
v_mfma_f32_16x16x32_bf16 a[28:31], a[252:255], v[176:179], a[28:31]
s_add_u32 s25, s25, 0x40000
v_fma_mix_f32 v192, v44, v144, v152 op_sel_hi:[1,0,0]
v_fma_mix_f32 v193, v44, v145, v153 op_sel:[1,0,0] op_sel_hi:[1,0,0]
v_cvt_pk_bf16_f32 v140, v192, v193
v_mfma_f32_16x16x32_bf16 a[60:63], a[252:255], v[180:183], a[60:63]
v_fma_mix_f32 v194, v45, v146, v154 op_sel_hi:[1,0,0]
v_fma_mix_f32 v195, v45, v147, v155 op_sel:[1,0,0] op_sel_hi:[1,0,0]
v_cvt_pk_bf16_f32 v141, v194, v195
v_mfma_f32_16x16x32_bf16 v[92:95], a[252:255], v[184:187], v[92:95]
v_fma_mix_f32 v196, v46, v148, v156 op_sel_hi:[1,0,0]
v_fma_mix_f32 v197, v46, v149, v157 op_sel:[1,0,0] op_sel_hi:[1,0,0]
v_cvt_pk_bf16_f32 v142, v196, v197
v_mfma_f32_16x16x32_bf16 v[124:127], a[252:255], v[188:191], v[124:127]
v_fma_mix_f32 v198, v47, v150, v158 op_sel_hi:[1,0,0]
v_fma_mix_f32 v199, v47, v151, v159 op_sel:[1,0,0] op_sel_hi:[1,0,0]
v_cvt_pk_bf16_f32 v143, v198, v199
s_waitcnt vmcnt(12) lgkmcnt(0)
v_mfma_f32_16x16x32_bf16 a[0:3], a[192:195], v[128:131], a[0:3]
ds_read_b64_tr_b16 a[224:225], v240 offset:24576
v_fma_mix_f32 v192, v48, v160, v168 op_sel_hi:[1,0,0]
v_mfma_f32_16x16x32_bf16 a[32:35], a[192:195], v[132:135], a[32:35]
ds_read_b64_tr_b16 a[226:227], v240 offset:25600
v_fma_mix_f32 v193, v48, v161, v169 op_sel:[1,0,0] op_sel_hi:[1,0,0]
v_mfma_f32_16x16x32_bf16 v[64:67], a[192:195], v[136:139], v[64:67]
ds_read_b64_tr_b16 a[228:229], v240 offset:24584
v_cvt_pk_bf16_f32 v176, v192, v193
v_mfma_f32_16x16x32_bf16 v[96:99], a[192:195], v[140:143], v[96:99]
ds_read_b64_tr_b16 a[230:231], v240 offset:25608
v_fma_mix_f32 v194, v49, v162, v170 op_sel_hi:[1,0,0]
v_mfma_f32_16x16x32_bf16 a[4:7], a[196:199], v[128:131], a[4:7]
ds_read_b64_tr_b16 a[232:233], v241 offset:24576
v_fma_mix_f32 v195, v49, v163, v171 op_sel:[1,0,0] op_sel_hi:[1,0,0]
v_mfma_f32_16x16x32_bf16 a[36:39], a[196:199], v[132:135], a[36:39]
ds_read_b64_tr_b16 a[234:235], v241 offset:25600
v_cvt_pk_bf16_f32 v177, v194, v195
v_mfma_f32_16x16x32_bf16 v[68:71], a[196:199], v[136:139], v[68:71]
ds_read_b64_tr_b16 a[236:237], v241 offset:24584
v_fma_mix_f32 v196, v50, v164, v172 op_sel_hi:[1,0,0]
v_mfma_f32_16x16x32_bf16 v[100:103], a[196:199], v[140:143], v[100:103]
ds_read_b64_tr_b16 a[238:239], v241 offset:25608
v_fma_mix_f32 v197, v50, v165, v173 op_sel:[1,0,0] op_sel_hi:[1,0,0]
v_mfma_f32_16x16x32_bf16 a[8:11], a[200:203], v[128:131], a[8:11]
ds_read_b64_tr_b16 a[240:241], v242 offset:24576
v_cvt_pk_bf16_f32 v178, v196, v197
v_mfma_f32_16x16x32_bf16 a[40:43], a[200:203], v[132:135], a[40:43]
ds_read_b64_tr_b16 a[242:243], v242 offset:25600
v_fma_mix_f32 v198, v51, v166, v174 op_sel_hi:[1,0,0]
v_mfma_f32_16x16x32_bf16 v[72:75], a[200:203], v[136:139], v[72:75]
ds_read_b64_tr_b16 a[244:245], v242 offset:24584
v_fma_mix_f32 v199, v51, v167, v175 op_sel:[1,0,0] op_sel_hi:[1,0,0]
v_mfma_f32_16x16x32_bf16 v[104:107], a[200:203], v[140:143], v[104:107]
ds_read_b64_tr_b16 a[246:247], v242 offset:25608
v_cvt_pk_bf16_f32 v179, v198, v199
v_mfma_f32_16x16x32_bf16 a[12:15], a[204:207], v[128:131], a[12:15]
ds_read_b64_tr_b16 a[248:249], v243 offset:24576
v_fma_mix_f32 v192, v52, v160, v168 op_sel_hi:[1,0,0]
v_mfma_f32_16x16x32_bf16 a[44:47], a[204:207], v[132:135], a[44:47]
ds_read_b64_tr_b16 a[250:251], v243 offset:25600
v_fma_mix_f32 v193, v52, v161, v169 op_sel:[1,0,0] op_sel_hi:[1,0,0]
v_mfma_f32_16x16x32_bf16 v[76:79], a[204:207], v[136:139], v[76:79]
ds_read_b64_tr_b16 a[252:253], v243 offset:24584
v_cvt_pk_bf16_f32 v180, v192, v193
v_mfma_f32_16x16x32_bf16 v[108:111], a[204:207], v[140:143], v[108:111]
ds_read_b64_tr_b16 a[254:255], v243 offset:25608
v_fma_mix_f32 v194, v53, v162, v170 op_sel_hi:[1,0,0]
v_mfma_f32_16x16x32_bf16 a[16:19], a[208:211], v[128:131], a[16:19]
ds_read_b128 v[144:147], v244 offset:512
v_fma_mix_f32 v195, v53, v163, v171 op_sel:[1,0,0] op_sel_hi:[1,0,0]
v_mfma_f32_16x16x32_bf16 a[48:51], a[208:211], v[132:135], a[48:51]
ds_read_b128 v[148:151], v244 offset:528
buffer_load_dwordx4 v[32:35], v247, s[16:19], s30 offen offset:0 sc1
v_cvt_pk_bf16_f32 v181, v194, v195
v_mfma_f32_16x16x32_bf16 v[80:83], a[208:211], v[136:139], v[80:83]
ds_read_b128 v[152:155], v244 offset:4608
v_fma_mix_f32 v196, v54, v164, v172 op_sel_hi:[1,0,0]
v_mfma_f32_16x16x32_bf16 v[112:115], a[208:211], v[140:143], v[112:115]
ds_read_b128 v[156:159], v244 offset:4624
buffer_load_dwordx4 v[36:39], v247, s[16:19], s30 offen offset:1024 sc1
v_fma_mix_f32 v197, v54, v165, v173 op_sel:[1,0,0] op_sel_hi:[1,0,0]
v_mfma_f32_16x16x32_bf16 a[20:23], a[212:215], v[128:131], a[20:23]
v_cvt_pk_bf16_f32 v182, v196, v197
v_fma_mix_f32 v198, v55, v166, v174 op_sel_hi:[1,0,0]
v_mfma_f32_16x16x32_bf16 a[52:55], a[212:215], v[132:135], a[52:55]
buffer_load_dwordx4 v[40:43], v247, s[16:19], s30 offen offset:2048 sc1
v_fma_mix_f32 v199, v55, v167, v175 op_sel:[1,0,0] op_sel_hi:[1,0,0]
v_cvt_pk_bf16_f32 v183, v198, v199
v_mfma_f32_16x16x32_bf16 v[84:87], a[212:215], v[136:139], v[84:87]
v_fma_mix_f32 v192, v56, v160, v168 op_sel_hi:[1,0,0]
v_fma_mix_f32 v193, v56, v161, v169 op_sel:[1,0,0] op_sel_hi:[1,0,0]
v_mfma_f32_16x16x32_bf16 v[116:119], a[212:215], v[140:143], v[116:119]
buffer_load_dwordx4 v[44:47], v247, s[16:19], s30 offen offset:3072 sc1
v_cvt_pk_bf16_f32 v184, v192, v193
v_fma_mix_f32 v194, v57, v162, v170 op_sel_hi:[1,0,0]
v_mfma_f32_16x16x32_bf16 a[24:27], a[216:219], v[128:131], a[24:27]
s_add_u32 s30, s30, 4096
s_and_b32 s30, s30, 0xffff
s_add_u32 m0, s26, 98304
s_and_b32 s25, s25, 0x3fffff
v_fma_mix_f32 v195, v57, v163, v171 op_sel:[1,0,0] op_sel_hi:[1,0,0]
v_cvt_pk_bf16_f32 v185, v194, v195
v_mfma_f32_16x16x32_bf16 a[56:59], a[216:219], v[132:135], a[56:59]
buffer_load_dwordx4 v245, s[20:23], s25 offen lds
v_fma_mix_f32 v196, v58, v164, v172 op_sel_hi:[1,0,0]
v_fma_mix_f32 v197, v58, v165, v173 op_sel:[1,0,0] op_sel_hi:[1,0,0]
v_mfma_f32_16x16x32_bf16 v[88:91], a[216:219], v[136:139], v[88:91]
v_cvt_pk_bf16_f32 v186, v196, v197
v_fma_mix_f32 v198, v59, v166, v174 op_sel_hi:[1,0,0]
v_mfma_f32_16x16x32_bf16 v[120:123], a[216:219], v[140:143], v[120:123]
buffer_load_dwordx4 v246, s[20:23], s25 offen offset:1024 lds
v_fma_mix_f32 v199, v59, v167, v175 op_sel:[1,0,0] op_sel_hi:[1,0,0]
v_cvt_pk_bf16_f32 v187, v198, v199
v_mfma_f32_16x16x32_bf16 a[28:31], a[220:223], v[128:131], a[28:31]
s_add_u32 s25, s25, 0x40000
v_fma_mix_f32 v192, v60, v160, v168 op_sel_hi:[1,0,0]
v_fma_mix_f32 v193, v60, v161, v169 op_sel:[1,0,0] op_sel_hi:[1,0,0]
v_cvt_pk_bf16_f32 v188, v192, v193
v_mfma_f32_16x16x32_bf16 a[60:63], a[220:223], v[132:135], a[60:63]
v_fma_mix_f32 v194, v61, v162, v170 op_sel_hi:[1,0,0]
v_fma_mix_f32 v195, v61, v163, v171 op_sel:[1,0,0] op_sel_hi:[1,0,0]
v_cvt_pk_bf16_f32 v189, v194, v195
v_mfma_f32_16x16x32_bf16 v[92:95], a[220:223], v[136:139], v[92:95]
v_fma_mix_f32 v196, v62, v164, v172 op_sel_hi:[1,0,0]
v_fma_mix_f32 v197, v62, v165, v173 op_sel:[1,0,0] op_sel_hi:[1,0,0]
Lpad1:
s_cbranch_execz Lpad5
v_cvt_pk_bf16_f32 v190, v196, v197
v_mfma_f32_16x16x32_bf16 v[124:127], a[220:223], v[140:143], v[124:127]
v_fma_mix_f32 v198, v63, v166, v174 op_sel_hi:[1,0,0]
v_fma_mix_f32 v199, v63, v167, v175 op_sel:[1,0,0] op_sel_hi:[1,0,0]
v_cvt_pk_bf16_f32 v191, v198, v199
s_waitcnt vmcnt(14) lgkmcnt(0)
v_mfma_f32_16x16x32_bf16 a[0:3], a[224:227], v[176:179], a[0:3]
ds_read_b64_tr_b16 a[192:193], v240 offset:32768
v_fma_mix_f32 v192, v0, v144, v152 op_sel_hi:[1,0,0]
v_mfma_f32_16x16x32_bf16 a[32:35], a[224:227], v[180:183], a[32:35]
ds_read_b64_tr_b16 a[194:195], v240 offset:33792
v_fma_mix_f32 v193, v0, v145, v153 op_sel:[1,0,0] op_sel_hi:[1,0,0]
v_mfma_f32_16x16x32_bf16 v[64:67], a[224:227], v[184:187], v[64:67]
ds_read_b64_tr_b16 a[196:197], v240 offset:32776
v_cvt_pk_bf16_f32 v128, v192, v193
v_mfma_f32_16x16x32_bf16 v[96:99], a[224:227], v[188:191], v[96:99]
ds_read_b64_tr_b16 a[198:199], v240 offset:33800
v_fma_mix_f32 v194, v1, v146, v154 op_sel_hi:[1,0,0]
v_mfma_f32_16x16x32_bf16 a[4:7], a[228:231], v[176:179], a[4:7]
ds_read_b64_tr_b16 a[200:201], v241 offset:32768
v_fma_mix_f32 v195, v1, v147, v155 op_sel:[1,0,0] op_sel_hi:[1,0,0]
v_mfma_f32_16x16x32_bf16 a[36:39], a[228:231], v[180:183], a[36:39]
ds_read_b64_tr_b16 a[202:203], v241 offset:33792
v_cvt_pk_bf16_f32 v129, v194, v195
v_mfma_f32_16x16x32_bf16 v[68:71], a[228:231], v[184:187], v[68:71]
ds_read_b64_tr_b16 a[204:205], v241 offset:32776
v_fma_mix_f32 v196, v2, v148, v156 op_sel_hi:[1,0,0]
v_mfma_f32_16x16x32_bf16 v[100:103], a[228:231], v[188:191], v[100:103]
ds_read_b64_tr_b16 a[206:207], v241 offset:33800
v_fma_mix_f32 v197, v2, v149, v157 op_sel:[1,0,0] op_sel_hi:[1,0,0]
v_mfma_f32_16x16x32_bf16 a[8:11], a[232:235], v[176:179], a[8:11]
ds_read_b64_tr_b16 a[208:209], v242 offset:32768
v_cvt_pk_bf16_f32 v130, v196, v197
v_mfma_f32_16x16x32_bf16 a[40:43], a[232:235], v[180:183], a[40:43]
ds_read_b64_tr_b16 a[210:211], v242 offset:33792
v_fma_mix_f32 v198, v3, v150, v158 op_sel_hi:[1,0,0]
v_mfma_f32_16x16x32_bf16 v[72:75], a[232:235], v[184:187], v[72:75]
ds_read_b64_tr_b16 a[212:213], v242 offset:32776
v_fma_mix_f32 v199, v3, v151, v159 op_sel:[1,0,0] op_sel_hi:[1,0,0]
v_mfma_f32_16x16x32_bf16 v[104:107], a[232:235], v[188:191], v[104:107]
ds_read_b64_tr_b16 a[214:215], v242 offset:33800
v_cvt_pk_bf16_f32 v131, v198, v199
v_mfma_f32_16x16x32_bf16 a[12:15], a[236:239], v[176:179], a[12:15]
ds_read_b64_tr_b16 a[216:217], v243 offset:32768
v_fma_mix_f32 v192, v4, v144, v152 op_sel_hi:[1,0,0]
v_mfma_f32_16x16x32_bf16 a[44:47], a[236:239], v[180:183], a[44:47]
ds_read_b64_tr_b16 a[218:219], v243 offset:33792
v_fma_mix_f32 v193, v4, v145, v153 op_sel:[1,0,0] op_sel_hi:[1,0,0]
v_mfma_f32_16x16x32_bf16 v[76:79], a[236:239], v[184:187], v[76:79]
ds_read_b64_tr_b16 a[220:221], v243 offset:32776
v_cvt_pk_bf16_f32 v132, v192, v193
v_mfma_f32_16x16x32_bf16 v[108:111], a[236:239], v[188:191], v[108:111]
ds_read_b64_tr_b16 a[222:223], v243 offset:33800
v_fma_mix_f32 v194, v5, v146, v154 op_sel_hi:[1,0,0]
v_mfma_f32_16x16x32_bf16 a[16:19], a[240:243], v[176:179], a[16:19]
ds_read_b128 v[160:163], v244 offset:640
v_fma_mix_f32 v195, v5, v147, v155 op_sel:[1,0,0] op_sel_hi:[1,0,0]
v_mfma_f32_16x16x32_bf16 a[48:51], a[240:243], v[180:183], a[48:51]
ds_read_b128 v[164:167], v244 offset:656
buffer_load_dwordx4 v[48:51], v247, s[16:19], s30 offen offset:0 sc1
v_cvt_pk_bf16_f32 v133, v194, v195
v_mfma_f32_16x16x32_bf16 v[80:83], a[240:243], v[184:187], v[80:83]
ds_read_b128 v[168:171], v244 offset:4736
v_fma_mix_f32 v196, v6, v148, v156 op_sel_hi:[1,0,0]
v_mfma_f32_16x16x32_bf16 v[112:115], a[240:243], v[188:191], v[112:115]
ds_read_b128 v[172:175], v244 offset:4752
buffer_load_dwordx4 v[52:55], v247, s[16:19], s30 offen offset:1024 sc1
v_fma_mix_f32 v197, v6, v149, v157 op_sel:[1,0,0] op_sel_hi:[1,0,0]
v_mfma_f32_16x16x32_bf16 a[20:23], a[244:247], v[176:179], a[20:23]
v_cvt_pk_bf16_f32 v134, v196, v197
v_fma_mix_f32 v198, v7, v150, v158 op_sel_hi:[1,0,0]
v_mfma_f32_16x16x32_bf16 a[52:55], a[244:247], v[180:183], a[52:55]
buffer_load_dwordx4 v[56:59], v247, s[16:19], s30 offen offset:2048 sc1
v_fma_mix_f32 v199, v7, v151, v159 op_sel:[1,0,0] op_sel_hi:[1,0,0]
v_cvt_pk_bf16_f32 v135, v198, v199
v_mfma_f32_16x16x32_bf16 v[84:87], a[244:247], v[184:187], v[84:87]
v_fma_mix_f32 v192, v8, v144, v152 op_sel_hi:[1,0,0]
v_fma_mix_f32 v193, v8, v145, v153 op_sel:[1,0,0] op_sel_hi:[1,0,0]
v_mfma_f32_16x16x32_bf16 v[116:119], a[244:247], v[188:191], v[116:119]
buffer_load_dwordx4 v[60:63], v247, s[16:19], s30 offen offset:3072 sc1
v_cvt_pk_bf16_f32 v136, v192, v193
v_fma_mix_f32 v194, v9, v146, v154 op_sel_hi:[1,0,0]
v_mfma_f32_16x16x32_bf16 a[24:27], a[248:251], v[176:179], a[24:27]
s_add_u32 s30, s30, 4096
s_and_b32 s30, s30, 0xffff
s_add_u32 m0, s26, 106496
s_and_b32 s25, s25, 0x3fffff
v_fma_mix_f32 v195, v9, v147, v155 op_sel:[1,0,0] op_sel_hi:[1,0,0]
v_cvt_pk_bf16_f32 v137, v194, v195
v_mfma_f32_16x16x32_bf16 a[56:59], a[248:251], v[180:183], a[56:59]
buffer_load_dwordx4 v245, s[20:23], s25 offen lds
v_fma_mix_f32 v196, v10, v148, v156 op_sel_hi:[1,0,0]
v_fma_mix_f32 v197, v10, v149, v157 op_sel:[1,0,0] op_sel_hi:[1,0,0]
v_mfma_f32_16x16x32_bf16 v[88:91], a[248:251], v[184:187], v[88:91]
v_cvt_pk_bf16_f32 v138, v196, v197
v_fma_mix_f32 v198, v11, v150, v158 op_sel_hi:[1,0,0]
v_mfma_f32_16x16x32_bf16 v[120:123], a[248:251], v[188:191], v[120:123]
buffer_load_dwordx4 v246, s[20:23], s25 offen offset:1024 lds
v_fma_mix_f32 v199, v11, v151, v159 op_sel:[1,0,0] op_sel_hi:[1,0,0]
v_cvt_pk_bf16_f32 v139, v198, v199
v_mfma_f32_16x16x32_bf16 a[28:31], a[252:255], v[176:179], a[28:31]
s_add_u32 s25, s25, 0x40000
v_fma_mix_f32 v192, v12, v144, v152 op_sel_hi:[1,0,0]
v_fma_mix_f32 v193, v12, v145, v153 op_sel:[1,0,0] op_sel_hi:[1,0,0]
v_cvt_pk_bf16_f32 v140, v192, v193
v_mfma_f32_16x16x32_bf16 a[60:63], a[252:255], v[180:183], a[60:63]
v_fma_mix_f32 v194, v13, v146, v154 op_sel_hi:[1,0,0]
v_fma_mix_f32 v195, v13, v147, v155 op_sel:[1,0,0] op_sel_hi:[1,0,0]
v_cvt_pk_bf16_f32 v141, v194, v195
v_mfma_f32_16x16x32_bf16 v[92:95], a[252:255], v[184:187], v[92:95]
v_fma_mix_f32 v196, v14, v148, v156 op_sel_hi:[1,0,0]
v_fma_mix_f32 v197, v14, v149, v157 op_sel:[1,0,0] op_sel_hi:[1,0,0]
v_cvt_pk_bf16_f32 v142, v196, v197
v_mfma_f32_16x16x32_bf16 v[124:127], a[252:255], v[188:191], v[124:127]
v_fma_mix_f32 v198, v15, v150, v158 op_sel_hi:[1,0,0]
v_fma_mix_f32 v199, v15, v151, v159 op_sel:[1,0,0] op_sel_hi:[1,0,0]
v_cvt_pk_bf16_f32 v143, v198, v199
s_waitcnt vmcnt(14) lgkmcnt(0)
v_mfma_f32_16x16x32_bf16 a[0:3], a[192:195], v[128:131], a[0:3]
ds_read_b64_tr_b16 a[224:225], v240 offset:40960
v_fma_mix_f32 v192, v16, v160, v168 op_sel_hi:[1,0,0]
v_mfma_f32_16x16x32_bf16 a[32:35], a[192:195], v[132:135], a[32:35]
ds_read_b64_tr_b16 a[226:227], v240 offset:41984
v_fma_mix_f32 v193, v16, v161, v169 op_sel:[1,0,0] op_sel_hi:[1,0,0]
v_mfma_f32_16x16x32_bf16 v[64:67], a[192:195], v[136:139], v[64:67]
ds_read_b64_tr_b16 a[228:229], v240 offset:40968
v_cvt_pk_bf16_f32 v176, v192, v193
v_mfma_f32_16x16x32_bf16 v[96:99], a[192:195], v[140:143], v[96:99]
ds_read_b64_tr_b16 a[230:231], v240 offset:41992
v_fma_mix_f32 v194, v17, v162, v170 op_sel_hi:[1,0,0]
v_mfma_f32_16x16x32_bf16 a[4:7], a[196:199], v[128:131], a[4:7]
ds_read_b64_tr_b16 a[232:233], v241 offset:40960
v_fma_mix_f32 v195, v17, v163, v171 op_sel:[1,0,0] op_sel_hi:[1,0,0]
v_mfma_f32_16x16x32_bf16 a[36:39], a[196:199], v[132:135], a[36:39]
ds_read_b64_tr_b16 a[234:235], v241 offset:41984
v_cvt_pk_bf16_f32 v177, v194, v195
v_mfma_f32_16x16x32_bf16 v[68:71], a[196:199], v[136:139], v[68:71]
ds_read_b64_tr_b16 a[236:237], v241 offset:40968
v_fma_mix_f32 v196, v18, v164, v172 op_sel_hi:[1,0,0]
v_mfma_f32_16x16x32_bf16 v[100:103], a[196:199], v[140:143], v[100:103]
ds_read_b64_tr_b16 a[238:239], v241 offset:41992
v_fma_mix_f32 v197, v18, v165, v173 op_sel:[1,0,0] op_sel_hi:[1,0,0]
v_mfma_f32_16x16x32_bf16 a[8:11], a[200:203], v[128:131], a[8:11]
ds_read_b64_tr_b16 a[240:241], v242 offset:40960
v_cvt_pk_bf16_f32 v178, v196, v197
v_mfma_f32_16x16x32_bf16 a[40:43], a[200:203], v[132:135], a[40:43]
ds_read_b64_tr_b16 a[242:243], v242 offset:41984
v_fma_mix_f32 v198, v19, v166, v174 op_sel_hi:[1,0,0]
v_mfma_f32_16x16x32_bf16 v[72:75], a[200:203], v[136:139], v[72:75]
ds_read_b64_tr_b16 a[244:245], v242 offset:40968
v_fma_mix_f32 v199, v19, v167, v175 op_sel:[1,0,0] op_sel_hi:[1,0,0]
v_mfma_f32_16x16x32_bf16 v[104:107], a[200:203], v[140:143], v[104:107]
ds_read_b64_tr_b16 a[246:247], v242 offset:41992
v_cvt_pk_bf16_f32 v179, v198, v199
v_mfma_f32_16x16x32_bf16 a[12:15], a[204:207], v[128:131], a[12:15]
ds_read_b64_tr_b16 a[248:249], v243 offset:40960
v_fma_mix_f32 v192, v20, v160, v168 op_sel_hi:[1,0,0]
v_mfma_f32_16x16x32_bf16 a[44:47], a[204:207], v[132:135], a[44:47]
ds_read_b64_tr_b16 a[250:251], v243 offset:41984
v_fma_mix_f32 v193, v20, v161, v169 op_sel:[1,0,0] op_sel_hi:[1,0,0]
v_mfma_f32_16x16x32_bf16 v[76:79], a[204:207], v[136:139], v[76:79]
ds_read_b64_tr_b16 a[252:253], v243 offset:40968
v_cvt_pk_bf16_f32 v180, v192, v193
v_mfma_f32_16x16x32_bf16 v[108:111], a[204:207], v[140:143], v[108:111]
ds_read_b64_tr_b16 a[254:255], v243 offset:41992
v_fma_mix_f32 v194, v21, v162, v170 op_sel_hi:[1,0,0]
v_mfma_f32_16x16x32_bf16 a[16:19], a[208:211], v[128:131], a[16:19]
ds_read_b128 v[144:147], v244 offset:768
v_fma_mix_f32 v195, v21, v163, v171 op_sel:[1,0,0] op_sel_hi:[1,0,0]
v_mfma_f32_16x16x32_bf16 a[48:51], a[208:211], v[132:135], a[48:51]
ds_read_b128 v[148:151], v244 offset:784
buffer_load_dwordx4 v[0:3], v247, s[16:19], s30 offen offset:0 sc1
v_cvt_pk_bf16_f32 v181, v194, v195
v_mfma_f32_16x16x32_bf16 v[80:83], a[208:211], v[136:139], v[80:83]
ds_read_b128 v[152:155], v244 offset:4864
v_fma_mix_f32 v196, v22, v164, v172 op_sel_hi:[1,0,0]
v_mfma_f32_16x16x32_bf16 v[112:115], a[208:211], v[140:143], v[112:115]
ds_read_b128 v[156:159], v244 offset:4880
buffer_load_dwordx4 v[4:7], v247, s[16:19], s30 offen offset:1024 sc1
v_fma_mix_f32 v197, v22, v165, v173 op_sel:[1,0,0] op_sel_hi:[1,0,0]
v_mfma_f32_16x16x32_bf16 a[20:23], a[212:215], v[128:131], a[20:23]
v_cvt_pk_bf16_f32 v182, v196, v197
v_fma_mix_f32 v198, v23, v166, v174 op_sel_hi:[1,0,0]
v_mfma_f32_16x16x32_bf16 a[52:55], a[212:215], v[132:135], a[52:55]
buffer_load_dwordx4 v[8:11], v247, s[16:19], s30 offen offset:2048 sc1
v_fma_mix_f32 v199, v23, v167, v175 op_sel:[1,0,0] op_sel_hi:[1,0,0]
v_cvt_pk_bf16_f32 v183, v198, v199
v_mfma_f32_16x16x32_bf16 v[84:87], a[212:215], v[136:139], v[84:87]
v_fma_mix_f32 v192, v24, v160, v168 op_sel_hi:[1,0,0]
v_fma_mix_f32 v193, v24, v161, v169 op_sel:[1,0,0] op_sel_hi:[1,0,0]
v_mfma_f32_16x16x32_bf16 v[116:119], a[212:215], v[140:143], v[116:119]
buffer_load_dwordx4 v[12:15], v247, s[16:19], s30 offen offset:3072 sc1
v_cvt_pk_bf16_f32 v184, v192, v193
v_fma_mix_f32 v194, v25, v162, v170 op_sel_hi:[1,0,0]
v_mfma_f32_16x16x32_bf16 a[24:27], a[216:219], v[128:131], a[24:27]
s_add_u32 s30, s30, 4096
s_and_b32 s30, s30, 0xffff
s_add_u32 m0, s26, 114688
s_and_b32 s25, s25, 0x3fffff
v_fma_mix_f32 v195, v25, v163, v171 op_sel:[1,0,0] op_sel_hi:[1,0,0]
v_cvt_pk_bf16_f32 v185, v194, v195
v_mfma_f32_16x16x32_bf16 a[56:59], a[216:219], v[132:135], a[56:59]
buffer_load_dwordx4 v245, s[20:23], s25 offen lds
v_fma_mix_f32 v196, v26, v164, v172 op_sel_hi:[1,0,0]
v_fma_mix_f32 v197, v26, v165, v173 op_sel:[1,0,0] op_sel_hi:[1,0,0]
v_mfma_f32_16x16x32_bf16 v[88:91], a[216:219], v[136:139], v[88:91]
v_cvt_pk_bf16_f32 v186, v196, v197
v_fma_mix_f32 v198, v27, v166, v174 op_sel_hi:[1,0,0]
v_mfma_f32_16x16x32_bf16 v[120:123], a[216:219], v[140:143], v[120:123]
buffer_load_dwordx4 v246, s[20:23], s25 offen offset:1024 lds
v_fma_mix_f32 v199, v27, v167, v175 op_sel:[1,0,0] op_sel_hi:[1,0,0]
v_cvt_pk_bf16_f32 v187, v198, v199
v_mfma_f32_16x16x32_bf16 a[28:31], a[220:223], v[128:131], a[28:31]
s_add_u32 s25, s25, 0x40000
v_fma_mix_f32 v192, v28, v160, v168 op_sel_hi:[1,0,0]
v_fma_mix_f32 v193, v28, v161, v169 op_sel:[1,0,0] op_sel_hi:[1,0,0]
v_cvt_pk_bf16_f32 v188, v192, v193
v_mfma_f32_16x16x32_bf16 a[60:63], a[220:223], v[132:135], a[60:63]
v_fma_mix_f32 v194, v29, v162, v170 op_sel_hi:[1,0,0]
v_fma_mix_f32 v195, v29, v163, v171 op_sel:[1,0,0] op_sel_hi:[1,0,0]
v_cvt_pk_bf16_f32 v189, v194, v195
v_mfma_f32_16x16x32_bf16 v[92:95], a[220:223], v[136:139], v[92:95]
v_fma_mix_f32 v196, v30, v164, v172 op_sel_hi:[1,0,0]
v_fma_mix_f32 v197, v30, v165, v173 op_sel:[1,0,0] op_sel_hi:[1,0,0]
v_cvt_pk_bf16_f32 v190, v196, v197
v_mfma_f32_16x16x32_bf16 v[124:127], a[220:223], v[140:143], v[124:127]
v_fma_mix_f32 v198, v31, v166, v174 op_sel_hi:[1,0,0]
v_fma_mix_f32 v199, v31, v167, v175 op_sel:[1,0,0] op_sel_hi:[1,0,0]
v_cvt_pk_bf16_f32 v191, v198, v199
s_waitcnt vmcnt(14) lgkmcnt(0)
s_barrier
v_mfma_f32_16x16x32_bf16 a[0:3], a[224:227], v[176:179], a[0:3]
ds_read_b64_tr_b16 a[192:193], v240 offset:49152
v_fma_mix_f32 v192, v32, v144, v152 op_sel_hi:[1,0,0]
v_mfma_f32_16x16x32_bf16 a[32:35], a[224:227], v[180:183], a[32:35]
ds_read_b64_tr_b16 a[194:195], v240 offset:50176
v_fma_mix_f32 v193, v32, v145, v153 op_sel:[1,0,0] op_sel_hi:[1,0,0]
v_mfma_f32_16x16x32_bf16 v[64:67], a[224:227], v[184:187], v[64:67]
ds_read_b64_tr_b16 a[196:197], v240 offset:49160
v_cvt_pk_bf16_f32 v128, v192, v193
v_mfma_f32_16x16x32_bf16 v[96:99], a[224:227], v[188:191], v[96:99]
ds_read_b64_tr_b16 a[198:199], v240 offset:50184
v_fma_mix_f32 v194, v33, v146, v154 op_sel_hi:[1,0,0]
v_mfma_f32_16x16x32_bf16 a[4:7], a[228:231], v[176:179], a[4:7]
ds_read_b64_tr_b16 a[200:201], v241 offset:49152
v_fma_mix_f32 v195, v33, v147, v155 op_sel:[1,0,0] op_sel_hi:[1,0,0]
v_mfma_f32_16x16x32_bf16 a[36:39], a[228:231], v[180:183], a[36:39]
ds_read_b64_tr_b16 a[202:203], v241 offset:50176
v_cvt_pk_bf16_f32 v129, v194, v195
v_mfma_f32_16x16x32_bf16 v[68:71], a[228:231], v[184:187], v[68:71]
ds_read_b64_tr_b16 a[204:205], v241 offset:49160
v_fma_mix_f32 v196, v34, v148, v156 op_sel_hi:[1,0,0]
v_mfma_f32_16x16x32_bf16 v[100:103], a[228:231], v[188:191], v[100:103]
ds_read_b64_tr_b16 a[206:207], v241 offset:50184
v_fma_mix_f32 v197, v34, v149, v157 op_sel:[1,0,0] op_sel_hi:[1,0,0]
v_mfma_f32_16x16x32_bf16 a[8:11], a[232:235], v[176:179], a[8:11]
ds_read_b64_tr_b16 a[208:209], v242 offset:49152
v_cvt_pk_bf16_f32 v130, v196, v197
v_mfma_f32_16x16x32_bf16 a[40:43], a[232:235], v[180:183], a[40:43]
ds_read_b64_tr_b16 a[210:211], v242 offset:50176
v_fma_mix_f32 v198, v35, v150, v158 op_sel_hi:[1,0,0]
v_mfma_f32_16x16x32_bf16 v[72:75], a[232:235], v[184:187], v[72:75]
ds_read_b64_tr_b16 a[212:213], v242 offset:49160
v_fma_mix_f32 v199, v35, v151, v159 op_sel:[1,0,0] op_sel_hi:[1,0,0]
v_mfma_f32_16x16x32_bf16 v[104:107], a[232:235], v[188:191], v[104:107]
ds_read_b64_tr_b16 a[214:215], v242 offset:50184
v_cvt_pk_bf16_f32 v131, v198, v199
v_mfma_f32_16x16x32_bf16 a[12:15], a[236:239], v[176:179], a[12:15]
ds_read_b64_tr_b16 a[216:217], v243 offset:49152
v_fma_mix_f32 v192, v36, v144, v152 op_sel_hi:[1,0,0]
v_mfma_f32_16x16x32_bf16 a[44:47], a[236:239], v[180:183], a[44:47]
ds_read_b64_tr_b16 a[218:219], v243 offset:50176
v_fma_mix_f32 v193, v36, v145, v153 op_sel:[1,0,0] op_sel_hi:[1,0,0]
v_mfma_f32_16x16x32_bf16 v[76:79], a[236:239], v[184:187], v[76:79]
ds_read_b64_tr_b16 a[220:221], v243 offset:49160
v_cvt_pk_bf16_f32 v132, v192, v193
v_mfma_f32_16x16x32_bf16 v[108:111], a[236:239], v[188:191], v[108:111]
ds_read_b64_tr_b16 a[222:223], v243 offset:50184
v_fma_mix_f32 v194, v37, v146, v154 op_sel_hi:[1,0,0]
v_mfma_f32_16x16x32_bf16 a[16:19], a[240:243], v[176:179], a[16:19]
ds_read_b128 v[160:163], v244 offset:896
v_fma_mix_f32 v195, v37, v147, v155 op_sel:[1,0,0] op_sel_hi:[1,0,0]
v_mfma_f32_16x16x32_bf16 a[48:51], a[240:243], v[180:183], a[48:51]
ds_read_b128 v[164:167], v244 offset:912
buffer_load_dwordx4 v[16:19], v247, s[16:19], s30 offen offset:0 sc1
v_cvt_pk_bf16_f32 v133, v194, v195
v_mfma_f32_16x16x32_bf16 v[80:83], a[240:243], v[184:187], v[80:83]
ds_read_b128 v[168:171], v244 offset:4992
v_fma_mix_f32 v196, v38, v148, v156 op_sel_hi:[1,0,0]
v_mfma_f32_16x16x32_bf16 v[112:115], a[240:243], v[188:191], v[112:115]
ds_read_b128 v[172:175], v244 offset:5008
buffer_load_dwordx4 v[20:23], v247, s[16:19], s30 offen offset:1024 sc1
v_fma_mix_f32 v197, v38, v149, v157 op_sel:[1,0,0] op_sel_hi:[1,0,0]
v_mfma_f32_16x16x32_bf16 a[20:23], a[244:247], v[176:179], a[20:23]
v_cvt_pk_bf16_f32 v134, v196, v197
v_fma_mix_f32 v198, v39, v150, v158 op_sel_hi:[1,0,0]
v_mfma_f32_16x16x32_bf16 a[52:55], a[244:247], v[180:183], a[52:55]
buffer_load_dwordx4 v[24:27], v247, s[16:19], s30 offen offset:2048 sc1
v_fma_mix_f32 v199, v39, v151, v159 op_sel:[1,0,0] op_sel_hi:[1,0,0]
v_cvt_pk_bf16_f32 v135, v198, v199
v_mfma_f32_16x16x32_bf16 v[84:87], a[244:247], v[184:187], v[84:87]
v_fma_mix_f32 v192, v40, v144, v152 op_sel_hi:[1,0,0]
v_fma_mix_f32 v193, v40, v145, v153 op_sel:[1,0,0] op_sel_hi:[1,0,0]
v_mfma_f32_16x16x32_bf16 v[116:119], a[244:247], v[188:191], v[116:119]
buffer_load_dwordx4 v[28:31], v247, s[16:19], s30 offen offset:3072 sc1
v_cvt_pk_bf16_f32 v136, v192, v193
v_fma_mix_f32 v194, v41, v146, v154 op_sel_hi:[1,0,0]
v_mfma_f32_16x16x32_bf16 a[24:27], a[248:251], v[176:179], a[24:27]
s_add_u32 s30, s30, 4096
s_and_b32 s30, s30, 0xffff
s_add_u32 m0, s26, 122880
s_and_b32 s25, s25, 0x3fffff
v_fma_mix_f32 v195, v41, v147, v155 op_sel:[1,0,0] op_sel_hi:[1,0,0]
v_cvt_pk_bf16_f32 v137, v194, v195
v_mfma_f32_16x16x32_bf16 a[56:59], a[248:251], v[180:183], a[56:59]
buffer_load_dwordx4 v245, s[20:23], s25 offen lds
v_fma_mix_f32 v196, v42, v148, v156 op_sel_hi:[1,0,0]
v_fma_mix_f32 v197, v42, v149, v157 op_sel:[1,0,0] op_sel_hi:[1,0,0]
v_mfma_f32_16x16x32_bf16 v[88:91], a[248:251], v[184:187], v[88:91]
v_cvt_pk_bf16_f32 v138, v196, v197
v_fma_mix_f32 v198, v43, v150, v158 op_sel_hi:[1,0,0]
v_mfma_f32_16x16x32_bf16 v[120:123], a[248:251], v[188:191], v[120:123]
buffer_load_dwordx4 v246, s[20:23], s25 offen offset:1024 lds
v_fma_mix_f32 v199, v43, v151, v159 op_sel:[1,0,0] op_sel_hi:[1,0,0]
v_cvt_pk_bf16_f32 v139, v198, v199
v_mfma_f32_16x16x32_bf16 a[28:31], a[252:255], v[176:179], a[28:31]
s_add_u32 s25, s25, 0x40000
v_fma_mix_f32 v192, v44, v144, v152 op_sel_hi:[1,0,0]
v_fma_mix_f32 v193, v44, v145, v153 op_sel:[1,0,0] op_sel_hi:[1,0,0]
v_cvt_pk_bf16_f32 v140, v192, v193
v_mfma_f32_16x16x32_bf16 a[60:63], a[252:255], v[180:183], a[60:63]
v_fma_mix_f32 v194, v45, v146, v154 op_sel_hi:[1,0,0]
v_fma_mix_f32 v195, v45, v147, v155 op_sel:[1,0,0] op_sel_hi:[1,0,0]
v_cvt_pk_bf16_f32 v141, v194, v195
v_mfma_f32_16x16x32_bf16 v[92:95], a[252:255], v[184:187], v[92:95]
v_fma_mix_f32 v196, v46, v148, v156 op_sel_hi:[1,0,0]
v_fma_mix_f32 v197, v46, v149, v157 op_sel:[1,0,0] op_sel_hi:[1,0,0]
v_cvt_pk_bf16_f32 v142, v196, v197
v_mfma_f32_16x16x32_bf16 v[124:127], a[252:255], v[188:191], v[124:127]
v_fma_mix_f32 v198, v47, v150, v158 op_sel_hi:[1,0,0]
v_fma_mix_f32 v199, v47, v151, v159 op_sel:[1,0,0] op_sel_hi:[1,0,0]
v_cvt_pk_bf16_f32 v143, v198, v199
s_waitcnt vmcnt(14) lgkmcnt(0)
v_mfma_f32_16x16x32_bf16 a[0:3], a[192:195], v[128:131], a[0:3]
ds_read_b64_tr_b16 a[224:225], v240 offset:57344
v_fma_mix_f32 v192, v48, v160, v168 op_sel_hi:[1,0,0]
v_mfma_f32_16x16x32_bf16 a[32:35], a[192:195], v[132:135], a[32:35]
ds_read_b64_tr_b16 a[226:227], v240 offset:58368
v_fma_mix_f32 v193, v48, v161, v169 op_sel:[1,0,0] op_sel_hi:[1,0,0]
v_mfma_f32_16x16x32_bf16 v[64:67], a[192:195], v[136:139], v[64:67]
ds_read_b64_tr_b16 a[228:229], v240 offset:57352
v_cvt_pk_bf16_f32 v176, v192, v193
v_mfma_f32_16x16x32_bf16 v[96:99], a[192:195], v[140:143], v[96:99]
ds_read_b64_tr_b16 a[230:231], v240 offset:58376
v_fma_mix_f32 v194, v49, v162, v170 op_sel_hi:[1,0,0]
v_mfma_f32_16x16x32_bf16 a[4:7], a[196:199], v[128:131], a[4:7]
ds_read_b64_tr_b16 a[232:233], v241 offset:57344
v_fma_mix_f32 v195, v49, v163, v171 op_sel:[1,0,0] op_sel_hi:[1,0,0]
v_mfma_f32_16x16x32_bf16 a[36:39], a[196:199], v[132:135], a[36:39]
ds_read_b64_tr_b16 a[234:235], v241 offset:58368
v_cvt_pk_bf16_f32 v177, v194, v195
v_mfma_f32_16x16x32_bf16 v[68:71], a[196:199], v[136:139], v[68:71]
ds_read_b64_tr_b16 a[236:237], v241 offset:57352
v_fma_mix_f32 v196, v50, v164, v172 op_sel_hi:[1,0,0]
v_mfma_f32_16x16x32_bf16 v[100:103], a[196:199], v[140:143], v[100:103]
ds_read_b64_tr_b16 a[238:239], v241 offset:58376
v_fma_mix_f32 v197, v50, v165, v173 op_sel:[1,0,0] op_sel_hi:[1,0,0]
v_mfma_f32_16x16x32_bf16 a[8:11], a[200:203], v[128:131], a[8:11]
ds_read_b64_tr_b16 a[240:241], v242 offset:57344
v_cvt_pk_bf16_f32 v178, v196, v197
v_mfma_f32_16x16x32_bf16 a[40:43], a[200:203], v[132:135], a[40:43]
ds_read_b64_tr_b16 a[242:243], v242 offset:58368
v_fma_mix_f32 v198, v51, v166, v174 op_sel_hi:[1,0,0]
v_mfma_f32_16x16x32_bf16 v[72:75], a[200:203], v[136:139], v[72:75]
ds_read_b64_tr_b16 a[244:245], v242 offset:57352
v_fma_mix_f32 v199, v51, v167, v175 op_sel:[1,0,0] op_sel_hi:[1,0,0]
v_mfma_f32_16x16x32_bf16 v[104:107], a[200:203], v[140:143], v[104:107]
ds_read_b64_tr_b16 a[246:247], v242 offset:58376
v_cvt_pk_bf16_f32 v179, v198, v199
v_mfma_f32_16x16x32_bf16 a[12:15], a[204:207], v[128:131], a[12:15]
ds_read_b64_tr_b16 a[248:249], v243 offset:57344
v_fma_mix_f32 v192, v52, v160, v168 op_sel_hi:[1,0,0]
v_mfma_f32_16x16x32_bf16 a[44:47], a[204:207], v[132:135], a[44:47]
ds_read_b64_tr_b16 a[250:251], v243 offset:58368
v_fma_mix_f32 v193, v52, v161, v169 op_sel:[1,0,0] op_sel_hi:[1,0,0]
v_mfma_f32_16x16x32_bf16 v[76:79], a[204:207], v[136:139], v[76:79]
ds_read_b64_tr_b16 a[252:253], v243 offset:57352
v_cvt_pk_bf16_f32 v180, v192, v193
v_mfma_f32_16x16x32_bf16 v[108:111], a[204:207], v[140:143], v[108:111]
ds_read_b64_tr_b16 a[254:255], v243 offset:58376
v_fma_mix_f32 v194, v53, v162, v170 op_sel_hi:[1,0,0]
v_mfma_f32_16x16x32_bf16 a[16:19], a[208:211], v[128:131], a[16:19]
ds_read_b128 v[144:147], v244 offset:1024
v_fma_mix_f32 v195, v53, v163, v171 op_sel:[1,0,0] op_sel_hi:[1,0,0]
v_mfma_f32_16x16x32_bf16 a[48:51], a[208:211], v[132:135], a[48:51]
ds_read_b128 v[148:151], v244 offset:1040
buffer_load_dwordx4 v[32:35], v247, s[16:19], s30 offen offset:0 sc1
v_cvt_pk_bf16_f32 v181, v194, v195
v_mfma_f32_16x16x32_bf16 v[80:83], a[208:211], v[136:139], v[80:83]
ds_read_b128 v[152:155], v244 offset:5120
v_fma_mix_f32 v196, v54, v164, v172 op_sel_hi:[1,0,0]
v_mfma_f32_16x16x32_bf16 v[112:115], a[208:211], v[140:143], v[112:115]
ds_read_b128 v[156:159], v244 offset:5136
buffer_load_dwordx4 v[36:39], v247, s[16:19], s30 offen offset:1024 sc1
v_fma_mix_f32 v197, v54, v165, v173 op_sel:[1,0,0] op_sel_hi:[1,0,0]
v_mfma_f32_16x16x32_bf16 a[20:23], a[212:215], v[128:131], a[20:23]
v_cvt_pk_bf16_f32 v182, v196, v197
v_fma_mix_f32 v198, v55, v166, v174 op_sel_hi:[1,0,0]
v_mfma_f32_16x16x32_bf16 a[52:55], a[212:215], v[132:135], a[52:55]
buffer_load_dwordx4 v[40:43], v247, s[16:19], s30 offen offset:2048 sc1
v_fma_mix_f32 v199, v55, v167, v175 op_sel:[1,0,0] op_sel_hi:[1,0,0]
v_cvt_pk_bf16_f32 v183, v198, v199
v_mfma_f32_16x16x32_bf16 v[84:87], a[212:215], v[136:139], v[84:87]
v_fma_mix_f32 v192, v56, v160, v168 op_sel_hi:[1,0,0]
v_fma_mix_f32 v193, v56, v161, v169 op_sel:[1,0,0] op_sel_hi:[1,0,0]
v_mfma_f32_16x16x32_bf16 v[116:119], a[212:215], v[140:143], v[116:119]
buffer_load_dwordx4 v[44:47], v247, s[16:19], s30 offen offset:3072 sc1
v_cvt_pk_bf16_f32 v184, v192, v193
v_fma_mix_f32 v194, v57, v162, v170 op_sel_hi:[1,0,0]
v_mfma_f32_16x16x32_bf16 a[24:27], a[216:219], v[128:131], a[24:27]
s_add_u32 s30, s30, 4096
s_and_b32 s30, s30, 0xffff
s_add_u32 m0, s26, 131072
s_and_b32 s25, s25, 0x3fffff
v_fma_mix_f32 v195, v57, v163, v171 op_sel:[1,0,0] op_sel_hi:[1,0,0]
v_cvt_pk_bf16_f32 v185, v194, v195
v_mfma_f32_16x16x32_bf16 a[56:59], a[216:219], v[132:135], a[56:59]
buffer_load_dwordx4 v245, s[20:23], s25 offen lds
v_fma_mix_f32 v196, v58, v164, v172 op_sel_hi:[1,0,0]
v_fma_mix_f32 v197, v58, v165, v173 op_sel:[1,0,0] op_sel_hi:[1,0,0]
v_mfma_f32_16x16x32_bf16 v[88:91], a[216:219], v[136:139], v[88:91]
v_cvt_pk_bf16_f32 v186, v196, v197
v_fma_mix_f32 v198, v59, v166, v174 op_sel_hi:[1,0,0]
v_mfma_f32_16x16x32_bf16 v[120:123], a[216:219], v[140:143], v[120:123]
buffer_load_dwordx4 v246, s[20:23], s25 offen offset:1024 lds
v_fma_mix_f32 v199, v59, v167, v175 op_sel:[1,0,0] op_sel_hi:[1,0,0]
v_cvt_pk_bf16_f32 v187, v198, v199
v_mfma_f32_16x16x32_bf16 a[28:31], a[220:223], v[128:131], a[28:31]
s_add_u32 s25, s25, 0x40000
v_fma_mix_f32 v192, v60, v160, v168 op_sel_hi:[1,0,0]
v_fma_mix_f32 v193, v60, v161, v169 op_sel:[1,0,0] op_sel_hi:[1,0,0]
v_cvt_pk_bf16_f32 v188, v192, v193
v_mfma_f32_16x16x32_bf16 a[60:63], a[220:223], v[132:135], a[60:63]
v_fma_mix_f32 v194, v61, v162, v170 op_sel_hi:[1,0,0]
v_fma_mix_f32 v195, v61, v163, v171 op_sel:[1,0,0] op_sel_hi:[1,0,0]
v_cvt_pk_bf16_f32 v189, v194, v195
v_mfma_f32_16x16x32_bf16 v[92:95], a[220:223], v[136:139], v[92:95]
v_fma_mix_f32 v196, v62, v164, v172 op_sel_hi:[1,0,0]
v_fma_mix_f32 v197, v62, v165, v173 op_sel:[1,0,0] op_sel_hi:[1,0,0]
v_cvt_pk_bf16_f32 v190, v196, v197
v_mfma_f32_16x16x32_bf16 v[124:127], a[220:223], v[140:143], v[124:127]
v_fma_mix_f32 v198, v63, v166, v174 op_sel_hi:[1,0,0]
v_fma_mix_f32 v199, v63, v167, v175 op_sel:[1,0,0] op_sel_hi:[1,0,0]
v_cvt_pk_bf16_f32 v191, v198, v199
s_waitcnt vmcnt(14) lgkmcnt(0)
s_barrier
v_add_u32 v240, 0x10000, v240
v_add_u32 v241, 0x10000, v241
v_add_u32 v242, 0x10000, v242
v_add_u32 v243, 0x10000, v243
v_mfma_f32_16x16x32_bf16 a[0:3], a[224:227], v[176:179], a[0:3]
ds_read_b64_tr_b16 a[192:193], v240 offset:0
v_fma_mix_f32 v192, v0, v144, v152 op_sel_hi:[1,0,0]
v_mfma_f32_16x16x32_bf16 a[32:35], a[224:227], v[180:183], a[32:35]
ds_read_b64_tr_b16 a[194:195], v240 offset:1024
v_fma_mix_f32 v193, v0, v145, v153 op_sel:[1,0,0] op_sel_hi:[1,0,0]
v_mfma_f32_16x16x32_bf16 v[64:67], a[224:227], v[184:187], v[64:67]
ds_read_b64_tr_b16 a[196:197], v240 offset:8
v_cvt_pk_bf16_f32 v128, v192, v193
v_mfma_f32_16x16x32_bf16 v[96:99], a[224:227], v[188:191], v[96:99]
ds_read_b64_tr_b16 a[198:199], v240 offset:1032
v_fma_mix_f32 v194, v1, v146, v154 op_sel_hi:[1,0,0]
v_mfma_f32_16x16x32_bf16 a[4:7], a[228:231], v[176:179], a[4:7]
ds_read_b64_tr_b16 a[200:201], v241 offset:0
v_fma_mix_f32 v195, v1, v147, v155 op_sel:[1,0,0] op_sel_hi:[1,0,0]
v_mfma_f32_16x16x32_bf16 a[36:39], a[228:231], v[180:183], a[36:39]
ds_read_b64_tr_b16 a[202:203], v241 offset:1024
v_cvt_pk_bf16_f32 v129, v194, v195
v_mfma_f32_16x16x32_bf16 v[68:71], a[228:231], v[184:187], v[68:71]
ds_read_b64_tr_b16 a[204:205], v241 offset:8
v_fma_mix_f32 v196, v2, v148, v156 op_sel_hi:[1,0,0]
v_mfma_f32_16x16x32_bf16 v[100:103], a[228:231], v[188:191], v[100:103]
ds_read_b64_tr_b16 a[206:207], v241 offset:1032
v_fma_mix_f32 v197, v2, v149, v157 op_sel:[1,0,0] op_sel_hi:[1,0,0]
v_mfma_f32_16x16x32_bf16 a[8:11], a[232:235], v[176:179], a[8:11]
ds_read_b64_tr_b16 a[208:209], v242 offset:0
v_cvt_pk_bf16_f32 v130, v196, v197
v_mfma_f32_16x16x32_bf16 a[40:43], a[232:235], v[180:183], a[40:43]
ds_read_b64_tr_b16 a[210:211], v242 offset:1024
v_fma_mix_f32 v198, v3, v150, v158 op_sel_hi:[1,0,0]
v_mfma_f32_16x16x32_bf16 v[72:75], a[232:235], v[184:187], v[72:75]
ds_read_b64_tr_b16 a[212:213], v242 offset:8
v_fma_mix_f32 v199, v3, v151, v159 op_sel:[1,0,0] op_sel_hi:[1,0,0]
v_mfma_f32_16x16x32_bf16 v[104:107], a[232:235], v[188:191], v[104:107]
ds_read_b64_tr_b16 a[214:215], v242 offset:1032
v_cvt_pk_bf16_f32 v131, v198, v199
v_mfma_f32_16x16x32_bf16 a[12:15], a[236:239], v[176:179], a[12:15]
ds_read_b64_tr_b16 a[216:217], v243 offset:0
v_fma_mix_f32 v192, v4, v144, v152 op_sel_hi:[1,0,0]
v_mfma_f32_16x16x32_bf16 a[44:47], a[236:239], v[180:183], a[44:47]
ds_read_b64_tr_b16 a[218:219], v243 offset:1024
v_fma_mix_f32 v193, v4, v145, v153 op_sel:[1,0,0] op_sel_hi:[1,0,0]
v_mfma_f32_16x16x32_bf16 v[76:79], a[236:239], v[184:187], v[76:79]
ds_read_b64_tr_b16 a[220:221], v243 offset:8
v_cvt_pk_bf16_f32 v132, v192, v193
v_mfma_f32_16x16x32_bf16 v[108:111], a[236:239], v[188:191], v[108:111]
ds_read_b64_tr_b16 a[222:223], v243 offset:1032
v_fma_mix_f32 v194, v5, v146, v154 op_sel_hi:[1,0,0]
v_mfma_f32_16x16x32_bf16 a[16:19], a[240:243], v[176:179], a[16:19]
ds_read_b128 v[160:163], v244 offset:1152
v_fma_mix_f32 v195, v5, v147, v155 op_sel:[1,0,0] op_sel_hi:[1,0,0]
v_mfma_f32_16x16x32_bf16 a[48:51], a[240:243], v[180:183], a[48:51]
ds_read_b128 v[164:167], v244 offset:1168
buffer_load_dwordx4 v[48:51], v247, s[16:19], s30 offen offset:0 sc1
v_cvt_pk_bf16_f32 v133, v194, v195
Lpad2:
s_cbranch_execz Lpad6
v_mfma_f32_16x16x32_bf16 v[80:83], a[240:243], v[184:187], v[80:83]
ds_read_b128 v[168:171], v244 offset:5248
v_fma_mix_f32 v196, v6, v148, v156 op_sel_hi:[1,0,0]
v_mfma_f32_16x16x32_bf16 v[112:115], a[240:243], v[188:191], v[112:115]
ds_read_b128 v[172:175], v244 offset:5264
buffer_load_dwordx4 v[52:55], v247, s[16:19], s30 offen offset:1024 sc1
v_fma_mix_f32 v197, v6, v149, v157 op_sel:[1,0,0] op_sel_hi:[1,0,0]
v_mfma_f32_16x16x32_bf16 a[20:23], a[244:247], v[176:179], a[20:23]
v_cvt_pk_bf16_f32 v134, v196, v197
v_fma_mix_f32 v198, v7, v150, v158 op_sel_hi:[1,0,0]
v_mfma_f32_16x16x32_bf16 a[52:55], a[244:247], v[180:183], a[52:55]
buffer_load_dwordx4 v[56:59], v247, s[16:19], s30 offen offset:2048 sc1
v_fma_mix_f32 v199, v7, v151, v159 op_sel:[1,0,0] op_sel_hi:[1,0,0]
v_cvt_pk_bf16_f32 v135, v198, v199
v_mfma_f32_16x16x32_bf16 v[84:87], a[244:247], v[184:187], v[84:87]
v_fma_mix_f32 v192, v8, v144, v152 op_sel_hi:[1,0,0]
v_fma_mix_f32 v193, v8, v145, v153 op_sel:[1,0,0] op_sel_hi:[1,0,0]
v_mfma_f32_16x16x32_bf16 v[116:119], a[244:247], v[188:191], v[116:119]
buffer_load_dwordx4 v[60:63], v247, s[16:19], s30 offen offset:3072 sc1
v_cvt_pk_bf16_f32 v136, v192, v193
v_fma_mix_f32 v194, v9, v146, v154 op_sel_hi:[1,0,0]
v_mfma_f32_16x16x32_bf16 a[24:27], a[248:251], v[176:179], a[24:27]
s_add_u32 s30, s30, 4096
s_and_b32 s30, s30, 0xffff
s_add_u32 m0, s26, 139264
s_and_b32 s25, s25, 0x3fffff
v_fma_mix_f32 v195, v9, v147, v155 op_sel:[1,0,0] op_sel_hi:[1,0,0]
v_cvt_pk_bf16_f32 v137, v194, v195
v_mfma_f32_16x16x32_bf16 a[56:59], a[248:251], v[180:183], a[56:59]
buffer_load_dwordx4 v245, s[20:23], s25 offen lds
v_fma_mix_f32 v196, v10, v148, v156 op_sel_hi:[1,0,0]
v_fma_mix_f32 v197, v10, v149, v157 op_sel:[1,0,0] op_sel_hi:[1,0,0]
v_mfma_f32_16x16x32_bf16 v[88:91], a[248:251], v[184:187], v[88:91]
v_cvt_pk_bf16_f32 v138, v196, v197
v_fma_mix_f32 v198, v11, v150, v158 op_sel_hi:[1,0,0]
v_mfma_f32_16x16x32_bf16 v[120:123], a[248:251], v[188:191], v[120:123]
buffer_load_dwordx4 v246, s[20:23], s25 offen offset:1024 lds
v_fma_mix_f32 v199, v11, v151, v159 op_sel:[1,0,0] op_sel_hi:[1,0,0]
v_cvt_pk_bf16_f32 v139, v198, v199
v_mfma_f32_16x16x32_bf16 a[28:31], a[252:255], v[176:179], a[28:31]
s_add_u32 s25, s25, 0x40000
v_fma_mix_f32 v192, v12, v144, v152 op_sel_hi:[1,0,0]
v_fma_mix_f32 v193, v12, v145, v153 op_sel:[1,0,0] op_sel_hi:[1,0,0]
v_cvt_pk_bf16_f32 v140, v192, v193
v_mfma_f32_16x16x32_bf16 a[60:63], a[252:255], v[180:183], a[60:63]
v_fma_mix_f32 v194, v13, v146, v154 op_sel_hi:[1,0,0]
v_fma_mix_f32 v195, v13, v147, v155 op_sel:[1,0,0] op_sel_hi:[1,0,0]
v_cvt_pk_bf16_f32 v141, v194, v195
v_mfma_f32_16x16x32_bf16 v[92:95], a[252:255], v[184:187], v[92:95]
v_fma_mix_f32 v196, v14, v148, v156 op_sel_hi:[1,0,0]
v_fma_mix_f32 v197, v14, v149, v157 op_sel:[1,0,0] op_sel_hi:[1,0,0]
v_cvt_pk_bf16_f32 v142, v196, v197
v_mfma_f32_16x16x32_bf16 v[124:127], a[252:255], v[188:191], v[124:127]
v_fma_mix_f32 v198, v15, v150, v158 op_sel_hi:[1,0,0]
v_fma_mix_f32 v199, v15, v151, v159 op_sel:[1,0,0] op_sel_hi:[1,0,0]
v_cvt_pk_bf16_f32 v143, v198, v199
s_waitcnt vmcnt(14) lgkmcnt(0)
v_mfma_f32_16x16x32_bf16 a[0:3], a[192:195], v[128:131], a[0:3]
ds_read_b64_tr_b16 a[224:225], v240 offset:8192
v_fma_mix_f32 v192, v16, v160, v168 op_sel_hi:[1,0,0]
v_mfma_f32_16x16x32_bf16 a[32:35], a[192:195], v[132:135], a[32:35]
ds_read_b64_tr_b16 a[226:227], v240 offset:9216
v_fma_mix_f32 v193, v16, v161, v169 op_sel:[1,0,0] op_sel_hi:[1,0,0]
v_mfma_f32_16x16x32_bf16 v[64:67], a[192:195], v[136:139], v[64:67]
ds_read_b64_tr_b16 a[228:229], v240 offset:8200
v_cvt_pk_bf16_f32 v176, v192, v193
v_mfma_f32_16x16x32_bf16 v[96:99], a[192:195], v[140:143], v[96:99]
ds_read_b64_tr_b16 a[230:231], v240 offset:9224
v_fma_mix_f32 v194, v17, v162, v170 op_sel_hi:[1,0,0]
v_mfma_f32_16x16x32_bf16 a[4:7], a[196:199], v[128:131], a[4:7]
ds_read_b64_tr_b16 a[232:233], v241 offset:8192
v_fma_mix_f32 v195, v17, v163, v171 op_sel:[1,0,0] op_sel_hi:[1,0,0]
v_mfma_f32_16x16x32_bf16 a[36:39], a[196:199], v[132:135], a[36:39]
ds_read_b64_tr_b16 a[234:235], v241 offset:9216
v_cvt_pk_bf16_f32 v177, v194, v195
v_mfma_f32_16x16x32_bf16 v[68:71], a[196:199], v[136:139], v[68:71]
ds_read_b64_tr_b16 a[236:237], v241 offset:8200
v_fma_mix_f32 v196, v18, v164, v172 op_sel_hi:[1,0,0]
v_mfma_f32_16x16x32_bf16 v[100:103], a[196:199], v[140:143], v[100:103]
ds_read_b64_tr_b16 a[238:239], v241 offset:9224
v_fma_mix_f32 v197, v18, v165, v173 op_sel:[1,0,0] op_sel_hi:[1,0,0]
v_mfma_f32_16x16x32_bf16 a[8:11], a[200:203], v[128:131], a[8:11]
ds_read_b64_tr_b16 a[240:241], v242 offset:8192
v_cvt_pk_bf16_f32 v178, v196, v197
v_mfma_f32_16x16x32_bf16 a[40:43], a[200:203], v[132:135], a[40:43]
ds_read_b64_tr_b16 a[242:243], v242 offset:9216
v_fma_mix_f32 v198, v19, v166, v174 op_sel_hi:[1,0,0]
v_mfma_f32_16x16x32_bf16 v[72:75], a[200:203], v[136:139], v[72:75]
ds_read_b64_tr_b16 a[244:245], v242 offset:8200
v_fma_mix_f32 v199, v19, v167, v175 op_sel:[1,0,0] op_sel_hi:[1,0,0]
v_mfma_f32_16x16x32_bf16 v[104:107], a[200:203], v[140:143], v[104:107]
ds_read_b64_tr_b16 a[246:247], v242 offset:9224
v_cvt_pk_bf16_f32 v179, v198, v199
v_mfma_f32_16x16x32_bf16 a[12:15], a[204:207], v[128:131], a[12:15]
ds_read_b64_tr_b16 a[248:249], v243 offset:8192
v_fma_mix_f32 v192, v20, v160, v168 op_sel_hi:[1,0,0]
v_mfma_f32_16x16x32_bf16 a[44:47], a[204:207], v[132:135], a[44:47]
ds_read_b64_tr_b16 a[250:251], v243 offset:9216
v_fma_mix_f32 v193, v20, v161, v169 op_sel:[1,0,0] op_sel_hi:[1,0,0]
v_mfma_f32_16x16x32_bf16 v[76:79], a[204:207], v[136:139], v[76:79]
ds_read_b64_tr_b16 a[252:253], v243 offset:8200
v_cvt_pk_bf16_f32 v180, v192, v193
v_mfma_f32_16x16x32_bf16 v[108:111], a[204:207], v[140:143], v[108:111]
ds_read_b64_tr_b16 a[254:255], v243 offset:9224
v_fma_mix_f32 v194, v21, v162, v170 op_sel_hi:[1,0,0]
v_mfma_f32_16x16x32_bf16 a[16:19], a[208:211], v[128:131], a[16:19]
ds_read_b128 v[144:147], v244 offset:1280
v_fma_mix_f32 v195, v21, v163, v171 op_sel:[1,0,0] op_sel_hi:[1,0,0]
v_mfma_f32_16x16x32_bf16 a[48:51], a[208:211], v[132:135], a[48:51]
ds_read_b128 v[148:151], v244 offset:1296
buffer_load_dwordx4 v[0:3], v247, s[16:19], s30 offen offset:0 sc1
v_cvt_pk_bf16_f32 v181, v194, v195
v_mfma_f32_16x16x32_bf16 v[80:83], a[208:211], v[136:139], v[80:83]
ds_read_b128 v[152:155], v244 offset:5376
v_fma_mix_f32 v196, v22, v164, v172 op_sel_hi:[1,0,0]
v_mfma_f32_16x16x32_bf16 v[112:115], a[208:211], v[140:143], v[112:115]
ds_read_b128 v[156:159], v244 offset:5392
buffer_load_dwordx4 v[4:7], v247, s[16:19], s30 offen offset:1024 sc1
v_fma_mix_f32 v197, v22, v165, v173 op_sel:[1,0,0] op_sel_hi:[1,0,0]
v_mfma_f32_16x16x32_bf16 a[20:23], a[212:215], v[128:131], a[20:23]
v_cvt_pk_bf16_f32 v182, v196, v197
v_fma_mix_f32 v198, v23, v166, v174 op_sel_hi:[1,0,0]
v_mfma_f32_16x16x32_bf16 a[52:55], a[212:215], v[132:135], a[52:55]
buffer_load_dwordx4 v[8:11], v247, s[16:19], s30 offen offset:2048 sc1
v_fma_mix_f32 v199, v23, v167, v175 op_sel:[1,0,0] op_sel_hi:[1,0,0]
v_cvt_pk_bf16_f32 v183, v198, v199
v_mfma_f32_16x16x32_bf16 v[84:87], a[212:215], v[136:139], v[84:87]
v_fma_mix_f32 v192, v24, v160, v168 op_sel_hi:[1,0,0]
v_fma_mix_f32 v193, v24, v161, v169 op_sel:[1,0,0] op_sel_hi:[1,0,0]
v_mfma_f32_16x16x32_bf16 v[116:119], a[212:215], v[140:143], v[116:119]
buffer_load_dwordx4 v[12:15], v247, s[16:19], s30 offen offset:3072 sc1
v_cvt_pk_bf16_f32 v184, v192, v193
v_fma_mix_f32 v194, v25, v162, v170 op_sel_hi:[1,0,0]
v_mfma_f32_16x16x32_bf16 a[24:27], a[216:219], v[128:131], a[24:27]
s_add_u32 s30, s30, 4096
s_and_b32 s30, s30, 0xffff
s_add_u32 m0, s26, 147456
s_and_b32 s25, s25, 0x3fffff
v_fma_mix_f32 v195, v25, v163, v171 op_sel:[1,0,0] op_sel_hi:[1,0,0]
v_cvt_pk_bf16_f32 v185, v194, v195
v_mfma_f32_16x16x32_bf16 a[56:59], a[216:219], v[132:135], a[56:59]
buffer_load_dwordx4 v245, s[20:23], s25 offen lds
v_fma_mix_f32 v196, v26, v164, v172 op_sel_hi:[1,0,0]
v_fma_mix_f32 v197, v26, v165, v173 op_sel:[1,0,0] op_sel_hi:[1,0,0]
v_mfma_f32_16x16x32_bf16 v[88:91], a[216:219], v[136:139], v[88:91]
v_cvt_pk_bf16_f32 v186, v196, v197
v_fma_mix_f32 v198, v27, v166, v174 op_sel_hi:[1,0,0]
v_mfma_f32_16x16x32_bf16 v[120:123], a[216:219], v[140:143], v[120:123]
buffer_load_dwordx4 v246, s[20:23], s25 offen offset:1024 lds
v_fma_mix_f32 v199, v27, v167, v175 op_sel:[1,0,0] op_sel_hi:[1,0,0]
v_cvt_pk_bf16_f32 v187, v198, v199
v_mfma_f32_16x16x32_bf16 a[28:31], a[220:223], v[128:131], a[28:31]
s_add_u32 s25, s25, 0x40000
v_fma_mix_f32 v192, v28, v160, v168 op_sel_hi:[1,0,0]
v_fma_mix_f32 v193, v28, v161, v169 op_sel:[1,0,0] op_sel_hi:[1,0,0]
v_cvt_pk_bf16_f32 v188, v192, v193
v_mfma_f32_16x16x32_bf16 a[60:63], a[220:223], v[132:135], a[60:63]
v_fma_mix_f32 v194, v29, v162, v170 op_sel_hi:[1,0,0]
v_fma_mix_f32 v195, v29, v163, v171 op_sel:[1,0,0] op_sel_hi:[1,0,0]
v_cvt_pk_bf16_f32 v189, v194, v195
v_mfma_f32_16x16x32_bf16 v[92:95], a[220:223], v[136:139], v[92:95]
v_fma_mix_f32 v196, v30, v164, v172 op_sel_hi:[1,0,0]
v_fma_mix_f32 v197, v30, v165, v173 op_sel:[1,0,0] op_sel_hi:[1,0,0]
v_cvt_pk_bf16_f32 v190, v196, v197
v_mfma_f32_16x16x32_bf16 v[124:127], a[220:223], v[140:143], v[124:127]
v_fma_mix_f32 v198, v31, v166, v174 op_sel_hi:[1,0,0]
v_fma_mix_f32 v199, v31, v167, v175 op_sel:[1,0,0] op_sel_hi:[1,0,0]
v_cvt_pk_bf16_f32 v191, v198, v199
s_waitcnt vmcnt(14) lgkmcnt(0)
s_barrier
v_mfma_f32_16x16x32_bf16 a[0:3], a[224:227], v[176:179], a[0:3]
ds_read_b64_tr_b16 a[192:193], v240 offset:16384
v_fma_mix_f32 v192, v32, v144, v152 op_sel_hi:[1,0,0]
v_mfma_f32_16x16x32_bf16 a[32:35], a[224:227], v[180:183], a[32:35]
ds_read_b64_tr_b16 a[194:195], v240 offset:17408
v_fma_mix_f32 v193, v32, v145, v153 op_sel:[1,0,0] op_sel_hi:[1,0,0]
v_mfma_f32_16x16x32_bf16 v[64:67], a[224:227], v[184:187], v[64:67]
ds_read_b64_tr_b16 a[196:197], v240 offset:16392
v_cvt_pk_bf16_f32 v128, v192, v193
v_mfma_f32_16x16x32_bf16 v[96:99], a[224:227], v[188:191], v[96:99]
ds_read_b64_tr_b16 a[198:199], v240 offset:17416
v_fma_mix_f32 v194, v33, v146, v154 op_sel_hi:[1,0,0]
v_mfma_f32_16x16x32_bf16 a[4:7], a[228:231], v[176:179], a[4:7]
ds_read_b64_tr_b16 a[200:201], v241 offset:16384
v_fma_mix_f32 v195, v33, v147, v155 op_sel:[1,0,0] op_sel_hi:[1,0,0]
v_mfma_f32_16x16x32_bf16 a[36:39], a[228:231], v[180:183], a[36:39]
ds_read_b64_tr_b16 a[202:203], v241 offset:17408
v_cvt_pk_bf16_f32 v129, v194, v195
v_mfma_f32_16x16x32_bf16 v[68:71], a[228:231], v[184:187], v[68:71]
ds_read_b64_tr_b16 a[204:205], v241 offset:16392
v_fma_mix_f32 v196, v34, v148, v156 op_sel_hi:[1,0,0]
v_mfma_f32_16x16x32_bf16 v[100:103], a[228:231], v[188:191], v[100:103]
ds_read_b64_tr_b16 a[206:207], v241 offset:17416
v_fma_mix_f32 v197, v34, v149, v157 op_sel:[1,0,0] op_sel_hi:[1,0,0]
v_mfma_f32_16x16x32_bf16 a[8:11], a[232:235], v[176:179], a[8:11]
ds_read_b64_tr_b16 a[208:209], v242 offset:16384
v_cvt_pk_bf16_f32 v130, v196, v197
v_mfma_f32_16x16x32_bf16 a[40:43], a[232:235], v[180:183], a[40:43]
ds_read_b64_tr_b16 a[210:211], v242 offset:17408
v_fma_mix_f32 v198, v35, v150, v158 op_sel_hi:[1,0,0]
v_mfma_f32_16x16x32_bf16 v[72:75], a[232:235], v[184:187], v[72:75]
ds_read_b64_tr_b16 a[212:213], v242 offset:16392
v_fma_mix_f32 v199, v35, v151, v159 op_sel:[1,0,0] op_sel_hi:[1,0,0]
v_mfma_f32_16x16x32_bf16 v[104:107], a[232:235], v[188:191], v[104:107]
ds_read_b64_tr_b16 a[214:215], v242 offset:17416
v_cvt_pk_bf16_f32 v131, v198, v199
v_mfma_f32_16x16x32_bf16 a[12:15], a[236:239], v[176:179], a[12:15]
ds_read_b64_tr_b16 a[216:217], v243 offset:16384
v_fma_mix_f32 v192, v36, v144, v152 op_sel_hi:[1,0,0]
v_mfma_f32_16x16x32_bf16 a[44:47], a[236:239], v[180:183], a[44:47]
ds_read_b64_tr_b16 a[218:219], v243 offset:17408
v_fma_mix_f32 v193, v36, v145, v153 op_sel:[1,0,0] op_sel_hi:[1,0,0]
v_mfma_f32_16x16x32_bf16 v[76:79], a[236:239], v[184:187], v[76:79]
ds_read_b64_tr_b16 a[220:221], v243 offset:16392
v_cvt_pk_bf16_f32 v132, v192, v193
v_mfma_f32_16x16x32_bf16 v[108:111], a[236:239], v[188:191], v[108:111]
ds_read_b64_tr_b16 a[222:223], v243 offset:17416
v_fma_mix_f32 v194, v37, v146, v154 op_sel_hi:[1,0,0]
v_mfma_f32_16x16x32_bf16 a[16:19], a[240:243], v[176:179], a[16:19]
ds_read_b128 v[160:163], v244 offset:1408
v_fma_mix_f32 v195, v37, v147, v155 op_sel:[1,0,0] op_sel_hi:[1,0,0]
v_mfma_f32_16x16x32_bf16 a[48:51], a[240:243], v[180:183], a[48:51]
ds_read_b128 v[164:167], v244 offset:1424
buffer_load_dwordx4 v[16:19], v247, s[16:19], s30 offen offset:0 sc1
v_cvt_pk_bf16_f32 v133, v194, v195
v_mfma_f32_16x16x32_bf16 v[80:83], a[240:243], v[184:187], v[80:83]
ds_read_b128 v[168:171], v244 offset:5504
v_fma_mix_f32 v196, v38, v148, v156 op_sel_hi:[1,0,0]
v_mfma_f32_16x16x32_bf16 v[112:115], a[240:243], v[188:191], v[112:115]
ds_read_b128 v[172:175], v244 offset:5520
buffer_load_dwordx4 v[20:23], v247, s[16:19], s30 offen offset:1024 sc1
v_fma_mix_f32 v197, v38, v149, v157 op_sel:[1,0,0] op_sel_hi:[1,0,0]
v_mfma_f32_16x16x32_bf16 a[20:23], a[244:247], v[176:179], a[20:23]
v_cvt_pk_bf16_f32 v134, v196, v197
v_fma_mix_f32 v198, v39, v150, v158 op_sel_hi:[1,0,0]
v_mfma_f32_16x16x32_bf16 a[52:55], a[244:247], v[180:183], a[52:55]
buffer_load_dwordx4 v[24:27], v247, s[16:19], s30 offen offset:2048 sc1
v_fma_mix_f32 v199, v39, v151, v159 op_sel:[1,0,0] op_sel_hi:[1,0,0]
v_cvt_pk_bf16_f32 v135, v198, v199
v_mfma_f32_16x16x32_bf16 v[84:87], a[244:247], v[184:187], v[84:87]
v_fma_mix_f32 v192, v40, v144, v152 op_sel_hi:[1,0,0]
v_fma_mix_f32 v193, v40, v145, v153 op_sel:[1,0,0] op_sel_hi:[1,0,0]
v_mfma_f32_16x16x32_bf16 v[116:119], a[244:247], v[188:191], v[116:119]
buffer_load_dwordx4 v[28:31], v247, s[16:19], s30 offen offset:3072 sc1
v_cvt_pk_bf16_f32 v136, v192, v193
v_fma_mix_f32 v194, v41, v146, v154 op_sel_hi:[1,0,0]
v_mfma_f32_16x16x32_bf16 a[24:27], a[248:251], v[176:179], a[24:27]
s_add_u32 s30, s30, 4096
s_and_b32 s30, s30, 0xffff
s_add_u32 m0, s26, 155648
s_and_b32 s25, s25, 0x3fffff
v_fma_mix_f32 v195, v41, v147, v155 op_sel:[1,0,0] op_sel_hi:[1,0,0]
v_cvt_pk_bf16_f32 v137, v194, v195
v_mfma_f32_16x16x32_bf16 a[56:59], a[248:251], v[180:183], a[56:59]
buffer_load_dwordx4 v245, s[20:23], s25 offen lds
v_fma_mix_f32 v196, v42, v148, v156 op_sel_hi:[1,0,0]
v_fma_mix_f32 v197, v42, v149, v157 op_sel:[1,0,0] op_sel_hi:[1,0,0]
v_mfma_f32_16x16x32_bf16 v[88:91], a[248:251], v[184:187], v[88:91]
v_cvt_pk_bf16_f32 v138, v196, v197
v_fma_mix_f32 v198, v43, v150, v158 op_sel_hi:[1,0,0]
v_mfma_f32_16x16x32_bf16 v[120:123], a[248:251], v[188:191], v[120:123]
buffer_load_dwordx4 v246, s[20:23], s25 offen offset:1024 lds
v_fma_mix_f32 v199, v43, v151, v159 op_sel:[1,0,0] op_sel_hi:[1,0,0]
v_cvt_pk_bf16_f32 v139, v198, v199
v_mfma_f32_16x16x32_bf16 a[28:31], a[252:255], v[176:179], a[28:31]
s_add_u32 s25, s25, 0x40000
v_fma_mix_f32 v192, v44, v144, v152 op_sel_hi:[1,0,0]
v_fma_mix_f32 v193, v44, v145, v153 op_sel:[1,0,0] op_sel_hi:[1,0,0]
v_cvt_pk_bf16_f32 v140, v192, v193
v_mfma_f32_16x16x32_bf16 a[60:63], a[252:255], v[180:183], a[60:63]
v_fma_mix_f32 v194, v45, v146, v154 op_sel_hi:[1,0,0]
v_fma_mix_f32 v195, v45, v147, v155 op_sel:[1,0,0] op_sel_hi:[1,0,0]
v_cvt_pk_bf16_f32 v141, v194, v195
v_mfma_f32_16x16x32_bf16 v[92:95], a[252:255], v[184:187], v[92:95]
v_fma_mix_f32 v196, v46, v148, v156 op_sel_hi:[1,0,0]
v_fma_mix_f32 v197, v46, v149, v157 op_sel:[1,0,0] op_sel_hi:[1,0,0]
v_cvt_pk_bf16_f32 v142, v196, v197
v_mfma_f32_16x16x32_bf16 v[124:127], a[252:255], v[188:191], v[124:127]
v_fma_mix_f32 v198, v47, v150, v158 op_sel_hi:[1,0,0]
v_fma_mix_f32 v199, v47, v151, v159 op_sel:[1,0,0] op_sel_hi:[1,0,0]
v_cvt_pk_bf16_f32 v143, v198, v199
s_waitcnt vmcnt(14) lgkmcnt(0)
v_mfma_f32_16x16x32_bf16 a[0:3], a[192:195], v[128:131], a[0:3]
ds_read_b64_tr_b16 a[224:225], v240 offset:24576
v_fma_mix_f32 v192, v48, v160, v168 op_sel_hi:[1,0,0]
v_mfma_f32_16x16x32_bf16 a[32:35], a[192:195], v[132:135], a[32:35]
ds_read_b64_tr_b16 a[226:227], v240 offset:25600
v_fma_mix_f32 v193, v48, v161, v169 op_sel:[1,0,0] op_sel_hi:[1,0,0]
v_mfma_f32_16x16x32_bf16 v[64:67], a[192:195], v[136:139], v[64:67]
ds_read_b64_tr_b16 a[228:229], v240 offset:24584
v_cvt_pk_bf16_f32 v176, v192, v193
v_mfma_f32_16x16x32_bf16 v[96:99], a[192:195], v[140:143], v[96:99]
ds_read_b64_tr_b16 a[230:231], v240 offset:25608
v_fma_mix_f32 v194, v49, v162, v170 op_sel_hi:[1,0,0]
v_mfma_f32_16x16x32_bf16 a[4:7], a[196:199], v[128:131], a[4:7]
ds_read_b64_tr_b16 a[232:233], v241 offset:24576
v_fma_mix_f32 v195, v49, v163, v171 op_sel:[1,0,0] op_sel_hi:[1,0,0]
v_mfma_f32_16x16x32_bf16 a[36:39], a[196:199], v[132:135], a[36:39]
ds_read_b64_tr_b16 a[234:235], v241 offset:25600
v_cvt_pk_bf16_f32 v177, v194, v195
v_mfma_f32_16x16x32_bf16 v[68:71], a[196:199], v[136:139], v[68:71]
ds_read_b64_tr_b16 a[236:237], v241 offset:24584
v_fma_mix_f32 v196, v50, v164, v172 op_sel_hi:[1,0,0]
v_mfma_f32_16x16x32_bf16 v[100:103], a[196:199], v[140:143], v[100:103]
ds_read_b64_tr_b16 a[238:239], v241 offset:25608
v_fma_mix_f32 v197, v50, v165, v173 op_sel:[1,0,0] op_sel_hi:[1,0,0]
v_mfma_f32_16x16x32_bf16 a[8:11], a[200:203], v[128:131], a[8:11]
ds_read_b64_tr_b16 a[240:241], v242 offset:24576
v_cvt_pk_bf16_f32 v178, v196, v197
v_mfma_f32_16x16x32_bf16 a[40:43], a[200:203], v[132:135], a[40:43]
ds_read_b64_tr_b16 a[242:243], v242 offset:25600
v_fma_mix_f32 v198, v51, v166, v174 op_sel_hi:[1,0,0]
v_mfma_f32_16x16x32_bf16 v[72:75], a[200:203], v[136:139], v[72:75]
ds_read_b64_tr_b16 a[244:245], v242 offset:24584
v_fma_mix_f32 v199, v51, v167, v175 op_sel:[1,0,0] op_sel_hi:[1,0,0]
v_mfma_f32_16x16x32_bf16 v[104:107], a[200:203], v[140:143], v[104:107]
ds_read_b64_tr_b16 a[246:247], v242 offset:25608
v_cvt_pk_bf16_f32 v179, v198, v199
v_mfma_f32_16x16x32_bf16 a[12:15], a[204:207], v[128:131], a[12:15]
ds_read_b64_tr_b16 a[248:249], v243 offset:24576
v_fma_mix_f32 v192, v52, v160, v168 op_sel_hi:[1,0,0]
v_mfma_f32_16x16x32_bf16 a[44:47], a[204:207], v[132:135], a[44:47]
ds_read_b64_tr_b16 a[250:251], v243 offset:25600
v_fma_mix_f32 v193, v52, v161, v169 op_sel:[1,0,0] op_sel_hi:[1,0,0]
v_mfma_f32_16x16x32_bf16 v[76:79], a[204:207], v[136:139], v[76:79]
ds_read_b64_tr_b16 a[252:253], v243 offset:24584
v_cvt_pk_bf16_f32 v180, v192, v193
v_mfma_f32_16x16x32_bf16 v[108:111], a[204:207], v[140:143], v[108:111]
ds_read_b64_tr_b16 a[254:255], v243 offset:25608
v_fma_mix_f32 v194, v53, v162, v170 op_sel_hi:[1,0,0]
v_mfma_f32_16x16x32_bf16 a[16:19], a[208:211], v[128:131], a[16:19]
ds_read_b128 v[144:147], v244 offset:1536
v_fma_mix_f32 v195, v53, v163, v171 op_sel:[1,0,0] op_sel_hi:[1,0,0]
v_mfma_f32_16x16x32_bf16 a[48:51], a[208:211], v[132:135], a[48:51]
ds_read_b128 v[148:151], v244 offset:1552
buffer_load_dwordx4 v[32:35], v247, s[16:19], s30 offen offset:0 sc1
v_cvt_pk_bf16_f32 v181, v194, v195
v_mfma_f32_16x16x32_bf16 v[80:83], a[208:211], v[136:139], v[80:83]
ds_read_b128 v[152:155], v244 offset:5632
v_fma_mix_f32 v196, v54, v164, v172 op_sel_hi:[1,0,0]
v_mfma_f32_16x16x32_bf16 v[112:115], a[208:211], v[140:143], v[112:115]
ds_read_b128 v[156:159], v244 offset:5648
buffer_load_dwordx4 v[36:39], v247, s[16:19], s30 offen offset:1024 sc1
v_fma_mix_f32 v197, v54, v165, v173 op_sel:[1,0,0] op_sel_hi:[1,0,0]
v_mfma_f32_16x16x32_bf16 a[20:23], a[212:215], v[128:131], a[20:23]
v_cvt_pk_bf16_f32 v182, v196, v197
v_fma_mix_f32 v198, v55, v166, v174 op_sel_hi:[1,0,0]
v_mfma_f32_16x16x32_bf16 a[52:55], a[212:215], v[132:135], a[52:55]
buffer_load_dwordx4 v[40:43], v247, s[16:19], s30 offen offset:2048 sc1
v_fma_mix_f32 v199, v55, v167, v175 op_sel:[1,0,0] op_sel_hi:[1,0,0]
v_cvt_pk_bf16_f32 v183, v198, v199
v_mfma_f32_16x16x32_bf16 v[84:87], a[212:215], v[136:139], v[84:87]
v_fma_mix_f32 v192, v56, v160, v168 op_sel_hi:[1,0,0]
v_fma_mix_f32 v193, v56, v161, v169 op_sel:[1,0,0] op_sel_hi:[1,0,0]
v_mfma_f32_16x16x32_bf16 v[116:119], a[212:215], v[140:143], v[116:119]
buffer_load_dwordx4 v[44:47], v247, s[16:19], s30 offen offset:3072 sc1
v_cvt_pk_bf16_f32 v184, v192, v193
v_fma_mix_f32 v194, v57, v162, v170 op_sel_hi:[1,0,0]
v_mfma_f32_16x16x32_bf16 a[24:27], a[216:219], v[128:131], a[24:27]
s_add_u32 s30, s30, 4096
s_and_b32 s30, s30, 0xffff
s_lshl1_add_u32 m0, s26, 2048
s_mov_b32 s31, 0
v_fma_mix_f32 v195, v57, v163, v171 op_sel:[1,0,0] op_sel_hi:[1,0,0]
v_cvt_pk_bf16_f32 v185, v194, v195
v_mfma_f32_16x16x32_bf16 a[56:59], a[216:219], v[132:135], a[56:59]
buffer_load_dwordx4 v230, s[8:11], s31 offen lds
v_fma_mix_f32 v196, v58, v164, v172 op_sel_hi:[1,0,0]
v_fma_mix_f32 v197, v58, v165, v173 op_sel:[1,0,0] op_sel_hi:[1,0,0]
v_mfma_f32_16x16x32_bf16 v[88:91], a[216:219], v[136:139], v[88:91]
v_cvt_pk_bf16_f32 v186, v196, v197
v_fma_mix_f32 v198, v59, v166, v174 op_sel_hi:[1,0,0]
v_mfma_f32_16x16x32_bf16 v[120:123], a[216:219], v[140:143], v[120:123]
buffer_load_dwordx4 v231, s[8:11], s31 offen offset:1024 lds
v_fma_mix_f32 v199, v59, v167, v175 op_sel:[1,0,0] op_sel_hi:[1,0,0]
v_cvt_pk_bf16_f32 v187, v198, v199
v_mfma_f32_16x16x32_bf16 a[28:31], a[220:223], v[128:131], a[28:31]
v_fma_mix_f32 v192, v60, v160, v168 op_sel_hi:[1,0,0]
v_fma_mix_f32 v193, v60, v161, v169 op_sel:[1,0,0] op_sel_hi:[1,0,0]
v_cvt_pk_bf16_f32 v188, v192, v193
v_mfma_f32_16x16x32_bf16 a[60:63], a[220:223], v[132:135], a[60:63]
v_fma_mix_f32 v194, v61, v162, v170 op_sel_hi:[1,0,0]
v_fma_mix_f32 v195, v61, v163, v171 op_sel:[1,0,0] op_sel_hi:[1,0,0]
v_cvt_pk_bf16_f32 v189, v194, v195
v_mfma_f32_16x16x32_bf16 v[92:95], a[220:223], v[136:139], v[92:95]
v_fma_mix_f32 v196, v62, v164, v172 op_sel_hi:[1,0,0]
v_fma_mix_f32 v197, v62, v165, v173 op_sel:[1,0,0] op_sel_hi:[1,0,0]
v_cvt_pk_bf16_f32 v190, v196, v197
v_mfma_f32_16x16x32_bf16 v[124:127], a[220:223], v[140:143], v[124:127]
v_fma_mix_f32 v198, v63, v166, v174 op_sel_hi:[1,0,0]
v_fma_mix_f32 v199, v63, v167, v175 op_sel:[1,0,0] op_sel_hi:[1,0,0]
v_cvt_pk_bf16_f32 v191, v198, v199
s_waitcnt vmcnt(14) lgkmcnt(0)
s_barrier
v_mfma_f32_16x16x32_bf16 a[0:3], a[224:227], v[176:179], a[0:3]
ds_read_b64_tr_b16 a[192:193], v240 offset:32768
v_fma_mix_f32 v192, v0, v144, v152 op_sel_hi:[1,0,0]
v_mfma_f32_16x16x32_bf16 a[32:35], a[224:227], v[180:183], a[32:35]
ds_read_b64_tr_b16 a[194:195], v240 offset:33792
v_fma_mix_f32 v193, v0, v145, v153 op_sel:[1,0,0] op_sel_hi:[1,0,0]
v_mfma_f32_16x16x32_bf16 v[64:67], a[224:227], v[184:187], v[64:67]
ds_read_b64_tr_b16 a[196:197], v240 offset:32776
v_cvt_pk_bf16_f32 v128, v192, v193
v_mfma_f32_16x16x32_bf16 v[96:99], a[224:227], v[188:191], v[96:99]
ds_read_b64_tr_b16 a[198:199], v240 offset:33800
v_fma_mix_f32 v194, v1, v146, v154 op_sel_hi:[1,0,0]
v_mfma_f32_16x16x32_bf16 a[4:7], a[228:231], v[176:179], a[4:7]
ds_read_b64_tr_b16 a[200:201], v241 offset:32768
v_fma_mix_f32 v195, v1, v147, v155 op_sel:[1,0,0] op_sel_hi:[1,0,0]
v_mfma_f32_16x16x32_bf16 a[36:39], a[228:231], v[180:183], a[36:39]
ds_read_b64_tr_b16 a[202:203], v241 offset:33792
v_cvt_pk_bf16_f32 v129, v194, v195
v_mfma_f32_16x16x32_bf16 v[68:71], a[228:231], v[184:187], v[68:71]
ds_read_b64_tr_b16 a[204:205], v241 offset:32776
v_fma_mix_f32 v196, v2, v148, v156 op_sel_hi:[1,0,0]
v_mfma_f32_16x16x32_bf16 v[100:103], a[228:231], v[188:191], v[100:103]
ds_read_b64_tr_b16 a[206:207], v241 offset:33800
v_fma_mix_f32 v197, v2, v149, v157 op_sel:[1,0,0] op_sel_hi:[1,0,0]
v_mfma_f32_16x16x32_bf16 a[8:11], a[232:235], v[176:179], a[8:11]
ds_read_b64_tr_b16 a[208:209], v242 offset:32768
v_cvt_pk_bf16_f32 v130, v196, v197
v_mfma_f32_16x16x32_bf16 a[40:43], a[232:235], v[180:183], a[40:43]
ds_read_b64_tr_b16 a[210:211], v242 offset:33792
v_fma_mix_f32 v198, v3, v150, v158 op_sel_hi:[1,0,0]
v_mfma_f32_16x16x32_bf16 v[72:75], a[232:235], v[184:187], v[72:75]
ds_read_b64_tr_b16 a[212:213], v242 offset:32776
v_fma_mix_f32 v199, v3, v151, v159 op_sel:[1,0,0] op_sel_hi:[1,0,0]
v_mfma_f32_16x16x32_bf16 v[104:107], a[232:235], v[188:191], v[104:107]
ds_read_b64_tr_b16 a[214:215], v242 offset:33800
v_cvt_pk_bf16_f32 v131, v198, v199
v_mfma_f32_16x16x32_bf16 a[12:15], a[236:239], v[176:179], a[12:15]
ds_read_b64_tr_b16 a[216:217], v243 offset:32768
v_fma_mix_f32 v192, v4, v144, v152 op_sel_hi:[1,0,0]
v_mfma_f32_16x16x32_bf16 a[44:47], a[236:239], v[180:183], a[44:47]
ds_read_b64_tr_b16 a[218:219], v243 offset:33792
v_fma_mix_f32 v193, v4, v145, v153 op_sel:[1,0,0] op_sel_hi:[1,0,0]
v_mfma_f32_16x16x32_bf16 v[76:79], a[236:239], v[184:187], v[76:79]
ds_read_b64_tr_b16 a[220:221], v243 offset:32776
v_cvt_pk_bf16_f32 v132, v192, v193
v_mfma_f32_16x16x32_bf16 v[108:111], a[236:239], v[188:191], v[108:111]
ds_read_b64_tr_b16 a[222:223], v243 offset:33800
v_fma_mix_f32 v194, v5, v146, v154 op_sel_hi:[1,0,0]
v_mfma_f32_16x16x32_bf16 a[16:19], a[240:243], v[176:179], a[16:19]
ds_read_b128 v[160:163], v244 offset:1664
v_fma_mix_f32 v195, v5, v147, v155 op_sel:[1,0,0] op_sel_hi:[1,0,0]
v_mfma_f32_16x16x32_bf16 a[48:51], a[240:243], v[180:183], a[48:51]
ds_read_b128 v[164:167], v244 offset:1680
buffer_load_dwordx4 v[48:51], v247, s[16:19], s30 offen offset:0 sc1
v_cvt_pk_bf16_f32 v133, v194, v195
v_mfma_f32_16x16x32_bf16 v[80:83], a[240:243], v[184:187], v[80:83]
ds_read_b128 v[168:171], v244 offset:5760
v_fma_mix_f32 v196, v6, v148, v156 op_sel_hi:[1,0,0]
v_mfma_f32_16x16x32_bf16 v[112:115], a[240:243], v[188:191], v[112:115]
ds_read_b128 v[172:175], v244 offset:5776
buffer_load_dwordx4 v[52:55], v247, s[16:19], s30 offen offset:1024 sc1
v_fma_mix_f32 v197, v6, v149, v157 op_sel:[1,0,0] op_sel_hi:[1,0,0]
v_mfma_f32_16x16x32_bf16 a[20:23], a[244:247], v[176:179], a[20:23]
v_cvt_pk_bf16_f32 v134, v196, v197
v_fma_mix_f32 v198, v7, v150, v158 op_sel_hi:[1,0,0]
v_mfma_f32_16x16x32_bf16 a[52:55], a[244:247], v[180:183], a[52:55]
buffer_load_dwordx4 v[56:59], v247, s[16:19], s30 offen offset:2048 sc1
v_fma_mix_f32 v199, v7, v151, v159 op_sel:[1,0,0] op_sel_hi:[1,0,0]
v_cvt_pk_bf16_f32 v135, v198, v199
v_mfma_f32_16x16x32_bf16 v[84:87], a[244:247], v[184:187], v[84:87]
v_fma_mix_f32 v192, v8, v144, v152 op_sel_hi:[1,0,0]
v_fma_mix_f32 v193, v8, v145, v153 op_sel:[1,0,0] op_sel_hi:[1,0,0]
v_mfma_f32_16x16x32_bf16 v[116:119], a[244:247], v[188:191], v[116:119]
buffer_load_dwordx4 v[60:63], v247, s[16:19], s30 offen offset:3072 sc1
v_cvt_pk_bf16_f32 v136, v192, v193
v_fma_mix_f32 v194, v9, v146, v154 op_sel_hi:[1,0,0]
v_mfma_f32_16x16x32_bf16 a[24:27], a[248:251], v[176:179], a[24:27]
s_add_u32 s30, s30, 4096
s_and_b32 s30, s30, 0xffff
s_lshl1_add_u32 m0, s26, 18432
s_mov_b32 s31, 8192
v_fma_mix_f32 v195, v9, v147, v155 op_sel:[1,0,0] op_sel_hi:[1,0,0]
v_cvt_pk_bf16_f32 v137, v194, v195
v_mfma_f32_16x16x32_bf16 a[56:59], a[248:251], v[180:183], a[56:59]
buffer_load_dwordx4 v230, s[8:11], s31 offen lds
v_fma_mix_f32 v196, v10, v148, v156 op_sel_hi:[1,0,0]
v_fma_mix_f32 v197, v10, v149, v157 op_sel:[1,0,0] op_sel_hi:[1,0,0]
v_mfma_f32_16x16x32_bf16 v[88:91], a[248:251], v[184:187], v[88:91]
v_cvt_pk_bf16_f32 v138, v196, v197
v_fma_mix_f32 v198, v11, v150, v158 op_sel_hi:[1,0,0]
v_mfma_f32_16x16x32_bf16 v[120:123], a[248:251], v[188:191], v[120:123]
buffer_load_dwordx4 v231, s[8:11], s31 offen offset:1024 lds
v_fma_mix_f32 v199, v11, v151, v159 op_sel:[1,0,0] op_sel_hi:[1,0,0]
v_cvt_pk_bf16_f32 v139, v198, v199
v_mfma_f32_16x16x32_bf16 a[28:31], a[252:255], v[176:179], a[28:31]
v_fma_mix_f32 v192, v12, v144, v152 op_sel_hi:[1,0,0]
v_fma_mix_f32 v193, v12, v145, v153 op_sel:[1,0,0] op_sel_hi:[1,0,0]
v_cvt_pk_bf16_f32 v140, v192, v193
v_mfma_f32_16x16x32_bf16 a[60:63], a[252:255], v[180:183], a[60:63]
v_fma_mix_f32 v194, v13, v146, v154 op_sel_hi:[1,0,0]
v_fma_mix_f32 v195, v13, v147, v155 op_sel:[1,0,0] op_sel_hi:[1,0,0]
v_cvt_pk_bf16_f32 v141, v194, v195
v_mfma_f32_16x16x32_bf16 v[92:95], a[252:255], v[184:187], v[92:95]
v_fma_mix_f32 v196, v14, v148, v156 op_sel_hi:[1,0,0]
v_fma_mix_f32 v197, v14, v149, v157 op_sel:[1,0,0] op_sel_hi:[1,0,0]
v_cvt_pk_bf16_f32 v142, v196, v197
v_mfma_f32_16x16x32_bf16 v[124:127], a[252:255], v[188:191], v[124:127]
v_fma_mix_f32 v198, v15, v150, v158 op_sel_hi:[1,0,0]
v_fma_mix_f32 v199, v15, v151, v159 op_sel:[1,0,0] op_sel_hi:[1,0,0]
v_cvt_pk_bf16_f32 v143, v198, v199
s_waitcnt vmcnt(14) lgkmcnt(0)
v_mfma_f32_16x16x32_bf16 a[0:3], a[192:195], v[128:131], a[0:3]
ds_read_b64_tr_b16 a[224:225], v240 offset:40960
v_fma_mix_f32 v192, v16, v160, v168 op_sel_hi:[1,0,0]
v_mfma_f32_16x16x32_bf16 a[32:35], a[192:195], v[132:135], a[32:35]
s_load_dwordx2 s[20:21], s[0:1], 32
ds_read_b64_tr_b16 a[226:227], v240 offset:41984
v_fma_mix_f32 v193, v16, v161, v169 op_sel:[1,0,0] op_sel_hi:[1,0,0]
v_mfma_f32_16x16x32_bf16 v[64:67], a[192:195], v[136:139], v[64:67]
ds_read_b64_tr_b16 a[228:229], v240 offset:40968
v_cvt_pk_bf16_f32 v176, v192, v193
v_mfma_f32_16x16x32_bf16 v[96:99], a[192:195], v[140:143], v[96:99]
Lpad3:
s_cbranch_execz Lpad7
ds_read_b64_tr_b16 a[230:231], v240 offset:41992
v_fma_mix_f32 v194, v17, v162, v170 op_sel_hi:[1,0,0]
v_mfma_f32_16x16x32_bf16 a[4:7], a[196:199], v[128:131], a[4:7]
ds_read_b64_tr_b16 a[232:233], v241 offset:40960
v_fma_mix_f32 v195, v17, v163, v171 op_sel:[1,0,0] op_sel_hi:[1,0,0]
v_mfma_f32_16x16x32_bf16 a[36:39], a[196:199], v[132:135], a[36:39]
ds_read_b64_tr_b16 a[234:235], v241 offset:41984
v_cvt_pk_bf16_f32 v177, v194, v195
v_mfma_f32_16x16x32_bf16 v[68:71], a[196:199], v[136:139], v[68:71]
ds_read_b64_tr_b16 a[236:237], v241 offset:40968
v_fma_mix_f32 v196, v18, v164, v172 op_sel_hi:[1,0,0]
v_mfma_f32_16x16x32_bf16 v[100:103], a[196:199], v[140:143], v[100:103]
ds_read_b64_tr_b16 a[238:239], v241 offset:41992
v_fma_mix_f32 v197, v18, v165, v173 op_sel:[1,0,0] op_sel_hi:[1,0,0]
v_mfma_f32_16x16x32_bf16 a[8:11], a[200:203], v[128:131], a[8:11]
ds_read_b64_tr_b16 a[240:241], v242 offset:40960
v_cvt_pk_bf16_f32 v178, v196, v197
v_mfma_f32_16x16x32_bf16 a[40:43], a[200:203], v[132:135], a[40:43]
ds_read_b64_tr_b16 a[242:243], v242 offset:41984
v_fma_mix_f32 v198, v19, v166, v174 op_sel_hi:[1,0,0]
v_mfma_f32_16x16x32_bf16 v[72:75], a[200:203], v[136:139], v[72:75]
ds_read_b64_tr_b16 a[244:245], v242 offset:40968
v_fma_mix_f32 v199, v19, v167, v175 op_sel:[1,0,0] op_sel_hi:[1,0,0]
v_mfma_f32_16x16x32_bf16 v[104:107], a[200:203], v[140:143], v[104:107]
ds_read_b64_tr_b16 a[246:247], v242 offset:41992
v_cvt_pk_bf16_f32 v179, v198, v199
v_mfma_f32_16x16x32_bf16 a[12:15], a[204:207], v[128:131], a[12:15]
ds_read_b64_tr_b16 a[248:249], v243 offset:40960
v_fma_mix_f32 v192, v20, v160, v168 op_sel_hi:[1,0,0]
v_mfma_f32_16x16x32_bf16 a[44:47], a[204:207], v[132:135], a[44:47]
ds_read_b64_tr_b16 a[250:251], v243 offset:41984
v_fma_mix_f32 v193, v20, v161, v169 op_sel:[1,0,0] op_sel_hi:[1,0,0]
v_mfma_f32_16x16x32_bf16 v[76:79], a[204:207], v[136:139], v[76:79]
ds_read_b64_tr_b16 a[252:253], v243 offset:40968
v_cvt_pk_bf16_f32 v180, v192, v193
v_mfma_f32_16x16x32_bf16 v[108:111], a[204:207], v[140:143], v[108:111]
ds_read_b64_tr_b16 a[254:255], v243 offset:41992
v_fma_mix_f32 v194, v21, v162, v170 op_sel_hi:[1,0,0]
v_mfma_f32_16x16x32_bf16 a[16:19], a[208:211], v[128:131], a[16:19]
ds_read_b128 v[144:147], v244 offset:1792
v_fma_mix_f32 v195, v21, v163, v171 op_sel:[1,0,0] op_sel_hi:[1,0,0]
v_mfma_f32_16x16x32_bf16 a[48:51], a[208:211], v[132:135], a[48:51]
ds_read_b128 v[148:151], v244 offset:1808
v_cvt_pk_bf16_f32 v181, v194, v195
v_mfma_f32_16x16x32_bf16 v[80:83], a[208:211], v[136:139], v[80:83]
ds_read_b128 v[152:155], v244 offset:5888
v_fma_mix_f32 v196, v22, v164, v172 op_sel_hi:[1,0,0]
v_mfma_f32_16x16x32_bf16 v[112:115], a[208:211], v[140:143], v[112:115]
ds_read_b128 v[156:159], v244 offset:5904
v_fma_mix_f32 v197, v22, v165, v173 op_sel:[1,0,0] op_sel_hi:[1,0,0]
v_mfma_f32_16x16x32_bf16 a[20:23], a[212:215], v[128:131], a[20:23]
s_lshl1_add_u32 m0, s26, 34816
s_mov_b32 s31, 16384
v_cvt_pk_bf16_f32 v182, v196, v197
v_fma_mix_f32 v198, v23, v166, v174 op_sel_hi:[1,0,0]
v_mfma_f32_16x16x32_bf16 a[52:55], a[212:215], v[132:135], a[52:55]
buffer_load_dwordx4 v230, s[8:11], s31 offen lds
v_fma_mix_f32 v199, v23, v167, v175 op_sel:[1,0,0] op_sel_hi:[1,0,0]
v_cvt_pk_bf16_f32 v183, v198, v199
v_mfma_f32_16x16x32_bf16 v[84:87], a[212:215], v[136:139], v[84:87]
v_fma_mix_f32 v192, v24, v160, v168 op_sel_hi:[1,0,0]
v_fma_mix_f32 v193, v24, v161, v169 op_sel:[1,0,0] op_sel_hi:[1,0,0]
v_mfma_f32_16x16x32_bf16 v[116:119], a[212:215], v[140:143], v[116:119]
buffer_load_dwordx4 v231, s[8:11], s31 offen offset:1024 lds
v_cvt_pk_bf16_f32 v184, v192, v193
v_fma_mix_f32 v194, v25, v162, v170 op_sel_hi:[1,0,0]
v_mfma_f32_16x16x32_bf16 a[24:27], a[216:219], v[128:131], a[24:27]
s_lshl1_add_u32 m0, s26, 51200
s_mov_b32 s31, 24576
v_fma_mix_f32 v195, v25, v163, v171 op_sel:[1,0,0] op_sel_hi:[1,0,0]
v_cvt_pk_bf16_f32 v185, v194, v195
v_mfma_f32_16x16x32_bf16 a[56:59], a[216:219], v[132:135], a[56:59]
buffer_load_dwordx4 v230, s[8:11], s31 offen lds
v_fma_mix_f32 v196, v26, v164, v172 op_sel_hi:[1,0,0]
v_fma_mix_f32 v197, v26, v165, v173 op_sel:[1,0,0] op_sel_hi:[1,0,0]
v_mfma_f32_16x16x32_bf16 v[88:91], a[216:219], v[136:139], v[88:91]
v_cvt_pk_bf16_f32 v186, v196, v197
v_fma_mix_f32 v198, v27, v166, v174 op_sel_hi:[1,0,0]
v_mfma_f32_16x16x32_bf16 v[120:123], a[216:219], v[140:143], v[120:123]
buffer_load_dwordx4 v231, s[8:11], s31 offen offset:1024 lds
v_fma_mix_f32 v199, v27, v167, v175 op_sel:[1,0,0] op_sel_hi:[1,0,0]
v_cvt_pk_bf16_f32 v187, v198, v199
v_mfma_f32_16x16x32_bf16 a[28:31], a[220:223], v[128:131], a[28:31]
v_fma_mix_f32 v192, v28, v160, v168 op_sel_hi:[1,0,0]
v_fma_mix_f32 v193, v28, v161, v169 op_sel:[1,0,0] op_sel_hi:[1,0,0]
v_cvt_pk_bf16_f32 v188, v192, v193
v_mfma_f32_16x16x32_bf16 a[60:63], a[220:223], v[132:135], a[60:63]
v_fma_mix_f32 v194, v29, v162, v170 op_sel_hi:[1,0,0]
v_fma_mix_f32 v195, v29, v163, v171 op_sel:[1,0,0] op_sel_hi:[1,0,0]
v_cvt_pk_bf16_f32 v189, v194, v195
v_mfma_f32_16x16x32_bf16 v[92:95], a[220:223], v[136:139], v[92:95]
v_fma_mix_f32 v196, v30, v164, v172 op_sel_hi:[1,0,0]
v_fma_mix_f32 v197, v30, v165, v173 op_sel:[1,0,0] op_sel_hi:[1,0,0]
v_cvt_pk_bf16_f32 v190, v196, v197
v_mfma_f32_16x16x32_bf16 v[124:127], a[220:223], v[140:143], v[124:127]
v_fma_mix_f32 v198, v31, v166, v174 op_sel_hi:[1,0,0]
v_fma_mix_f32 v199, v31, v167, v175 op_sel:[1,0,0] op_sel_hi:[1,0,0]
v_cvt_pk_bf16_f32 v191, v198, v199
s_waitcnt vmcnt(12) lgkmcnt(0)
s_barrier
v_mfma_f32_16x16x32_bf16 a[0:3], a[224:227], v[176:179], a[0:3]
ds_read_b64_tr_b16 a[192:193], v240 offset:49152
v_fma_mix_f32 v192, v32, v144, v152 op_sel_hi:[1,0,0]
v_mfma_f32_16x16x32_bf16 a[32:35], a[224:227], v[180:183], a[32:35]
ds_read_b64_tr_b16 a[194:195], v240 offset:50176
v_fma_mix_f32 v193, v32, v145, v153 op_sel:[1,0,0] op_sel_hi:[1,0,0]
v_mfma_f32_16x16x32_bf16 v[64:67], a[224:227], v[184:187], v[64:67]
ds_read_b64_tr_b16 a[196:197], v240 offset:49160
v_cvt_pk_bf16_f32 v128, v192, v193
v_mfma_f32_16x16x32_bf16 v[96:99], a[224:227], v[188:191], v[96:99]
ds_read_b64_tr_b16 a[198:199], v240 offset:50184
v_fma_mix_f32 v194, v33, v146, v154 op_sel_hi:[1,0,0]
v_mfma_f32_16x16x32_bf16 a[4:7], a[228:231], v[176:179], a[4:7]
ds_read_b64_tr_b16 a[200:201], v241 offset:49152
v_fma_mix_f32 v195, v33, v147, v155 op_sel:[1,0,0] op_sel_hi:[1,0,0]
v_mfma_f32_16x16x32_bf16 a[36:39], a[228:231], v[180:183], a[36:39]
ds_read_b64_tr_b16 a[202:203], v241 offset:50176
v_cvt_pk_bf16_f32 v129, v194, v195
v_mfma_f32_16x16x32_bf16 v[68:71], a[228:231], v[184:187], v[68:71]
ds_read_b64_tr_b16 a[204:205], v241 offset:49160
v_fma_mix_f32 v196, v34, v148, v156 op_sel_hi:[1,0,0]
v_mfma_f32_16x16x32_bf16 v[100:103], a[228:231], v[188:191], v[100:103]
ds_read_b64_tr_b16 a[206:207], v241 offset:50184
v_fma_mix_f32 v197, v34, v149, v157 op_sel:[1,0,0] op_sel_hi:[1,0,0]
v_mfma_f32_16x16x32_bf16 a[8:11], a[232:235], v[176:179], a[8:11]
ds_read_b64_tr_b16 a[208:209], v242 offset:49152
v_cvt_pk_bf16_f32 v130, v196, v197
v_mfma_f32_16x16x32_bf16 a[40:43], a[232:235], v[180:183], a[40:43]
ds_read_b64_tr_b16 a[210:211], v242 offset:50176
v_fma_mix_f32 v198, v35, v150, v158 op_sel_hi:[1,0,0]
v_mfma_f32_16x16x32_bf16 v[72:75], a[232:235], v[184:187], v[72:75]
ds_read_b64_tr_b16 a[212:213], v242 offset:49160
v_fma_mix_f32 v199, v35, v151, v159 op_sel:[1,0,0] op_sel_hi:[1,0,0]
v_mfma_f32_16x16x32_bf16 v[104:107], a[232:235], v[188:191], v[104:107]
ds_read_b64_tr_b16 a[214:215], v242 offset:50184
v_cvt_pk_bf16_f32 v131, v198, v199
v_mfma_f32_16x16x32_bf16 a[12:15], a[236:239], v[176:179], a[12:15]
ds_read_b64_tr_b16 a[216:217], v243 offset:49152
v_fma_mix_f32 v192, v36, v144, v152 op_sel_hi:[1,0,0]
v_mfma_f32_16x16x32_bf16 a[44:47], a[236:239], v[180:183], a[44:47]
ds_read_b64_tr_b16 a[218:219], v243 offset:50176
v_fma_mix_f32 v193, v36, v145, v153 op_sel:[1,0,0] op_sel_hi:[1,0,0]
v_mfma_f32_16x16x32_bf16 v[76:79], a[236:239], v[184:187], v[76:79]
ds_read_b64_tr_b16 a[220:221], v243 offset:49160
v_cvt_pk_bf16_f32 v132, v192, v193
v_mfma_f32_16x16x32_bf16 v[108:111], a[236:239], v[188:191], v[108:111]
ds_read_b64_tr_b16 a[222:223], v243 offset:50184
v_fma_mix_f32 v194, v37, v146, v154 op_sel_hi:[1,0,0]
v_mfma_f32_16x16x32_bf16 a[16:19], a[240:243], v[176:179], a[16:19]
ds_read_b128 v[160:163], v244 offset:1920
v_fma_mix_f32 v195, v37, v147, v155 op_sel:[1,0,0] op_sel_hi:[1,0,0]
v_mfma_f32_16x16x32_bf16 a[48:51], a[240:243], v[180:183], a[48:51]
ds_read_b128 v[164:167], v244 offset:1936
v_cvt_pk_bf16_f32 v133, v194, v195
v_mfma_f32_16x16x32_bf16 v[80:83], a[240:243], v[184:187], v[80:83]
ds_read_b128 v[168:171], v244 offset:6016
v_fma_mix_f32 v196, v38, v148, v156 op_sel_hi:[1,0,0]
v_mfma_f32_16x16x32_bf16 v[112:115], a[240:243], v[188:191], v[112:115]
ds_read_b128 v[172:175], v244 offset:6032
v_fma_mix_f32 v197, v38, v149, v157 op_sel:[1,0,0] op_sel_hi:[1,0,0]
v_mfma_f32_16x16x32_bf16 a[20:23], a[244:247], v[176:179], a[20:23]
s_lshl1_add_u32 m0, s26, 49152
s_nop 0
v_cvt_pk_bf16_f32 v134, v196, v197
v_fma_mix_f32 v198, v39, v150, v158 op_sel_hi:[1,0,0]
v_mfma_f32_16x16x32_bf16 a[52:55], a[244:247], v[180:183], a[52:55]
buffer_load_dwordx4 v228, s[12:15], 0 offen lds
v_fma_mix_f32 v199, v39, v151, v159 op_sel:[1,0,0] op_sel_hi:[1,0,0]
v_cvt_pk_bf16_f32 v135, v198, v199
v_mfma_f32_16x16x32_bf16 v[84:87], a[244:247], v[184:187], v[84:87]
v_fma_mix_f32 v192, v40, v144, v152 op_sel_hi:[1,0,0]
v_fma_mix_f32 v193, v40, v145, v153 op_sel:[1,0,0] op_sel_hi:[1,0,0]
v_mfma_f32_16x16x32_bf16 v[116:119], a[244:247], v[188:191], v[116:119]
buffer_load_dwordx4 v229, s[12:15], 0 offen offset:1024 lds
v_cvt_pk_bf16_f32 v136, v192, v193
v_fma_mix_f32 v194, v41, v146, v154 op_sel_hi:[1,0,0]
v_mfma_f32_16x16x32_bf16 a[24:27], a[248:251], v[176:179], a[24:27]
v_fma_mix_f32 v195, v41, v147, v155 op_sel:[1,0,0] op_sel_hi:[1,0,0]
v_cvt_pk_bf16_f32 v137, v194, v195
v_mfma_f32_16x16x32_bf16 a[56:59], a[248:251], v[180:183], a[56:59]
v_fma_mix_f32 v196, v42, v148, v156 op_sel_hi:[1,0,0]
v_fma_mix_f32 v197, v42, v149, v157 op_sel:[1,0,0] op_sel_hi:[1,0,0]
v_mfma_f32_16x16x32_bf16 v[88:91], a[248:251], v[184:187], v[88:91]
v_cvt_pk_bf16_f32 v138, v196, v197
v_fma_mix_f32 v198, v43, v150, v158 op_sel_hi:[1,0,0]
v_mfma_f32_16x16x32_bf16 v[120:123], a[248:251], v[188:191], v[120:123]
v_fma_mix_f32 v199, v43, v151, v159 op_sel:[1,0,0] op_sel_hi:[1,0,0]
v_cvt_pk_bf16_f32 v139, v198, v199
v_mfma_f32_16x16x32_bf16 a[28:31], a[252:255], v[176:179], a[28:31]
v_fma_mix_f32 v192, v44, v144, v152 op_sel_hi:[1,0,0]
v_fma_mix_f32 v193, v44, v145, v153 op_sel:[1,0,0] op_sel_hi:[1,0,0]
v_cvt_pk_bf16_f32 v140, v192, v193
v_mfma_f32_16x16x32_bf16 a[60:63], a[252:255], v[180:183], a[60:63]
v_fma_mix_f32 v194, v45, v146, v154 op_sel_hi:[1,0,0]
v_fma_mix_f32 v195, v45, v147, v155 op_sel:[1,0,0] op_sel_hi:[1,0,0]
v_cvt_pk_bf16_f32 v141, v194, v195
v_mfma_f32_16x16x32_bf16 v[92:95], a[252:255], v[184:187], v[92:95]
v_fma_mix_f32 v196, v46, v148, v156 op_sel_hi:[1,0,0]
v_fma_mix_f32 v197, v46, v149, v157 op_sel:[1,0,0] op_sel_hi:[1,0,0]
v_cvt_pk_bf16_f32 v142, v196, v197
v_mfma_f32_16x16x32_bf16 v[124:127], a[252:255], v[188:191], v[124:127]
v_fma_mix_f32 v198, v47, v150, v158 op_sel_hi:[1,0,0]
v_fma_mix_f32 v199, v47, v151, v159 op_sel:[1,0,0] op_sel_hi:[1,0,0]
v_cvt_pk_bf16_f32 v143, v198, v199
s_waitcnt vmcnt(8) lgkmcnt(0)
v_mfma_f32_16x16x32_bf16 a[0:3], a[192:195], v[128:131], a[0:3]
ds_read_b64_tr_b16 a[224:225], v240 offset:57344
v_fma_mix_f32 v192, v48, v160, v168 op_sel_hi:[1,0,0]
v_mfma_f32_16x16x32_bf16 a[32:35], a[192:195], v[132:135], a[32:35]
ds_read_b64_tr_b16 a[226:227], v240 offset:58368
v_fma_mix_f32 v193, v48, v161, v169 op_sel:[1,0,0] op_sel_hi:[1,0,0]
v_mfma_f32_16x16x32_bf16 v[64:67], a[192:195], v[136:139], v[64:67]
ds_read_b64_tr_b16 a[228:229], v240 offset:57352
v_cvt_pk_bf16_f32 v176, v192, v193
v_mfma_f32_16x16x32_bf16 v[96:99], a[192:195], v[140:143], v[96:99]
ds_read_b64_tr_b16 a[230:231], v240 offset:58376
v_fma_mix_f32 v194, v49, v162, v170 op_sel_hi:[1,0,0]
v_mfma_f32_16x16x32_bf16 a[4:7], a[196:199], v[128:131], a[4:7]
ds_read_b64_tr_b16 a[232:233], v241 offset:57344
v_fma_mix_f32 v195, v49, v163, v171 op_sel:[1,0,0] op_sel_hi:[1,0,0]
v_mfma_f32_16x16x32_bf16 a[36:39], a[196:199], v[132:135], a[36:39]
ds_read_b64_tr_b16 a[234:235], v241 offset:58368
v_cvt_pk_bf16_f32 v177, v194, v195
v_mfma_f32_16x16x32_bf16 v[68:71], a[196:199], v[136:139], v[68:71]
ds_read_b64_tr_b16 a[236:237], v241 offset:57352
v_fma_mix_f32 v196, v50, v164, v172 op_sel_hi:[1,0,0]
v_mfma_f32_16x16x32_bf16 v[100:103], a[196:199], v[140:143], v[100:103]
ds_read_b64_tr_b16 a[238:239], v241 offset:58376
v_fma_mix_f32 v197, v50, v165, v173 op_sel:[1,0,0] op_sel_hi:[1,0,0]
v_mfma_f32_16x16x32_bf16 a[8:11], a[200:203], v[128:131], a[8:11]
ds_read_b64_tr_b16 a[240:241], v242 offset:57344
v_cvt_pk_bf16_f32 v178, v196, v197
v_mfma_f32_16x16x32_bf16 a[40:43], a[200:203], v[132:135], a[40:43]
ds_read_b64_tr_b16 a[242:243], v242 offset:58368
v_fma_mix_f32 v198, v51, v166, v174 op_sel_hi:[1,0,0]
v_mfma_f32_16x16x32_bf16 v[72:75], a[200:203], v[136:139], v[72:75]
ds_read_b64_tr_b16 a[244:245], v242 offset:57352
v_fma_mix_f32 v199, v51, v167, v175 op_sel:[1,0,0] op_sel_hi:[1,0,0]
v_mfma_f32_16x16x32_bf16 v[104:107], a[200:203], v[140:143], v[104:107]
ds_read_b64_tr_b16 a[246:247], v242 offset:58376
v_cvt_pk_bf16_f32 v179, v198, v199
v_mfma_f32_16x16x32_bf16 a[12:15], a[204:207], v[128:131], a[12:15]
ds_read_b64_tr_b16 a[248:249], v243 offset:57344
v_fma_mix_f32 v192, v52, v160, v168 op_sel_hi:[1,0,0]
v_mfma_f32_16x16x32_bf16 a[44:47], a[204:207], v[132:135], a[44:47]
ds_read_b64_tr_b16 a[250:251], v243 offset:58368
v_fma_mix_f32 v193, v52, v161, v169 op_sel:[1,0,0] op_sel_hi:[1,0,0]
v_mfma_f32_16x16x32_bf16 v[76:79], a[204:207], v[136:139], v[76:79]
ds_read_b64_tr_b16 a[252:253], v243 offset:57352
v_cvt_pk_bf16_f32 v180, v192, v193
v_mfma_f32_16x16x32_bf16 v[108:111], a[204:207], v[140:143], v[108:111]
ds_read_b64_tr_b16 a[254:255], v243 offset:58376
v_fma_mix_f32 v194, v53, v162, v170 op_sel_hi:[1,0,0]
v_mfma_f32_16x16x32_bf16 a[16:19], a[208:211], v[128:131], a[16:19]
v_fma_mix_f32 v195, v53, v163, v171 op_sel:[1,0,0] op_sel_hi:[1,0,0]
v_mfma_f32_16x16x32_bf16 a[48:51], a[208:211], v[132:135], a[48:51]
v_cvt_pk_bf16_f32 v181, v194, v195
v_mfma_f32_16x16x32_bf16 v[80:83], a[208:211], v[136:139], v[80:83]
v_fma_mix_f32 v196, v54, v164, v172 op_sel_hi:[1,0,0]
v_mfma_f32_16x16x32_bf16 v[112:115], a[208:211], v[140:143], v[112:115]
v_fma_mix_f32 v197, v54, v165, v173 op_sel:[1,0,0] op_sel_hi:[1,0,0]
v_mfma_f32_16x16x32_bf16 a[20:23], a[212:215], v[128:131], a[20:23]
s_lshl2_add_u32 s36, s2, s27
s_lshl_b32 s36, s36, 9
s_add_u32 s36, s36, 30408704
v_cvt_pk_bf16_f32 v182, v196, v197
v_fma_mix_f32 v198, v55, v166, v174 op_sel_hi:[1,0,0]
v_mfma_f32_16x16x32_bf16 a[52:55], a[212:215], v[132:135], a[52:55]
buffer_store_dwordx2 v[202:203], v204, s[16:19], s36 offen sc1
v_fma_mix_f32 v199, v55, v167, v175 op_sel:[1,0,0] op_sel_hi:[1,0,0]
v_cvt_pk_bf16_f32 v183, v198, v199
v_mfma_f32_16x16x32_bf16 v[84:87], a[212:215], v[136:139], v[84:87]
v_fma_mix_f32 v192, v56, v160, v168 op_sel_hi:[1,0,0]
v_fma_mix_f32 v193, v56, v161, v169 op_sel:[1,0,0] op_sel_hi:[1,0,0]
v_mfma_f32_16x16x32_bf16 v[116:119], a[212:215], v[140:143], v[116:119]
v_cvt_pk_bf16_f32 v184, v192, v193
v_fma_mix_f32 v194, v57, v162, v170 op_sel_hi:[1,0,0]
v_mfma_f32_16x16x32_bf16 a[24:27], a[216:219], v[128:131], a[24:27]
v_fma_mix_f32 v195, v57, v163, v171 op_sel:[1,0,0] op_sel_hi:[1,0,0]
v_cvt_pk_bf16_f32 v185, v194, v195
v_mfma_f32_16x16x32_bf16 a[56:59], a[216:219], v[132:135], a[56:59]
v_fma_mix_f32 v196, v58, v164, v172 op_sel_hi:[1,0,0]
v_fma_mix_f32 v197, v58, v165, v173 op_sel:[1,0,0] op_sel_hi:[1,0,0]
v_mfma_f32_16x16x32_bf16 v[88:91], a[216:219], v[136:139], v[88:91]
v_cvt_pk_bf16_f32 v186, v196, v197
v_fma_mix_f32 v198, v59, v166, v174 op_sel_hi:[1,0,0]
v_mfma_f32_16x16x32_bf16 v[120:123], a[216:219], v[140:143], v[120:123]
v_fma_mix_f32 v199, v59, v167, v175 op_sel:[1,0,0] op_sel_hi:[1,0,0]
v_cvt_pk_bf16_f32 v187, v198, v199
v_mfma_f32_16x16x32_bf16 a[28:31], a[220:223], v[128:131], a[28:31]
v_fma_mix_f32 v192, v60, v160, v168 op_sel_hi:[1,0,0]
v_fma_mix_f32 v193, v60, v161, v169 op_sel:[1,0,0] op_sel_hi:[1,0,0]
v_cvt_pk_bf16_f32 v188, v192, v193
v_mfma_f32_16x16x32_bf16 a[60:63], a[220:223], v[132:135], a[60:63]
v_fma_mix_f32 v194, v61, v162, v170 op_sel_hi:[1,0,0]
v_fma_mix_f32 v195, v61, v163, v171 op_sel:[1,0,0] op_sel_hi:[1,0,0]
v_cvt_pk_bf16_f32 v189, v194, v195
v_mfma_f32_16x16x32_bf16 v[92:95], a[220:223], v[136:139], v[92:95]
v_fma_mix_f32 v196, v62, v164, v172 op_sel_hi:[1,0,0]
v_fma_mix_f32 v197, v62, v165, v173 op_sel:[1,0,0] op_sel_hi:[1,0,0]
v_cvt_pk_bf16_f32 v190, v196, v197
v_mfma_f32_16x16x32_bf16 v[124:127], a[220:223], v[140:143], v[124:127]
v_fma_mix_f32 v198, v63, v166, v174 op_sel_hi:[1,0,0]
v_fma_mix_f32 v199, v63, v167, v175 op_sel:[1,0,0] op_sel_hi:[1,0,0]
v_cvt_pk_bf16_f32 v191, v198, v199
s_waitcnt vmcnt(7) lgkmcnt(0)
s_barrier
v_mfma_f32_16x16x32_bf16 a[0:3], a[224:227], v[176:179], a[0:3]
ds_read_b128 a[192:195], v216 offset:0
v_add_u32 v230, 22528, v230
v_mfma_f32_16x16x32_bf16 a[4:7], a[228:231], v[176:179], a[4:7]
ds_read_b128 a[196:199], v217 offset:0
v_add_u32 v231, 22528, v231
v_mfma_f32_16x16x32_bf16 a[8:11], a[232:235], v[176:179], a[8:11]
ds_read_b128 a[200:203], v218 offset:0
ds_read_b128 a[204:207], v219 offset:0
v_mfma_f32_16x16x32_bf16 a[12:15], a[236:239], v[176:179], a[12:15]
ds_read_b128 a[208:211], v216 offset:8192
ds_read_b128 a[212:215], v217 offset:8192
v_mfma_f32_16x16x32_bf16 a[16:19], a[240:243], v[176:179], a[16:19]
ds_read_b128 a[216:219], v218 offset:8192
ds_read_b128 a[220:223], v219 offset:8192
v_mfma_f32_16x16x32_bf16 a[20:23], a[244:247], v[176:179], a[20:23]
v_mfma_f32_16x16x32_bf16 a[24:27], a[248:251], v[176:179], a[24:27]
v_accvgpr_read_b32 v192, a0
v_accvgpr_read_b32 v193, a1
v_accvgpr_read_b32 v194, a2
v_accvgpr_read_b32 v195, a3
v_accvgpr_read_b32 v196, a4
v_mfma_f32_16x16x32_bf16 a[28:31], a[252:255], v[176:179], a[28:31]
v_accvgpr_read_b32 v197, a5
v_accvgpr_read_b32 v198, a6
v_mfma_f32_16x16x32_bf16 a[32:35], a[224:227], v[180:183], a[32:35]
v_accvgpr_read_b32 v199, a7
v_cvt_pk_bf16_f32 v128, v192, v193
v_mfma_f32_16x16x32_bf16 a[36:39], a[228:231], v[180:183], a[36:39]
v_cvt_pk_bf16_f32 v129, v194, v195
v_cvt_pk_bf16_f32 v130, v196, v197
v_mfma_f32_16x16x32_bf16 a[40:43], a[232:235], v[180:183], a[40:43]
v_cvt_pk_bf16_f32 v131, v198, v199
v_accvgpr_read_b32 v200, a8
v_mfma_f32_16x16x32_bf16 a[44:47], a[236:239], v[180:183], a[44:47]
v_accvgpr_read_b32 v201, a9
v_accvgpr_read_b32 v202, a10
v_mfma_f32_16x16x32_bf16 a[48:51], a[240:243], v[180:183], a[48:51]
v_accvgpr_read_b32 v203, a11
v_accvgpr_read_b32 v204, a12
v_mfma_f32_16x16x32_bf16 a[52:55], a[244:247], v[180:183], a[52:55]
v_accvgpr_read_b32 v205, a13
v_accvgpr_read_b32 v206, a14
v_mfma_f32_16x16x32_bf16 a[56:59], a[248:251], v[180:183], a[56:59]
v_accvgpr_read_b32 v207, a15
v_cvt_pk_bf16_f32 v132, v200, v201
v_mfma_f32_16x16x32_bf16 a[60:63], a[252:255], v[180:183], a[60:63]
v_cvt_pk_bf16_f32 v133, v202, v203
v_cvt_pk_bf16_f32 v134, v204, v205
v_mfma_f32_16x16x32_bf16 v[64:67], a[224:227], v[184:187], v[64:67]
v_cvt_pk_bf16_f32 v135, v206, v207
v_accvgpr_read_b32 v192, a16
v_mfma_f32_16x16x32_bf16 v[68:71], a[228:231], v[184:187], v[68:71]
v_accvgpr_read_b32 v193, a17
v_accvgpr_read_b32 v194, a18
v_mfma_f32_16x16x32_bf16 v[72:75], a[232:235], v[184:187], v[72:75]
v_accvgpr_read_b32 v195, a19
v_accvgpr_read_b32 v196, a20
v_mfma_f32_16x16x32_bf16 v[76:79], a[236:239], v[184:187], v[76:79]
v_accvgpr_read_b32 v197, a21
v_accvgpr_read_b32 v198, a22
v_mfma_f32_16x16x32_bf16 v[80:83], a[240:243], v[184:187], v[80:83]
v_accvgpr_read_b32 v199, a23
v_cvt_pk_bf16_f32 v136, v192, v193
v_mfma_f32_16x16x32_bf16 v[84:87], a[244:247], v[184:187], v[84:87]
v_cvt_pk_bf16_f32 v137, v194, v195
v_cvt_pk_bf16_f32 v138, v196, v197
v_mfma_f32_16x16x32_bf16 v[88:91], a[248:251], v[184:187], v[88:91]
v_cvt_pk_bf16_f32 v139, v198, v199
v_accvgpr_read_b32 v200, a24
v_mfma_f32_16x16x32_bf16 v[92:95], a[252:255], v[184:187], v[92:95]
v_accvgpr_read_b32 v201, a25
v_accvgpr_read_b32 v202, a26
v_mfma_f32_16x16x32_bf16 v[96:99], a[224:227], v[188:191], v[96:99]
v_accvgpr_read_b32 v203, a27
v_accvgpr_read_b32 v204, a28
v_mfma_f32_16x16x32_bf16 v[100:103], a[228:231], v[188:191], v[100:103]
v_accvgpr_read_b32 v205, a29
v_accvgpr_read_b32 v206, a30
v_mfma_f32_16x16x32_bf16 v[104:107], a[232:235], v[188:191], v[104:107]
v_accvgpr_read_b32 v207, a31
v_cvt_pk_bf16_f32 v140, v200, v201
v_mfma_f32_16x16x32_bf16 v[108:111], a[236:239], v[188:191], v[108:111]
v_cvt_pk_bf16_f32 v141, v202, v203
v_cvt_pk_bf16_f32 v142, v204, v205
v_mfma_f32_16x16x32_bf16 v[112:115], a[240:243], v[188:191], v[112:115]
v_cvt_pk_bf16_f32 v143, v206, v207
v_accvgpr_read_b32 v192, a32
v_mfma_f32_16x16x32_bf16 v[116:119], a[244:247], v[188:191], v[116:119]
v_accvgpr_read_b32 v193, a33
v_accvgpr_read_b32 v194, a34
v_accvgpr_read_b32 v195, a35
v_accvgpr_read_b32 v196, a36
v_mfma_f32_16x16x32_bf16 v[120:123], a[248:251], v[188:191], v[120:123]
v_accvgpr_read_b32 v197, a37
v_accvgpr_read_b32 v198, a38
v_accvgpr_read_b32 v199, a39
v_cvt_pk_bf16_f32 v144, v192, v193
v_cvt_pk_bf16_f32 v145, v194, v195
v_cvt_pk_bf16_f32 v146, v196, v197
v_mfma_f32_16x16x32_bf16 v[124:127], a[252:255], v[188:191], v[124:127]
s_waitcnt lgkmcnt(0)
v_cvt_pk_bf16_f32 v147, v198, v199
v_accvgpr_read_b32 v200, a40
v_accvgpr_read_b32 v201, a41
v_accvgpr_read_b32 v202, a42
v_accvgpr_read_b32 v203, a43
v_accvgpr_read_b32 v204, a44
v_mfma_f32_16x16x32_bf16 v[0:3], a[192:195], v[128:131], 0
v_accvgpr_read_b32 v205, a45
v_accvgpr_read_b32 v206, a46
v_accvgpr_read_b32 v207, a47
v_cvt_pk_bf16_f32 v148, v200, v201
v_cvt_pk_bf16_f32 v149, v202, v203
v_cvt_pk_bf16_f32 v150, v204, v205
v_mfma_f32_16x16x32_bf16 v[0:3], a[196:199], v[132:135], v[0:3]
v_cvt_pk_bf16_f32 v151, v206, v207
v_accvgpr_read_b32 v192, a48
v_accvgpr_read_b32 v193, a49
v_accvgpr_read_b32 v194, a50
v_accvgpr_read_b32 v195, a51
v_accvgpr_read_b32 v196, a52
v_mfma_f32_16x16x32_bf16 v[0:3], a[200:203], v[136:139], v[0:3]
ds_read_b128 a[224:227], v216 offset:16384
v_accvgpr_read_b32 v197, a53
v_accvgpr_read_b32 v198, a54
v_accvgpr_read_b32 v199, a55
v_cvt_pk_bf16_f32 v152, v192, v193
v_cvt_pk_bf16_f32 v153, v194, v195
v_cvt_pk_bf16_f32 v154, v196, v197
v_mfma_f32_16x16x32_bf16 v[0:3], a[204:207], v[140:143], v[0:3]
v_cvt_pk_bf16_f32 v155, v198, v199
v_accvgpr_read_b32 v200, a56
v_accvgpr_read_b32 v201, a57
v_accvgpr_read_b32 v202, a58
v_accvgpr_read_b32 v203, a59
v_accvgpr_read_b32 v204, a60
v_mfma_f32_16x16x32_bf16 v[4:7], a[208:211], v[128:131], 0
ds_read_b128 a[228:231], v217 offset:16384
v_accvgpr_read_b32 v205, a61
v_accvgpr_read_b32 v206, a62
v_accvgpr_read_b32 v207, a63
v_cvt_pk_bf16_f32 v156, v200, v201
v_cvt_pk_bf16_f32 v157, v202, v203
v_cvt_pk_bf16_f32 v158, v204, v205
v_mfma_f32_16x16x32_bf16 v[4:7], a[212:215], v[132:135], v[4:7]
v_cvt_pk_bf16_f32 v159, v206, v207
v_cvt_pk_bf16_f32 v160, v64, v65
v_mfma_f32_16x16x32_bf16 v[4:7], a[216:219], v[136:139], v[4:7]
ds_read_b128 a[232:235], v218 offset:16384
v_cvt_pk_bf16_f32 v161, v66, v67
v_cvt_pk_bf16_f32 v162, v68, v69
v_mfma_f32_16x16x32_bf16 v[4:7], a[220:223], v[140:143], v[4:7]
v_cvt_pk_bf16_f32 v163, v70, v71
v_cvt_pk_bf16_f32 v164, v72, v73
v_mfma_f32_16x16x32_bf16 v[8:11], a[192:195], v[144:147], 0
ds_read_b128 a[236:239], v219 offset:16384
v_cvt_pk_bf16_f32 v165, v74, v75
v_cvt_pk_bf16_f32 v166, v76, v77
v_mfma_f32_16x16x32_bf16 v[8:11], a[196:199], v[148:151], v[8:11]
v_cvt_pk_bf16_f32 v167, v78, v79
v_cvt_pk_bf16_f32 v168, v80, v81
v_mfma_f32_16x16x32_bf16 v[8:11], a[200:203], v[152:155], v[8:11]
ds_read_b128 a[240:243], v216 offset:24576
v_cvt_pk_bf16_f32 v169, v82, v83
v_cvt_pk_bf16_f32 v170, v84, v85
v_mfma_f32_16x16x32_bf16 v[8:11], a[204:207], v[156:159], v[8:11]
v_cvt_pk_bf16_f32 v171, v86, v87
v_cvt_pk_bf16_f32 v172, v88, v89
v_mfma_f32_16x16x32_bf16 v[12:15], a[208:211], v[144:147], 0
ds_read_b128 a[244:247], v217 offset:24576
v_cvt_pk_bf16_f32 v173, v90, v91
v_cvt_pk_bf16_f32 v174, v92, v93
v_mfma_f32_16x16x32_bf16 v[12:15], a[212:215], v[148:151], v[12:15]
v_cvt_pk_bf16_f32 v175, v94, v95
v_cvt_pk_bf16_f32 v176, v96, v97
v_mfma_f32_16x16x32_bf16 v[12:15], a[216:219], v[152:155], v[12:15]
ds_read_b128 a[248:251], v218 offset:24576
v_cvt_pk_bf16_f32 v177, v98, v99
v_cvt_pk_bf16_f32 v178, v100, v101
v_mfma_f32_16x16x32_bf16 v[12:15], a[220:223], v[156:159], v[12:15]
v_cvt_pk_bf16_f32 v179, v102, v103
v_cvt_pk_bf16_f32 v180, v104, v105
v_mfma_f32_16x16x32_bf16 v[16:19], a[192:195], v[160:163], 0
ds_read_b128 a[252:255], v219 offset:24576
v_cvt_pk_bf16_f32 v181, v106, v107
v_cvt_pk_bf16_f32 v182, v108, v109
v_mfma_f32_16x16x32_bf16 v[16:19], a[196:199], v[164:167], v[16:19]
v_cvt_pk_bf16_f32 v183, v110, v111
v_cvt_pk_bf16_f32 v184, v112, v113
v_mfma_f32_16x16x32_bf16 v[16:19], a[200:203], v[168:171], v[16:19]
v_cvt_pk_bf16_f32 v185, v114, v115
v_cvt_pk_bf16_f32 v186, v116, v117
v_mfma_f32_16x16x32_bf16 v[16:19], a[204:207], v[172:175], v[16:19]
v_cvt_pk_bf16_f32 v187, v118, v119
v_cvt_pk_bf16_f32 v188, v120, v121
v_mfma_f32_16x16x32_bf16 v[20:23], a[208:211], v[160:163], 0
v_cvt_pk_bf16_f32 v189, v122, v123
v_cvt_pk_bf16_f32 v190, v124, v125
v_mfma_f32_16x16x32_bf16 v[20:23], a[212:215], v[164:167], v[20:23]
v_cvt_pk_bf16_f32 v191, v126, v127
v_max3_f32 v208, v236, v0, v1
v_max3_f32 v209, v237, v8, v9
v_max3_f32 v208, v208, v2, v3
v_mfma_f32_16x16x32_bf16 v[20:23], a[216:219], v[168:171], v[20:23]
v_max3_f32 v209, v209, v10, v11
v_max3_f32 v208, v208, v4, v5
v_max3_f32 v209, v209, v12, v13
v_max3_f32 v208, v208, v6, v7
Lpad4:
s_cbranch_execz Lpad8
v_mfma_f32_16x16x32_bf16 v[20:23], a[220:223], v[172:175], v[20:23]
v_max3_f32 v209, v209, v14, v15
v_mfma_f32_16x16x32_bf16 v[24:27], a[192:195], v[176:179], 0
s_nop 0
v_mov_b32 v212, v208
v_mov_b32 v213, v209
v_mfma_f32_16x16x32_bf16 v[24:27], a[196:199], v[180:183], v[24:27]
s_nop 0
v_permlane16_swap_b32 v208, v212
v_permlane16_swap_b32 v209, v213
v_max_f32 v208, v208, v212
v_max_f32 v209, v209, v213
v_mfma_f32_16x16x32_bf16 v[24:27], a[200:203], v[184:187], v[24:27]
s_nop 0
v_mov_b32 v212, v208
v_mov_b32 v213, v209
v_mfma_f32_16x16x32_bf16 v[24:27], a[204:207], v[188:191], v[24:27]
s_nop 0
v_permlane32_swap_b32 v208, v212
v_permlane32_swap_b32 v209, v213
v_max_f32 v208, v208, v212
v_max_f32 v209, v209, v213
v_sub_f32 v64, 0, v208
v_sub_f32 v65, 0, v208
v_sub_f32 v66, 0, v208
v_mfma_f32_16x16x32_bf16 v[28:31], a[208:211], v[176:179], 0
v_sub_f32 v67, 0, v208
v_sub_f32 v68, 0, v209
v_sub_f32 v69, 0, v209
v_sub_f32 v70, 0, v209
v_mfma_f32_16x16x32_bf16 v[28:31], a[212:215], v[180:183], v[28:31]
v_sub_f32 v71, 0, v209
v_mfma_f32_16x16x32_bf16 v[28:31], a[216:219], v[184:187], v[28:31]
v_mfma_f32_16x16x32_bf16 v[28:31], a[220:223], v[188:191], v[28:31]
s_waitcnt vmcnt(5) lgkmcnt(0)
s_barrier
v_mfma_f32_16x16x32_bf16 v[32:35], a[224:227], v[128:131], v[64:67]
s_lshl1_add_u32 m0, s26, 0
ds_read_b128 a[192:195], v216 offset:32768
ds_read_b128 a[196:199], v217 offset:32768
v_mfma_f32_16x16x32_bf16 v[32:35], a[228:231], v[132:135], v[32:35]
s_mov_b32 s24, 8192
ds_read_b128 a[200:203], v218 offset:32768
ds_read_b128 a[204:207], v219 offset:32768
v_mfma_f32_16x16x32_bf16 v[32:35], a[232:235], v[136:139], v[32:35]
ds_read_b128 a[208:211], v216 offset:40960
ds_read_b128 a[212:215], v217 offset:40960
v_mfma_f32_16x16x32_bf16 v[32:35], a[236:239], v[140:143], v[32:35]
buffer_load_dwordx4 v228, s[12:15], s24 offen  lds
v_mfma_f32_16x16x32_bf16 v[36:39], a[240:243], v[128:131], v[64:67]
ds_read_b128 a[216:219], v218 offset:40960
ds_read_b128 a[220:223], v219 offset:40960
v_mfma_f32_16x16x32_bf16 v[36:39], a[244:247], v[132:135], v[36:39]
v_max3_f32 v208, v238, v16, v17
v_max3_f32 v209, v239, v24, v25
v_max3_f32 v208, v208, v18, v19
v_mfma_f32_16x16x32_bf16 v[36:39], a[248:251], v[136:139], v[36:39]
v_max3_f32 v209, v209, v26, v27
v_max3_f32 v208, v208, v20, v21
v_max3_f32 v209, v209, v28, v29
v_max3_f32 v208, v208, v22, v23
v_mfma_f32_16x16x32_bf16 v[36:39], a[252:255], v[140:143], v[36:39]
v_max3_f32 v209, v209, v30, v31
v_mfma_f32_16x16x32_bf16 v[40:43], a[224:227], v[144:147], v[68:71]
s_nop 0
v_mov_b32 v212, v208
v_mov_b32 v213, v209
v_mfma_f32_16x16x32_bf16 v[40:43], a[228:231], v[148:151], v[40:43]
s_nop 0
v_permlane16_swap_b32 v208, v212
v_permlane16_swap_b32 v209, v213
v_max_f32 v208, v208, v212
v_max_f32 v209, v209, v213
v_mfma_f32_16x16x32_bf16 v[40:43], a[232:235], v[152:155], v[40:43]
s_nop 0
buffer_load_dwordx4 v229, s[12:15], s24 offen offset:1024  lds
v_mov_b32 v212, v208
v_mov_b32 v213, v209
v_mfma_f32_16x16x32_bf16 v[40:43], a[236:239], v[156:159], v[40:43]
s_nop 0
v_permlane32_swap_b32 v208, v212
v_permlane32_swap_b32 v209, v213
v_max_f32 v208, v208, v212
v_max_f32 v209, v209, v213
v_sub_f32 v72, 0, v208
v_sub_f32 v73, 0, v208
v_sub_f32 v74, 0, v208
v_mfma_f32_16x16x32_bf16 v[44:47], a[240:243], v[144:147], v[68:71]
buffer_load_dwordx4 v230, s[8:11], s24 offen offset:2048  lds
v_sub_f32 v75, 0, v208
v_sub_f32 v76, 0, v209
v_sub_f32 v77, 0, v209
v_sub_f32 v78, 0, v209
v_mfma_f32_16x16x32_bf16 v[44:47], a[244:247], v[148:151], v[44:47]
v_sub_f32 v79, 0, v209
v_add_f32 v0, v0, v64
v_add_f32 v1, v1, v64
v_add_f32 v2, v2, v64
v_mfma_f32_16x16x32_bf16 v[44:47], a[248:251], v[152:155], v[44:47]
v_add_f32 v3, v3, v64
v_add_f32 v4, v4, v64
v_add_f32 v5, v5, v64
v_mfma_f32_16x16x32_bf16 v[44:47], a[252:255], v[156:159], v[44:47]
buffer_load_dwordx4 v231, s[8:11], s24 offen offset:3072  lds
v_add_f32 v6, v6, v64
v_add_f32 v7, v7, v64
v_add_f32 v8, v8, v68
v_mfma_f32_16x16x32_bf16 v[48:51], a[224:227], v[160:163], v[72:75]
v_add_f32 v9, v9, v68
v_add_f32 v10, v10, v68
v_add_f32 v11, v11, v68
v_mfma_f32_16x16x32_bf16 v[48:51], a[228:231], v[164:167], v[48:51]
s_lshl1_add_u32 m0, s26, 16384
v_add_f32 v12, v12, v68
v_add_f32 v13, v13, v68
v_add_f32 v14, v14, v68
v_mfma_f32_16x16x32_bf16 v[48:51], a[232:235], v[168:171], v[48:51]
v_add_f32 v15, v15, v68
v_exp_f32 v0, v0
v_mfma_f32_16x16x32_bf16 v[48:51], a[236:239], v[172:175], v[48:51]
s_mov_b32 s24, 16384
v_exp_f32 v1, v1
v_mfma_f32_16x16x32_bf16 v[52:55], a[240:243], v[160:163], v[72:75]
v_exp_f32 v2, v2
v_mfma_f32_16x16x32_bf16 v[52:55], a[244:247], v[164:167], v[52:55]
v_cvt_pk_bf16_f32 v96, v0, v1
v_exp_f32 v3, v3
v_mfma_f32_16x16x32_bf16 v[52:55], a[248:251], v[168:171], v[52:55]
buffer_load_dwordx4 v228, s[12:15], s24 offen  lds
v_exp_f32 v4, v4
v_mfma_f32_16x16x32_bf16 v[52:55], a[252:255], v[172:175], v[52:55]
v_cvt_pk_bf16_f32 v97, v2, v3
v_mfma_f32_16x16x32_bf16 v[56:59], a[224:227], v[176:179], v[76:79]
v_exp_f32 v5, v5
v_exp_f32 v6, v6
v_mfma_f32_16x16x32_bf16 v[56:59], a[228:231], v[180:183], v[56:59]
buffer_load_dwordx4 v229, s[12:15], s24 offen offset:1024  lds
v_cvt_pk_bf16_f32 v98, v4, v5
v_mfma_f32_16x16x32_bf16 v[56:59], a[232:235], v[184:187], v[56:59]
v_exp_f32 v7, v7
v_mfma_f32_16x16x32_bf16 v[56:59], a[236:239], v[188:191], v[56:59]
buffer_load_dwordx4 v230, s[8:11], s24 offen offset:2048  lds
v_exp_f32 v8, v8
v_mfma_f32_16x16x32_bf16 v[60:63], a[240:243], v[176:179], v[76:79]
v_cvt_pk_bf16_f32 v99, v6, v7
v_exp_f32 v9, v9
v_mfma_f32_16x16x32_bf16 v[60:63], a[244:247], v[180:183], v[60:63]
v_exp_f32 v10, v10
v_mfma_f32_16x16x32_bf16 v[60:63], a[248:251], v[184:187], v[60:63]
buffer_load_dwordx4 v231, s[8:11], s24 offen offset:3072  lds
v_cvt_pk_bf16_f32 v100, v8, v9
v_mfma_f32_16x16x32_bf16 v[60:63], a[252:255], v[188:191], v[60:63]
v_exp_f32 v11, v11
v_exp_f32 v12, v12
v_cvt_pk_bf16_f32 v101, v10, v11
v_exp_f32 v13, v13
v_exp_f32 v14, v14
v_cvt_pk_bf16_f32 v102, v12, v13
v_add_f32 v16, v16, v72
v_add_f32 v17, v17, v72
v_add_f32 v18, v18, v72
v_add_f32 v19, v19, v72
v_add_f32 v20, v20, v72
v_add_f32 v21, v21, v72
v_add_f32 v22, v22, v72
v_add_f32 v23, v23, v72
v_add_f32 v24, v24, v76
v_add_f32 v25, v25, v76
v_add_f32 v26, v26, v76
v_add_f32 v27, v27, v76
v_add_f32 v28, v28, v76
v_add_f32 v29, v29, v76
v_add_f32 v30, v30, v76
v_add_f32 v31, v31, v76
v_exp_f32 v15, v15
v_exp_f32 v16, v16
v_cvt_pk_bf16_f32 v103, v14, v15
v_exp_f32 v17, v17
v_exp_f32 v18, v18
v_cvt_pk_bf16_f32 v104, v16, v17
v_exp_f32 v19, v19
v_exp_f32 v20, v20
v_cvt_pk_bf16_f32 v105, v18, v19
v_exp_f32 v21, v21
v_exp_f32 v22, v22
v_cvt_pk_bf16_f32 v106, v20, v21
v_exp_f32 v23, v23
v_exp_f32 v24, v24
v_cvt_pk_bf16_f32 v107, v22, v23
v_exp_f32 v25, v25
v_exp_f32 v26, v26
v_cvt_pk_bf16_f32 v108, v24, v25
v_exp_f32 v27, v27
v_exp_f32 v28, v28
v_cvt_pk_bf16_f32 v109, v26, v27
v_exp_f32 v29, v29
v_exp_f32 v30, v30
v_cvt_pk_bf16_f32 v110, v28, v29
v_exp_f32 v31, v31
s_nop 0
v_cvt_pk_bf16_f32 v111, v30, v31
s_lshl_b32 s39, s27, 14
s_cmp_eq_u32 s61, 2
s_cselect_b32 s49, 262144, 0
s_mov_b32 s50, 2752
s_cselect_b32 s50, s49, s50
s_mov_b32 s52, 1024
s_cselect_b32 s52, 4096, s52
s_mov_b32 s51, 4096
s_cselect_b32 s51, 1024, s51
s_mov_b32 s48, 5504
s_cselect_b32 s48, 1024, s48
s_mov_b32 s36, 22016
s_cselect_b32 s36, 4096, s36
v_mul_u32_u24 v240, s36, v248
s_mul_i32 s51, s51, s27
s_add_u32 s51, s51, 131072
s_mul_i32 s48, s48, s27
s_lshl4_add_u32 s48, s63, s48
v_lshrrev_b32 v241, 3, v248
v_lshlrev_b32 v241, 10, v241
v_and_b32 v242, 7, v248
v_lshl_add_u32 v241, v242, 4, v241
s_lshr_b32 s53, s2, 1
s_and_b32 s36, s2, 1
s_lshl2_add_u32 s36, s36, s27
s_lshl_b32 s36, s36, 7
s_add_u32 s54, s36, s53
s_lshl_b32 s54, s54, 12
s_add_u32 s54, s54, 2097152
s_lshl_b32 s53, s53, 15
s_add_u32 s53, s53, s36
v_lshrrev_b32 v242, 2, v248
v_lshlrev_b32 v242, 7, v242
v_and_b32 v243, 3, v248
v_lshl_add_u32 v242, v243, 4, v242
s_add_u32 s36, s39, 65536
v_add_u32 v242, s36, v242
v_lshl_add_u32 v243, s27, 6, v248
v_mul_u32_u24 v243, 6144, v243
s_and_b32 s36, s2, 7
s_lshl_b32 s36, s36, 5
s_lshr_b32 s55, s2, 3
s_add_u32 s55, s55, s36
s_lshl_b32 s55, s55, 4
v_mov_b32 v80, 0
v_mov_b32 v81, 0
v_mov_b32 v82, 0
v_mov_b32 v83, 0
v_mov_b32 v84, 0
v_mov_b32 v85, 0
v_mov_b32 v86, 0
v_mov_b32 v87, 0
v_and_b32 v88, 1, v248
v_mul_u32_u24 v88, 0xaaaa, v88
v_or_b32 v88, 0x4444, v88
v_exp_f32 v32, v32
v_exp_f32 v33, v33
s_waitcnt vmcnt(9) lgkmcnt(0)
s_barrier
s_lshl1_add_u32 m0, s26, 32768
s_mov_b32 s24, 24576
buffer_load_dwordx4 v228, s[12:15], s24 offen  lds
La_go:
v_mfma_f32_16x16x32_bf16 v[0:3], a[192:195], v[128:131], v[64:67]
v_exp_f32 v34, v34
v_mfma_f32_16x16x32_bf16 v[0:3], a[196:199], v[132:135], v[0:3]
ds_read_b64_tr_b16 a[224:225], v220 offset:49152
v_cvt_pk_bf16_f32 v112, v32, v33
v_mfma_f32_16x16x32_bf16 v[0:3], a[200:203], v[136:139], v[0:3]
v_exp_f32 v35, v35
v_mfma_f32_16x16x32_bf16 v[0:3], a[204:207], v[140:143], v[0:3]
ds_read_b64_tr_b16 a[226:227], v220 offset:57344
ds_read_b64_tr_b16 a[228:229], v221 offset:49152
v_mfma_f32_16x16x32_bf16 v[4:7], a[208:211], v[128:131], v[64:67]
v_exp_f32 v36, v36
v_mfma_f32_16x16x32_bf16 v[4:7], a[212:215], v[132:135], v[4:7]
ds_read_b64_tr_b16 a[230:231], v221 offset:57344
v_cvt_pk_bf16_f32 v113, v34, v35
v_mfma_f32_16x16x32_bf16 v[4:7], a[216:219], v[136:139], v[4:7]
v_exp_f32 v37, v37
v_mfma_f32_16x16x32_bf16 v[4:7], a[220:223], v[140:143], v[4:7]
buffer_load_dwordx4 v229, s[12:15], s24 offen offset:1024  lds
v_mfma_f32_16x16x32_bf16 v[8:11], a[192:195], v[144:147], v[68:71]
v_exp_f32 v38, v38
v_mfma_f32_16x16x32_bf16 v[8:11], a[196:199], v[148:151], v[8:11]
ds_read_b64_tr_b16 a[232:233], v222 offset:49152
v_cvt_pk_bf16_f32 v114, v36, v37
v_mfma_f32_16x16x32_bf16 v[8:11], a[200:203], v[152:155], v[8:11]
v_exp_f32 v39, v39
v_mfma_f32_16x16x32_bf16 v[8:11], a[204:207], v[156:159], v[8:11]
ds_read_b64_tr_b16 a[234:235], v222 offset:57344
ds_read_b64_tr_b16 a[236:237], v223 offset:49152
v_mfma_f32_16x16x32_bf16 v[12:15], a[208:211], v[144:147], v[68:71]
v_exp_f32 v40, v40
v_mfma_f32_16x16x32_bf16 v[12:15], a[212:215], v[148:151], v[12:15]
ds_read_b64_tr_b16 a[238:239], v223 offset:57344
v_cvt_pk_bf16_f32 v115, v38, v39
v_mfma_f32_16x16x32_bf16 v[12:15], a[216:219], v[152:155], v[12:15]
v_exp_f32 v41, v41
v_mfma_f32_16x16x32_bf16 v[12:15], a[220:223], v[156:159], v[12:15]
ds_read_b64_tr_b16 a[240:241], v224 offset:49152
ds_read_b64_tr_b16 a[242:243], v224 offset:57344
v_mfma_f32_16x16x32_bf16 v[16:19], a[192:195], v[160:163], v[72:75]
v_exp_f32 v42, v42
v_mfma_f32_16x16x32_bf16 v[16:19], a[196:199], v[164:167], v[16:19]
ds_read_b64_tr_b16 a[244:245], v225 offset:49152
v_cvt_pk_bf16_f32 v116, v40, v41
v_mfma_f32_16x16x32_bf16 v[16:19], a[200:203], v[168:171], v[16:19]
v_exp_f32 v43, v43
v_mfma_f32_16x16x32_bf16 v[16:19], a[204:207], v[172:175], v[16:19]
ds_read_b64_tr_b16 a[246:247], v225 offset:57344
ds_read_b64_tr_b16 a[248:249], v226 offset:49152
v_mfma_f32_16x16x32_bf16 v[20:23], a[208:211], v[160:163], v[72:75]
v_exp_f32 v44, v44
v_mfma_f32_16x16x32_bf16 v[20:23], a[212:215], v[164:167], v[20:23]
ds_read_b64_tr_b16 a[250:251], v226 offset:57344
v_cvt_pk_bf16_f32 v117, v42, v43
v_mfma_f32_16x16x32_bf16 v[20:23], a[216:219], v[168:171], v[20:23]
v_exp_f32 v45, v45
v_mfma_f32_16x16x32_bf16 v[20:23], a[220:223], v[172:175], v[20:23]
buffer_load_dwordx4 v230, s[8:11], s24 offen offset:2048  lds
v_mfma_f32_16x16x32_bf16 v[24:27], a[192:195], v[176:179], v[76:79]
v_exp_f32 v46, v46
v_mfma_f32_16x16x32_bf16 v[24:27], a[196:199], v[180:183], v[24:27]
ds_read_b64_tr_b16 a[252:253], v227 offset:49152
v_cvt_pk_bf16_f32 v118, v44, v45
v_mfma_f32_16x16x32_bf16 v[24:27], a[200:203], v[184:187], v[24:27]
v_exp_f32 v47, v47
v_mfma_f32_16x16x32_bf16 v[24:27], a[204:207], v[188:191], v[24:27]
ds_read_b64_tr_b16 a[254:255], v227 offset:57344
v_mfma_f32_16x16x32_bf16 v[28:31], a[208:211], v[176:179], v[76:79]
v_exp_f32 v48, v48
v_smfmac_f32_16x16x64_bf16 v[80:83], v[232:235], v[96:103], v88
v_cvt_pk_bf16_f32 v119, v46, v47
v_mfma_f32_16x16x32_bf16 v[28:31], a[212:215], v[180:183], v[28:31]
s_add_u32 m0, s39, 65536
v_exp_f32 v49, v49
v_mfma_f32_16x16x32_bf16 v[28:31], a[216:219], v[184:187], v[28:31]
buffer_load_dwordx4 v241, s[20:23], s53 offen lds
v_mfma_f32_16x16x32_bf16 v[28:31], a[220:223], v[188:191], v[28:31]
s_lshl1_add_u32 m0, s26, 32768
v_exp_f32 v50, v50
v_smfmac_f32_16x16x64_bf16 v[84:87], v[232:235], v[104:111], v88
s_waitcnt lgkmcnt(0)
v_cvt_pk_bf16_f32 v120, v48, v49
v_mfma_f32_16x16x32_bf16 a[0:3], a[224:227], v[96:99], 0
s_add_u32 s53, s53, 8192
v_exp_f32 v51, v51
v_mfma_f32_16x16x32_bf16 a[4:7], a[224:227], v[100:103], 0
v_exp_f32 v52, v52
v_mfma_f32_16x16x32_bf16 a[8:11], a[224:227], v[104:107], 0
ds_read_b128 a[192:195], v216 offset:49152
v_cvt_pk_bf16_f32 v121, v50, v51
v_mfma_f32_16x16x32_bf16 a[12:15], a[224:227], v[108:111], 0
v_exp_f32 v53, v53
v_mfma_f32_16x16x32_bf16 a[16:19], a[228:231], v[96:99], 0
ds_read_b128 a[196:199], v217 offset:49152
ds_read_b128 a[200:203], v218 offset:49152
v_mfma_f32_16x16x32_bf16 a[20:23], a[228:231], v[100:103], 0
v_exp_f32 v54, v54
v_mfma_f32_16x16x32_bf16 a[24:27], a[228:231], v[104:107], 0
ds_read_b128 a[204:207], v219 offset:49152
v_cvt_pk_bf16_f32 v122, v52, v53
v_mfma_f32_16x16x32_bf16 a[28:31], a[228:231], v[108:111], 0
v_exp_f32 v55, v55
v_mfma_f32_16x16x32_bf16 a[32:35], a[232:235], v[96:99], 0
buffer_load_dwordx4 v231, s[8:11], s24 offen offset:3072  lds
v_mfma_f32_16x16x32_bf16 a[36:39], a[232:235], v[100:103], 0
s_add_u32 s24, s24, 8192
v_exp_f32 v56, v56
v_mfma_f32_16x16x32_bf16 a[40:43], a[232:235], v[104:107], 0
ds_read_b128 a[208:211], v216 offset:57344
v_cvt_pk_bf16_f32 v123, v54, v55
v_mfma_f32_16x16x32_bf16 a[44:47], a[232:235], v[108:111], 0
v_exp_f32 v57, v57
v_mfma_f32_16x16x32_bf16 a[48:51], a[236:239], v[96:99], 0
ds_read_b128 a[212:215], v217 offset:57344
ds_read_b128 a[216:219], v218 offset:57344
v_mfma_f32_16x16x32_bf16 a[52:55], a[236:239], v[100:103], 0
v_exp_f32 v58, v58
v_mfma_f32_16x16x32_bf16 a[56:59], a[236:239], v[104:107], 0
ds_read_b128 a[220:223], v219 offset:57344
v_cvt_pk_bf16_f32 v124, v56, v57
v_mfma_f32_16x16x32_bf16 a[60:63], a[236:239], v[108:111], 0
v_exp_f32 v59, v59
v_mfma_f32_16x16x32_bf16 a[64:67], a[240:243], v[96:99], 0
v_mfma_f32_16x16x32_bf16 a[68:71], a[240:243], v[100:103], 0
v_exp_f32 v60, v60
v_mfma_f32_16x16x32_bf16 a[72:75], a[240:243], v[104:107], 0
v_cvt_pk_bf16_f32 v125, v58, v59
v_mfma_f32_16x16x32_bf16 a[76:79], a[240:243], v[108:111], 0
v_exp_f32 v61, v61
v_mfma_f32_16x16x32_bf16 a[80:83], a[244:247], v[96:99], 0
s_lshl1_add_u32 m0, s26, 49152
v_mfma_f32_16x16x32_bf16 a[84:87], a[244:247], v[100:103], 0
s_waitcnt vmcnt(9) lgkmcnt(0)
s_barrier
v_mfma_f32_16x16x32_bf16 a[88:91], a[244:247], v[104:107], 0
buffer_load_dwordx4 v228, s[12:15], s24 offen  lds
v_mfma_f32_16x16x32_bf16 a[92:95], a[244:247], v[108:111], 0
v_mfma_f32_16x16x32_bf16 a[96:99], a[248:251], v[96:99], 0
v_exp_f32 v62, v62
v_mfma_f32_16x16x32_bf16 a[100:103], a[248:251], v[100:103], 0
v_cvt_pk_bf16_f32 v126, v60, v61
v_mfma_f32_16x16x32_bf16 a[104:107], a[248:251], v[104:107], 0
v_exp_f32 v63, v63
v_mfma_f32_16x16x32_bf16 a[108:111], a[248:251], v[108:111], 0
v_mfma_f32_16x16x32_bf16 a[112:115], a[252:255], v[96:99], 0
v_exp_f32 v0, v0
v_mfma_f32_16x16x32_bf16 a[116:119], a[252:255], v[100:103], 0
v_cvt_pk_bf16_f32 v127, v62, v63
v_mfma_f32_16x16x32_bf16 a[120:123], a[252:255], v[104:107], 0
v_exp_f32 v1, v1
v_mfma_f32_16x16x32_bf16 a[124:127], a[252:255], v[108:111], 0
v_mfma_f32_16x16x32_bf16 v[32:35], a[192:195], v[128:131], v[64:67]
v_exp_f32 v2, v2
v_mfma_f32_16x16x32_bf16 v[32:35], a[196:199], v[132:135], v[32:35]
ds_read_b64_tr_b16 a[224:225], v220 offset:0
v_cvt_pk_bf16_f32 v96, v0, v1
v_mfma_f32_16x16x32_bf16 v[32:35], a[200:203], v[136:139], v[32:35]
v_exp_f32 v3, v3
v_mfma_f32_16x16x32_bf16 v[32:35], a[204:207], v[140:143], v[32:35]
ds_read_b64_tr_b16 a[226:227], v220 offset:8192
ds_read_b64_tr_b16 a[228:229], v221 offset:0
v_mfma_f32_16x16x32_bf16 v[36:39], a[208:211], v[128:131], v[64:67]
v_exp_f32 v4, v4
v_mfma_f32_16x16x32_bf16 v[36:39], a[212:215], v[132:135], v[36:39]
ds_read_b64_tr_b16 a[230:231], v221 offset:8192
v_cvt_pk_bf16_f32 v97, v2, v3
v_mfma_f32_16x16x32_bf16 v[36:39], a[216:219], v[136:139], v[36:39]
v_exp_f32 v5, v5
v_mfma_f32_16x16x32_bf16 v[36:39], a[220:223], v[140:143], v[36:39]
buffer_load_dwordx4 v229, s[12:15], s24 offen offset:1024  lds
v_mfma_f32_16x16x32_bf16 v[40:43], a[192:195], v[144:147], v[68:71]
v_exp_f32 v6, v6
v_mfma_f32_16x16x32_bf16 v[40:43], a[196:199], v[148:151], v[40:43]
ds_read_b64_tr_b16 a[232:233], v222 offset:0
v_cvt_pk_bf16_f32 v98, v4, v5
v_mfma_f32_16x16x32_bf16 v[40:43], a[200:203], v[152:155], v[40:43]
v_exp_f32 v7, v7
v_mfma_f32_16x16x32_bf16 v[40:43], a[204:207], v[156:159], v[40:43]
ds_read_b64_tr_b16 a[234:235], v222 offset:8192
ds_read_b64_tr_b16 a[236:237], v223 offset:0
v_mfma_f32_16x16x32_bf16 v[44:47], a[208:211], v[144:147], v[68:71]
v_exp_f32 v8, v8
v_mfma_f32_16x16x32_bf16 v[44:47], a[212:215], v[148:151], v[44:47]
ds_read_b64_tr_b16 a[238:239], v223 offset:8192
v_cvt_pk_bf16_f32 v99, v6, v7
v_mfma_f32_16x16x32_bf16 v[44:47], a[216:219], v[152:155], v[44:47]
v_exp_f32 v9, v9
v_mfma_f32_16x16x32_bf16 v[44:47], a[220:223], v[156:159], v[44:47]
ds_read_b64_tr_b16 a[240:241], v224 offset:0
ds_read_b64_tr_b16 a[242:243], v224 offset:8192
v_mfma_f32_16x16x32_bf16 v[48:51], a[192:195], v[160:163], v[72:75]
v_exp_f32 v10, v10
v_mfma_f32_16x16x32_bf16 v[48:51], a[196:199], v[164:167], v[48:51]
ds_read_b64_tr_b16 a[244:245], v225 offset:0
v_cvt_pk_bf16_f32 v100, v8, v9
v_mfma_f32_16x16x32_bf16 v[48:51], a[200:203], v[168:171], v[48:51]
v_exp_f32 v11, v11
v_mfma_f32_16x16x32_bf16 v[48:51], a[204:207], v[172:175], v[48:51]
ds_read_b64_tr_b16 a[246:247], v225 offset:8192
ds_read_b64_tr_b16 a[248:249], v226 offset:0
v_mfma_f32_16x16x32_bf16 v[52:55], a[208:211], v[160:163], v[72:75]
v_exp_f32 v12, v12
v_mfma_f32_16x16x32_bf16 v[52:55], a[212:215], v[164:167], v[52:55]
ds_read_b64_tr_b16 a[250:251], v226 offset:8192
v_cvt_pk_bf16_f32 v101, v10, v11
v_mfma_f32_16x16x32_bf16 v[52:55], a[216:219], v[168:171], v[52:55]
v_exp_f32 v13, v13
v_mfma_f32_16x16x32_bf16 v[52:55], a[220:223], v[172:175], v[52:55]
buffer_load_dwordx4 v230, s[8:11], s24 offen offset:2048  lds
v_mfma_f32_16x16x32_bf16 v[56:59], a[192:195], v[176:179], v[76:79]
v_exp_f32 v14, v14
v_mfma_f32_16x16x32_bf16 v[56:59], a[196:199], v[180:183], v[56:59]
ds_read_b64_tr_b16 a[252:253], v227 offset:0
v_cvt_pk_bf16_f32 v102, v12, v13
v_mfma_f32_16x16x32_bf16 v[56:59], a[200:203], v[184:187], v[56:59]
v_exp_f32 v15, v15
v_mfma_f32_16x16x32_bf16 v[56:59], a[204:207], v[188:191], v[56:59]
ds_read_b64_tr_b16 a[254:255], v227 offset:8192
v_mfma_f32_16x16x32_bf16 v[60:63], a[208:211], v[176:179], v[76:79]
v_exp_f32 v16, v16
v_smfmac_f32_16x16x64_bf16 v[80:83], v[232:235], v[112:119], v88
v_cvt_pk_bf16_f32 v103, v14, v15
v_mfma_f32_16x16x32_bf16 v[60:63], a[212:215], v[180:183], v[60:63]
s_add_u32 m0, s39, 66560
v_exp_f32 v17, v17
v_mfma_f32_16x16x32_bf16 v[60:63], a[216:219], v[184:187], v[60:63]
buffer_load_dwordx4 v241, s[20:23], s53 offen lds
v_mfma_f32_16x16x32_bf16 v[60:63], a[220:223], v[188:191], v[60:63]
s_lshl1_add_u32 m0, s26, 49152
v_exp_f32 v18, v18
v_smfmac_f32_16x16x64_bf16 v[84:87], v[232:235], v[120:127], v88
s_waitcnt lgkmcnt(0)
v_cvt_pk_bf16_f32 v104, v16, v17
v_mfma_f32_16x16x32_bf16 a[0:3], a[224:227], v[112:115], a[0:3]
s_add_u32 s53, s53, 8192
v_exp_f32 v19, v19
v_mfma_f32_16x16x32_bf16 a[4:7], a[224:227], v[116:119], a[4:7]
v_exp_f32 v20, v20
v_mfma_f32_16x16x32_bf16 a[8:11], a[224:227], v[120:123], a[8:11]
ds_read_b128 a[192:195], v216 offset:0
v_cvt_pk_bf16_f32 v105, v18, v19
v_mfma_f32_16x16x32_bf16 a[12:15], a[224:227], v[124:127], a[12:15]
v_exp_f32 v21, v21
v_mfma_f32_16x16x32_bf16 a[16:19], a[228:231], v[112:115], a[16:19]
ds_read_b128 a[196:199], v217 offset:0
ds_read_b128 a[200:203], v218 offset:0
v_mfma_f32_16x16x32_bf16 a[20:23], a[228:231], v[116:119], a[20:23]
v_exp_f32 v22, v22
v_mfma_f32_16x16x32_bf16 a[24:27], a[228:231], v[120:123], a[24:27]
ds_read_b128 a[204:207], v219 offset:0
v_cvt_pk_bf16_f32 v106, v20, v21
v_mfma_f32_16x16x32_bf16 a[28:31], a[228:231], v[124:127], a[28:31]
v_exp_f32 v23, v23
v_mfma_f32_16x16x32_bf16 a[32:35], a[232:235], v[112:115], a[32:35]
buffer_load_dwordx4 v231, s[8:11], s24 offen offset:3072  lds
v_mfma_f32_16x16x32_bf16 a[36:39], a[232:235], v[116:119], a[36:39]
s_add_u32 s24, s24, 8192
v_exp_f32 v24, v24
v_mfma_f32_16x16x32_bf16 a[40:43], a[232:235], v[120:123], a[40:43]
ds_read_b128 a[208:211], v216 offset:8192
v_cvt_pk_bf16_f32 v107, v22, v23
v_mfma_f32_16x16x32_bf16 a[44:47], a[232:235], v[124:127], a[44:47]
v_exp_f32 v25, v25
v_mfma_f32_16x16x32_bf16 a[48:51], a[236:239], v[112:115], a[48:51]
ds_read_b128 a[212:215], v217 offset:8192
ds_read_b128 a[216:219], v218 offset:8192
v_mfma_f32_16x16x32_bf16 a[52:55], a[236:239], v[116:119], a[52:55]
v_exp_f32 v26, v26
v_mfma_f32_16x16x32_bf16 a[56:59], a[236:239], v[120:123], a[56:59]
ds_read_b128 a[220:223], v219 offset:8192
v_cvt_pk_bf16_f32 v108, v24, v25
v_mfma_f32_16x16x32_bf16 a[60:63], a[236:239], v[124:127], a[60:63]
v_exp_f32 v27, v27
v_mfma_f32_16x16x32_bf16 a[64:67], a[240:243], v[112:115], a[64:67]
v_mfma_f32_16x16x32_bf16 a[68:71], a[240:243], v[116:119], a[68:71]
v_exp_f32 v28, v28
v_mfma_f32_16x16x32_bf16 a[72:75], a[240:243], v[120:123], a[72:75]
v_cvt_pk_bf16_f32 v109, v26, v27
v_mfma_f32_16x16x32_bf16 a[76:79], a[240:243], v[124:127], a[76:79]
v_exp_f32 v29, v29
v_mfma_f32_16x16x32_bf16 a[80:83], a[244:247], v[112:115], a[80:83]
s_lshl1_add_u32 m0, s26, 0
v_mfma_f32_16x16x32_bf16 a[84:87], a[244:247], v[116:119], a[84:87]
s_waitcnt vmcnt(10) lgkmcnt(0)
s_barrier
v_mfma_f32_16x16x32_bf16 a[88:91], a[244:247], v[120:123], a[88:91]
buffer_load_dwordx4 v228, s[12:15], s24 offen  lds
v_mfma_f32_16x16x32_bf16 a[92:95], a[244:247], v[124:127], a[92:95]
v_mfma_f32_16x16x32_bf16 a[96:99], a[248:251], v[112:115], a[96:99]
v_exp_f32 v30, v30
v_mfma_f32_16x16x32_bf16 a[100:103], a[248:251], v[116:119], a[100:103]
v_cvt_pk_bf16_f32 v110, v28, v29
v_mfma_f32_16x16x32_bf16 a[104:107], a[248:251], v[120:123], a[104:107]
v_exp_f32 v31, v31
v_mfma_f32_16x16x32_bf16 a[108:111], a[248:251], v[124:127], a[108:111]
v_mfma_f32_16x16x32_bf16 a[112:115], a[252:255], v[112:115], a[112:115]
v_exp_f32 v32, v32
v_mfma_f32_16x16x32_bf16 a[116:119], a[252:255], v[116:119], a[116:119]
v_cvt_pk_bf16_f32 v111, v30, v31
v_mfma_f32_16x16x32_bf16 a[120:123], a[252:255], v[120:123], a[120:123]
v_exp_f32 v33, v33
v_mfma_f32_16x16x32_bf16 a[124:127], a[252:255], v[124:127], a[124:127]
v_mfma_f32_16x16x32_bf16 v[0:3], a[192:195], v[128:131], v[64:67]
v_exp_f32 v34, v34
v_mfma_f32_16x16x32_bf16 v[0:3], a[196:199], v[132:135], v[0:3]
ds_read_b64_tr_b16 a[224:225], v220 offset:16384
v_cvt_pk_bf16_f32 v112, v32, v33
v_mfma_f32_16x16x32_bf16 v[0:3], a[200:203], v[136:139], v[0:3]
v_exp_f32 v35, v35
v_mfma_f32_16x16x32_bf16 v[0:3], a[204:207], v[140:143], v[0:3]
ds_read_b64_tr_b16 a[226:227], v220 offset:24576
ds_read_b64_tr_b16 a[228:229], v221 offset:16384
v_mfma_f32_16x16x32_bf16 v[4:7], a[208:211], v[128:131], v[64:67]
v_exp_f32 v36, v36
v_mfma_f32_16x16x32_bf16 v[4:7], a[212:215], v[132:135], v[4:7]
ds_read_b64_tr_b16 a[230:231], v221 offset:24576
v_cvt_pk_bf16_f32 v113, v34, v35
v_mfma_f32_16x16x32_bf16 v[4:7], a[216:219], v[136:139], v[4:7]
v_exp_f32 v37, v37
v_mfma_f32_16x16x32_bf16 v[4:7], a[220:223], v[140:143], v[4:7]
buffer_load_dwordx4 v229, s[12:15], s24 offen offset:1024  lds
v_mfma_f32_16x16x32_bf16 v[8:11], a[192:195], v[144:147], v[68:71]
v_exp_f32 v38, v38
v_mfma_f32_16x16x32_bf16 v[8:11], a[196:199], v[148:151], v[8:11]
ds_read_b64_tr_b16 a[232:233], v222 offset:16384
v_cvt_pk_bf16_f32 v114, v36, v37
v_mfma_f32_16x16x32_bf16 v[8:11], a[200:203], v[152:155], v[8:11]
v_exp_f32 v39, v39
v_mfma_f32_16x16x32_bf16 v[8:11], a[204:207], v[156:159], v[8:11]
ds_read_b64_tr_b16 a[234:235], v222 offset:24576
ds_read_b64_tr_b16 a[236:237], v223 offset:16384
v_mfma_f32_16x16x32_bf16 v[12:15], a[208:211], v[144:147], v[68:71]
v_exp_f32 v40, v40
v_mfma_f32_16x16x32_bf16 v[12:15], a[212:215], v[148:151], v[12:15]
ds_read_b64_tr_b16 a[238:239], v223 offset:24576
v_cvt_pk_bf16_f32 v115, v38, v39
v_mfma_f32_16x16x32_bf16 v[12:15], a[216:219], v[152:155], v[12:15]
v_exp_f32 v41, v41
v_mfma_f32_16x16x32_bf16 v[12:15], a[220:223], v[156:159], v[12:15]
ds_read_b64_tr_b16 a[240:241], v224 offset:16384
ds_read_b64_tr_b16 a[242:243], v224 offset:24576
v_mfma_f32_16x16x32_bf16 v[16:19], a[192:195], v[160:163], v[72:75]
v_exp_f32 v42, v42
v_mfma_f32_16x16x32_bf16 v[16:19], a[196:199], v[164:167], v[16:19]
ds_read_b64_tr_b16 a[244:245], v225 offset:16384
v_cvt_pk_bf16_f32 v116, v40, v41
v_mfma_f32_16x16x32_bf16 v[16:19], a[200:203], v[168:171], v[16:19]
v_exp_f32 v43, v43
v_mfma_f32_16x16x32_bf16 v[16:19], a[204:207], v[172:175], v[16:19]
ds_read_b64_tr_b16 a[246:247], v225 offset:24576
ds_read_b64_tr_b16 a[248:249], v226 offset:16384
v_mfma_f32_16x16x32_bf16 v[20:23], a[208:211], v[160:163], v[72:75]
v_exp_f32 v44, v44
v_mfma_f32_16x16x32_bf16 v[20:23], a[212:215], v[164:167], v[20:23]
ds_read_b64_tr_b16 a[250:251], v226 offset:24576
v_cvt_pk_bf16_f32 v117, v42, v43
v_mfma_f32_16x16x32_bf16 v[20:23], a[216:219], v[168:171], v[20:23]
v_exp_f32 v45, v45
v_mfma_f32_16x16x32_bf16 v[20:23], a[220:223], v[172:175], v[20:23]
buffer_load_dwordx4 v230, s[8:11], s24 offen offset:2048  lds
v_mfma_f32_16x16x32_bf16 v[24:27], a[192:195], v[176:179], v[76:79]
v_exp_f32 v46, v46
v_mfma_f32_16x16x32_bf16 v[24:27], a[196:199], v[180:183], v[24:27]
ds_read_b64_tr_b16 a[252:253], v227 offset:16384
v_cvt_pk_bf16_f32 v118, v44, v45
v_mfma_f32_16x16x32_bf16 v[24:27], a[200:203], v[184:187], v[24:27]
v_exp_f32 v47, v47
v_mfma_f32_16x16x32_bf16 v[24:27], a[204:207], v[188:191], v[24:27]
ds_read_b64_tr_b16 a[254:255], v227 offset:24576
Lpad5:
s_cbranch_execz Lpad9
v_mfma_f32_16x16x32_bf16 v[28:31], a[208:211], v[176:179], v[76:79]
v_exp_f32 v48, v48
v_smfmac_f32_16x16x64_bf16 v[80:83], v[232:235], v[96:103], v88
v_cvt_pk_bf16_f32 v119, v46, v47
v_mfma_f32_16x16x32_bf16 v[28:31], a[212:215], v[180:183], v[28:31]
s_add_u32 m0, s39, 67584
v_exp_f32 v49, v49
v_mfma_f32_16x16x32_bf16 v[28:31], a[216:219], v[184:187], v[28:31]
buffer_load_dwordx4 v241, s[20:23], s53 offen lds
v_mfma_f32_16x16x32_bf16 v[28:31], a[220:223], v[188:191], v[28:31]
s_lshl1_add_u32 m0, s26, 0
v_exp_f32 v50, v50
v_smfmac_f32_16x16x64_bf16 v[84:87], v[232:235], v[104:111], v88
s_waitcnt lgkmcnt(0)
v_cvt_pk_bf16_f32 v120, v48, v49
v_mfma_f32_16x16x32_bf16 a[0:3], a[224:227], v[96:99], a[0:3]
s_add_u32 s53, s53, 8192
v_exp_f32 v51, v51
v_mfma_f32_16x16x32_bf16 a[4:7], a[224:227], v[100:103], a[4:7]
v_exp_f32 v52, v52
v_mfma_f32_16x16x32_bf16 a[8:11], a[224:227], v[104:107], a[8:11]
ds_read_b128 a[192:195], v216 offset:16384
v_cvt_pk_bf16_f32 v121, v50, v51
v_mfma_f32_16x16x32_bf16 a[12:15], a[224:227], v[108:111], a[12:15]
v_exp_f32 v53, v53
v_mfma_f32_16x16x32_bf16 a[16:19], a[228:231], v[96:99], a[16:19]
ds_read_b128 a[196:199], v217 offset:16384
ds_read_b128 a[200:203], v218 offset:16384
v_mfma_f32_16x16x32_bf16 a[20:23], a[228:231], v[100:103], a[20:23]
v_exp_f32 v54, v54
v_mfma_f32_16x16x32_bf16 a[24:27], a[228:231], v[104:107], a[24:27]
ds_read_b128 a[204:207], v219 offset:16384
v_cvt_pk_bf16_f32 v122, v52, v53
v_mfma_f32_16x16x32_bf16 a[28:31], a[228:231], v[108:111], a[28:31]
v_exp_f32 v55, v55
v_mfma_f32_16x16x32_bf16 a[32:35], a[232:235], v[96:99], a[32:35]
buffer_load_dwordx4 v231, s[8:11], s24 offen offset:3072  lds
v_mfma_f32_16x16x32_bf16 a[36:39], a[232:235], v[100:103], a[36:39]
s_add_u32 s24, s24, 8192
v_exp_f32 v56, v56
v_mfma_f32_16x16x32_bf16 a[40:43], a[232:235], v[104:107], a[40:43]
ds_read_b128 a[208:211], v216 offset:24576
v_cvt_pk_bf16_f32 v123, v54, v55
v_mfma_f32_16x16x32_bf16 a[44:47], a[232:235], v[108:111], a[44:47]
v_exp_f32 v57, v57
v_mfma_f32_16x16x32_bf16 a[48:51], a[236:239], v[96:99], a[48:51]
ds_read_b128 a[212:215], v217 offset:24576
ds_read_b128 a[216:219], v218 offset:24576
v_mfma_f32_16x16x32_bf16 a[52:55], a[236:239], v[100:103], a[52:55]
v_exp_f32 v58, v58
v_mfma_f32_16x16x32_bf16 a[56:59], a[236:239], v[104:107], a[56:59]
ds_read_b128 a[220:223], v219 offset:24576
v_cvt_pk_bf16_f32 v124, v56, v57
v_mfma_f32_16x16x32_bf16 a[60:63], a[236:239], v[108:111], a[60:63]
v_exp_f32 v59, v59
v_mfma_f32_16x16x32_bf16 a[64:67], a[240:243], v[96:99], a[64:67]
v_mfma_f32_16x16x32_bf16 a[68:71], a[240:243], v[100:103], a[68:71]
v_exp_f32 v60, v60
v_mfma_f32_16x16x32_bf16 a[72:75], a[240:243], v[104:107], a[72:75]
v_cvt_pk_bf16_f32 v125, v58, v59
v_mfma_f32_16x16x32_bf16 a[76:79], a[240:243], v[108:111], a[76:79]
v_exp_f32 v61, v61
v_mfma_f32_16x16x32_bf16 a[80:83], a[244:247], v[96:99], a[80:83]
s_lshl1_add_u32 m0, s26, 16384
v_mfma_f32_16x16x32_bf16 a[84:87], a[244:247], v[100:103], a[84:87]
s_waitcnt vmcnt(10) lgkmcnt(0)
s_barrier
v_mfma_f32_16x16x32_bf16 a[88:91], a[244:247], v[104:107], a[88:91]
buffer_load_dwordx4 v228, s[12:15], s24 offen  lds
v_mfma_f32_16x16x32_bf16 a[92:95], a[244:247], v[108:111], a[92:95]
v_mfma_f32_16x16x32_bf16 a[96:99], a[248:251], v[96:99], a[96:99]
v_exp_f32 v62, v62
v_mfma_f32_16x16x32_bf16 a[100:103], a[248:251], v[100:103], a[100:103]
v_cvt_pk_bf16_f32 v126, v60, v61
v_mfma_f32_16x16x32_bf16 a[104:107], a[248:251], v[104:107], a[104:107]
v_exp_f32 v63, v63
v_mfma_f32_16x16x32_bf16 a[108:111], a[248:251], v[108:111], a[108:111]
v_mfma_f32_16x16x32_bf16 a[112:115], a[252:255], v[96:99], a[112:115]
v_exp_f32 v0, v0
v_mfma_f32_16x16x32_bf16 a[116:119], a[252:255], v[100:103], a[116:119]
v_cvt_pk_bf16_f32 v127, v62, v63
v_mfma_f32_16x16x32_bf16 a[120:123], a[252:255], v[104:107], a[120:123]
v_exp_f32 v1, v1
v_mfma_f32_16x16x32_bf16 a[124:127], a[252:255], v[108:111], a[124:127]
v_mfma_f32_16x16x32_bf16 v[32:35], a[192:195], v[128:131], v[64:67]
v_exp_f32 v2, v2
v_mfma_f32_16x16x32_bf16 v[32:35], a[196:199], v[132:135], v[32:35]
ds_read_b64_tr_b16 a[224:225], v220 offset:32768
v_cvt_pk_bf16_f32 v96, v0, v1
v_mfma_f32_16x16x32_bf16 v[32:35], a[200:203], v[136:139], v[32:35]
v_exp_f32 v3, v3
v_mfma_f32_16x16x32_bf16 v[32:35], a[204:207], v[140:143], v[32:35]
ds_read_b64_tr_b16 a[226:227], v220 offset:40960
ds_read_b64_tr_b16 a[228:229], v221 offset:32768
v_mfma_f32_16x16x32_bf16 v[36:39], a[208:211], v[128:131], v[64:67]
v_exp_f32 v4, v4
v_mfma_f32_16x16x32_bf16 v[36:39], a[212:215], v[132:135], v[36:39]
ds_read_b64_tr_b16 a[230:231], v221 offset:40960
v_cvt_pk_bf16_f32 v97, v2, v3
v_mfma_f32_16x16x32_bf16 v[36:39], a[216:219], v[136:139], v[36:39]
v_exp_f32 v5, v5
v_mfma_f32_16x16x32_bf16 v[36:39], a[220:223], v[140:143], v[36:39]
buffer_load_dwordx4 v229, s[12:15], s24 offen offset:1024  lds
v_mfma_f32_16x16x32_bf16 v[40:43], a[192:195], v[144:147], v[68:71]
v_exp_f32 v6, v6
v_mfma_f32_16x16x32_bf16 v[40:43], a[196:199], v[148:151], v[40:43]
ds_read_b64_tr_b16 a[232:233], v222 offset:32768
v_cvt_pk_bf16_f32 v98, v4, v5
v_mfma_f32_16x16x32_bf16 v[40:43], a[200:203], v[152:155], v[40:43]
v_exp_f32 v7, v7
v_mfma_f32_16x16x32_bf16 v[40:43], a[204:207], v[156:159], v[40:43]
ds_read_b64_tr_b16 a[234:235], v222 offset:40960
ds_read_b64_tr_b16 a[236:237], v223 offset:32768
v_mfma_f32_16x16x32_bf16 v[44:47], a[208:211], v[144:147], v[68:71]
v_exp_f32 v8, v8
v_mfma_f32_16x16x32_bf16 v[44:47], a[212:215], v[148:151], v[44:47]
ds_read_b64_tr_b16 a[238:239], v223 offset:40960
v_cvt_pk_bf16_f32 v99, v6, v7
v_mfma_f32_16x16x32_bf16 v[44:47], a[216:219], v[152:155], v[44:47]
v_exp_f32 v9, v9
v_mfma_f32_16x16x32_bf16 v[44:47], a[220:223], v[156:159], v[44:47]
ds_read_b64_tr_b16 a[240:241], v224 offset:32768
ds_read_b64_tr_b16 a[242:243], v224 offset:40960
v_mfma_f32_16x16x32_bf16 v[48:51], a[192:195], v[160:163], v[72:75]
v_exp_f32 v10, v10
v_mfma_f32_16x16x32_bf16 v[48:51], a[196:199], v[164:167], v[48:51]
ds_read_b64_tr_b16 a[244:245], v225 offset:32768
v_cvt_pk_bf16_f32 v100, v8, v9
v_mfma_f32_16x16x32_bf16 v[48:51], a[200:203], v[168:171], v[48:51]
v_exp_f32 v11, v11
v_mfma_f32_16x16x32_bf16 v[48:51], a[204:207], v[172:175], v[48:51]
ds_read_b64_tr_b16 a[246:247], v225 offset:40960
ds_read_b64_tr_b16 a[248:249], v226 offset:32768
v_mfma_f32_16x16x32_bf16 v[52:55], a[208:211], v[160:163], v[72:75]
v_exp_f32 v12, v12
v_mfma_f32_16x16x32_bf16 v[52:55], a[212:215], v[164:167], v[52:55]
ds_read_b64_tr_b16 a[250:251], v226 offset:40960
v_cvt_pk_bf16_f32 v101, v10, v11
v_mfma_f32_16x16x32_bf16 v[52:55], a[216:219], v[168:171], v[52:55]
v_exp_f32 v13, v13
v_mfma_f32_16x16x32_bf16 v[52:55], a[220:223], v[172:175], v[52:55]
buffer_load_dwordx4 v230, s[8:11], s24 offen offset:2048  lds
v_mfma_f32_16x16x32_bf16 v[56:59], a[192:195], v[176:179], v[76:79]
v_exp_f32 v14, v14
v_mfma_f32_16x16x32_bf16 v[56:59], a[196:199], v[180:183], v[56:59]
ds_read_b64_tr_b16 a[252:253], v227 offset:32768
v_cvt_pk_bf16_f32 v102, v12, v13
v_mfma_f32_16x16x32_bf16 v[56:59], a[200:203], v[184:187], v[56:59]
v_exp_f32 v15, v15
v_mfma_f32_16x16x32_bf16 v[56:59], a[204:207], v[188:191], v[56:59]
ds_read_b64_tr_b16 a[254:255], v227 offset:40960
v_mfma_f32_16x16x32_bf16 v[60:63], a[208:211], v[176:179], v[76:79]
v_exp_f32 v16, v16
v_smfmac_f32_16x16x64_bf16 v[80:83], v[232:235], v[112:119], v88
v_cvt_pk_bf16_f32 v103, v14, v15
v_mfma_f32_16x16x32_bf16 v[60:63], a[212:215], v[180:183], v[60:63]
s_add_u32 m0, s39, 68608
v_exp_f32 v17, v17
v_mfma_f32_16x16x32_bf16 v[60:63], a[216:219], v[184:187], v[60:63]
buffer_load_dwordx4 v241, s[20:23], s53 offen lds
v_mfma_f32_16x16x32_bf16 v[60:63], a[220:223], v[188:191], v[60:63]
s_lshl1_add_u32 m0, s26, 16384
v_exp_f32 v18, v18
v_smfmac_f32_16x16x64_bf16 v[84:87], v[232:235], v[120:127], v88
s_waitcnt lgkmcnt(0)
v_cvt_pk_bf16_f32 v104, v16, v17
v_mfma_f32_16x16x32_bf16 a[0:3], a[224:227], v[112:115], a[0:3]
s_add_u32 s53, s53, 8192
v_exp_f32 v19, v19
v_mfma_f32_16x16x32_bf16 a[4:7], a[224:227], v[116:119], a[4:7]
v_exp_f32 v20, v20
v_mfma_f32_16x16x32_bf16 a[8:11], a[224:227], v[120:123], a[8:11]
ds_read_b128 a[192:195], v216 offset:32768
v_cvt_pk_bf16_f32 v105, v18, v19
v_mfma_f32_16x16x32_bf16 a[12:15], a[224:227], v[124:127], a[12:15]
v_exp_f32 v21, v21
v_mfma_f32_16x16x32_bf16 a[16:19], a[228:231], v[112:115], a[16:19]
ds_read_b128 a[196:199], v217 offset:32768
ds_read_b128 a[200:203], v218 offset:32768
v_mfma_f32_16x16x32_bf16 a[20:23], a[228:231], v[116:119], a[20:23]
v_exp_f32 v22, v22
v_mfma_f32_16x16x32_bf16 a[24:27], a[228:231], v[120:123], a[24:27]
ds_read_b128 a[204:207], v219 offset:32768
v_cvt_pk_bf16_f32 v106, v20, v21
v_mfma_f32_16x16x32_bf16 a[28:31], a[228:231], v[124:127], a[28:31]
v_exp_f32 v23, v23
v_mfma_f32_16x16x32_bf16 a[32:35], a[232:235], v[112:115], a[32:35]
buffer_load_dwordx4 v231, s[8:11], s24 offen offset:3072  lds
v_mfma_f32_16x16x32_bf16 a[36:39], a[232:235], v[116:119], a[36:39]
s_add_u32 s24, s24, 8192
v_exp_f32 v24, v24
v_mfma_f32_16x16x32_bf16 a[40:43], a[232:235], v[120:123], a[40:43]
ds_read_b128 a[208:211], v216 offset:40960
v_cvt_pk_bf16_f32 v107, v22, v23
v_mfma_f32_16x16x32_bf16 a[44:47], a[232:235], v[124:127], a[44:47]
v_exp_f32 v25, v25
v_mfma_f32_16x16x32_bf16 a[48:51], a[236:239], v[112:115], a[48:51]
ds_read_b128 a[212:215], v217 offset:40960
ds_read_b128 a[216:219], v218 offset:40960
v_mfma_f32_16x16x32_bf16 a[52:55], a[236:239], v[116:119], a[52:55]
v_exp_f32 v26, v26
v_mfma_f32_16x16x32_bf16 a[56:59], a[236:239], v[120:123], a[56:59]
ds_read_b128 a[220:223], v219 offset:40960
v_cvt_pk_bf16_f32 v108, v24, v25
v_mfma_f32_16x16x32_bf16 a[60:63], a[236:239], v[124:127], a[60:63]
v_exp_f32 v27, v27
v_mfma_f32_16x16x32_bf16 a[64:67], a[240:243], v[112:115], a[64:67]
v_mfma_f32_16x16x32_bf16 a[68:71], a[240:243], v[116:119], a[68:71]
v_exp_f32 v28, v28
v_mfma_f32_16x16x32_bf16 a[72:75], a[240:243], v[120:123], a[72:75]
v_cvt_pk_bf16_f32 v109, v26, v27
v_mfma_f32_16x16x32_bf16 a[76:79], a[240:243], v[124:127], a[76:79]
v_exp_f32 v29, v29
v_mfma_f32_16x16x32_bf16 a[80:83], a[244:247], v[112:115], a[80:83]
s_lshl1_add_u32 m0, s26, 32768
v_mfma_f32_16x16x32_bf16 a[84:87], a[244:247], v[116:119], a[84:87]
s_waitcnt vmcnt(10) lgkmcnt(0)
s_barrier
v_mfma_f32_16x16x32_bf16 a[88:91], a[244:247], v[120:123], a[88:91]
buffer_load_dwordx4 v228, s[12:15], s24 offen  lds
v_mfma_f32_16x16x32_bf16 a[92:95], a[244:247], v[124:127], a[92:95]
v_mfma_f32_16x16x32_bf16 a[96:99], a[248:251], v[112:115], a[96:99]
v_exp_f32 v30, v30
v_mfma_f32_16x16x32_bf16 a[100:103], a[248:251], v[116:119], a[100:103]
v_cvt_pk_bf16_f32 v110, v28, v29
v_mfma_f32_16x16x32_bf16 a[104:107], a[248:251], v[120:123], a[104:107]
v_exp_f32 v31, v31
v_mfma_f32_16x16x32_bf16 a[108:111], a[248:251], v[124:127], a[108:111]
v_mfma_f32_16x16x32_bf16 a[112:115], a[252:255], v[112:115], a[112:115]
v_exp_f32 v32, v32
v_mfma_f32_16x16x32_bf16 a[116:119], a[252:255], v[116:119], a[116:119]
v_cvt_pk_bf16_f32 v111, v30, v31
v_mfma_f32_16x16x32_bf16 a[120:123], a[252:255], v[120:123], a[120:123]
v_exp_f32 v33, v33
v_mfma_f32_16x16x32_bf16 a[124:127], a[252:255], v[124:127], a[124:127]
v_mfma_f32_16x16x32_bf16 v[0:3], a[192:195], v[128:131], v[64:67]
v_exp_f32 v34, v34
v_mfma_f32_16x16x32_bf16 v[0:3], a[196:199], v[132:135], v[0:3]
ds_read_b64_tr_b16 a[224:225], v220 offset:49152
v_cvt_pk_bf16_f32 v112, v32, v33
v_mfma_f32_16x16x32_bf16 v[0:3], a[200:203], v[136:139], v[0:3]
v_exp_f32 v35, v35
v_mfma_f32_16x16x32_bf16 v[0:3], a[204:207], v[140:143], v[0:3]
ds_read_b64_tr_b16 a[226:227], v220 offset:57344
ds_read_b64_tr_b16 a[228:229], v221 offset:49152
v_mfma_f32_16x16x32_bf16 v[4:7], a[208:211], v[128:131], v[64:67]
v_exp_f32 v36, v36
v_mfma_f32_16x16x32_bf16 v[4:7], a[212:215], v[132:135], v[4:7]
ds_read_b64_tr_b16 a[230:231], v221 offset:57344
v_cvt_pk_bf16_f32 v113, v34, v35
v_mfma_f32_16x16x32_bf16 v[4:7], a[216:219], v[136:139], v[4:7]
v_exp_f32 v37, v37
v_mfma_f32_16x16x32_bf16 v[4:7], a[220:223], v[140:143], v[4:7]
buffer_load_dwordx4 v229, s[12:15], s24 offen offset:1024  lds
v_mfma_f32_16x16x32_bf16 v[8:11], a[192:195], v[144:147], v[68:71]
v_exp_f32 v38, v38
v_mfma_f32_16x16x32_bf16 v[8:11], a[196:199], v[148:151], v[8:11]
ds_read_b64_tr_b16 a[232:233], v222 offset:49152
v_cvt_pk_bf16_f32 v114, v36, v37
v_mfma_f32_16x16x32_bf16 v[8:11], a[200:203], v[152:155], v[8:11]
v_exp_f32 v39, v39
v_mfma_f32_16x16x32_bf16 v[8:11], a[204:207], v[156:159], v[8:11]
ds_read_b64_tr_b16 a[234:235], v222 offset:57344
ds_read_b64_tr_b16 a[236:237], v223 offset:49152
v_mfma_f32_16x16x32_bf16 v[12:15], a[208:211], v[144:147], v[68:71]
v_exp_f32 v40, v40
v_mfma_f32_16x16x32_bf16 v[12:15], a[212:215], v[148:151], v[12:15]
ds_read_b64_tr_b16 a[238:239], v223 offset:57344
v_cvt_pk_bf16_f32 v115, v38, v39
v_mfma_f32_16x16x32_bf16 v[12:15], a[216:219], v[152:155], v[12:15]
v_exp_f32 v41, v41
v_mfma_f32_16x16x32_bf16 v[12:15], a[220:223], v[156:159], v[12:15]
ds_read_b64_tr_b16 a[240:241], v224 offset:49152
ds_read_b64_tr_b16 a[242:243], v224 offset:57344
v_mfma_f32_16x16x32_bf16 v[16:19], a[192:195], v[160:163], v[72:75]
v_exp_f32 v42, v42
v_mfma_f32_16x16x32_bf16 v[16:19], a[196:199], v[164:167], v[16:19]
ds_read_b64_tr_b16 a[244:245], v225 offset:49152
v_cvt_pk_bf16_f32 v116, v40, v41
v_mfma_f32_16x16x32_bf16 v[16:19], a[200:203], v[168:171], v[16:19]
v_exp_f32 v43, v43
v_mfma_f32_16x16x32_bf16 v[16:19], a[204:207], v[172:175], v[16:19]
ds_read_b64_tr_b16 a[246:247], v225 offset:57344
ds_read_b64_tr_b16 a[248:249], v226 offset:49152
v_mfma_f32_16x16x32_bf16 v[20:23], a[208:211], v[160:163], v[72:75]
v_exp_f32 v44, v44
v_mfma_f32_16x16x32_bf16 v[20:23], a[212:215], v[164:167], v[20:23]
ds_read_b64_tr_b16 a[250:251], v226 offset:57344
v_cvt_pk_bf16_f32 v117, v42, v43
v_mfma_f32_16x16x32_bf16 v[20:23], a[216:219], v[168:171], v[20:23]
v_exp_f32 v45, v45
v_mfma_f32_16x16x32_bf16 v[20:23], a[220:223], v[172:175], v[20:23]
buffer_load_dwordx4 v230, s[8:11], s24 offen offset:2048  lds
v_mfma_f32_16x16x32_bf16 v[24:27], a[192:195], v[176:179], v[76:79]
v_exp_f32 v46, v46
v_mfma_f32_16x16x32_bf16 v[24:27], a[196:199], v[180:183], v[24:27]
ds_read_b64_tr_b16 a[252:253], v227 offset:49152
v_cvt_pk_bf16_f32 v118, v44, v45
v_mfma_f32_16x16x32_bf16 v[24:27], a[200:203], v[184:187], v[24:27]
v_exp_f32 v47, v47
v_mfma_f32_16x16x32_bf16 v[24:27], a[204:207], v[188:191], v[24:27]
ds_read_b64_tr_b16 a[254:255], v227 offset:57344
v_mfma_f32_16x16x32_bf16 v[28:31], a[208:211], v[176:179], v[76:79]
v_exp_f32 v48, v48
v_smfmac_f32_16x16x64_bf16 v[80:83], v[232:235], v[96:103], v88
v_cvt_pk_bf16_f32 v119, v46, v47
v_mfma_f32_16x16x32_bf16 v[28:31], a[212:215], v[180:183], v[28:31]
v_exp_f32 v49, v49
v_mfma_f32_16x16x32_bf16 v[28:31], a[216:219], v[184:187], v[28:31]
s_mov_b32 exec_lo, 0xffff
s_mov_b32 exec_hi, 0x0
buffer_load_dword v215, v253, s[4:7], 0 offen
s_mov_b64 exec, -1
v_mfma_f32_16x16x32_bf16 v[28:31], a[220:223], v[188:191], v[28:31]
v_exp_f32 v50, v50
v_smfmac_f32_16x16x64_bf16 v[84:87], v[232:235], v[104:111], v88
s_waitcnt lgkmcnt(0)
v_cvt_pk_bf16_f32 v120, v48, v49
v_mfma_f32_16x16x32_bf16 a[0:3], a[224:227], v[96:99], a[0:3]
v_exp_f32 v51, v51
v_mfma_f32_16x16x32_bf16 a[4:7], a[224:227], v[100:103], a[4:7]
v_exp_f32 v52, v52
v_mfma_f32_16x16x32_bf16 a[8:11], a[224:227], v[104:107], a[8:11]
ds_read_b128 a[192:195], v216 offset:49152
v_cvt_pk_bf16_f32 v121, v50, v51
v_mfma_f32_16x16x32_bf16 a[12:15], a[224:227], v[108:111], a[12:15]
v_exp_f32 v53, v53
v_mfma_f32_16x16x32_bf16 a[16:19], a[228:231], v[96:99], a[16:19]
ds_read_b128 a[196:199], v217 offset:49152
ds_read_b128 a[200:203], v218 offset:49152
v_mfma_f32_16x16x32_bf16 a[20:23], a[228:231], v[100:103], a[20:23]
v_exp_f32 v54, v54
v_mfma_f32_16x16x32_bf16 a[24:27], a[228:231], v[104:107], a[24:27]
ds_read_b128 a[204:207], v219 offset:49152
v_cvt_pk_bf16_f32 v122, v52, v53
v_mfma_f32_16x16x32_bf16 a[28:31], a[228:231], v[108:111], a[28:31]
v_exp_f32 v55, v55
v_mfma_f32_16x16x32_bf16 a[32:35], a[232:235], v[96:99], a[32:35]
buffer_load_dwordx4 v231, s[8:11], s24 offen offset:3072  lds
v_mfma_f32_16x16x32_bf16 a[36:39], a[232:235], v[100:103], a[36:39]
s_add_u32 s24, s24, 8192
v_exp_f32 v56, v56
v_mfma_f32_16x16x32_bf16 a[40:43], a[232:235], v[104:107], a[40:43]
ds_read_b128 a[208:211], v216 offset:57344
v_cvt_pk_bf16_f32 v123, v54, v55
v_mfma_f32_16x16x32_bf16 a[44:47], a[232:235], v[108:111], a[44:47]
v_exp_f32 v57, v57
v_mfma_f32_16x16x32_bf16 a[48:51], a[236:239], v[96:99], a[48:51]
ds_read_b128 a[212:215], v217 offset:57344
ds_read_b128 a[216:219], v218 offset:57344
v_mfma_f32_16x16x32_bf16 a[52:55], a[236:239], v[100:103], a[52:55]
v_exp_f32 v58, v58
v_mfma_f32_16x16x32_bf16 a[56:59], a[236:239], v[104:107], a[56:59]
ds_read_b128 a[220:223], v219 offset:57344
v_cvt_pk_bf16_f32 v124, v56, v57
v_mfma_f32_16x16x32_bf16 a[60:63], a[236:239], v[108:111], a[60:63]
v_exp_f32 v59, v59
v_mfma_f32_16x16x32_bf16 a[64:67], a[240:243], v[96:99], a[64:67]
v_mfma_f32_16x16x32_bf16 a[68:71], a[240:243], v[100:103], a[68:71]
v_exp_f32 v60, v60
v_mfma_f32_16x16x32_bf16 a[72:75], a[240:243], v[104:107], a[72:75]
v_cvt_pk_bf16_f32 v125, v58, v59
v_mfma_f32_16x16x32_bf16 a[76:79], a[240:243], v[108:111], a[76:79]
v_exp_f32 v61, v61
v_mfma_f32_16x16x32_bf16 a[80:83], a[244:247], v[96:99], a[80:83]
s_lshl1_add_u32 m0, s26, 49152
v_mfma_f32_16x16x32_bf16 a[84:87], a[244:247], v[100:103], a[84:87]
s_waitcnt vmcnt(10) lgkmcnt(0)
s_barrier
v_mfma_f32_16x16x32_bf16 a[88:91], a[244:247], v[104:107], a[88:91]
buffer_load_dwordx4 v228, s[12:15], s24 offen  lds
v_mfma_f32_16x16x32_bf16 a[92:95], a[244:247], v[108:111], a[92:95]
v_mfma_f32_16x16x32_bf16 a[96:99], a[248:251], v[96:99], a[96:99]
v_exp_f32 v62, v62
v_mfma_f32_16x16x32_bf16 a[100:103], a[248:251], v[100:103], a[100:103]
v_cvt_pk_bf16_f32 v126, v60, v61
v_mfma_f32_16x16x32_bf16 a[104:107], a[248:251], v[104:107], a[104:107]
v_exp_f32 v63, v63
v_mfma_f32_16x16x32_bf16 a[108:111], a[248:251], v[108:111], a[108:111]
v_mfma_f32_16x16x32_bf16 a[112:115], a[252:255], v[96:99], a[112:115]
v_exp_f32 v0, v0
v_mfma_f32_16x16x32_bf16 a[116:119], a[252:255], v[100:103], a[116:119]
v_cvt_pk_bf16_f32 v127, v62, v63
v_mfma_f32_16x16x32_bf16 a[120:123], a[252:255], v[104:107], a[120:123]
v_exp_f32 v1, v1
v_mfma_f32_16x16x32_bf16 a[124:127], a[252:255], v[108:111], a[124:127]
v_mfma_f32_16x16x32_bf16 v[32:35], a[192:195], v[128:131], v[64:67]
v_exp_f32 v2, v2
v_mfma_f32_16x16x32_bf16 v[32:35], a[196:199], v[132:135], v[32:35]
ds_read_b64_tr_b16 a[224:225], v220 offset:0
v_cvt_pk_bf16_f32 v96, v0, v1
v_mfma_f32_16x16x32_bf16 v[32:35], a[200:203], v[136:139], v[32:35]
v_exp_f32 v3, v3
v_mfma_f32_16x16x32_bf16 v[32:35], a[204:207], v[140:143], v[32:35]
ds_read_b64_tr_b16 a[226:227], v220 offset:8192
ds_read_b64_tr_b16 a[228:229], v221 offset:0
v_mfma_f32_16x16x32_bf16 v[36:39], a[208:211], v[128:131], v[64:67]
v_exp_f32 v4, v4
v_mfma_f32_16x16x32_bf16 v[36:39], a[212:215], v[132:135], v[36:39]
ds_read_b64_tr_b16 a[230:231], v221 offset:8192
v_cvt_pk_bf16_f32 v97, v2, v3
v_mfma_f32_16x16x32_bf16 v[36:39], a[216:219], v[136:139], v[36:39]
v_exp_f32 v5, v5
v_mfma_f32_16x16x32_bf16 v[36:39], a[220:223], v[140:143], v[36:39]
buffer_load_dwordx4 v229, s[12:15], s24 offen offset:1024  lds
v_mfma_f32_16x16x32_bf16 v[40:43], a[192:195], v[144:147], v[68:71]
v_exp_f32 v6, v6
v_mfma_f32_16x16x32_bf16 v[40:43], a[196:199], v[148:151], v[40:43]
ds_read_b64_tr_b16 a[232:233], v222 offset:0
v_cvt_pk_bf16_f32 v98, v4, v5
v_mfma_f32_16x16x32_bf16 v[40:43], a[200:203], v[152:155], v[40:43]
v_exp_f32 v7, v7
v_mfma_f32_16x16x32_bf16 v[40:43], a[204:207], v[156:159], v[40:43]
ds_read_b64_tr_b16 a[234:235], v222 offset:8192
ds_read_b64_tr_b16 a[236:237], v223 offset:0
v_mfma_f32_16x16x32_bf16 v[44:47], a[208:211], v[144:147], v[68:71]
v_exp_f32 v8, v8
v_mfma_f32_16x16x32_bf16 v[44:47], a[212:215], v[148:151], v[44:47]
ds_read_b64_tr_b16 a[238:239], v223 offset:8192
v_cvt_pk_bf16_f32 v99, v6, v7
v_mfma_f32_16x16x32_bf16 v[44:47], a[216:219], v[152:155], v[44:47]
v_exp_f32 v9, v9
v_mfma_f32_16x16x32_bf16 v[44:47], a[220:223], v[156:159], v[44:47]
ds_read_b64_tr_b16 a[240:241], v224 offset:0
ds_read_b64_tr_b16 a[242:243], v224 offset:8192
v_mfma_f32_16x16x32_bf16 v[48:51], a[192:195], v[160:163], v[72:75]
v_exp_f32 v10, v10
v_mfma_f32_16x16x32_bf16 v[48:51], a[196:199], v[164:167], v[48:51]
ds_read_b64_tr_b16 a[244:245], v225 offset:0
v_cvt_pk_bf16_f32 v100, v8, v9
v_mfma_f32_16x16x32_bf16 v[48:51], a[200:203], v[168:171], v[48:51]
v_exp_f32 v11, v11
v_mfma_f32_16x16x32_bf16 v[48:51], a[204:207], v[172:175], v[48:51]
ds_read_b64_tr_b16 a[246:247], v225 offset:8192
ds_read_b64_tr_b16 a[248:249], v226 offset:0
v_mfma_f32_16x16x32_bf16 v[52:55], a[208:211], v[160:163], v[72:75]
v_exp_f32 v12, v12
v_mfma_f32_16x16x32_bf16 v[52:55], a[212:215], v[164:167], v[52:55]
ds_read_b64_tr_b16 a[250:251], v226 offset:8192
v_cvt_pk_bf16_f32 v101, v10, v11
v_mfma_f32_16x16x32_bf16 v[52:55], a[216:219], v[168:171], v[52:55]
v_exp_f32 v13, v13
v_mfma_f32_16x16x32_bf16 v[52:55], a[220:223], v[172:175], v[52:55]
buffer_load_dwordx4 v230, s[8:11], s24 offen offset:2048  lds
v_mfma_f32_16x16x32_bf16 v[56:59], a[192:195], v[176:179], v[76:79]
v_exp_f32 v14, v14
v_mfma_f32_16x16x32_bf16 v[56:59], a[196:199], v[180:183], v[56:59]
ds_read_b64_tr_b16 a[252:253], v227 offset:0
v_cvt_pk_bf16_f32 v102, v12, v13
v_mfma_f32_16x16x32_bf16 v[56:59], a[200:203], v[184:187], v[56:59]
v_exp_f32 v15, v15
v_mfma_f32_16x16x32_bf16 v[56:59], a[204:207], v[188:191], v[56:59]
ds_read_b64_tr_b16 a[254:255], v227 offset:8192
v_mfma_f32_16x16x32_bf16 v[60:63], a[208:211], v[176:179], v[76:79]
v_exp_f32 v16, v16
v_smfmac_f32_16x16x64_bf16 v[80:83], v[232:235], v[112:119], v88
v_cvt_pk_bf16_f32 v103, v14, v15
v_mfma_f32_16x16x32_bf16 v[60:63], a[212:215], v[180:183], v[60:63]
v_exp_f32 v17, v17
v_mfma_f32_16x16x32_bf16 v[60:63], a[216:219], v[184:187], v[60:63]
s_mov_b32 exec_lo, 0xffff0000
s_mov_b32 exec_hi, 0x0
buffer_load_dword v215, v253, s[4:7], 0 offen
s_mov_b64 exec, -1
v_mfma_f32_16x16x32_bf16 v[60:63], a[220:223], v[188:191], v[60:63]
v_exp_f32 v18, v18
v_smfmac_f32_16x16x64_bf16 v[84:87], v[232:235], v[120:127], v88
s_waitcnt lgkmcnt(0)
v_cvt_pk_bf16_f32 v104, v16, v17
v_mfma_f32_16x16x32_bf16 a[0:3], a[224:227], v[112:115], a[0:3]
v_exp_f32 v19, v19
v_mfma_f32_16x16x32_bf16 a[4:7], a[224:227], v[116:119], a[4:7]
v_exp_f32 v20, v20
v_mfma_f32_16x16x32_bf16 a[8:11], a[224:227], v[120:123], a[8:11]
ds_read_b128 a[192:195], v216 offset:0
v_cvt_pk_bf16_f32 v105, v18, v19
v_mfma_f32_16x16x32_bf16 a[12:15], a[224:227], v[124:127], a[12:15]
v_exp_f32 v21, v21
v_mfma_f32_16x16x32_bf16 a[16:19], a[228:231], v[112:115], a[16:19]
ds_read_b128 a[196:199], v217 offset:0
ds_read_b128 a[200:203], v218 offset:0
v_mfma_f32_16x16x32_bf16 a[20:23], a[228:231], v[116:119], a[20:23]
v_exp_f32 v22, v22
v_mfma_f32_16x16x32_bf16 a[24:27], a[228:231], v[120:123], a[24:27]
ds_read_b128 a[204:207], v219 offset:0
v_cvt_pk_bf16_f32 v106, v20, v21
v_mfma_f32_16x16x32_bf16 a[28:31], a[228:231], v[124:127], a[28:31]
v_exp_f32 v23, v23
v_mfma_f32_16x16x32_bf16 a[32:35], a[232:235], v[112:115], a[32:35]
buffer_load_dwordx4 v231, s[8:11], s24 offen offset:3072  lds
v_mfma_f32_16x16x32_bf16 a[36:39], a[232:235], v[116:119], a[36:39]
s_add_u32 s24, s24, 8192
v_exp_f32 v24, v24
v_mfma_f32_16x16x32_bf16 a[40:43], a[232:235], v[120:123], a[40:43]
ds_read_b128 a[208:211], v216 offset:8192
v_cvt_pk_bf16_f32 v107, v22, v23
v_mfma_f32_16x16x32_bf16 a[44:47], a[232:235], v[124:127], a[44:47]
v_exp_f32 v25, v25
v_mfma_f32_16x16x32_bf16 a[48:51], a[236:239], v[112:115], a[48:51]
ds_read_b128 a[212:215], v217 offset:8192
ds_read_b128 a[216:219], v218 offset:8192
v_mfma_f32_16x16x32_bf16 a[52:55], a[236:239], v[116:119], a[52:55]
v_exp_f32 v26, v26
v_mfma_f32_16x16x32_bf16 a[56:59], a[236:239], v[120:123], a[56:59]
ds_read_b128 a[220:223], v219 offset:8192
v_cvt_pk_bf16_f32 v108, v24, v25
v_mfma_f32_16x16x32_bf16 a[60:63], a[236:239], v[124:127], a[60:63]
v_exp_f32 v27, v27
v_mfma_f32_16x16x32_bf16 a[64:67], a[240:243], v[112:115], a[64:67]
v_mfma_f32_16x16x32_bf16 a[68:71], a[240:243], v[116:119], a[68:71]
v_exp_f32 v28, v28
v_mfma_f32_16x16x32_bf16 a[72:75], a[240:243], v[120:123], a[72:75]
v_cvt_pk_bf16_f32 v109, v26, v27
v_mfma_f32_16x16x32_bf16 a[76:79], a[240:243], v[124:127], a[76:79]
v_exp_f32 v29, v29
v_mfma_f32_16x16x32_bf16 a[80:83], a[244:247], v[112:115], a[80:83]
s_lshl1_add_u32 m0, s26, 0
v_mfma_f32_16x16x32_bf16 a[84:87], a[244:247], v[116:119], a[84:87]
s_waitcnt vmcnt(10) lgkmcnt(0)
s_barrier
v_mfma_f32_16x16x32_bf16 a[88:91], a[244:247], v[120:123], a[88:91]
buffer_load_dwordx4 v228, s[12:15], s24 offen  lds
v_mfma_f32_16x16x32_bf16 a[92:95], a[244:247], v[124:127], a[92:95]
v_mfma_f32_16x16x32_bf16 a[96:99], a[248:251], v[112:115], a[96:99]
v_exp_f32 v30, v30
v_mfma_f32_16x16x32_bf16 a[100:103], a[248:251], v[116:119], a[100:103]
v_cvt_pk_bf16_f32 v110, v28, v29
v_mfma_f32_16x16x32_bf16 a[104:107], a[248:251], v[120:123], a[104:107]
v_exp_f32 v31, v31
v_mfma_f32_16x16x32_bf16 a[108:111], a[248:251], v[124:127], a[108:111]
v_mfma_f32_16x16x32_bf16 a[112:115], a[252:255], v[112:115], a[112:115]
v_exp_f32 v32, v32
v_mfma_f32_16x16x32_bf16 a[116:119], a[252:255], v[116:119], a[116:119]
v_cvt_pk_bf16_f32 v111, v30, v31
v_mfma_f32_16x16x32_bf16 a[120:123], a[252:255], v[120:123], a[120:123]
v_exp_f32 v33, v33
v_mfma_f32_16x16x32_bf16 a[124:127], a[252:255], v[124:127], a[124:127]
v_mfma_f32_16x16x32_bf16 v[0:3], a[192:195], v[128:131], v[64:67]
v_exp_f32 v34, v34
v_mfma_f32_16x16x32_bf16 v[0:3], a[196:199], v[132:135], v[0:3]
ds_read_b64_tr_b16 a[224:225], v220 offset:16384
v_cvt_pk_bf16_f32 v112, v32, v33
v_mfma_f32_16x16x32_bf16 v[0:3], a[200:203], v[136:139], v[0:3]
v_exp_f32 v35, v35
v_mfma_f32_16x16x32_bf16 v[0:3], a[204:207], v[140:143], v[0:3]
ds_read_b64_tr_b16 a[226:227], v220 offset:24576
ds_read_b64_tr_b16 a[228:229], v221 offset:16384
v_mfma_f32_16x16x32_bf16 v[4:7], a[208:211], v[128:131], v[64:67]
v_exp_f32 v36, v36
v_mfma_f32_16x16x32_bf16 v[4:7], a[212:215], v[132:135], v[4:7]
ds_read_b64_tr_b16 a[230:231], v221 offset:24576
v_cvt_pk_bf16_f32 v113, v34, v35
v_mfma_f32_16x16x32_bf16 v[4:7], a[216:219], v[136:139], v[4:7]
v_exp_f32 v37, v37
v_mfma_f32_16x16x32_bf16 v[4:7], a[220:223], v[140:143], v[4:7]
buffer_load_dwordx4 v229, s[12:15], s24 offen offset:1024  lds
v_mfma_f32_16x16x32_bf16 v[8:11], a[192:195], v[144:147], v[68:71]
v_exp_f32 v38, v38
v_mfma_f32_16x16x32_bf16 v[8:11], a[196:199], v[148:151], v[8:11]
ds_read_b64_tr_b16 a[232:233], v222 offset:16384
v_cvt_pk_bf16_f32 v114, v36, v37
v_mfma_f32_16x16x32_bf16 v[8:11], a[200:203], v[152:155], v[8:11]
v_exp_f32 v39, v39
v_mfma_f32_16x16x32_bf16 v[8:11], a[204:207], v[156:159], v[8:11]
ds_read_b64_tr_b16 a[234:235], v222 offset:24576
ds_read_b64_tr_b16 a[236:237], v223 offset:16384
v_mfma_f32_16x16x32_bf16 v[12:15], a[208:211], v[144:147], v[68:71]
v_exp_f32 v40, v40
v_mfma_f32_16x16x32_bf16 v[12:15], a[212:215], v[148:151], v[12:15]
ds_read_b64_tr_b16 a[238:239], v223 offset:24576
v_cvt_pk_bf16_f32 v115, v38, v39
v_mfma_f32_16x16x32_bf16 v[12:15], a[216:219], v[152:155], v[12:15]
v_exp_f32 v41, v41
v_mfma_f32_16x16x32_bf16 v[12:15], a[220:223], v[156:159], v[12:15]
ds_read_b64_tr_b16 a[240:241], v224 offset:16384
ds_read_b64_tr_b16 a[242:243], v224 offset:24576
v_mfma_f32_16x16x32_bf16 v[16:19], a[192:195], v[160:163], v[72:75]
v_exp_f32 v42, v42
v_mfma_f32_16x16x32_bf16 v[16:19], a[196:199], v[164:167], v[16:19]
ds_read_b64_tr_b16 a[244:245], v225 offset:16384
v_cvt_pk_bf16_f32 v116, v40, v41
v_mfma_f32_16x16x32_bf16 v[16:19], a[200:203], v[168:171], v[16:19]
Lpad6:
s_cbranch_execz Lpad10
v_exp_f32 v43, v43
v_mfma_f32_16x16x32_bf16 v[16:19], a[204:207], v[172:175], v[16:19]
ds_read_b64_tr_b16 a[246:247], v225 offset:24576
ds_read_b64_tr_b16 a[248:249], v226 offset:16384
v_mfma_f32_16x16x32_bf16 v[20:23], a[208:211], v[160:163], v[72:75]
v_exp_f32 v44, v44
v_mfma_f32_16x16x32_bf16 v[20:23], a[212:215], v[164:167], v[20:23]
ds_read_b64_tr_b16 a[250:251], v226 offset:24576
v_cvt_pk_bf16_f32 v117, v42, v43
v_mfma_f32_16x16x32_bf16 v[20:23], a[216:219], v[168:171], v[20:23]
v_exp_f32 v45, v45
v_mfma_f32_16x16x32_bf16 v[20:23], a[220:223], v[172:175], v[20:23]
buffer_load_dwordx4 v230, s[8:11], s24 offen offset:2048  lds
v_mfma_f32_16x16x32_bf16 v[24:27], a[192:195], v[176:179], v[76:79]
v_exp_f32 v46, v46
v_mfma_f32_16x16x32_bf16 v[24:27], a[196:199], v[180:183], v[24:27]
ds_read_b64_tr_b16 a[252:253], v227 offset:16384
v_cvt_pk_bf16_f32 v118, v44, v45
v_mfma_f32_16x16x32_bf16 v[24:27], a[200:203], v[184:187], v[24:27]
v_exp_f32 v47, v47
v_mfma_f32_16x16x32_bf16 v[24:27], a[204:207], v[188:191], v[24:27]
ds_read_b64_tr_b16 a[254:255], v227 offset:24576
v_mfma_f32_16x16x32_bf16 v[28:31], a[208:211], v[176:179], v[76:79]
v_exp_f32 v48, v48
v_smfmac_f32_16x16x64_bf16 v[80:83], v[232:235], v[96:103], v88
v_cvt_pk_bf16_f32 v119, v46, v47
v_mfma_f32_16x16x32_bf16 v[28:31], a[212:215], v[180:183], v[28:31]
v_exp_f32 v49, v49
v_mfma_f32_16x16x32_bf16 v[28:31], a[216:219], v[184:187], v[28:31]
s_mov_b32 exec_lo, 0x0
s_mov_b32 exec_hi, 0xffff
buffer_load_dword v215, v253, s[4:7], 0 offen
s_mov_b64 exec, -1
v_mfma_f32_16x16x32_bf16 v[28:31], a[220:223], v[188:191], v[28:31]
v_exp_f32 v50, v50
v_smfmac_f32_16x16x64_bf16 v[84:87], v[232:235], v[104:111], v88
s_waitcnt lgkmcnt(0)
v_cvt_pk_bf16_f32 v120, v48, v49
v_mfma_f32_16x16x32_bf16 a[0:3], a[224:227], v[96:99], a[0:3]
v_exp_f32 v51, v51
v_mfma_f32_16x16x32_bf16 a[4:7], a[224:227], v[100:103], a[4:7]
v_exp_f32 v52, v52
v_mfma_f32_16x16x32_bf16 a[8:11], a[224:227], v[104:107], a[8:11]
ds_read_b128 a[192:195], v216 offset:16384
v_cvt_pk_bf16_f32 v121, v50, v51
v_mfma_f32_16x16x32_bf16 a[12:15], a[224:227], v[108:111], a[12:15]
v_exp_f32 v53, v53
v_mfma_f32_16x16x32_bf16 a[16:19], a[228:231], v[96:99], a[16:19]
ds_read_b128 a[196:199], v217 offset:16384
ds_read_b128 a[200:203], v218 offset:16384
v_mfma_f32_16x16x32_bf16 a[20:23], a[228:231], v[100:103], a[20:23]
v_exp_f32 v54, v54
v_mfma_f32_16x16x32_bf16 a[24:27], a[228:231], v[104:107], a[24:27]
ds_read_b128 a[204:207], v219 offset:16384
v_cvt_pk_bf16_f32 v122, v52, v53
v_mfma_f32_16x16x32_bf16 a[28:31], a[228:231], v[108:111], a[28:31]
v_exp_f32 v55, v55
v_mfma_f32_16x16x32_bf16 a[32:35], a[232:235], v[96:99], a[32:35]
buffer_load_dwordx4 v231, s[8:11], s24 offen offset:3072  lds
v_mfma_f32_16x16x32_bf16 a[36:39], a[232:235], v[100:103], a[36:39]
s_add_u32 s24, s24, 8192
v_exp_f32 v56, v56
v_mfma_f32_16x16x32_bf16 a[40:43], a[232:235], v[104:107], a[40:43]
ds_read_b128 a[208:211], v216 offset:24576
v_cvt_pk_bf16_f32 v123, v54, v55
v_mfma_f32_16x16x32_bf16 a[44:47], a[232:235], v[108:111], a[44:47]
v_exp_f32 v57, v57
v_mfma_f32_16x16x32_bf16 a[48:51], a[236:239], v[96:99], a[48:51]
ds_read_b128 a[212:215], v217 offset:24576
ds_read_b128 a[216:219], v218 offset:24576
v_mfma_f32_16x16x32_bf16 a[52:55], a[236:239], v[100:103], a[52:55]
v_exp_f32 v58, v58
v_mfma_f32_16x16x32_bf16 a[56:59], a[236:239], v[104:107], a[56:59]
ds_read_b128 a[220:223], v219 offset:24576
v_cvt_pk_bf16_f32 v124, v56, v57
v_mfma_f32_16x16x32_bf16 a[60:63], a[236:239], v[108:111], a[60:63]
v_exp_f32 v59, v59
v_mfma_f32_16x16x32_bf16 a[64:67], a[240:243], v[96:99], a[64:67]
v_mfma_f32_16x16x32_bf16 a[68:71], a[240:243], v[100:103], a[68:71]
v_exp_f32 v60, v60
v_mfma_f32_16x16x32_bf16 a[72:75], a[240:243], v[104:107], a[72:75]
v_cvt_pk_bf16_f32 v125, v58, v59
v_mfma_f32_16x16x32_bf16 a[76:79], a[240:243], v[108:111], a[76:79]
v_exp_f32 v61, v61
v_mfma_f32_16x16x32_bf16 a[80:83], a[244:247], v[96:99], a[80:83]
s_lshl1_add_u32 m0, s26, 16384
v_mfma_f32_16x16x32_bf16 a[84:87], a[244:247], v[100:103], a[84:87]
s_waitcnt vmcnt(10) lgkmcnt(0)
s_barrier
v_mfma_f32_16x16x32_bf16 a[88:91], a[244:247], v[104:107], a[88:91]
buffer_load_dwordx4 v228, s[12:15], s24 offen  lds
v_mfma_f32_16x16x32_bf16 a[92:95], a[244:247], v[108:111], a[92:95]
ds_read_b64_tr_b16 v[192:193], v242 offset:0
ds_read_b64_tr_b16 v[194:195], v242 offset:2048
ds_read_b64_tr_b16 v[196:197], v242 offset:8
ds_read_b64_tr_b16 v[198:199], v242 offset:2056
v_mfma_f32_16x16x32_bf16 a[96:99], a[248:251], v[96:99], a[96:99]
v_exp_f32 v62, v62
v_mfma_f32_16x16x32_bf16 a[100:103], a[248:251], v[100:103], a[100:103]
v_cvt_pk_bf16_f32 v126, v60, v61
v_mfma_f32_16x16x32_bf16 a[104:107], a[248:251], v[104:107], a[104:107]
v_exp_f32 v63, v63
v_mfma_f32_16x16x32_bf16 a[108:111], a[248:251], v[108:111], a[108:111]
ds_read_b64_tr_b16 v[200:201], v242 offset:64
ds_read_b64_tr_b16 v[202:203], v242 offset:2112
v_mfma_f32_16x16x32_bf16 a[112:115], a[252:255], v[96:99], a[112:115]
v_exp_f32 v0, v0
v_mfma_f32_16x16x32_bf16 a[116:119], a[252:255], v[100:103], a[116:119]
v_cvt_pk_bf16_f32 v127, v62, v63
v_mfma_f32_16x16x32_bf16 a[120:123], a[252:255], v[104:107], a[120:123]
v_exp_f32 v1, v1
v_mfma_f32_16x16x32_bf16 a[124:127], a[252:255], v[108:111], a[124:127]
ds_read_b64_tr_b16 v[204:205], v242 offset:72
ds_read_b64_tr_b16 v[206:207], v242 offset:2120
v_mfma_f32_16x16x32_bf16 v[32:35], a[192:195], v[128:131], v[64:67]
v_exp_f32 v2, v2
v_mfma_f32_16x16x32_bf16 v[32:35], a[196:199], v[132:135], v[32:35]
ds_read_b64_tr_b16 a[224:225], v220 offset:32768
v_cvt_pk_bf16_f32 v96, v0, v1
v_mfma_f32_16x16x32_bf16 v[32:35], a[200:203], v[136:139], v[32:35]
v_exp_f32 v3, v3
v_mfma_f32_16x16x32_bf16 v[32:35], a[204:207], v[140:143], v[32:35]
ds_read_b64_tr_b16 a[226:227], v220 offset:40960
ds_read_b64_tr_b16 a[228:229], v221 offset:32768
v_mfma_f32_16x16x32_bf16 v[36:39], a[208:211], v[128:131], v[64:67]
v_exp_f32 v4, v4
v_mfma_f32_16x16x32_bf16 v[36:39], a[212:215], v[132:135], v[36:39]
ds_read_b64_tr_b16 a[230:231], v221 offset:40960
v_cvt_pk_bf16_f32 v97, v2, v3
v_mfma_f32_16x16x32_bf16 v[36:39], a[216:219], v[136:139], v[36:39]
v_exp_f32 v5, v5
v_mfma_f32_16x16x32_bf16 v[36:39], a[220:223], v[140:143], v[36:39]
buffer_load_dwordx4 v229, s[12:15], s24 offen offset:1024  lds
v_mfma_f32_16x16x32_bf16 v[40:43], a[192:195], v[144:147], v[68:71]
v_exp_f32 v6, v6
v_mfma_f32_16x16x32_bf16 v[40:43], a[196:199], v[148:151], v[40:43]
ds_read_b64_tr_b16 a[232:233], v222 offset:32768
v_cvt_pk_bf16_f32 v98, v4, v5
v_mfma_f32_16x16x32_bf16 v[40:43], a[200:203], v[152:155], v[40:43]
v_exp_f32 v7, v7
v_mfma_f32_16x16x32_bf16 v[40:43], a[204:207], v[156:159], v[40:43]
ds_read_b64_tr_b16 a[234:235], v222 offset:40960
ds_read_b64_tr_b16 a[236:237], v223 offset:32768
v_mfma_f32_16x16x32_bf16 v[44:47], a[208:211], v[144:147], v[68:71]
v_exp_f32 v8, v8
v_mfma_f32_16x16x32_bf16 v[44:47], a[212:215], v[148:151], v[44:47]
ds_read_b64_tr_b16 a[238:239], v223 offset:40960
v_cvt_pk_bf16_f32 v99, v6, v7
v_mfma_f32_16x16x32_bf16 v[44:47], a[216:219], v[152:155], v[44:47]
v_exp_f32 v9, v9
v_mfma_f32_16x16x32_bf16 v[44:47], a[220:223], v[156:159], v[44:47]
ds_read_b64_tr_b16 a[240:241], v224 offset:32768
ds_read_b64_tr_b16 a[242:243], v224 offset:40960
v_mfma_f32_16x16x32_bf16 v[48:51], a[192:195], v[160:163], v[72:75]
v_exp_f32 v10, v10
v_mfma_f32_16x16x32_bf16 v[48:51], a[196:199], v[164:167], v[48:51]
ds_read_b64_tr_b16 a[244:245], v225 offset:32768
v_cvt_pk_bf16_f32 v100, v8, v9
v_mfma_f32_16x16x32_bf16 v[48:51], a[200:203], v[168:171], v[48:51]
v_exp_f32 v11, v11
v_mfma_f32_16x16x32_bf16 v[48:51], a[204:207], v[172:175], v[48:51]
ds_read_b64_tr_b16 a[246:247], v225 offset:40960
ds_read_b64_tr_b16 a[248:249], v226 offset:32768
v_mfma_f32_16x16x32_bf16 v[52:55], a[208:211], v[160:163], v[72:75]
v_exp_f32 v12, v12
v_mfma_f32_16x16x32_bf16 v[52:55], a[212:215], v[164:167], v[52:55]
ds_read_b64_tr_b16 a[250:251], v226 offset:40960
v_cvt_pk_bf16_f32 v101, v10, v11
v_mfma_f32_16x16x32_bf16 v[52:55], a[216:219], v[168:171], v[52:55]
v_exp_f32 v13, v13
v_mfma_f32_16x16x32_bf16 v[52:55], a[220:223], v[172:175], v[52:55]
buffer_load_dwordx4 v230, s[8:11], s24 offen offset:2048  lds
v_mfma_f32_16x16x32_bf16 v[56:59], a[192:195], v[176:179], v[76:79]
v_exp_f32 v14, v14
v_mfma_f32_16x16x32_bf16 v[56:59], a[196:199], v[180:183], v[56:59]
ds_read_b64_tr_b16 a[252:253], v227 offset:32768
v_cvt_pk_bf16_f32 v102, v12, v13
v_mfma_f32_16x16x32_bf16 v[56:59], a[200:203], v[184:187], v[56:59]
v_exp_f32 v15, v15
v_mfma_f32_16x16x32_bf16 v[56:59], a[204:207], v[188:191], v[56:59]
ds_read_b64_tr_b16 a[254:255], v227 offset:40960
v_mfma_f32_16x16x32_bf16 v[60:63], a[208:211], v[176:179], v[76:79]
v_exp_f32 v16, v16
v_smfmac_f32_16x16x64_bf16 v[80:83], v[232:235], v[112:119], v88
v_cvt_pk_bf16_f32 v103, v14, v15
v_mfma_f32_16x16x32_bf16 v[60:63], a[212:215], v[180:183], v[60:63]
v_exp_f32 v17, v17
v_mfma_f32_16x16x32_bf16 v[60:63], a[216:219], v[184:187], v[60:63]
s_mov_b32 exec_lo, 0x0
s_mov_b32 exec_hi, 0xffff0000
buffer_load_dword v215, v253, s[4:7], 0 offen
s_mov_b64 exec, -1
v_mfma_f32_16x16x32_bf16 v[60:63], a[220:223], v[188:191], v[60:63]
v_exp_f32 v18, v18
v_smfmac_f32_16x16x64_bf16 v[84:87], v[232:235], v[120:127], v88
s_waitcnt lgkmcnt(0)
v_cvt_pk_bf16_f32 v104, v16, v17
v_mfma_f32_16x16x32_bf16 a[0:3], a[224:227], v[112:115], a[0:3]
v_exp_f32 v19, v19
v_mfma_f32_16x16x32_bf16 a[4:7], a[224:227], v[116:119], a[4:7]
v_exp_f32 v20, v20
v_mfma_f32_16x16x32_bf16 a[8:11], a[224:227], v[120:123], a[8:11]
ds_read_b128 a[192:195], v216 offset:32768
v_cvt_pk_bf16_f32 v105, v18, v19
v_mfma_f32_16x16x32_bf16 a[12:15], a[224:227], v[124:127], a[12:15]
v_exp_f32 v21, v21
v_mfma_f32_16x16x32_bf16 a[16:19], a[228:231], v[112:115], a[16:19]
ds_read_b128 a[196:199], v217 offset:32768
ds_read_b128 a[200:203], v218 offset:32768
v_mfma_f32_16x16x32_bf16 a[20:23], a[228:231], v[116:119], a[20:23]
v_exp_f32 v22, v22
v_mfma_f32_16x16x32_bf16 a[24:27], a[228:231], v[120:123], a[24:27]
ds_read_b128 a[204:207], v219 offset:32768
v_cvt_pk_bf16_f32 v106, v20, v21
v_mfma_f32_16x16x32_bf16 a[28:31], a[228:231], v[124:127], a[28:31]
v_exp_f32 v23, v23
v_mfma_f32_16x16x32_bf16 a[32:35], a[232:235], v[112:115], a[32:35]
buffer_load_dwordx4 v231, s[8:11], s24 offen offset:3072  lds
v_mfma_f32_16x16x32_bf16 a[36:39], a[232:235], v[116:119], a[36:39]
s_add_u32 s24, s24, 8192
v_exp_f32 v24, v24
v_mfma_f32_16x16x32_bf16 a[40:43], a[232:235], v[120:123], a[40:43]
ds_read_b128 a[208:211], v216 offset:40960
v_cvt_pk_bf16_f32 v107, v22, v23
v_mfma_f32_16x16x32_bf16 a[44:47], a[232:235], v[124:127], a[44:47]
v_exp_f32 v25, v25
v_mfma_f32_16x16x32_bf16 a[48:51], a[236:239], v[112:115], a[48:51]
ds_read_b128 a[212:215], v217 offset:40960
ds_read_b128 a[216:219], v218 offset:40960
v_mfma_f32_16x16x32_bf16 a[52:55], a[236:239], v[116:119], a[52:55]
v_exp_f32 v26, v26
v_mfma_f32_16x16x32_bf16 a[56:59], a[236:239], v[120:123], a[56:59]
ds_read_b128 a[220:223], v219 offset:40960
v_cvt_pk_bf16_f32 v108, v24, v25
v_mfma_f32_16x16x32_bf16 a[60:63], a[236:239], v[124:127], a[60:63]
v_exp_f32 v27, v27
v_mfma_f32_16x16x32_bf16 a[64:67], a[240:243], v[112:115], a[64:67]
v_mfma_f32_16x16x32_bf16 a[68:71], a[240:243], v[116:119], a[68:71]
v_exp_f32 v28, v28
v_mfma_f32_16x16x32_bf16 a[72:75], a[240:243], v[120:123], a[72:75]
v_cvt_pk_bf16_f32 v109, v26, v27
v_mfma_f32_16x16x32_bf16 a[76:79], a[240:243], v[124:127], a[76:79]
v_exp_f32 v29, v29
v_mfma_f32_16x16x32_bf16 a[80:83], a[244:247], v[112:115], a[80:83]
s_lshl1_add_u32 m0, s26, 32768
v_mfma_f32_16x16x32_bf16 a[84:87], a[244:247], v[116:119], a[84:87]
s_waitcnt vmcnt(10) lgkmcnt(0)
s_barrier
v_mfma_f32_16x16x32_bf16 a[88:91], a[244:247], v[120:123], a[88:91]
buffer_load_dwordx4 v228, s[12:15], s24 offen  lds
v_mfma_f32_16x16x32_bf16 a[92:95], a[244:247], v[124:127], a[92:95]
v_mfma_f32_16x16x32_bf16 a[96:99], a[248:251], v[112:115], a[96:99]
v_exp_f32 v30, v30
v_mfma_f32_16x16x32_bf16 a[100:103], a[248:251], v[116:119], a[100:103]
v_cvt_pk_bf16_f32 v110, v28, v29
v_mfma_f32_16x16x32_bf16 a[104:107], a[248:251], v[120:123], a[104:107]
v_exp_f32 v31, v31
v_mfma_f32_16x16x32_bf16 a[108:111], a[248:251], v[124:127], a[108:111]
buffer_store_dwordx4 v[192:195], v255, s[16:19], s54 offen offset:0 sc1
v_mfma_f32_16x16x32_bf16 a[112:115], a[252:255], v[112:115], a[112:115]
v_exp_f32 v32, v32
v_mfma_f32_16x16x32_bf16 a[116:119], a[252:255], v[116:119], a[116:119]
v_cvt_pk_bf16_f32 v111, v30, v31
v_mfma_f32_16x16x32_bf16 a[120:123], a[252:255], v[120:123], a[120:123]
v_exp_f32 v33, v33
v_mfma_f32_16x16x32_bf16 a[124:127], a[252:255], v[124:127], a[124:127]
v_mfma_f32_16x16x32_bf16 v[0:3], a[192:195], v[128:131], v[64:67]
v_exp_f32 v34, v34
v_mfma_f32_16x16x32_bf16 v[0:3], a[196:199], v[132:135], v[0:3]
ds_read_b64_tr_b16 a[224:225], v220 offset:49152
v_cvt_pk_bf16_f32 v112, v32, v33
v_mfma_f32_16x16x32_bf16 v[0:3], a[200:203], v[136:139], v[0:3]
v_exp_f32 v35, v35
v_mfma_f32_16x16x32_bf16 v[0:3], a[204:207], v[140:143], v[0:3]
ds_read_b64_tr_b16 a[226:227], v220 offset:57344
ds_read_b64_tr_b16 a[228:229], v221 offset:49152
v_mfma_f32_16x16x32_bf16 v[4:7], a[208:211], v[128:131], v[64:67]
v_exp_f32 v36, v36
v_mfma_f32_16x16x32_bf16 v[4:7], a[212:215], v[132:135], v[4:7]
ds_read_b64_tr_b16 a[230:231], v221 offset:57344
v_cvt_pk_bf16_f32 v113, v34, v35
v_mfma_f32_16x16x32_bf16 v[4:7], a[216:219], v[136:139], v[4:7]
v_exp_f32 v37, v37
v_mfma_f32_16x16x32_bf16 v[4:7], a[220:223], v[140:143], v[4:7]
buffer_load_dwordx4 v229, s[12:15], s24 offen offset:1024  lds
v_mfma_f32_16x16x32_bf16 v[8:11], a[192:195], v[144:147], v[68:71]
v_exp_f32 v38, v38
v_mfma_f32_16x16x32_bf16 v[8:11], a[196:199], v[148:151], v[8:11]
ds_read_b64_tr_b16 a[232:233], v222 offset:49152
v_cvt_pk_bf16_f32 v114, v36, v37
v_mfma_f32_16x16x32_bf16 v[8:11], a[200:203], v[152:155], v[8:11]
v_exp_f32 v39, v39
v_mfma_f32_16x16x32_bf16 v[8:11], a[204:207], v[156:159], v[8:11]
ds_read_b64_tr_b16 a[234:235], v222 offset:57344
ds_read_b64_tr_b16 a[236:237], v223 offset:49152
v_mfma_f32_16x16x32_bf16 v[12:15], a[208:211], v[144:147], v[68:71]
v_exp_f32 v40, v40
v_mfma_f32_16x16x32_bf16 v[12:15], a[212:215], v[148:151], v[12:15]
ds_read_b64_tr_b16 a[238:239], v223 offset:57344
v_cvt_pk_bf16_f32 v115, v38, v39
v_mfma_f32_16x16x32_bf16 v[12:15], a[216:219], v[152:155], v[12:15]
v_exp_f32 v41, v41
v_mfma_f32_16x16x32_bf16 v[12:15], a[220:223], v[156:159], v[12:15]
ds_read_b64_tr_b16 a[240:241], v224 offset:49152
ds_read_b64_tr_b16 a[242:243], v224 offset:57344
v_mfma_f32_16x16x32_bf16 v[16:19], a[192:195], v[160:163], v[72:75]
v_exp_f32 v42, v42
v_mfma_f32_16x16x32_bf16 v[16:19], a[196:199], v[164:167], v[16:19]
ds_read_b64_tr_b16 a[244:245], v225 offset:49152
v_cvt_pk_bf16_f32 v116, v40, v41
v_mfma_f32_16x16x32_bf16 v[16:19], a[200:203], v[168:171], v[16:19]
v_exp_f32 v43, v43
v_mfma_f32_16x16x32_bf16 v[16:19], a[204:207], v[172:175], v[16:19]
ds_read_b64_tr_b16 a[246:247], v225 offset:57344
ds_read_b64_tr_b16 a[248:249], v226 offset:49152
v_mfma_f32_16x16x32_bf16 v[20:23], a[208:211], v[160:163], v[72:75]
v_exp_f32 v44, v44
v_mfma_f32_16x16x32_bf16 v[20:23], a[212:215], v[164:167], v[20:23]
ds_read_b64_tr_b16 a[250:251], v226 offset:57344
v_cvt_pk_bf16_f32 v117, v42, v43
v_mfma_f32_16x16x32_bf16 v[20:23], a[216:219], v[168:171], v[20:23]
v_exp_f32 v45, v45
v_mfma_f32_16x16x32_bf16 v[20:23], a[220:223], v[172:175], v[20:23]
buffer_load_dwordx4 v230, s[8:11], s24 offen offset:2048  lds
v_mfma_f32_16x16x32_bf16 v[24:27], a[192:195], v[176:179], v[76:79]
v_exp_f32 v46, v46
v_mfma_f32_16x16x32_bf16 v[24:27], a[196:199], v[180:183], v[24:27]
ds_read_b64_tr_b16 a[252:253], v227 offset:49152
v_cvt_pk_bf16_f32 v118, v44, v45
v_mfma_f32_16x16x32_bf16 v[24:27], a[200:203], v[184:187], v[24:27]
v_exp_f32 v47, v47
v_mfma_f32_16x16x32_bf16 v[24:27], a[204:207], v[188:191], v[24:27]
ds_read_b64_tr_b16 a[254:255], v227 offset:57344
v_mfma_f32_16x16x32_bf16 v[28:31], a[208:211], v[176:179], v[76:79]
v_exp_f32 v48, v48
v_smfmac_f32_16x16x64_bf16 v[80:83], v[232:235], v[96:103], v88
v_cvt_pk_bf16_f32 v119, v46, v47
v_mfma_f32_16x16x32_bf16 v[28:31], a[212:215], v[180:183], v[28:31]
v_exp_f32 v49, v49
v_mfma_f32_16x16x32_bf16 v[28:31], a[216:219], v[184:187], v[28:31]
s_mov_b32 exec_lo, 0xff
s_mov_b32 exec_hi, 0x0
buffer_load_dword v215, v254, s[96:99], 0 offen offset:2048
s_mov_b64 exec, -1
v_mfma_f32_16x16x32_bf16 v[28:31], a[220:223], v[188:191], v[28:31]
v_exp_f32 v50, v50
v_smfmac_f32_16x16x64_bf16 v[84:87], v[232:235], v[104:111], v88
s_waitcnt lgkmcnt(0)
v_cvt_pk_bf16_f32 v120, v48, v49
v_mfma_f32_16x16x32_bf16 a[0:3], a[224:227], v[96:99], a[0:3]
v_exp_f32 v51, v51
v_mfma_f32_16x16x32_bf16 a[4:7], a[224:227], v[100:103], a[4:7]
v_exp_f32 v52, v52
v_mfma_f32_16x16x32_bf16 a[8:11], a[224:227], v[104:107], a[8:11]
ds_read_b128 a[192:195], v216 offset:49152
v_cvt_pk_bf16_f32 v121, v50, v51
v_mfma_f32_16x16x32_bf16 a[12:15], a[224:227], v[108:111], a[12:15]
v_exp_f32 v53, v53
v_mfma_f32_16x16x32_bf16 a[16:19], a[228:231], v[96:99], a[16:19]
ds_read_b128 a[196:199], v217 offset:49152
ds_read_b128 a[200:203], v218 offset:49152
v_mfma_f32_16x16x32_bf16 a[20:23], a[228:231], v[100:103], a[20:23]
v_exp_f32 v54, v54
v_mfma_f32_16x16x32_bf16 a[24:27], a[228:231], v[104:107], a[24:27]
ds_read_b128 a[204:207], v219 offset:49152
v_cvt_pk_bf16_f32 v122, v52, v53
v_mfma_f32_16x16x32_bf16 a[28:31], a[228:231], v[108:111], a[28:31]
v_exp_f32 v55, v55
v_mfma_f32_16x16x32_bf16 a[32:35], a[232:235], v[96:99], a[32:35]
buffer_load_dwordx4 v231, s[8:11], s24 offen offset:3072  lds
v_mfma_f32_16x16x32_bf16 a[36:39], a[232:235], v[100:103], a[36:39]
s_add_u32 s24, s24, 8192
v_exp_f32 v56, v56
v_mfma_f32_16x16x32_bf16 a[40:43], a[232:235], v[104:107], a[40:43]
ds_read_b128 a[208:211], v216 offset:57344
v_cvt_pk_bf16_f32 v123, v54, v55
v_mfma_f32_16x16x32_bf16 a[44:47], a[232:235], v[108:111], a[44:47]
v_exp_f32 v57, v57
v_mfma_f32_16x16x32_bf16 a[48:51], a[236:239], v[96:99], a[48:51]
ds_read_b128 a[212:215], v217 offset:57344
ds_read_b128 a[216:219], v218 offset:57344
v_mfma_f32_16x16x32_bf16 a[52:55], a[236:239], v[100:103], a[52:55]
v_exp_f32 v58, v58
v_mfma_f32_16x16x32_bf16 a[56:59], a[236:239], v[104:107], a[56:59]
ds_read_b128 a[220:223], v219 offset:57344
v_cvt_pk_bf16_f32 v124, v56, v57
v_mfma_f32_16x16x32_bf16 a[60:63], a[236:239], v[108:111], a[60:63]
v_exp_f32 v59, v59
v_mfma_f32_16x16x32_bf16 a[64:67], a[240:243], v[96:99], a[64:67]
v_mfma_f32_16x16x32_bf16 a[68:71], a[240:243], v[100:103], a[68:71]
v_exp_f32 v60, v60
v_mfma_f32_16x16x32_bf16 a[72:75], a[240:243], v[104:107], a[72:75]
v_cvt_pk_bf16_f32 v125, v58, v59
v_mfma_f32_16x16x32_bf16 a[76:79], a[240:243], v[108:111], a[76:79]
v_exp_f32 v61, v61
v_mfma_f32_16x16x32_bf16 a[80:83], a[244:247], v[96:99], a[80:83]
s_lshl1_add_u32 m0, s26, 49152
v_mfma_f32_16x16x32_bf16 a[84:87], a[244:247], v[100:103], a[84:87]
s_waitcnt vmcnt(11) lgkmcnt(0)
s_barrier
v_mfma_f32_16x16x32_bf16 a[88:91], a[244:247], v[104:107], a[88:91]
buffer_load_dwordx4 v228, s[12:15], s24 offen  lds
v_mfma_f32_16x16x32_bf16 a[92:95], a[244:247], v[108:111], a[92:95]
v_mfma_f32_16x16x32_bf16 a[96:99], a[248:251], v[96:99], a[96:99]
v_exp_f32 v62, v62
v_mfma_f32_16x16x32_bf16 a[100:103], a[248:251], v[100:103], a[100:103]
v_cvt_pk_bf16_f32 v126, v60, v61
v_mfma_f32_16x16x32_bf16 a[104:107], a[248:251], v[104:107], a[104:107]
v_exp_f32 v63, v63
v_mfma_f32_16x16x32_bf16 a[108:111], a[248:251], v[108:111], a[108:111]
buffer_store_dwordx4 v[196:199], v255, s[16:19], s54 offen offset:1024 sc1
v_mfma_f32_16x16x32_bf16 a[112:115], a[252:255], v[96:99], a[112:115]
v_exp_f32 v0, v0
v_mfma_f32_16x16x32_bf16 a[116:119], a[252:255], v[100:103], a[116:119]
v_cvt_pk_bf16_f32 v127, v62, v63
v_mfma_f32_16x16x32_bf16 a[120:123], a[252:255], v[104:107], a[120:123]
v_exp_f32 v1, v1
v_mfma_f32_16x16x32_bf16 a[124:127], a[252:255], v[108:111], a[124:127]
v_mfma_f32_16x16x32_bf16 v[32:35], a[192:195], v[128:131], v[64:67]
v_exp_f32 v2, v2
v_mfma_f32_16x16x32_bf16 v[32:35], a[196:199], v[132:135], v[32:35]
ds_read_b64_tr_b16 a[224:225], v220 offset:0
v_cvt_pk_bf16_f32 v96, v0, v1
v_mfma_f32_16x16x32_bf16 v[32:35], a[200:203], v[136:139], v[32:35]
v_exp_f32 v3, v3
v_mfma_f32_16x16x32_bf16 v[32:35], a[204:207], v[140:143], v[32:35]
ds_read_b64_tr_b16 a[226:227], v220 offset:8192
ds_read_b64_tr_b16 a[228:229], v221 offset:0
v_mfma_f32_16x16x32_bf16 v[36:39], a[208:211], v[128:131], v[64:67]
v_exp_f32 v4, v4
v_mfma_f32_16x16x32_bf16 v[36:39], a[212:215], v[132:135], v[36:39]
ds_read_b64_tr_b16 a[230:231], v221 offset:8192
v_cvt_pk_bf16_f32 v97, v2, v3
v_mfma_f32_16x16x32_bf16 v[36:39], a[216:219], v[136:139], v[36:39]
v_exp_f32 v5, v5
v_mfma_f32_16x16x32_bf16 v[36:39], a[220:223], v[140:143], v[36:39]
buffer_load_dwordx4 v229, s[12:15], s24 offen offset:1024  lds
v_mfma_f32_16x16x32_bf16 v[40:43], a[192:195], v[144:147], v[68:71]
v_exp_f32 v6, v6
v_mfma_f32_16x16x32_bf16 v[40:43], a[196:199], v[148:151], v[40:43]
ds_read_b64_tr_b16 a[232:233], v222 offset:0
v_cvt_pk_bf16_f32 v98, v4, v5
v_mfma_f32_16x16x32_bf16 v[40:43], a[200:203], v[152:155], v[40:43]
v_exp_f32 v7, v7
v_mfma_f32_16x16x32_bf16 v[40:43], a[204:207], v[156:159], v[40:43]
ds_read_b64_tr_b16 a[234:235], v222 offset:8192
ds_read_b64_tr_b16 a[236:237], v223 offset:0
v_mfma_f32_16x16x32_bf16 v[44:47], a[208:211], v[144:147], v[68:71]
v_exp_f32 v8, v8
v_mfma_f32_16x16x32_bf16 v[44:47], a[212:215], v[148:151], v[44:47]
ds_read_b64_tr_b16 a[238:239], v223 offset:8192
v_cvt_pk_bf16_f32 v99, v6, v7
v_mfma_f32_16x16x32_bf16 v[44:47], a[216:219], v[152:155], v[44:47]
v_exp_f32 v9, v9
v_mfma_f32_16x16x32_bf16 v[44:47], a[220:223], v[156:159], v[44:47]
ds_read_b64_tr_b16 a[240:241], v224 offset:0
ds_read_b64_tr_b16 a[242:243], v224 offset:8192
v_mfma_f32_16x16x32_bf16 v[48:51], a[192:195], v[160:163], v[72:75]
v_exp_f32 v10, v10
v_mfma_f32_16x16x32_bf16 v[48:51], a[196:199], v[164:167], v[48:51]
ds_read_b64_tr_b16 a[244:245], v225 offset:0
v_cvt_pk_bf16_f32 v100, v8, v9
v_mfma_f32_16x16x32_bf16 v[48:51], a[200:203], v[168:171], v[48:51]
v_exp_f32 v11, v11
v_mfma_f32_16x16x32_bf16 v[48:51], a[204:207], v[172:175], v[48:51]
ds_read_b64_tr_b16 a[246:247], v225 offset:8192
ds_read_b64_tr_b16 a[248:249], v226 offset:0
v_mfma_f32_16x16x32_bf16 v[52:55], a[208:211], v[160:163], v[72:75]
v_exp_f32 v12, v12
v_mfma_f32_16x16x32_bf16 v[52:55], a[212:215], v[164:167], v[52:55]
ds_read_b64_tr_b16 a[250:251], v226 offset:8192
v_cvt_pk_bf16_f32 v101, v10, v11
v_mfma_f32_16x16x32_bf16 v[52:55], a[216:219], v[168:171], v[52:55]
v_exp_f32 v13, v13
v_mfma_f32_16x16x32_bf16 v[52:55], a[220:223], v[172:175], v[52:55]
buffer_load_dwordx4 v230, s[8:11], s24 offen offset:2048  lds
v_mfma_f32_16x16x32_bf16 v[56:59], a[192:195], v[176:179], v[76:79]
v_exp_f32 v14, v14
v_mfma_f32_16x16x32_bf16 v[56:59], a[196:199], v[180:183], v[56:59]
ds_read_b64_tr_b16 a[252:253], v227 offset:0
v_cvt_pk_bf16_f32 v102, v12, v13
v_mfma_f32_16x16x32_bf16 v[56:59], a[200:203], v[184:187], v[56:59]
v_exp_f32 v15, v15
v_mfma_f32_16x16x32_bf16 v[56:59], a[204:207], v[188:191], v[56:59]
ds_read_b64_tr_b16 a[254:255], v227 offset:8192
v_mfma_f32_16x16x32_bf16 v[60:63], a[208:211], v[176:179], v[76:79]
v_exp_f32 v16, v16
v_smfmac_f32_16x16x64_bf16 v[80:83], v[232:235], v[112:119], v88
v_cvt_pk_bf16_f32 v103, v14, v15
v_mfma_f32_16x16x32_bf16 v[60:63], a[212:215], v[180:183], v[60:63]
v_exp_f32 v17, v17
v_mfma_f32_16x16x32_bf16 v[60:63], a[216:219], v[184:187], v[60:63]
s_mov_b32 exec_lo, 0xff00
s_mov_b32 exec_hi, 0x0
buffer_load_dword v215, v254, s[96:99], 0 offen offset:2048
s_mov_b64 exec, -1
v_mfma_f32_16x16x32_bf16 v[60:63], a[220:223], v[188:191], v[60:63]
v_exp_f32 v18, v18
v_smfmac_f32_16x16x64_bf16 v[84:87], v[232:235], v[120:127], v88
s_waitcnt lgkmcnt(0)
v_cvt_pk_bf16_f32 v104, v16, v17
v_mfma_f32_16x16x32_bf16 a[0:3], a[224:227], v[112:115], a[0:3]
v_exp_f32 v19, v19
v_mfma_f32_16x16x32_bf16 a[4:7], a[224:227], v[116:119], a[4:7]
v_exp_f32 v20, v20
v_mfma_f32_16x16x32_bf16 a[8:11], a[224:227], v[120:123], a[8:11]
ds_read_b128 a[192:195], v216 offset:0
v_cvt_pk_bf16_f32 v105, v18, v19
v_mfma_f32_16x16x32_bf16 a[12:15], a[224:227], v[124:127], a[12:15]
v_exp_f32 v21, v21
v_mfma_f32_16x16x32_bf16 a[16:19], a[228:231], v[112:115], a[16:19]
ds_read_b128 a[196:199], v217 offset:0
ds_read_b128 a[200:203], v218 offset:0
v_mfma_f32_16x16x32_bf16 a[20:23], a[228:231], v[116:119], a[20:23]
v_exp_f32 v22, v22
v_mfma_f32_16x16x32_bf16 a[24:27], a[228:231], v[120:123], a[24:27]
ds_read_b128 a[204:207], v219 offset:0
v_cvt_pk_bf16_f32 v106, v20, v21
v_mfma_f32_16x16x32_bf16 a[28:31], a[228:231], v[124:127], a[28:31]
v_exp_f32 v23, v23
v_mfma_f32_16x16x32_bf16 a[32:35], a[232:235], v[112:115], a[32:35]
buffer_load_dwordx4 v231, s[8:11], s24 offen offset:3072  lds
v_mfma_f32_16x16x32_bf16 a[36:39], a[232:235], v[116:119], a[36:39]
s_add_u32 s24, s24, 8192
v_exp_f32 v24, v24
v_mfma_f32_16x16x32_bf16 a[40:43], a[232:235], v[120:123], a[40:43]
ds_read_b128 a[208:211], v216 offset:8192
v_cvt_pk_bf16_f32 v107, v22, v23
v_mfma_f32_16x16x32_bf16 a[44:47], a[232:235], v[124:127], a[44:47]
v_exp_f32 v25, v25
v_mfma_f32_16x16x32_bf16 a[48:51], a[236:239], v[112:115], a[48:51]
ds_read_b128 a[212:215], v217 offset:8192
ds_read_b128 a[216:219], v218 offset:8192
v_mfma_f32_16x16x32_bf16 a[52:55], a[236:239], v[116:119], a[52:55]
v_exp_f32 v26, v26
v_mfma_f32_16x16x32_bf16 a[56:59], a[236:239], v[120:123], a[56:59]
ds_read_b128 a[220:223], v219 offset:8192
v_cvt_pk_bf16_f32 v108, v24, v25
v_mfma_f32_16x16x32_bf16 a[60:63], a[236:239], v[124:127], a[60:63]
v_exp_f32 v27, v27
v_mfma_f32_16x16x32_bf16 a[64:67], a[240:243], v[112:115], a[64:67]
v_mfma_f32_16x16x32_bf16 a[68:71], a[240:243], v[116:119], a[68:71]
v_exp_f32 v28, v28
v_mfma_f32_16x16x32_bf16 a[72:75], a[240:243], v[120:123], a[72:75]
v_cvt_pk_bf16_f32 v109, v26, v27
v_mfma_f32_16x16x32_bf16 a[76:79], a[240:243], v[124:127], a[76:79]
v_exp_f32 v29, v29
v_mfma_f32_16x16x32_bf16 a[80:83], a[244:247], v[112:115], a[80:83]
s_lshl1_add_u32 m0, s26, 0
v_mfma_f32_16x16x32_bf16 a[84:87], a[244:247], v[116:119], a[84:87]
s_waitcnt vmcnt(12) lgkmcnt(0)
s_barrier
v_mfma_f32_16x16x32_bf16 a[88:91], a[244:247], v[120:123], a[88:91]
buffer_load_dwordx4 v228, s[12:15], s24 offen  lds
v_mfma_f32_16x16x32_bf16 a[92:95], a[244:247], v[124:127], a[92:95]
v_mfma_f32_16x16x32_bf16 a[96:99], a[248:251], v[112:115], a[96:99]
v_exp_f32 v30, v30
v_mfma_f32_16x16x32_bf16 a[100:103], a[248:251], v[116:119], a[100:103]
v_cvt_pk_bf16_f32 v110, v28, v29
v_mfma_f32_16x16x32_bf16 a[104:107], a[248:251], v[120:123], a[104:107]
v_exp_f32 v31, v31
v_mfma_f32_16x16x32_bf16 a[108:111], a[248:251], v[124:127], a[108:111]
buffer_store_dwordx4 v[200:203], v255, s[16:19], s54 offen offset:2048 sc1
v_mfma_f32_16x16x32_bf16 a[112:115], a[252:255], v[112:115], a[112:115]
v_exp_f32 v32, v32
v_mfma_f32_16x16x32_bf16 a[116:119], a[252:255], v[116:119], a[116:119]
v_cvt_pk_bf16_f32 v111, v30, v31
v_mfma_f32_16x16x32_bf16 a[120:123], a[252:255], v[120:123], a[120:123]
v_exp_f32 v33, v33
v_mfma_f32_16x16x32_bf16 a[124:127], a[252:255], v[124:127], a[124:127]
v_mfma_f32_16x16x32_bf16 v[0:3], a[192:195], v[128:131], v[64:67]
v_exp_f32 v34, v34
v_mfma_f32_16x16x32_bf16 v[0:3], a[196:199], v[132:135], v[0:3]
ds_read_b64_tr_b16 a[224:225], v220 offset:16384
v_cvt_pk_bf16_f32 v112, v32, v33
v_mfma_f32_16x16x32_bf16 v[0:3], a[200:203], v[136:139], v[0:3]
v_exp_f32 v35, v35
v_mfma_f32_16x16x32_bf16 v[0:3], a[204:207], v[140:143], v[0:3]
ds_read_b64_tr_b16 a[226:227], v220 offset:24576
ds_read_b64_tr_b16 a[228:229], v221 offset:16384
v_mfma_f32_16x16x32_bf16 v[4:7], a[208:211], v[128:131], v[64:67]
v_exp_f32 v36, v36
v_mfma_f32_16x16x32_bf16 v[4:7], a[212:215], v[132:135], v[4:7]
Lpad7:
s_cbranch_execz Lpad11
ds_read_b64_tr_b16 a[230:231], v221 offset:24576
v_cvt_pk_bf16_f32 v113, v34, v35
v_mfma_f32_16x16x32_bf16 v[4:7], a[216:219], v[136:139], v[4:7]
v_exp_f32 v37, v37
v_mfma_f32_16x16x32_bf16 v[4:7], a[220:223], v[140:143], v[4:7]
buffer_load_dwordx4 v229, s[12:15], s24 offen offset:1024  lds
v_mfma_f32_16x16x32_bf16 v[8:11], a[192:195], v[144:147], v[68:71]
v_exp_f32 v38, v38
v_mfma_f32_16x16x32_bf16 v[8:11], a[196:199], v[148:151], v[8:11]
ds_read_b64_tr_b16 a[232:233], v222 offset:16384
v_cvt_pk_bf16_f32 v114, v36, v37
v_mfma_f32_16x16x32_bf16 v[8:11], a[200:203], v[152:155], v[8:11]
v_exp_f32 v39, v39
v_mfma_f32_16x16x32_bf16 v[8:11], a[204:207], v[156:159], v[8:11]
ds_read_b64_tr_b16 a[234:235], v222 offset:24576
ds_read_b64_tr_b16 a[236:237], v223 offset:16384
v_mfma_f32_16x16x32_bf16 v[12:15], a[208:211], v[144:147], v[68:71]
v_exp_f32 v40, v40
v_mfma_f32_16x16x32_bf16 v[12:15], a[212:215], v[148:151], v[12:15]
ds_read_b64_tr_b16 a[238:239], v223 offset:24576
v_cvt_pk_bf16_f32 v115, v38, v39
v_mfma_f32_16x16x32_bf16 v[12:15], a[216:219], v[152:155], v[12:15]
v_exp_f32 v41, v41
v_mfma_f32_16x16x32_bf16 v[12:15], a[220:223], v[156:159], v[12:15]
ds_read_b64_tr_b16 a[240:241], v224 offset:16384
ds_read_b64_tr_b16 a[242:243], v224 offset:24576
v_mfma_f32_16x16x32_bf16 v[16:19], a[192:195], v[160:163], v[72:75]
v_exp_f32 v42, v42
v_mfma_f32_16x16x32_bf16 v[16:19], a[196:199], v[164:167], v[16:19]
ds_read_b64_tr_b16 a[244:245], v225 offset:16384
v_cvt_pk_bf16_f32 v116, v40, v41
v_mfma_f32_16x16x32_bf16 v[16:19], a[200:203], v[168:171], v[16:19]
v_exp_f32 v43, v43
v_mfma_f32_16x16x32_bf16 v[16:19], a[204:207], v[172:175], v[16:19]
ds_read_b64_tr_b16 a[246:247], v225 offset:24576
ds_read_b64_tr_b16 a[248:249], v226 offset:16384
v_mfma_f32_16x16x32_bf16 v[20:23], a[208:211], v[160:163], v[72:75]
v_exp_f32 v44, v44
v_mfma_f32_16x16x32_bf16 v[20:23], a[212:215], v[164:167], v[20:23]
ds_read_b64_tr_b16 a[250:251], v226 offset:24576
v_cvt_pk_bf16_f32 v117, v42, v43
v_mfma_f32_16x16x32_bf16 v[20:23], a[216:219], v[168:171], v[20:23]
v_exp_f32 v45, v45
v_mfma_f32_16x16x32_bf16 v[20:23], a[220:223], v[172:175], v[20:23]
buffer_load_dwordx4 v230, s[8:11], s24 offen offset:2048  lds
v_mfma_f32_16x16x32_bf16 v[24:27], a[192:195], v[176:179], v[76:79]
v_exp_f32 v46, v46
v_mfma_f32_16x16x32_bf16 v[24:27], a[196:199], v[180:183], v[24:27]
ds_read_b64_tr_b16 a[252:253], v227 offset:16384
v_cvt_pk_bf16_f32 v118, v44, v45
v_mfma_f32_16x16x32_bf16 v[24:27], a[200:203], v[184:187], v[24:27]
v_exp_f32 v47, v47
v_mfma_f32_16x16x32_bf16 v[24:27], a[204:207], v[188:191], v[24:27]
ds_read_b64_tr_b16 a[254:255], v227 offset:24576
v_mfma_f32_16x16x32_bf16 v[28:31], a[208:211], v[176:179], v[76:79]
v_exp_f32 v48, v48
v_smfmac_f32_16x16x64_bf16 v[80:83], v[232:235], v[96:103], v88
v_cvt_pk_bf16_f32 v119, v46, v47
v_mfma_f32_16x16x32_bf16 v[28:31], a[212:215], v[180:183], v[28:31]
v_exp_f32 v49, v49
v_mfma_f32_16x16x32_bf16 v[28:31], a[216:219], v[184:187], v[28:31]
s_mov_b32 m0, s51
s_mov_b32 exec_lo, 0xffffffff
s_mov_b32 exec_hi, 0x0
buffer_load_dwordx4 v240, s[56:59], s48 offen lds
s_mov_b64 exec, -1
s_lshl1_add_u32 m0, s26, 0
v_mfma_f32_16x16x32_bf16 v[28:31], a[220:223], v[188:191], v[28:31]
v_exp_f32 v50, v50
v_smfmac_f32_16x16x64_bf16 v[84:87], v[232:235], v[104:111], v88
s_waitcnt lgkmcnt(0)
v_cvt_pk_bf16_f32 v120, v48, v49
v_mfma_f32_16x16x32_bf16 a[0:3], a[224:227], v[96:99], a[0:3]
v_exp_f32 v51, v51
v_mfma_f32_16x16x32_bf16 a[4:7], a[224:227], v[100:103], a[4:7]
v_exp_f32 v52, v52
v_mfma_f32_16x16x32_bf16 a[8:11], a[224:227], v[104:107], a[8:11]
ds_read_b128 a[192:195], v216 offset:16384
v_cvt_pk_bf16_f32 v121, v50, v51
v_mfma_f32_16x16x32_bf16 a[12:15], a[224:227], v[108:111], a[12:15]
v_exp_f32 v53, v53
v_mfma_f32_16x16x32_bf16 a[16:19], a[228:231], v[96:99], a[16:19]
ds_read_b128 a[196:199], v217 offset:16384
ds_read_b128 a[200:203], v218 offset:16384
v_mfma_f32_16x16x32_bf16 a[20:23], a[228:231], v[100:103], a[20:23]
v_exp_f32 v54, v54
v_mfma_f32_16x16x32_bf16 a[24:27], a[228:231], v[104:107], a[24:27]
ds_read_b128 a[204:207], v219 offset:16384
v_cvt_pk_bf16_f32 v122, v52, v53
v_mfma_f32_16x16x32_bf16 a[28:31], a[228:231], v[108:111], a[28:31]
v_exp_f32 v55, v55
v_mfma_f32_16x16x32_bf16 a[32:35], a[232:235], v[96:99], a[32:35]
buffer_load_dwordx4 v231, s[8:11], s24 offen offset:3072  lds
v_mfma_f32_16x16x32_bf16 a[36:39], a[232:235], v[100:103], a[36:39]
s_add_u32 s24, s24, 8192
v_exp_f32 v56, v56
v_mfma_f32_16x16x32_bf16 a[40:43], a[232:235], v[104:107], a[40:43]
ds_read_b128 a[208:211], v216 offset:24576
v_cvt_pk_bf16_f32 v123, v54, v55
v_mfma_f32_16x16x32_bf16 a[44:47], a[232:235], v[108:111], a[44:47]
v_exp_f32 v57, v57
v_mfma_f32_16x16x32_bf16 a[48:51], a[236:239], v[96:99], a[48:51]
ds_read_b128 a[212:215], v217 offset:24576
ds_read_b128 a[216:219], v218 offset:24576
v_mfma_f32_16x16x32_bf16 a[52:55], a[236:239], v[100:103], a[52:55]
v_exp_f32 v58, v58
v_mfma_f32_16x16x32_bf16 a[56:59], a[236:239], v[104:107], a[56:59]
ds_read_b128 a[220:223], v219 offset:24576
v_cvt_pk_bf16_f32 v124, v56, v57
v_mfma_f32_16x16x32_bf16 a[60:63], a[236:239], v[108:111], a[60:63]
v_exp_f32 v59, v59
v_mfma_f32_16x16x32_bf16 a[64:67], a[240:243], v[96:99], a[64:67]
v_mfma_f32_16x16x32_bf16 a[68:71], a[240:243], v[100:103], a[68:71]
v_exp_f32 v60, v60
v_mfma_f32_16x16x32_bf16 a[72:75], a[240:243], v[104:107], a[72:75]
v_cvt_pk_bf16_f32 v125, v58, v59
v_mfma_f32_16x16x32_bf16 a[76:79], a[240:243], v[108:111], a[76:79]
v_exp_f32 v61, v61
v_mfma_f32_16x16x32_bf16 a[80:83], a[244:247], v[96:99], a[80:83]
s_lshl1_add_u32 m0, s26, 16384
v_mfma_f32_16x16x32_bf16 a[84:87], a[244:247], v[100:103], a[84:87]
s_waitcnt vmcnt(12) lgkmcnt(0)
s_barrier
v_mfma_f32_16x16x32_bf16 a[88:91], a[244:247], v[104:107], a[88:91]
buffer_load_dwordx4 v228, s[12:15], s24 offen  lds
v_mfma_f32_16x16x32_bf16 a[92:95], a[244:247], v[108:111], a[92:95]
s_mov_b32 m0, s51
s_mov_b32 exec_lo, 0x0
s_mov_b32 exec_hi, 0xffffffff
buffer_load_dwordx4 v240, s[56:59], s48 offen lds
s_mov_b64 exec, -1
s_lshl1_add_u32 m0, s26, 16384
v_mfma_f32_16x16x32_bf16 a[96:99], a[248:251], v[96:99], a[96:99]
v_exp_f32 v62, v62
v_mfma_f32_16x16x32_bf16 a[100:103], a[248:251], v[100:103], a[100:103]
v_cvt_pk_bf16_f32 v126, v60, v61
v_mfma_f32_16x16x32_bf16 a[104:107], a[248:251], v[104:107], a[104:107]
v_exp_f32 v63, v63
v_mfma_f32_16x16x32_bf16 a[108:111], a[248:251], v[108:111], a[108:111]
buffer_store_dwordx4 v[204:207], v255, s[16:19], s54 offen offset:3072 sc1
v_mfma_f32_16x16x32_bf16 a[112:115], a[252:255], v[96:99], a[112:115]
v_exp_f32 v0, v0
v_mfma_f32_16x16x32_bf16 a[116:119], a[252:255], v[100:103], a[116:119]
v_cvt_pk_bf16_f32 v127, v62, v63
v_mfma_f32_16x16x32_bf16 a[120:123], a[252:255], v[104:107], a[120:123]
v_exp_f32 v1, v1
v_mfma_f32_16x16x32_bf16 a[124:127], a[252:255], v[108:111], a[124:127]
v_mfma_f32_16x16x32_bf16 v[32:35], a[192:195], v[128:131], v[64:67]
v_exp_f32 v2, v2
v_mfma_f32_16x16x32_bf16 v[32:35], a[196:199], v[132:135], v[32:35]
ds_read_b64_tr_b16 a[224:225], v220 offset:32768
v_cvt_pk_bf16_f32 v96, v0, v1
v_mfma_f32_16x16x32_bf16 v[32:35], a[200:203], v[136:139], v[32:35]
s_add_u32 s51, s51, s52
v_exp_f32 v3, v3
v_mfma_f32_16x16x32_bf16 v[32:35], a[204:207], v[140:143], v[32:35]
ds_read_b64_tr_b16 a[226:227], v220 offset:40960
ds_read_b64_tr_b16 a[228:229], v221 offset:32768
v_mfma_f32_16x16x32_bf16 v[36:39], a[208:211], v[128:131], v[64:67]
s_add_u32 s48, s48, s49
v_exp_f32 v4, v4
v_mfma_f32_16x16x32_bf16 v[36:39], a[212:215], v[132:135], v[36:39]
ds_read_b64_tr_b16 a[230:231], v221 offset:40960
v_cvt_pk_bf16_f32 v97, v2, v3
v_mfma_f32_16x16x32_bf16 v[36:39], a[216:219], v[136:139], v[36:39]
v_exp_f32 v5, v5
v_mfma_f32_16x16x32_bf16 v[36:39], a[220:223], v[140:143], v[36:39]
buffer_load_dwordx4 v229, s[12:15], s24 offen offset:1024  lds
v_mfma_f32_16x16x32_bf16 v[40:43], a[192:195], v[144:147], v[68:71]
v_exp_f32 v6, v6
v_mfma_f32_16x16x32_bf16 v[40:43], a[196:199], v[148:151], v[40:43]
ds_read_b64_tr_b16 a[232:233], v222 offset:32768
v_cvt_pk_bf16_f32 v98, v4, v5
v_mfma_f32_16x16x32_bf16 v[40:43], a[200:203], v[152:155], v[40:43]
v_exp_f32 v7, v7
v_mfma_f32_16x16x32_bf16 v[40:43], a[204:207], v[156:159], v[40:43]
ds_read_b64_tr_b16 a[234:235], v222 offset:40960
ds_read_b64_tr_b16 a[236:237], v223 offset:32768
v_mfma_f32_16x16x32_bf16 v[44:47], a[208:211], v[144:147], v[68:71]
v_exp_f32 v8, v8
v_mfma_f32_16x16x32_bf16 v[44:47], a[212:215], v[148:151], v[44:47]
ds_read_b64_tr_b16 a[238:239], v223 offset:40960
v_cvt_pk_bf16_f32 v99, v6, v7
v_mfma_f32_16x16x32_bf16 v[44:47], a[216:219], v[152:155], v[44:47]
v_exp_f32 v9, v9
v_mfma_f32_16x16x32_bf16 v[44:47], a[220:223], v[156:159], v[44:47]
ds_read_b64_tr_b16 a[240:241], v224 offset:32768
ds_read_b64_tr_b16 a[242:243], v224 offset:40960
v_mfma_f32_16x16x32_bf16 v[48:51], a[192:195], v[160:163], v[72:75]
v_exp_f32 v10, v10
v_mfma_f32_16x16x32_bf16 v[48:51], a[196:199], v[164:167], v[48:51]
ds_read_b64_tr_b16 a[244:245], v225 offset:32768
v_cvt_pk_bf16_f32 v100, v8, v9
v_mfma_f32_16x16x32_bf16 v[48:51], a[200:203], v[168:171], v[48:51]
v_exp_f32 v11, v11
v_mfma_f32_16x16x32_bf16 v[48:51], a[204:207], v[172:175], v[48:51]
ds_read_b64_tr_b16 a[246:247], v225 offset:40960
ds_read_b64_tr_b16 a[248:249], v226 offset:32768
v_mfma_f32_16x16x32_bf16 v[52:55], a[208:211], v[160:163], v[72:75]
v_exp_f32 v12, v12
v_mfma_f32_16x16x32_bf16 v[52:55], a[212:215], v[164:167], v[52:55]
ds_read_b64_tr_b16 a[250:251], v226 offset:40960
v_cvt_pk_bf16_f32 v101, v10, v11
v_mfma_f32_16x16x32_bf16 v[52:55], a[216:219], v[168:171], v[52:55]
v_exp_f32 v13, v13
v_mfma_f32_16x16x32_bf16 v[52:55], a[220:223], v[172:175], v[52:55]
buffer_load_dwordx4 v230, s[8:11], s24 offen offset:2048  lds
v_mfma_f32_16x16x32_bf16 v[56:59], a[192:195], v[176:179], v[76:79]
v_exp_f32 v14, v14
v_mfma_f32_16x16x32_bf16 v[56:59], a[196:199], v[180:183], v[56:59]
ds_read_b64_tr_b16 a[252:253], v227 offset:32768
v_cvt_pk_bf16_f32 v102, v12, v13
v_mfma_f32_16x16x32_bf16 v[56:59], a[200:203], v[184:187], v[56:59]
v_exp_f32 v15, v15
v_mfma_f32_16x16x32_bf16 v[56:59], a[204:207], v[188:191], v[56:59]
ds_read_b64_tr_b16 a[254:255], v227 offset:40960
v_mfma_f32_16x16x32_bf16 v[60:63], a[208:211], v[176:179], v[76:79]
v_exp_f32 v16, v16
v_smfmac_f32_16x16x64_bf16 v[80:83], v[232:235], v[112:119], v88
v_cvt_pk_bf16_f32 v103, v14, v15
v_mfma_f32_16x16x32_bf16 v[60:63], a[212:215], v[180:183], v[60:63]
v_exp_f32 v17, v17
v_mfma_f32_16x16x32_bf16 v[60:63], a[216:219], v[184:187], v[60:63]
s_mov_b32 m0, s51
s_mov_b32 exec_lo, 0xffffffff
s_mov_b32 exec_hi, 0x0
buffer_load_dwordx4 v240, s[92:95], s48 offen lds
s_mov_b64 exec, -1
s_lshl1_add_u32 m0, s26, 16384
v_mfma_f32_16x16x32_bf16 v[60:63], a[220:223], v[188:191], v[60:63]
v_exp_f32 v18, v18
v_smfmac_f32_16x16x64_bf16 v[84:87], v[232:235], v[120:127], v88
s_waitcnt lgkmcnt(0)
v_cvt_pk_bf16_f32 v104, v16, v17
v_mfma_f32_16x16x32_bf16 a[0:3], a[224:227], v[112:115], a[0:3]
v_exp_f32 v19, v19
v_mfma_f32_16x16x32_bf16 a[4:7], a[224:227], v[116:119], a[4:7]
v_exp_f32 v20, v20
v_mfma_f32_16x16x32_bf16 a[8:11], a[224:227], v[120:123], a[8:11]
ds_read_b128 a[192:195], v216 offset:32768
v_cvt_pk_bf16_f32 v105, v18, v19
v_mfma_f32_16x16x32_bf16 a[12:15], a[224:227], v[124:127], a[12:15]
v_exp_f32 v21, v21
v_mfma_f32_16x16x32_bf16 a[16:19], a[228:231], v[112:115], a[16:19]
ds_read_b128 a[196:199], v217 offset:32768
ds_read_b128 a[200:203], v218 offset:32768
v_mfma_f32_16x16x32_bf16 a[20:23], a[228:231], v[116:119], a[20:23]
v_exp_f32 v22, v22
v_mfma_f32_16x16x32_bf16 a[24:27], a[228:231], v[120:123], a[24:27]
ds_read_b128 a[204:207], v219 offset:32768
v_cvt_pk_bf16_f32 v106, v20, v21
v_mfma_f32_16x16x32_bf16 a[28:31], a[228:231], v[124:127], a[28:31]
v_exp_f32 v23, v23
v_mfma_f32_16x16x32_bf16 a[32:35], a[232:235], v[112:115], a[32:35]
buffer_load_dwordx4 v231, s[8:11], s24 offen offset:3072  lds
v_mfma_f32_16x16x32_bf16 a[36:39], a[232:235], v[116:119], a[36:39]
s_add_u32 s24, s24, 8192
v_exp_f32 v24, v24
v_mfma_f32_16x16x32_bf16 a[40:43], a[232:235], v[120:123], a[40:43]
ds_read_b128 a[208:211], v216 offset:40960
v_cvt_pk_bf16_f32 v107, v22, v23
v_mfma_f32_16x16x32_bf16 a[44:47], a[232:235], v[124:127], a[44:47]
v_exp_f32 v25, v25
v_mfma_f32_16x16x32_bf16 a[48:51], a[236:239], v[112:115], a[48:51]
ds_read_b128 a[212:215], v217 offset:40960
ds_read_b128 a[216:219], v218 offset:40960
v_mfma_f32_16x16x32_bf16 a[52:55], a[236:239], v[116:119], a[52:55]
v_exp_f32 v26, v26
v_mfma_f32_16x16x32_bf16 a[56:59], a[236:239], v[120:123], a[56:59]
ds_read_b128 a[220:223], v219 offset:40960
v_cvt_pk_bf16_f32 v108, v24, v25
v_mfma_f32_16x16x32_bf16 a[60:63], a[236:239], v[124:127], a[60:63]
v_exp_f32 v27, v27
v_mfma_f32_16x16x32_bf16 a[64:67], a[240:243], v[112:115], a[64:67]
v_mfma_f32_16x16x32_bf16 a[68:71], a[240:243], v[116:119], a[68:71]
v_exp_f32 v28, v28
v_mfma_f32_16x16x32_bf16 a[72:75], a[240:243], v[120:123], a[72:75]
v_cvt_pk_bf16_f32 v109, v26, v27
v_mfma_f32_16x16x32_bf16 a[76:79], a[240:243], v[124:127], a[76:79]
v_exp_f32 v29, v29
v_mfma_f32_16x16x32_bf16 a[80:83], a[244:247], v[112:115], a[80:83]
s_lshl1_add_u32 m0, s26, 32768
v_mfma_f32_16x16x32_bf16 a[84:87], a[244:247], v[116:119], a[84:87]
s_waitcnt vmcnt(13) lgkmcnt(0)
s_barrier
v_mfma_f32_16x16x32_bf16 a[88:91], a[244:247], v[120:123], a[88:91]
buffer_load_dwordx4 v228, s[12:15], s24 offen  lds
v_mfma_f32_16x16x32_bf16 a[92:95], a[244:247], v[124:127], a[92:95]
s_mov_b32 m0, s51
s_mov_b32 exec_lo, 0x0
s_mov_b32 exec_hi, 0xffffffff
buffer_load_dwordx4 v240, s[92:95], s48 offen lds
s_mov_b64 exec, -1
s_lshl1_add_u32 m0, s26, 32768
v_mfma_f32_16x16x32_bf16 a[96:99], a[248:251], v[112:115], a[96:99]
v_exp_f32 v30, v30
v_mfma_f32_16x16x32_bf16 a[100:103], a[248:251], v[116:119], a[100:103]
v_cvt_pk_bf16_f32 v110, v28, v29
v_mfma_f32_16x16x32_bf16 a[104:107], a[248:251], v[120:123], a[104:107]
v_exp_f32 v31, v31
v_mfma_f32_16x16x32_bf16 a[108:111], a[248:251], v[124:127], a[108:111]
v_mfma_f32_16x16x32_bf16 a[112:115], a[252:255], v[112:115], a[112:115]
v_exp_f32 v32, v32
v_mfma_f32_16x16x32_bf16 a[116:119], a[252:255], v[116:119], a[116:119]
v_cvt_pk_bf16_f32 v111, v30, v31
v_mfma_f32_16x16x32_bf16 a[120:123], a[252:255], v[120:123], a[120:123]
v_exp_f32 v33, v33
v_mfma_f32_16x16x32_bf16 a[124:127], a[252:255], v[124:127], a[124:127]
v_mfma_f32_16x16x32_bf16 v[0:3], a[192:195], v[128:131], v[64:67]
v_exp_f32 v34, v34
v_mfma_f32_16x16x32_bf16 v[0:3], a[196:199], v[132:135], v[0:3]
ds_read_b64_tr_b16 a[224:225], v220 offset:49152
v_cvt_pk_bf16_f32 v112, v32, v33
v_mfma_f32_16x16x32_bf16 v[0:3], a[200:203], v[136:139], v[0:3]
s_add_u32 s51, s51, s52
v_exp_f32 v35, v35
v_mfma_f32_16x16x32_bf16 v[0:3], a[204:207], v[140:143], v[0:3]
ds_read_b64_tr_b16 a[226:227], v220 offset:57344
ds_read_b64_tr_b16 a[228:229], v221 offset:49152
v_mfma_f32_16x16x32_bf16 v[4:7], a[208:211], v[128:131], v[64:67]
s_add_u32 s48, s48, s50
v_exp_f32 v36, v36
v_mfma_f32_16x16x32_bf16 v[4:7], a[212:215], v[132:135], v[4:7]
ds_read_b64_tr_b16 a[230:231], v221 offset:57344
v_cvt_pk_bf16_f32 v113, v34, v35
v_mfma_f32_16x16x32_bf16 v[4:7], a[216:219], v[136:139], v[4:7]
v_exp_f32 v37, v37
v_mfma_f32_16x16x32_bf16 v[4:7], a[220:223], v[140:143], v[4:7]
buffer_load_dwordx4 v229, s[12:15], s24 offen offset:1024  lds
v_mfma_f32_16x16x32_bf16 v[8:11], a[192:195], v[144:147], v[68:71]
v_exp_f32 v38, v38
v_mfma_f32_16x16x32_bf16 v[8:11], a[196:199], v[148:151], v[8:11]
ds_read_b64_tr_b16 a[232:233], v222 offset:49152
v_cvt_pk_bf16_f32 v114, v36, v37
v_mfma_f32_16x16x32_bf16 v[8:11], a[200:203], v[152:155], v[8:11]
v_exp_f32 v39, v39
v_mfma_f32_16x16x32_bf16 v[8:11], a[204:207], v[156:159], v[8:11]
ds_read_b64_tr_b16 a[234:235], v222 offset:57344
ds_read_b64_tr_b16 a[236:237], v223 offset:49152
v_mfma_f32_16x16x32_bf16 v[12:15], a[208:211], v[144:147], v[68:71]
v_exp_f32 v40, v40
v_mfma_f32_16x16x32_bf16 v[12:15], a[212:215], v[148:151], v[12:15]
ds_read_b64_tr_b16 a[238:239], v223 offset:57344
v_cvt_pk_bf16_f32 v115, v38, v39
v_mfma_f32_16x16x32_bf16 v[12:15], a[216:219], v[152:155], v[12:15]
v_exp_f32 v41, v41
v_mfma_f32_16x16x32_bf16 v[12:15], a[220:223], v[156:159], v[12:15]
ds_read_b64_tr_b16 a[240:241], v224 offset:49152
ds_read_b64_tr_b16 a[242:243], v224 offset:57344
v_mfma_f32_16x16x32_bf16 v[16:19], a[192:195], v[160:163], v[72:75]
v_exp_f32 v42, v42
v_mfma_f32_16x16x32_bf16 v[16:19], a[196:199], v[164:167], v[16:19]
ds_read_b64_tr_b16 a[244:245], v225 offset:49152
v_cvt_pk_bf16_f32 v116, v40, v41
v_mfma_f32_16x16x32_bf16 v[16:19], a[200:203], v[168:171], v[16:19]
v_exp_f32 v43, v43
v_mfma_f32_16x16x32_bf16 v[16:19], a[204:207], v[172:175], v[16:19]
ds_read_b64_tr_b16 a[246:247], v225 offset:57344
ds_read_b64_tr_b16 a[248:249], v226 offset:49152
v_mfma_f32_16x16x32_bf16 v[20:23], a[208:211], v[160:163], v[72:75]
v_exp_f32 v44, v44
v_mfma_f32_16x16x32_bf16 v[20:23], a[212:215], v[164:167], v[20:23]
ds_read_b64_tr_b16 a[250:251], v226 offset:57344
v_cvt_pk_bf16_f32 v117, v42, v43
v_mfma_f32_16x16x32_bf16 v[20:23], a[216:219], v[168:171], v[20:23]
v_exp_f32 v45, v45
v_mfma_f32_16x16x32_bf16 v[20:23], a[220:223], v[172:175], v[20:23]
buffer_load_dwordx4 v230, s[8:11], s24 offen offset:2048  lds
v_mfma_f32_16x16x32_bf16 v[24:27], a[192:195], v[176:179], v[76:79]
v_exp_f32 v46, v46
v_mfma_f32_16x16x32_bf16 v[24:27], a[196:199], v[180:183], v[24:27]
ds_read_b64_tr_b16 a[252:253], v227 offset:49152
v_cvt_pk_bf16_f32 v118, v44, v45
v_mfma_f32_16x16x32_bf16 v[24:27], a[200:203], v[184:187], v[24:27]
v_exp_f32 v47, v47
v_mfma_f32_16x16x32_bf16 v[24:27], a[204:207], v[188:191], v[24:27]
ds_read_b64_tr_b16 a[254:255], v227 offset:57344
v_mfma_f32_16x16x32_bf16 v[28:31], a[208:211], v[176:179], v[76:79]
v_exp_f32 v48, v48
v_smfmac_f32_16x16x64_bf16 v[80:83], v[232:235], v[96:103], v88
v_cvt_pk_bf16_f32 v119, v46, v47
v_mfma_f32_16x16x32_bf16 v[28:31], a[212:215], v[180:183], v[28:31]
v_exp_f32 v49, v49
v_mfma_f32_16x16x32_bf16 v[28:31], a[216:219], v[184:187], v[28:31]
s_mov_b32 m0, s51
s_mov_b32 exec_lo, 0xffffffff
s_mov_b32 exec_hi, 0x0
buffer_load_dwordx4 v240, s[56:59], s48 offen lds
s_mov_b64 exec, -1
s_lshl1_add_u32 m0, s26, 32768
v_mfma_f32_16x16x32_bf16 v[28:31], a[220:223], v[188:191], v[28:31]
v_exp_f32 v50, v50
v_smfmac_f32_16x16x64_bf16 v[84:87], v[232:235], v[104:111], v88
s_waitcnt lgkmcnt(0)
v_cvt_pk_bf16_f32 v120, v48, v49
v_mfma_f32_16x16x32_bf16 a[0:3], a[224:227], v[96:99], a[0:3]
v_exp_f32 v51, v51
v_mfma_f32_16x16x32_bf16 a[4:7], a[224:227], v[100:103], a[4:7]
v_exp_f32 v52, v52
v_mfma_f32_16x16x32_bf16 a[8:11], a[224:227], v[104:107], a[8:11]
ds_read_b128 a[192:195], v216 offset:49152
v_cvt_pk_bf16_f32 v121, v50, v51
v_mfma_f32_16x16x32_bf16 a[12:15], a[224:227], v[108:111], a[12:15]
v_exp_f32 v53, v53
v_mfma_f32_16x16x32_bf16 a[16:19], a[228:231], v[96:99], a[16:19]
ds_read_b128 a[196:199], v217 offset:49152
ds_read_b128 a[200:203], v218 offset:49152
v_mfma_f32_16x16x32_bf16 a[20:23], a[228:231], v[100:103], a[20:23]
v_exp_f32 v54, v54
v_mfma_f32_16x16x32_bf16 a[24:27], a[228:231], v[104:107], a[24:27]
ds_read_b128 a[204:207], v219 offset:49152
v_cvt_pk_bf16_f32 v122, v52, v53
v_mfma_f32_16x16x32_bf16 a[28:31], a[228:231], v[108:111], a[28:31]
v_exp_f32 v55, v55
v_mfma_f32_16x16x32_bf16 a[32:35], a[232:235], v[96:99], a[32:35]
buffer_load_dwordx4 v231, s[8:11], s24 offen offset:3072  lds
v_mfma_f32_16x16x32_bf16 a[36:39], a[232:235], v[100:103], a[36:39]
s_add_u32 s24, s24, 8192
v_exp_f32 v56, v56
v_mfma_f32_16x16x32_bf16 a[40:43], a[232:235], v[104:107], a[40:43]
ds_read_b128 a[208:211], v216 offset:57344
v_cvt_pk_bf16_f32 v123, v54, v55
v_mfma_f32_16x16x32_bf16 a[44:47], a[232:235], v[108:111], a[44:47]
v_exp_f32 v57, v57
v_mfma_f32_16x16x32_bf16 a[48:51], a[236:239], v[96:99], a[48:51]
ds_read_b128 a[212:215], v217 offset:57344
ds_read_b128 a[216:219], v218 offset:57344
v_mfma_f32_16x16x32_bf16 a[52:55], a[236:239], v[100:103], a[52:55]
v_exp_f32 v58, v58
v_mfma_f32_16x16x32_bf16 a[56:59], a[236:239], v[104:107], a[56:59]
ds_read_b128 a[220:223], v219 offset:57344
v_cvt_pk_bf16_f32 v124, v56, v57
v_mfma_f32_16x16x32_bf16 a[60:63], a[236:239], v[108:111], a[60:63]
v_exp_f32 v59, v59
v_mfma_f32_16x16x32_bf16 a[64:67], a[240:243], v[96:99], a[64:67]
v_mfma_f32_16x16x32_bf16 a[68:71], a[240:243], v[100:103], a[68:71]
v_exp_f32 v60, v60
v_mfma_f32_16x16x32_bf16 a[72:75], a[240:243], v[104:107], a[72:75]
v_cvt_pk_bf16_f32 v125, v58, v59
v_mfma_f32_16x16x32_bf16 a[76:79], a[240:243], v[108:111], a[76:79]
v_exp_f32 v61, v61
v_mfma_f32_16x16x32_bf16 a[80:83], a[244:247], v[96:99], a[80:83]
s_lshl1_add_u32 m0, s26, 49152
v_mfma_f32_16x16x32_bf16 a[84:87], a[244:247], v[100:103], a[84:87]
s_waitcnt vmcnt(13) lgkmcnt(0)
s_barrier
v_mfma_f32_16x16x32_bf16 a[88:91], a[244:247], v[104:107], a[88:91]
buffer_load_dwordx4 v228, s[12:15], s24 offen  lds
v_mfma_f32_16x16x32_bf16 a[92:95], a[244:247], v[108:111], a[92:95]
s_mov_b32 m0, s51
s_mov_b32 exec_lo, 0x0
s_mov_b32 exec_hi, 0xffffffff
buffer_load_dwordx4 v240, s[56:59], s48 offen lds
s_mov_b64 exec, -1
s_lshl1_add_u32 m0, s26, 49152
v_mfma_f32_16x16x32_bf16 a[96:99], a[248:251], v[96:99], a[96:99]
v_exp_f32 v62, v62
v_mfma_f32_16x16x32_bf16 a[100:103], a[248:251], v[100:103], a[100:103]
v_cvt_pk_bf16_f32 v126, v60, v61
v_mfma_f32_16x16x32_bf16 a[104:107], a[248:251], v[104:107], a[104:107]
v_exp_f32 v63, v63
v_mfma_f32_16x16x32_bf16 a[108:111], a[248:251], v[108:111], a[108:111]
v_mfma_f32_16x16x32_bf16 a[112:115], a[252:255], v[96:99], a[112:115]
v_exp_f32 v0, v0
v_mfma_f32_16x16x32_bf16 a[116:119], a[252:255], v[100:103], a[116:119]
v_cvt_pk_bf16_f32 v127, v62, v63
v_mfma_f32_16x16x32_bf16 a[120:123], a[252:255], v[104:107], a[120:123]
v_exp_f32 v1, v1
v_mfma_f32_16x16x32_bf16 a[124:127], a[252:255], v[108:111], a[124:127]
v_mfma_f32_16x16x32_bf16 v[32:35], a[192:195], v[128:131], v[64:67]
v_exp_f32 v2, v2
v_mfma_f32_16x16x32_bf16 v[32:35], a[196:199], v[132:135], v[32:35]
ds_read_b64_tr_b16 a[224:225], v220 offset:0
v_cvt_pk_bf16_f32 v96, v0, v1
v_mfma_f32_16x16x32_bf16 v[32:35], a[200:203], v[136:139], v[32:35]
s_add_u32 s51, s51, s52
v_exp_f32 v3, v3
v_mfma_f32_16x16x32_bf16 v[32:35], a[204:207], v[140:143], v[32:35]
ds_read_b64_tr_b16 a[226:227], v220 offset:8192
ds_read_b64_tr_b16 a[228:229], v221 offset:0
v_mfma_f32_16x16x32_bf16 v[36:39], a[208:211], v[128:131], v[64:67]
s_add_u32 s48, s48, s49
v_exp_f32 v4, v4
v_mfma_f32_16x16x32_bf16 v[36:39], a[212:215], v[132:135], v[36:39]
ds_read_b64_tr_b16 a[230:231], v221 offset:8192
v_cvt_pk_bf16_f32 v97, v2, v3
v_mfma_f32_16x16x32_bf16 v[36:39], a[216:219], v[136:139], v[36:39]
v_exp_f32 v5, v5
v_mfma_f32_16x16x32_bf16 v[36:39], a[220:223], v[140:143], v[36:39]
buffer_load_dwordx4 v229, s[12:15], s24 offen offset:1024  lds
v_mfma_f32_16x16x32_bf16 v[40:43], a[192:195], v[144:147], v[68:71]
v_exp_f32 v6, v6
v_mfma_f32_16x16x32_bf16 v[40:43], a[196:199], v[148:151], v[40:43]
ds_read_b64_tr_b16 a[232:233], v222 offset:0
v_cvt_pk_bf16_f32 v98, v4, v5
v_mfma_f32_16x16x32_bf16 v[40:43], a[200:203], v[152:155], v[40:43]
v_exp_f32 v7, v7
v_mfma_f32_16x16x32_bf16 v[40:43], a[204:207], v[156:159], v[40:43]
ds_read_b64_tr_b16 a[234:235], v222 offset:8192
ds_read_b64_tr_b16 a[236:237], v223 offset:0
v_mfma_f32_16x16x32_bf16 v[44:47], a[208:211], v[144:147], v[68:71]
v_exp_f32 v8, v8
v_mfma_f32_16x16x32_bf16 v[44:47], a[212:215], v[148:151], v[44:47]
ds_read_b64_tr_b16 a[238:239], v223 offset:8192
v_cvt_pk_bf16_f32 v99, v6, v7
v_mfma_f32_16x16x32_bf16 v[44:47], a[216:219], v[152:155], v[44:47]
v_exp_f32 v9, v9
v_mfma_f32_16x16x32_bf16 v[44:47], a[220:223], v[156:159], v[44:47]
ds_read_b64_tr_b16 a[240:241], v224 offset:0
ds_read_b64_tr_b16 a[242:243], v224 offset:8192
v_mfma_f32_16x16x32_bf16 v[48:51], a[192:195], v[160:163], v[72:75]
v_exp_f32 v10, v10
v_mfma_f32_16x16x32_bf16 v[48:51], a[196:199], v[164:167], v[48:51]
ds_read_b64_tr_b16 a[244:245], v225 offset:0
v_cvt_pk_bf16_f32 v100, v8, v9
v_mfma_f32_16x16x32_bf16 v[48:51], a[200:203], v[168:171], v[48:51]
v_exp_f32 v11, v11
v_mfma_f32_16x16x32_bf16 v[48:51], a[204:207], v[172:175], v[48:51]
ds_read_b64_tr_b16 a[246:247], v225 offset:8192
ds_read_b64_tr_b16 a[248:249], v226 offset:0
v_mfma_f32_16x16x32_bf16 v[52:55], a[208:211], v[160:163], v[72:75]
v_exp_f32 v12, v12
v_mfma_f32_16x16x32_bf16 v[52:55], a[212:215], v[164:167], v[52:55]
ds_read_b64_tr_b16 a[250:251], v226 offset:8192
v_cvt_pk_bf16_f32 v101, v10, v11
v_mfma_f32_16x16x32_bf16 v[52:55], a[216:219], v[168:171], v[52:55]
v_exp_f32 v13, v13
v_mfma_f32_16x16x32_bf16 v[52:55], a[220:223], v[172:175], v[52:55]
buffer_load_dwordx4 v230, s[8:11], s24 offen offset:2048  lds
v_mfma_f32_16x16x32_bf16 v[56:59], a[192:195], v[176:179], v[76:79]
v_exp_f32 v14, v14
v_mfma_f32_16x16x32_bf16 v[56:59], a[196:199], v[180:183], v[56:59]
ds_read_b64_tr_b16 a[252:253], v227 offset:0
v_cvt_pk_bf16_f32 v102, v12, v13
v_mfma_f32_16x16x32_bf16 v[56:59], a[200:203], v[184:187], v[56:59]
v_exp_f32 v15, v15
v_mfma_f32_16x16x32_bf16 v[56:59], a[204:207], v[188:191], v[56:59]
ds_read_b64_tr_b16 a[254:255], v227 offset:8192
v_mfma_f32_16x16x32_bf16 v[60:63], a[208:211], v[176:179], v[76:79]
v_exp_f32 v16, v16
v_smfmac_f32_16x16x64_bf16 v[80:83], v[232:235], v[112:119], v88
v_cvt_pk_bf16_f32 v103, v14, v15
v_mfma_f32_16x16x32_bf16 v[60:63], a[212:215], v[180:183], v[60:63]
v_exp_f32 v17, v17
v_mfma_f32_16x16x32_bf16 v[60:63], a[216:219], v[184:187], v[60:63]
s_mov_b32 m0, s51
s_mov_b32 exec_lo, 0xffffffff
s_mov_b32 exec_hi, 0x0
buffer_load_dwordx4 v240, s[92:95], s48 offen lds
s_mov_b64 exec, -1
s_lshl1_add_u32 m0, s26, 49152
v_mfma_f32_16x16x32_bf16 v[60:63], a[220:223], v[188:191], v[60:63]
v_exp_f32 v18, v18
v_smfmac_f32_16x16x64_bf16 v[84:87], v[232:235], v[120:127], v88
s_waitcnt lgkmcnt(0)
v_cvt_pk_bf16_f32 v104, v16, v17
v_mfma_f32_16x16x32_bf16 a[0:3], a[224:227], v[112:115], a[0:3]
v_exp_f32 v19, v19
v_mfma_f32_16x16x32_bf16 a[4:7], a[224:227], v[116:119], a[4:7]
v_exp_f32 v20, v20
v_mfma_f32_16x16x32_bf16 a[8:11], a[224:227], v[120:123], a[8:11]
ds_read_b128 a[192:195], v216 offset:0
v_cvt_pk_bf16_f32 v105, v18, v19
v_mfma_f32_16x16x32_bf16 a[12:15], a[224:227], v[124:127], a[12:15]
v_exp_f32 v21, v21
v_mfma_f32_16x16x32_bf16 a[16:19], a[228:231], v[112:115], a[16:19]
ds_read_b128 a[196:199], v217 offset:0
ds_read_b128 a[200:203], v218 offset:0
v_mfma_f32_16x16x32_bf16 a[20:23], a[228:231], v[116:119], a[20:23]
v_exp_f32 v22, v22
v_mfma_f32_16x16x32_bf16 a[24:27], a[228:231], v[120:123], a[24:27]
ds_read_b128 a[204:207], v219 offset:0
v_cvt_pk_bf16_f32 v106, v20, v21
v_mfma_f32_16x16x32_bf16 a[28:31], a[228:231], v[124:127], a[28:31]
v_exp_f32 v23, v23
v_mfma_f32_16x16x32_bf16 a[32:35], a[232:235], v[112:115], a[32:35]
buffer_load_dwordx4 v231, s[8:11], s24 offen offset:3072  lds
v_mfma_f32_16x16x32_bf16 a[36:39], a[232:235], v[116:119], a[36:39]
s_add_u32 s24, s24, 8192
v_exp_f32 v24, v24
v_mfma_f32_16x16x32_bf16 a[40:43], a[232:235], v[120:123], a[40:43]
ds_read_b128 a[208:211], v216 offset:8192
v_cvt_pk_bf16_f32 v107, v22, v23
v_mfma_f32_16x16x32_bf16 a[44:47], a[232:235], v[124:127], a[44:47]
v_exp_f32 v25, v25
v_mfma_f32_16x16x32_bf16 a[48:51], a[236:239], v[112:115], a[48:51]
ds_read_b128 a[212:215], v217 offset:8192
ds_read_b128 a[216:219], v218 offset:8192
v_mfma_f32_16x16x32_bf16 a[52:55], a[236:239], v[116:119], a[52:55]
v_exp_f32 v26, v26
v_mfma_f32_16x16x32_bf16 a[56:59], a[236:239], v[120:123], a[56:59]
ds_read_b128 a[220:223], v219 offset:8192
v_cvt_pk_bf16_f32 v108, v24, v25
Lpad8:
s_cbranch_execz Lpad12
v_mfma_f32_16x16x32_bf16 a[60:63], a[236:239], v[124:127], a[60:63]
v_exp_f32 v27, v27
v_mfma_f32_16x16x32_bf16 a[64:67], a[240:243], v[112:115], a[64:67]
v_mfma_f32_16x16x32_bf16 a[68:71], a[240:243], v[116:119], a[68:71]
v_exp_f32 v28, v28
v_mfma_f32_16x16x32_bf16 a[72:75], a[240:243], v[120:123], a[72:75]
v_cvt_pk_bf16_f32 v109, v26, v27
v_mfma_f32_16x16x32_bf16 a[76:79], a[240:243], v[124:127], a[76:79]
v_exp_f32 v29, v29
v_mfma_f32_16x16x32_bf16 a[80:83], a[244:247], v[112:115], a[80:83]
s_lshl1_add_u32 m0, s26, 0
v_mfma_f32_16x16x32_bf16 a[84:87], a[244:247], v[116:119], a[84:87]
s_waitcnt vmcnt(12) lgkmcnt(0)
s_barrier
v_mfma_f32_16x16x32_bf16 a[88:91], a[244:247], v[120:123], a[88:91]
buffer_load_dwordx4 v228, s[12:15], s24 offen  lds
v_mfma_f32_16x16x32_bf16 a[92:95], a[244:247], v[124:127], a[92:95]
s_mov_b32 m0, s51
s_mov_b32 exec_lo, 0x0
s_mov_b32 exec_hi, 0xffffffff
buffer_load_dwordx4 v240, s[92:95], s48 offen lds
s_mov_b64 exec, -1
s_lshl1_add_u32 m0, s26, 0
v_mfma_f32_16x16x32_bf16 a[96:99], a[248:251], v[112:115], a[96:99]
v_exp_f32 v30, v30
v_mfma_f32_16x16x32_bf16 a[100:103], a[248:251], v[116:119], a[100:103]
v_cvt_pk_bf16_f32 v110, v28, v29
v_mfma_f32_16x16x32_bf16 a[104:107], a[248:251], v[120:123], a[104:107]
v_exp_f32 v31, v31
v_mfma_f32_16x16x32_bf16 a[108:111], a[248:251], v[124:127], a[108:111]
v_mfma_f32_16x16x32_bf16 a[112:115], a[252:255], v[112:115], a[112:115]
v_exp_f32 v32, v32
v_mfma_f32_16x16x32_bf16 a[116:119], a[252:255], v[116:119], a[116:119]
v_cvt_pk_bf16_f32 v111, v30, v31
v_mfma_f32_16x16x32_bf16 a[120:123], a[252:255], v[120:123], a[120:123]
v_exp_f32 v33, v33
v_mfma_f32_16x16x32_bf16 a[124:127], a[252:255], v[124:127], a[124:127]
v_mfma_f32_16x16x32_bf16 v[0:3], a[192:195], v[128:131], v[64:67]
v_exp_f32 v34, v34
v_mfma_f32_16x16x32_bf16 v[0:3], a[196:199], v[132:135], v[0:3]
ds_read_b64_tr_b16 a[224:225], v220 offset:16384
v_cvt_pk_bf16_f32 v112, v32, v33
v_mfma_f32_16x16x32_bf16 v[0:3], a[200:203], v[136:139], v[0:3]
s_add_u32 s51, s51, s52
v_exp_f32 v35, v35
v_mfma_f32_16x16x32_bf16 v[0:3], a[204:207], v[140:143], v[0:3]
ds_read_b64_tr_b16 a[226:227], v220 offset:24576
ds_read_b64_tr_b16 a[228:229], v221 offset:16384
v_mfma_f32_16x16x32_bf16 v[4:7], a[208:211], v[128:131], v[64:67]
s_add_u32 s48, s48, s50
v_exp_f32 v36, v36
v_mfma_f32_16x16x32_bf16 v[4:7], a[212:215], v[132:135], v[4:7]
ds_read_b64_tr_b16 a[230:231], v221 offset:24576
v_cvt_pk_bf16_f32 v113, v34, v35
v_mfma_f32_16x16x32_bf16 v[4:7], a[216:219], v[136:139], v[4:7]
v_exp_f32 v37, v37
v_mfma_f32_16x16x32_bf16 v[4:7], a[220:223], v[140:143], v[4:7]
buffer_load_dwordx4 v229, s[12:15], s24 offen offset:1024  lds
v_mfma_f32_16x16x32_bf16 v[8:11], a[192:195], v[144:147], v[68:71]
v_exp_f32 v38, v38
v_mfma_f32_16x16x32_bf16 v[8:11], a[196:199], v[148:151], v[8:11]
ds_read_b64_tr_b16 a[232:233], v222 offset:16384
v_cvt_pk_bf16_f32 v114, v36, v37
v_mfma_f32_16x16x32_bf16 v[8:11], a[200:203], v[152:155], v[8:11]
v_exp_f32 v39, v39
v_mfma_f32_16x16x32_bf16 v[8:11], a[204:207], v[156:159], v[8:11]
ds_read_b64_tr_b16 a[234:235], v222 offset:24576
ds_read_b64_tr_b16 a[236:237], v223 offset:16384
v_mfma_f32_16x16x32_bf16 v[12:15], a[208:211], v[144:147], v[68:71]
v_exp_f32 v40, v40
v_mfma_f32_16x16x32_bf16 v[12:15], a[212:215], v[148:151], v[12:15]
ds_read_b64_tr_b16 a[238:239], v223 offset:24576
v_cvt_pk_bf16_f32 v115, v38, v39
v_mfma_f32_16x16x32_bf16 v[12:15], a[216:219], v[152:155], v[12:15]
v_exp_f32 v41, v41
v_mfma_f32_16x16x32_bf16 v[12:15], a[220:223], v[156:159], v[12:15]
ds_read_b64_tr_b16 a[240:241], v224 offset:16384
ds_read_b64_tr_b16 a[242:243], v224 offset:24576
v_mfma_f32_16x16x32_bf16 v[16:19], a[192:195], v[160:163], v[72:75]
v_exp_f32 v42, v42
v_mfma_f32_16x16x32_bf16 v[16:19], a[196:199], v[164:167], v[16:19]
ds_read_b64_tr_b16 a[244:245], v225 offset:16384
v_cvt_pk_bf16_f32 v116, v40, v41
v_mfma_f32_16x16x32_bf16 v[16:19], a[200:203], v[168:171], v[16:19]
v_exp_f32 v43, v43
v_mfma_f32_16x16x32_bf16 v[16:19], a[204:207], v[172:175], v[16:19]
ds_read_b64_tr_b16 a[246:247], v225 offset:24576
ds_read_b64_tr_b16 a[248:249], v226 offset:16384
v_mfma_f32_16x16x32_bf16 v[20:23], a[208:211], v[160:163], v[72:75]
v_exp_f32 v44, v44
v_mfma_f32_16x16x32_bf16 v[20:23], a[212:215], v[164:167], v[20:23]
ds_read_b64_tr_b16 a[250:251], v226 offset:24576
v_cvt_pk_bf16_f32 v117, v42, v43
v_mfma_f32_16x16x32_bf16 v[20:23], a[216:219], v[168:171], v[20:23]
v_exp_f32 v45, v45
v_mfma_f32_16x16x32_bf16 v[20:23], a[220:223], v[172:175], v[20:23]
buffer_load_dwordx4 v230, s[8:11], s24 offen offset:2048  lds
v_mfma_f32_16x16x32_bf16 v[24:27], a[192:195], v[176:179], v[76:79]
v_exp_f32 v46, v46
v_mfma_f32_16x16x32_bf16 v[24:27], a[196:199], v[180:183], v[24:27]
ds_read_b64_tr_b16 a[252:253], v227 offset:16384
v_cvt_pk_bf16_f32 v118, v44, v45
v_mfma_f32_16x16x32_bf16 v[24:27], a[200:203], v[184:187], v[24:27]
v_exp_f32 v47, v47
v_mfma_f32_16x16x32_bf16 v[24:27], a[204:207], v[188:191], v[24:27]
ds_read_b64_tr_b16 a[254:255], v227 offset:24576
v_mfma_f32_16x16x32_bf16 v[28:31], a[208:211], v[176:179], v[76:79]
v_exp_f32 v48, v48
v_smfmac_f32_16x16x64_bf16 v[80:83], v[232:235], v[96:103], v88
v_cvt_pk_bf16_f32 v119, v46, v47
v_mfma_f32_16x16x32_bf16 v[28:31], a[212:215], v[180:183], v[28:31]
v_exp_f32 v49, v49
v_mfma_f32_16x16x32_bf16 v[28:31], a[216:219], v[184:187], v[28:31]
s_cmp_lg_u32 s61, 2
s_cbranch_scc1 La_g40
s_mov_b32 m0, s51
s_mov_b32 exec_lo, 0xffffffff
s_mov_b32 exec_hi, 0x0
buffer_load_dwordx4 v240, s[56:59], s48 offen lds
s_mov_b64 exec, -1
s_lshl1_add_u32 m0, s26, 0
La_g40:
v_mfma_f32_16x16x32_bf16 v[28:31], a[220:223], v[188:191], v[28:31]
v_exp_f32 v50, v50
v_smfmac_f32_16x16x64_bf16 v[84:87], v[232:235], v[104:111], v88
s_waitcnt lgkmcnt(0)
v_cvt_pk_bf16_f32 v120, v48, v49
v_mfma_f32_16x16x32_bf16 a[0:3], a[224:227], v[96:99], a[0:3]
v_exp_f32 v51, v51
v_mfma_f32_16x16x32_bf16 a[4:7], a[224:227], v[100:103], a[4:7]
v_exp_f32 v52, v52
v_mfma_f32_16x16x32_bf16 a[8:11], a[224:227], v[104:107], a[8:11]
ds_read_b128 a[192:195], v216 offset:16384
v_cvt_pk_bf16_f32 v121, v50, v51
v_mfma_f32_16x16x32_bf16 a[12:15], a[224:227], v[108:111], a[12:15]
v_exp_f32 v53, v53
v_mfma_f32_16x16x32_bf16 a[16:19], a[228:231], v[96:99], a[16:19]
ds_read_b128 a[196:199], v217 offset:16384
ds_read_b128 a[200:203], v218 offset:16384
v_mfma_f32_16x16x32_bf16 a[20:23], a[228:231], v[100:103], a[20:23]
v_exp_f32 v54, v54
v_mfma_f32_16x16x32_bf16 a[24:27], a[228:231], v[104:107], a[24:27]
ds_read_b128 a[204:207], v219 offset:16384
v_cvt_pk_bf16_f32 v122, v52, v53
v_mfma_f32_16x16x32_bf16 a[28:31], a[228:231], v[108:111], a[28:31]
v_exp_f32 v55, v55
v_mfma_f32_16x16x32_bf16 a[32:35], a[232:235], v[96:99], a[32:35]
buffer_load_dwordx4 v231, s[8:11], s24 offen offset:3072  lds
v_mfma_f32_16x16x32_bf16 a[36:39], a[232:235], v[100:103], a[36:39]
s_add_u32 s24, s24, 8192
v_exp_f32 v56, v56
v_mfma_f32_16x16x32_bf16 a[40:43], a[232:235], v[104:107], a[40:43]
ds_read_b128 a[208:211], v216 offset:24576
v_cvt_pk_bf16_f32 v123, v54, v55
v_mfma_f32_16x16x32_bf16 a[44:47], a[232:235], v[108:111], a[44:47]
v_exp_f32 v57, v57
v_mfma_f32_16x16x32_bf16 a[48:51], a[236:239], v[96:99], a[48:51]
ds_read_b128 a[212:215], v217 offset:24576
ds_read_b128 a[216:219], v218 offset:24576
v_mfma_f32_16x16x32_bf16 a[52:55], a[236:239], v[100:103], a[52:55]
v_exp_f32 v58, v58
v_mfma_f32_16x16x32_bf16 a[56:59], a[236:239], v[104:107], a[56:59]
ds_read_b128 a[220:223], v219 offset:24576
v_cvt_pk_bf16_f32 v124, v56, v57
v_mfma_f32_16x16x32_bf16 a[60:63], a[236:239], v[108:111], a[60:63]
v_exp_f32 v59, v59
v_mfma_f32_16x16x32_bf16 a[64:67], a[240:243], v[96:99], a[64:67]
v_mfma_f32_16x16x32_bf16 a[68:71], a[240:243], v[100:103], a[68:71]
v_exp_f32 v60, v60
v_mfma_f32_16x16x32_bf16 a[72:75], a[240:243], v[104:107], a[72:75]
v_cvt_pk_bf16_f32 v125, v58, v59
v_mfma_f32_16x16x32_bf16 a[76:79], a[240:243], v[108:111], a[76:79]
v_exp_f32 v61, v61
v_mfma_f32_16x16x32_bf16 a[80:83], a[244:247], v[96:99], a[80:83]
s_lshl1_add_u32 m0, s26, 16384
v_mfma_f32_16x16x32_bf16 a[84:87], a[244:247], v[100:103], a[84:87]
s_waitcnt vmcnt(11) lgkmcnt(0)
s_barrier
v_mfma_f32_16x16x32_bf16 a[88:91], a[244:247], v[104:107], a[88:91]
buffer_load_dwordx4 v228, s[12:15], s24 offen  lds
v_mfma_f32_16x16x32_bf16 a[92:95], a[244:247], v[108:111], a[92:95]
s_cmp_lg_u32 s61, 2
s_cbranch_scc1 La_g41
s_mov_b32 m0, s51
s_mov_b32 exec_lo, 0x0
s_mov_b32 exec_hi, 0xffffffff
buffer_load_dwordx4 v240, s[56:59], s48 offen lds
s_mov_b64 exec, -1
s_lshl1_add_u32 m0, s26, 16384
La_g41:
v_mfma_f32_16x16x32_bf16 a[96:99], a[248:251], v[96:99], a[96:99]
v_exp_f32 v62, v62
v_mfma_f32_16x16x32_bf16 a[100:103], a[248:251], v[100:103], a[100:103]
v_cvt_pk_bf16_f32 v126, v60, v61
v_mfma_f32_16x16x32_bf16 a[104:107], a[248:251], v[104:107], a[104:107]
v_exp_f32 v63, v63
v_mfma_f32_16x16x32_bf16 a[108:111], a[248:251], v[108:111], a[108:111]
v_mfma_f32_16x16x32_bf16 a[112:115], a[252:255], v[96:99], a[112:115]
v_exp_f32 v0, v0
v_mfma_f32_16x16x32_bf16 a[116:119], a[252:255], v[100:103], a[116:119]
v_cvt_pk_bf16_f32 v127, v62, v63
v_mfma_f32_16x16x32_bf16 a[120:123], a[252:255], v[104:107], a[120:123]
v_exp_f32 v1, v1
v_mfma_f32_16x16x32_bf16 a[124:127], a[252:255], v[108:111], a[124:127]
v_mfma_f32_16x16x32_bf16 v[32:35], a[192:195], v[128:131], v[64:67]
v_exp_f32 v2, v2
v_mfma_f32_16x16x32_bf16 v[32:35], a[196:199], v[132:135], v[32:35]
ds_read_b64_tr_b16 a[224:225], v220 offset:32768
v_cvt_pk_bf16_f32 v96, v0, v1
v_mfma_f32_16x16x32_bf16 v[32:35], a[200:203], v[136:139], v[32:35]
s_add_u32 s51, s51, s52
v_exp_f32 v3, v3
v_mfma_f32_16x16x32_bf16 v[32:35], a[204:207], v[140:143], v[32:35]
ds_read_b64_tr_b16 a[226:227], v220 offset:40960
ds_read_b64_tr_b16 a[228:229], v221 offset:32768
v_mfma_f32_16x16x32_bf16 v[36:39], a[208:211], v[128:131], v[64:67]
s_add_u32 s48, s48, s49
v_exp_f32 v4, v4
v_mfma_f32_16x16x32_bf16 v[36:39], a[212:215], v[132:135], v[36:39]
ds_read_b64_tr_b16 a[230:231], v221 offset:40960
v_cvt_pk_bf16_f32 v97, v2, v3
v_mfma_f32_16x16x32_bf16 v[36:39], a[216:219], v[136:139], v[36:39]
v_exp_f32 v5, v5
v_mfma_f32_16x16x32_bf16 v[36:39], a[220:223], v[140:143], v[36:39]
buffer_load_dwordx4 v229, s[12:15], s24 offen offset:1024  lds
v_mfma_f32_16x16x32_bf16 v[40:43], a[192:195], v[144:147], v[68:71]
v_exp_f32 v6, v6
v_mfma_f32_16x16x32_bf16 v[40:43], a[196:199], v[148:151], v[40:43]
ds_read_b64_tr_b16 a[232:233], v222 offset:32768
v_cvt_pk_bf16_f32 v98, v4, v5
v_mfma_f32_16x16x32_bf16 v[40:43], a[200:203], v[152:155], v[40:43]
v_exp_f32 v7, v7
v_mfma_f32_16x16x32_bf16 v[40:43], a[204:207], v[156:159], v[40:43]
ds_read_b64_tr_b16 a[234:235], v222 offset:40960
ds_read_b64_tr_b16 a[236:237], v223 offset:32768
v_mfma_f32_16x16x32_bf16 v[44:47], a[208:211], v[144:147], v[68:71]
v_exp_f32 v8, v8
v_mfma_f32_16x16x32_bf16 v[44:47], a[212:215], v[148:151], v[44:47]
ds_read_b64_tr_b16 a[238:239], v223 offset:40960
v_cvt_pk_bf16_f32 v99, v6, v7
v_mfma_f32_16x16x32_bf16 v[44:47], a[216:219], v[152:155], v[44:47]
v_exp_f32 v9, v9
v_mfma_f32_16x16x32_bf16 v[44:47], a[220:223], v[156:159], v[44:47]
ds_read_b64_tr_b16 a[240:241], v224 offset:32768
ds_read_b64_tr_b16 a[242:243], v224 offset:40960
v_mfma_f32_16x16x32_bf16 v[48:51], a[192:195], v[160:163], v[72:75]
v_exp_f32 v10, v10
v_mfma_f32_16x16x32_bf16 v[48:51], a[196:199], v[164:167], v[48:51]
ds_read_b64_tr_b16 a[244:245], v225 offset:32768
v_cvt_pk_bf16_f32 v100, v8, v9
v_mfma_f32_16x16x32_bf16 v[48:51], a[200:203], v[168:171], v[48:51]
v_exp_f32 v11, v11
v_mfma_f32_16x16x32_bf16 v[48:51], a[204:207], v[172:175], v[48:51]
ds_read_b64_tr_b16 a[246:247], v225 offset:40960
ds_read_b64_tr_b16 a[248:249], v226 offset:32768
v_mfma_f32_16x16x32_bf16 v[52:55], a[208:211], v[160:163], v[72:75]
v_exp_f32 v12, v12
v_mfma_f32_16x16x32_bf16 v[52:55], a[212:215], v[164:167], v[52:55]
ds_read_b64_tr_b16 a[250:251], v226 offset:40960
v_cvt_pk_bf16_f32 v101, v10, v11
v_mfma_f32_16x16x32_bf16 v[52:55], a[216:219], v[168:171], v[52:55]
v_exp_f32 v13, v13
v_mfma_f32_16x16x32_bf16 v[52:55], a[220:223], v[172:175], v[52:55]
buffer_load_dwordx4 v230, s[8:11], s24 offen offset:2048  lds
v_mfma_f32_16x16x32_bf16 v[56:59], a[192:195], v[176:179], v[76:79]
v_exp_f32 v14, v14
v_mfma_f32_16x16x32_bf16 v[56:59], a[196:199], v[180:183], v[56:59]
ds_read_b64_tr_b16 a[252:253], v227 offset:32768
v_cvt_pk_bf16_f32 v102, v12, v13
v_mfma_f32_16x16x32_bf16 v[56:59], a[200:203], v[184:187], v[56:59]
v_exp_f32 v15, v15
v_mfma_f32_16x16x32_bf16 v[56:59], a[204:207], v[188:191], v[56:59]
ds_read_b64_tr_b16 a[254:255], v227 offset:40960
v_mfma_f32_16x16x32_bf16 v[60:63], a[208:211], v[176:179], v[76:79]
v_exp_f32 v16, v16
v_smfmac_f32_16x16x64_bf16 v[80:83], v[232:235], v[112:119], v88
v_cvt_pk_bf16_f32 v103, v14, v15
v_mfma_f32_16x16x32_bf16 v[60:63], a[212:215], v[180:183], v[60:63]
v_exp_f32 v17, v17
v_mfma_f32_16x16x32_bf16 v[60:63], a[216:219], v[184:187], v[60:63]
s_cmp_lg_u32 s61, 2
s_cbranch_scc1 La_g50
s_mov_b32 m0, s51
s_mov_b32 exec_lo, 0xffffffff
s_mov_b32 exec_hi, 0x0
buffer_load_dwordx4 v240, s[92:95], s48 offen lds
s_mov_b64 exec, -1
s_lshl1_add_u32 m0, s26, 16384
La_g50:
v_mfma_f32_16x16x32_bf16 v[60:63], a[220:223], v[188:191], v[60:63]
v_exp_f32 v18, v18
v_smfmac_f32_16x16x64_bf16 v[84:87], v[232:235], v[120:127], v88
s_waitcnt lgkmcnt(0)
v_cvt_pk_bf16_f32 v104, v16, v17
v_mfma_f32_16x16x32_bf16 a[0:3], a[224:227], v[112:115], a[0:3]
v_exp_f32 v19, v19
v_mfma_f32_16x16x32_bf16 a[4:7], a[224:227], v[116:119], a[4:7]
v_exp_f32 v20, v20
v_mfma_f32_16x16x32_bf16 a[8:11], a[224:227], v[120:123], a[8:11]
ds_read_b128 a[192:195], v216 offset:32768
v_cvt_pk_bf16_f32 v105, v18, v19
v_mfma_f32_16x16x32_bf16 a[12:15], a[224:227], v[124:127], a[12:15]
v_exp_f32 v21, v21
v_mfma_f32_16x16x32_bf16 a[16:19], a[228:231], v[112:115], a[16:19]
ds_read_b128 a[196:199], v217 offset:32768
ds_read_b128 a[200:203], v218 offset:32768
v_mfma_f32_16x16x32_bf16 a[20:23], a[228:231], v[116:119], a[20:23]
v_exp_f32 v22, v22
v_mfma_f32_16x16x32_bf16 a[24:27], a[228:231], v[120:123], a[24:27]
ds_read_b128 a[204:207], v219 offset:32768
v_cvt_pk_bf16_f32 v106, v20, v21
v_mfma_f32_16x16x32_bf16 a[28:31], a[228:231], v[124:127], a[28:31]
v_exp_f32 v23, v23
v_mfma_f32_16x16x32_bf16 a[32:35], a[232:235], v[112:115], a[32:35]
buffer_load_dwordx4 v231, s[8:11], s24 offen offset:3072  lds
v_mfma_f32_16x16x32_bf16 a[36:39], a[232:235], v[116:119], a[36:39]
s_add_u32 s24, s24, 8192
v_exp_f32 v24, v24
v_mfma_f32_16x16x32_bf16 a[40:43], a[232:235], v[120:123], a[40:43]
ds_read_b128 a[208:211], v216 offset:40960
v_cvt_pk_bf16_f32 v107, v22, v23
v_mfma_f32_16x16x32_bf16 a[44:47], a[232:235], v[124:127], a[44:47]
v_exp_f32 v25, v25
v_mfma_f32_16x16x32_bf16 a[48:51], a[236:239], v[112:115], a[48:51]
ds_read_b128 a[212:215], v217 offset:40960
ds_read_b128 a[216:219], v218 offset:40960
v_mfma_f32_16x16x32_bf16 a[52:55], a[236:239], v[116:119], a[52:55]
v_exp_f32 v26, v26
v_mfma_f32_16x16x32_bf16 a[56:59], a[236:239], v[120:123], a[56:59]
ds_read_b128 a[220:223], v219 offset:40960
v_cvt_pk_bf16_f32 v108, v24, v25
v_mfma_f32_16x16x32_bf16 a[60:63], a[236:239], v[124:127], a[60:63]
v_exp_f32 v27, v27
v_mfma_f32_16x16x32_bf16 a[64:67], a[240:243], v[112:115], a[64:67]
v_mfma_f32_16x16x32_bf16 a[68:71], a[240:243], v[116:119], a[68:71]
v_exp_f32 v28, v28
v_mfma_f32_16x16x32_bf16 a[72:75], a[240:243], v[120:123], a[72:75]
v_cvt_pk_bf16_f32 v109, v26, v27
v_mfma_f32_16x16x32_bf16 a[76:79], a[240:243], v[124:127], a[76:79]
v_exp_f32 v29, v29
v_mfma_f32_16x16x32_bf16 a[80:83], a[244:247], v[112:115], a[80:83]
s_lshl1_add_u32 m0, s26, 32768
v_mfma_f32_16x16x32_bf16 a[84:87], a[244:247], v[116:119], a[84:87]
s_waitcnt vmcnt(9) lgkmcnt(0)
s_barrier
v_mfma_f32_16x16x32_bf16 a[88:91], a[244:247], v[120:123], a[88:91]
buffer_load_dwordx4 v228, s[12:15], s24 offen  lds
v_mfma_f32_16x16x32_bf16 a[92:95], a[244:247], v[124:127], a[92:95]
s_cmp_lg_u32 s61, 2
s_cbranch_scc1 La_g51
s_mov_b32 m0, s51
s_mov_b32 exec_lo, 0x0
s_mov_b32 exec_hi, 0xffffffff
buffer_load_dwordx4 v240, s[92:95], s48 offen lds
s_mov_b64 exec, -1
s_lshl1_add_u32 m0, s26, 32768
La_g51:
v_mfma_f32_16x16x32_bf16 a[96:99], a[248:251], v[112:115], a[96:99]
v_exp_f32 v30, v30
v_mfma_f32_16x16x32_bf16 a[100:103], a[248:251], v[116:119], a[100:103]
v_cvt_pk_bf16_f32 v110, v28, v29
v_mfma_f32_16x16x32_bf16 a[104:107], a[248:251], v[120:123], a[104:107]
v_exp_f32 v31, v31
v_mfma_f32_16x16x32_bf16 a[108:111], a[248:251], v[124:127], a[108:111]
v_mfma_f32_16x16x32_bf16 a[112:115], a[252:255], v[112:115], a[112:115]
v_exp_f32 v32, v32
v_mfma_f32_16x16x32_bf16 a[116:119], a[252:255], v[116:119], a[116:119]
v_cvt_pk_bf16_f32 v111, v30, v31
v_mfma_f32_16x16x32_bf16 a[120:123], a[252:255], v[120:123], a[120:123]
v_exp_f32 v33, v33
v_mfma_f32_16x16x32_bf16 a[124:127], a[252:255], v[124:127], a[124:127]
v_mfma_f32_16x16x32_bf16 v[0:3], a[192:195], v[128:131], v[64:67]
v_exp_f32 v34, v34
v_mfma_f32_16x16x32_bf16 v[0:3], a[196:199], v[132:135], v[0:3]
ds_read_b64_tr_b16 a[224:225], v220 offset:49152
v_cvt_pk_bf16_f32 v112, v32, v33
v_mfma_f32_16x16x32_bf16 v[0:3], a[200:203], v[136:139], v[0:3]
s_add_u32 s51, s51, s52
v_exp_f32 v35, v35
v_mfma_f32_16x16x32_bf16 v[0:3], a[204:207], v[140:143], v[0:3]
ds_read_b64_tr_b16 a[226:227], v220 offset:57344
ds_read_b64_tr_b16 a[228:229], v221 offset:49152
v_mfma_f32_16x16x32_bf16 v[4:7], a[208:211], v[128:131], v[64:67]
s_add_u32 s48, s48, s50
v_exp_f32 v36, v36
v_mfma_f32_16x16x32_bf16 v[4:7], a[212:215], v[132:135], v[4:7]
ds_read_b64_tr_b16 a[230:231], v221 offset:57344
v_cvt_pk_bf16_f32 v113, v34, v35
v_mfma_f32_16x16x32_bf16 v[4:7], a[216:219], v[136:139], v[4:7]
v_exp_f32 v37, v37
v_mfma_f32_16x16x32_bf16 v[4:7], a[220:223], v[140:143], v[4:7]
buffer_load_dwordx4 v229, s[12:15], s24 offen offset:1024  lds
v_mfma_f32_16x16x32_bf16 v[8:11], a[192:195], v[144:147], v[68:71]
v_exp_f32 v38, v38
v_mfma_f32_16x16x32_bf16 v[8:11], a[196:199], v[148:151], v[8:11]
ds_read_b64_tr_b16 a[232:233], v222 offset:49152
v_cvt_pk_bf16_f32 v114, v36, v37
v_mfma_f32_16x16x32_bf16 v[8:11], a[200:203], v[152:155], v[8:11]
v_exp_f32 v39, v39
v_mfma_f32_16x16x32_bf16 v[8:11], a[204:207], v[156:159], v[8:11]
ds_read_b64_tr_b16 a[234:235], v222 offset:57344
ds_read_b64_tr_b16 a[236:237], v223 offset:49152
v_mfma_f32_16x16x32_bf16 v[12:15], a[208:211], v[144:147], v[68:71]
v_exp_f32 v40, v40
v_mfma_f32_16x16x32_bf16 v[12:15], a[212:215], v[148:151], v[12:15]
ds_read_b64_tr_b16 a[238:239], v223 offset:57344
v_cvt_pk_bf16_f32 v115, v38, v39
v_mfma_f32_16x16x32_bf16 v[12:15], a[216:219], v[152:155], v[12:15]
v_exp_f32 v41, v41
v_mfma_f32_16x16x32_bf16 v[12:15], a[220:223], v[156:159], v[12:15]
ds_read_b64_tr_b16 a[240:241], v224 offset:49152
ds_read_b64_tr_b16 a[242:243], v224 offset:57344
v_mfma_f32_16x16x32_bf16 v[16:19], a[192:195], v[160:163], v[72:75]
v_exp_f32 v42, v42
v_mfma_f32_16x16x32_bf16 v[16:19], a[196:199], v[164:167], v[16:19]
ds_read_b64_tr_b16 a[244:245], v225 offset:49152
v_cvt_pk_bf16_f32 v116, v40, v41
v_mfma_f32_16x16x32_bf16 v[16:19], a[200:203], v[168:171], v[16:19]
v_exp_f32 v43, v43
v_mfma_f32_16x16x32_bf16 v[16:19], a[204:207], v[172:175], v[16:19]
ds_read_b64_tr_b16 a[246:247], v225 offset:57344
ds_read_b64_tr_b16 a[248:249], v226 offset:49152
v_mfma_f32_16x16x32_bf16 v[20:23], a[208:211], v[160:163], v[72:75]
v_exp_f32 v44, v44
v_mfma_f32_16x16x32_bf16 v[20:23], a[212:215], v[164:167], v[20:23]
ds_read_b64_tr_b16 a[250:251], v226 offset:57344
v_cvt_pk_bf16_f32 v117, v42, v43
v_mfma_f32_16x16x32_bf16 v[20:23], a[216:219], v[168:171], v[20:23]
v_exp_f32 v45, v45
v_mfma_f32_16x16x32_bf16 v[20:23], a[220:223], v[172:175], v[20:23]
buffer_load_dwordx4 v230, s[8:11], s24 offen offset:2048  lds
v_mfma_f32_16x16x32_bf16 v[24:27], a[192:195], v[176:179], v[76:79]
v_exp_f32 v46, v46
v_mfma_f32_16x16x32_bf16 v[24:27], a[196:199], v[180:183], v[24:27]
ds_read_b64_tr_b16 a[252:253], v227 offset:49152
v_cvt_pk_bf16_f32 v118, v44, v45
v_mfma_f32_16x16x32_bf16 v[24:27], a[200:203], v[184:187], v[24:27]
v_exp_f32 v47, v47
v_mfma_f32_16x16x32_bf16 v[24:27], a[204:207], v[188:191], v[24:27]
ds_read_b64_tr_b16 a[254:255], v227 offset:57344
v_mfma_f32_16x16x32_bf16 v[28:31], a[208:211], v[176:179], v[76:79]
v_exp_f32 v48, v48
v_smfmac_f32_16x16x64_bf16 v[80:83], v[232:235], v[96:103], v88
v_cvt_pk_bf16_f32 v119, v46, v47
v_mfma_f32_16x16x32_bf16 v[28:31], a[212:215], v[180:183], v[28:31]
v_exp_f32 v49, v49
v_mfma_f32_16x16x32_bf16 v[28:31], a[216:219], v[184:187], v[28:31]
s_mov_b32 exec_lo, 0xffffffff
s_mov_b32 exec_hi, 0x0
buffer_load_dwordx4 v[192:195], v243, s[96:99], s55 offen offset:2048
s_mov_b64 exec, -1
v_mfma_f32_16x16x32_bf16 v[28:31], a[220:223], v[188:191], v[28:31]
v_exp_f32 v50, v50
v_smfmac_f32_16x16x64_bf16 v[84:87], v[232:235], v[104:111], v88
s_waitcnt lgkmcnt(0)
v_cvt_pk_bf16_f32 v120, v48, v49
v_mfma_f32_16x16x32_bf16 a[0:3], a[224:227], v[96:99], a[0:3]
v_exp_f32 v51, v51
v_mfma_f32_16x16x32_bf16 a[4:7], a[224:227], v[100:103], a[4:7]
v_exp_f32 v52, v52
v_mfma_f32_16x16x32_bf16 a[8:11], a[224:227], v[104:107], a[8:11]
ds_read_b128 a[192:195], v216 offset:49152
v_cvt_pk_bf16_f32 v121, v50, v51
v_mfma_f32_16x16x32_bf16 a[12:15], a[224:227], v[108:111], a[12:15]
v_exp_f32 v53, v53
v_mfma_f32_16x16x32_bf16 a[16:19], a[228:231], v[96:99], a[16:19]
ds_read_b128 a[196:199], v217 offset:49152
ds_read_b128 a[200:203], v218 offset:49152
v_mfma_f32_16x16x32_bf16 a[20:23], a[228:231], v[100:103], a[20:23]
v_exp_f32 v54, v54
v_mfma_f32_16x16x32_bf16 a[24:27], a[228:231], v[104:107], a[24:27]
ds_read_b128 a[204:207], v219 offset:49152
v_cvt_pk_bf16_f32 v122, v52, v53
v_mfma_f32_16x16x32_bf16 a[28:31], a[228:231], v[108:111], a[28:31]
v_exp_f32 v55, v55
v_mfma_f32_16x16x32_bf16 a[32:35], a[232:235], v[96:99], a[32:35]
buffer_load_dwordx4 v231, s[8:11], s24 offen offset:3072  lds
v_mfma_f32_16x16x32_bf16 a[36:39], a[232:235], v[100:103], a[36:39]
s_add_u32 s24, s24, 8192
v_exp_f32 v56, v56
v_mfma_f32_16x16x32_bf16 a[40:43], a[232:235], v[104:107], a[40:43]
ds_read_b128 a[208:211], v216 offset:57344
v_cvt_pk_bf16_f32 v123, v54, v55
v_mfma_f32_16x16x32_bf16 a[44:47], a[232:235], v[108:111], a[44:47]
v_exp_f32 v57, v57
v_mfma_f32_16x16x32_bf16 a[48:51], a[236:239], v[96:99], a[48:51]
ds_read_b128 a[212:215], v217 offset:57344
ds_read_b128 a[216:219], v218 offset:57344
v_mfma_f32_16x16x32_bf16 a[52:55], a[236:239], v[100:103], a[52:55]
v_exp_f32 v58, v58
v_mfma_f32_16x16x32_bf16 a[56:59], a[236:239], v[104:107], a[56:59]
ds_read_b128 a[220:223], v219 offset:57344
v_cvt_pk_bf16_f32 v124, v56, v57
v_mfma_f32_16x16x32_bf16 a[60:63], a[236:239], v[108:111], a[60:63]
v_exp_f32 v59, v59
v_mfma_f32_16x16x32_bf16 a[64:67], a[240:243], v[96:99], a[64:67]
v_mfma_f32_16x16x32_bf16 a[68:71], a[240:243], v[100:103], a[68:71]
v_exp_f32 v60, v60
v_mfma_f32_16x16x32_bf16 a[72:75], a[240:243], v[104:107], a[72:75]
v_cvt_pk_bf16_f32 v125, v58, v59
v_mfma_f32_16x16x32_bf16 a[76:79], a[240:243], v[108:111], a[76:79]
v_exp_f32 v61, v61
v_mfma_f32_16x16x32_bf16 a[80:83], a[244:247], v[96:99], a[80:83]
s_lshl1_add_u32 m0, s26, 49152
v_mfma_f32_16x16x32_bf16 a[84:87], a[244:247], v[100:103], a[84:87]
s_waitcnt vmcnt(9) lgkmcnt(0)
s_barrier
v_mfma_f32_16x16x32_bf16 a[88:91], a[244:247], v[104:107], a[88:91]
buffer_load_dwordx4 v228, s[12:15], s24 offen  lds
v_mfma_f32_16x16x32_bf16 a[92:95], a[244:247], v[108:111], a[92:95]
s_mov_b32 exec_lo, 0x0
s_mov_b32 exec_hi, 0xffffffff
buffer_load_dwordx4 v[192:195], v243, s[96:99], s55 offen offset:2048
s_mov_b64 exec, -1
v_mfma_f32_16x16x32_bf16 a[96:99], a[248:251], v[96:99], a[96:99]
s_add_u32 s37, s55, 1572864
v_exp_f32 v62, v62
v_mfma_f32_16x16x32_bf16 a[100:103], a[248:251], v[100:103], a[100:103]
v_cvt_pk_bf16_f32 v126, v60, v61
v_mfma_f32_16x16x32_bf16 a[104:107], a[248:251], v[104:107], a[104:107]
v_exp_f32 v63, v63
v_mfma_f32_16x16x32_bf16 a[108:111], a[248:251], v[108:111], a[108:111]
v_mfma_f32_16x16x32_bf16 a[112:115], a[252:255], v[96:99], a[112:115]
v_exp_f32 v0, v0
v_mfma_f32_16x16x32_bf16 a[116:119], a[252:255], v[100:103], a[116:119]
v_cvt_pk_bf16_f32 v127, v62, v63
v_mfma_f32_16x16x32_bf16 a[120:123], a[252:255], v[104:107], a[120:123]
v_exp_f32 v1, v1
v_mfma_f32_16x16x32_bf16 a[124:127], a[252:255], v[108:111], a[124:127]
v_mfma_f32_16x16x32_bf16 v[32:35], a[192:195], v[128:131], v[64:67]
v_exp_f32 v2, v2
v_mfma_f32_16x16x32_bf16 v[32:35], a[196:199], v[132:135], v[32:35]
ds_read_b64_tr_b16 a[224:225], v220 offset:0
v_cvt_pk_bf16_f32 v96, v0, v1
v_mfma_f32_16x16x32_bf16 v[32:35], a[200:203], v[136:139], v[32:35]
v_exp_f32 v3, v3
v_mfma_f32_16x16x32_bf16 v[32:35], a[204:207], v[140:143], v[32:35]
ds_read_b64_tr_b16 a[226:227], v220 offset:8192
ds_read_b64_tr_b16 a[228:229], v221 offset:0
v_mfma_f32_16x16x32_bf16 v[36:39], a[208:211], v[128:131], v[64:67]
v_exp_f32 v4, v4
v_mfma_f32_16x16x32_bf16 v[36:39], a[212:215], v[132:135], v[36:39]
ds_read_b64_tr_b16 a[230:231], v221 offset:8192
v_cvt_pk_bf16_f32 v97, v2, v3
v_mfma_f32_16x16x32_bf16 v[36:39], a[216:219], v[136:139], v[36:39]
v_exp_f32 v5, v5
v_mfma_f32_16x16x32_bf16 v[36:39], a[220:223], v[140:143], v[36:39]
buffer_load_dwordx4 v229, s[12:15], s24 offen offset:1024  lds
v_mfma_f32_16x16x32_bf16 v[40:43], a[192:195], v[144:147], v[68:71]
v_exp_f32 v6, v6
v_mfma_f32_16x16x32_bf16 v[40:43], a[196:199], v[148:151], v[40:43]
ds_read_b64_tr_b16 a[232:233], v222 offset:0
v_cvt_pk_bf16_f32 v98, v4, v5
v_mfma_f32_16x16x32_bf16 v[40:43], a[200:203], v[152:155], v[40:43]
v_exp_f32 v7, v7
v_mfma_f32_16x16x32_bf16 v[40:43], a[204:207], v[156:159], v[40:43]
ds_read_b64_tr_b16 a[234:235], v222 offset:8192
ds_read_b64_tr_b16 a[236:237], v223 offset:0
v_mfma_f32_16x16x32_bf16 v[44:47], a[208:211], v[144:147], v[68:71]
v_exp_f32 v8, v8
v_mfma_f32_16x16x32_bf16 v[44:47], a[212:215], v[148:151], v[44:47]
ds_read_b64_tr_b16 a[238:239], v223 offset:8192
v_cvt_pk_bf16_f32 v99, v6, v7
v_mfma_f32_16x16x32_bf16 v[44:47], a[216:219], v[152:155], v[44:47]
v_exp_f32 v9, v9
v_mfma_f32_16x16x32_bf16 v[44:47], a[220:223], v[156:159], v[44:47]
ds_read_b64_tr_b16 a[240:241], v224 offset:0
ds_read_b64_tr_b16 a[242:243], v224 offset:8192
v_mfma_f32_16x16x32_bf16 v[48:51], a[192:195], v[160:163], v[72:75]
v_exp_f32 v10, v10
v_mfma_f32_16x16x32_bf16 v[48:51], a[196:199], v[164:167], v[48:51]
ds_read_b64_tr_b16 a[244:245], v225 offset:0
v_cvt_pk_bf16_f32 v100, v8, v9
v_mfma_f32_16x16x32_bf16 v[48:51], a[200:203], v[168:171], v[48:51]
v_exp_f32 v11, v11
v_mfma_f32_16x16x32_bf16 v[48:51], a[204:207], v[172:175], v[48:51]
ds_read_b64_tr_b16 a[246:247], v225 offset:8192
ds_read_b64_tr_b16 a[248:249], v226 offset:0
v_mfma_f32_16x16x32_bf16 v[52:55], a[208:211], v[160:163], v[72:75]
v_exp_f32 v12, v12
v_mfma_f32_16x16x32_bf16 v[52:55], a[212:215], v[164:167], v[52:55]
ds_read_b64_tr_b16 a[250:251], v226 offset:8192
v_cvt_pk_bf16_f32 v101, v10, v11
v_mfma_f32_16x16x32_bf16 v[52:55], a[216:219], v[168:171], v[52:55]
v_exp_f32 v13, v13
v_mfma_f32_16x16x32_bf16 v[52:55], a[220:223], v[172:175], v[52:55]
buffer_load_dwordx4 v230, s[8:11], s24 offen offset:2048  lds
v_mfma_f32_16x16x32_bf16 v[56:59], a[192:195], v[176:179], v[76:79]
v_exp_f32 v14, v14
v_mfma_f32_16x16x32_bf16 v[56:59], a[196:199], v[180:183], v[56:59]
ds_read_b64_tr_b16 a[252:253], v227 offset:0
v_cvt_pk_bf16_f32 v102, v12, v13
v_mfma_f32_16x16x32_bf16 v[56:59], a[200:203], v[184:187], v[56:59]
v_exp_f32 v15, v15
v_mfma_f32_16x16x32_bf16 v[56:59], a[204:207], v[188:191], v[56:59]
ds_read_b64_tr_b16 a[254:255], v227 offset:8192
v_mfma_f32_16x16x32_bf16 v[60:63], a[208:211], v[176:179], v[76:79]
v_exp_f32 v16, v16
v_smfmac_f32_16x16x64_bf16 v[80:83], v[232:235], v[112:119], v88
v_cvt_pk_bf16_f32 v103, v14, v15
v_mfma_f32_16x16x32_bf16 v[60:63], a[212:215], v[180:183], v[60:63]
Lpad9:
s_cbranch_execz Lpad13
v_exp_f32 v17, v17
v_mfma_f32_16x16x32_bf16 v[60:63], a[216:219], v[184:187], v[60:63]
s_mov_b32 exec_lo, 0xffffffff
s_mov_b32 exec_hi, 0x0
buffer_load_dwordx4 v[196:199], v243, s[96:99], s37 offen offset:2048
s_mov_b64 exec, -1
v_mfma_f32_16x16x32_bf16 v[60:63], a[220:223], v[188:191], v[60:63]
v_exp_f32 v18, v18
v_smfmac_f32_16x16x64_bf16 v[84:87], v[232:235], v[120:127], v88
s_waitcnt lgkmcnt(0)
v_cvt_pk_bf16_f32 v104, v16, v17
v_mfma_f32_16x16x32_bf16 a[0:3], a[224:227], v[112:115], a[0:3]
v_exp_f32 v19, v19
v_mfma_f32_16x16x32_bf16 a[4:7], a[224:227], v[116:119], a[4:7]
v_exp_f32 v20, v20
v_mfma_f32_16x16x32_bf16 a[8:11], a[224:227], v[120:123], a[8:11]
ds_read_b128 a[192:195], v216 offset:0
v_cvt_pk_bf16_f32 v105, v18, v19
v_mfma_f32_16x16x32_bf16 a[12:15], a[224:227], v[124:127], a[12:15]
v_exp_f32 v21, v21
v_mfma_f32_16x16x32_bf16 a[16:19], a[228:231], v[112:115], a[16:19]
ds_read_b128 a[196:199], v217 offset:0
ds_read_b128 a[200:203], v218 offset:0
v_mfma_f32_16x16x32_bf16 a[20:23], a[228:231], v[116:119], a[20:23]
v_exp_f32 v22, v22
v_mfma_f32_16x16x32_bf16 a[24:27], a[228:231], v[120:123], a[24:27]
ds_read_b128 a[204:207], v219 offset:0
v_cvt_pk_bf16_f32 v106, v20, v21
v_mfma_f32_16x16x32_bf16 a[28:31], a[228:231], v[124:127], a[28:31]
v_exp_f32 v23, v23
v_mfma_f32_16x16x32_bf16 a[32:35], a[232:235], v[112:115], a[32:35]
buffer_load_dwordx4 v231, s[8:11], s24 offen offset:3072  lds
v_mfma_f32_16x16x32_bf16 a[36:39], a[232:235], v[116:119], a[36:39]
s_add_u32 s24, s24, 8192
v_exp_f32 v24, v24
v_mfma_f32_16x16x32_bf16 a[40:43], a[232:235], v[120:123], a[40:43]
ds_read_b128 a[208:211], v216 offset:8192
v_cvt_pk_bf16_f32 v107, v22, v23
v_mfma_f32_16x16x32_bf16 a[44:47], a[232:235], v[124:127], a[44:47]
v_exp_f32 v25, v25
v_mfma_f32_16x16x32_bf16 a[48:51], a[236:239], v[112:115], a[48:51]
ds_read_b128 a[212:215], v217 offset:8192
ds_read_b128 a[216:219], v218 offset:8192
v_mfma_f32_16x16x32_bf16 a[52:55], a[236:239], v[116:119], a[52:55]
v_exp_f32 v26, v26
v_mfma_f32_16x16x32_bf16 a[56:59], a[236:239], v[120:123], a[56:59]
ds_read_b128 a[220:223], v219 offset:8192
v_cvt_pk_bf16_f32 v108, v24, v25
v_mfma_f32_16x16x32_bf16 a[60:63], a[236:239], v[124:127], a[60:63]
v_exp_f32 v27, v27
v_mfma_f32_16x16x32_bf16 a[64:67], a[240:243], v[112:115], a[64:67]
v_mfma_f32_16x16x32_bf16 a[68:71], a[240:243], v[116:119], a[68:71]
v_exp_f32 v28, v28
v_mfma_f32_16x16x32_bf16 a[72:75], a[240:243], v[120:123], a[72:75]
v_cvt_pk_bf16_f32 v109, v26, v27
v_mfma_f32_16x16x32_bf16 a[76:79], a[240:243], v[124:127], a[76:79]
v_exp_f32 v29, v29
v_mfma_f32_16x16x32_bf16 a[80:83], a[244:247], v[112:115], a[80:83]
s_lshl1_add_u32 m0, s26, 0
v_mfma_f32_16x16x32_bf16 a[84:87], a[244:247], v[116:119], a[84:87]
s_waitcnt vmcnt(11) lgkmcnt(0)
s_barrier
v_mfma_f32_16x16x32_bf16 a[88:91], a[244:247], v[120:123], a[88:91]
buffer_load_dwordx4 v228, s[12:15], s24 offen  lds
v_mfma_f32_16x16x32_bf16 a[92:95], a[244:247], v[124:127], a[92:95]
s_mov_b32 exec_lo, 0x0
s_mov_b32 exec_hi, 0xffffffff
buffer_load_dwordx4 v[196:199], v243, s[96:99], s37 offen offset:2048
s_mov_b64 exec, -1
v_mfma_f32_16x16x32_bf16 a[96:99], a[248:251], v[112:115], a[96:99]
v_exp_f32 v30, v30
v_mfma_f32_16x16x32_bf16 a[100:103], a[248:251], v[116:119], a[100:103]
v_cvt_pk_bf16_f32 v110, v28, v29
v_mfma_f32_16x16x32_bf16 a[104:107], a[248:251], v[120:123], a[104:107]
v_exp_f32 v31, v31
v_mfma_f32_16x16x32_bf16 a[108:111], a[248:251], v[124:127], a[108:111]
v_mfma_f32_16x16x32_bf16 a[112:115], a[252:255], v[112:115], a[112:115]
v_exp_f32 v32, v32
v_mfma_f32_16x16x32_bf16 a[116:119], a[252:255], v[116:119], a[116:119]
v_cvt_pk_bf16_f32 v111, v30, v31
v_mfma_f32_16x16x32_bf16 a[120:123], a[252:255], v[120:123], a[120:123]
v_exp_f32 v33, v33
v_mfma_f32_16x16x32_bf16 a[124:127], a[252:255], v[124:127], a[124:127]
v_mfma_f32_16x16x32_bf16 v[0:3], a[192:195], v[128:131], v[64:67]
v_exp_f32 v34, v34
v_mfma_f32_16x16x32_bf16 v[0:3], a[196:199], v[132:135], v[0:3]
ds_read_b64_tr_b16 a[224:225], v220 offset:16384
v_cvt_pk_bf16_f32 v112, v32, v33
v_mfma_f32_16x16x32_bf16 v[0:3], a[200:203], v[136:139], v[0:3]
v_exp_f32 v35, v35
v_mfma_f32_16x16x32_bf16 v[0:3], a[204:207], v[140:143], v[0:3]
ds_read_b64_tr_b16 a[226:227], v220 offset:24576
ds_read_b64_tr_b16 a[228:229], v221 offset:16384
v_mfma_f32_16x16x32_bf16 v[4:7], a[208:211], v[128:131], v[64:67]
v_exp_f32 v36, v36
v_mfma_f32_16x16x32_bf16 v[4:7], a[212:215], v[132:135], v[4:7]
ds_read_b64_tr_b16 a[230:231], v221 offset:24576
v_cvt_pk_bf16_f32 v113, v34, v35
v_mfma_f32_16x16x32_bf16 v[4:7], a[216:219], v[136:139], v[4:7]
v_exp_f32 v37, v37
v_mfma_f32_16x16x32_bf16 v[4:7], a[220:223], v[140:143], v[4:7]
buffer_load_dwordx4 v229, s[12:15], s24 offen offset:1024  lds
v_mfma_f32_16x16x32_bf16 v[8:11], a[192:195], v[144:147], v[68:71]
v_exp_f32 v38, v38
v_mfma_f32_16x16x32_bf16 v[8:11], a[196:199], v[148:151], v[8:11]
ds_read_b64_tr_b16 a[232:233], v222 offset:16384
v_cvt_pk_bf16_f32 v114, v36, v37
v_mfma_f32_16x16x32_bf16 v[8:11], a[200:203], v[152:155], v[8:11]
v_exp_f32 v39, v39
v_mfma_f32_16x16x32_bf16 v[8:11], a[204:207], v[156:159], v[8:11]
ds_read_b64_tr_b16 a[234:235], v222 offset:24576
ds_read_b64_tr_b16 a[236:237], v223 offset:16384
v_mfma_f32_16x16x32_bf16 v[12:15], a[208:211], v[144:147], v[68:71]
v_exp_f32 v40, v40
v_mfma_f32_16x16x32_bf16 v[12:15], a[212:215], v[148:151], v[12:15]
ds_read_b64_tr_b16 a[238:239], v223 offset:24576
v_cvt_pk_bf16_f32 v115, v38, v39
v_mfma_f32_16x16x32_bf16 v[12:15], a[216:219], v[152:155], v[12:15]
v_exp_f32 v41, v41
v_mfma_f32_16x16x32_bf16 v[12:15], a[220:223], v[156:159], v[12:15]
ds_read_b64_tr_b16 a[240:241], v224 offset:16384
ds_read_b64_tr_b16 a[242:243], v224 offset:24576
v_mfma_f32_16x16x32_bf16 v[16:19], a[192:195], v[160:163], v[72:75]
v_exp_f32 v42, v42
v_mfma_f32_16x16x32_bf16 v[16:19], a[196:199], v[164:167], v[16:19]
ds_read_b64_tr_b16 a[244:245], v225 offset:16384
v_cvt_pk_bf16_f32 v116, v40, v41
v_mfma_f32_16x16x32_bf16 v[16:19], a[200:203], v[168:171], v[16:19]
v_exp_f32 v43, v43
v_mfma_f32_16x16x32_bf16 v[16:19], a[204:207], v[172:175], v[16:19]
ds_read_b64_tr_b16 a[246:247], v225 offset:24576
ds_read_b64_tr_b16 a[248:249], v226 offset:16384
v_mfma_f32_16x16x32_bf16 v[20:23], a[208:211], v[160:163], v[72:75]
v_exp_f32 v44, v44
v_mfma_f32_16x16x32_bf16 v[20:23], a[212:215], v[164:167], v[20:23]
ds_read_b64_tr_b16 a[250:251], v226 offset:24576
v_cvt_pk_bf16_f32 v117, v42, v43
v_mfma_f32_16x16x32_bf16 v[20:23], a[216:219], v[168:171], v[20:23]
v_exp_f32 v45, v45
v_mfma_f32_16x16x32_bf16 v[20:23], a[220:223], v[172:175], v[20:23]
buffer_load_dwordx4 v230, s[8:11], s24 offen offset:2048  lds
v_mfma_f32_16x16x32_bf16 v[24:27], a[192:195], v[176:179], v[76:79]
v_exp_f32 v46, v46
v_mfma_f32_16x16x32_bf16 v[24:27], a[196:199], v[180:183], v[24:27]
ds_read_b64_tr_b16 a[252:253], v227 offset:16384
v_cvt_pk_bf16_f32 v118, v44, v45
v_mfma_f32_16x16x32_bf16 v[24:27], a[200:203], v[184:187], v[24:27]
v_exp_f32 v47, v47
v_mfma_f32_16x16x32_bf16 v[24:27], a[204:207], v[188:191], v[24:27]
ds_read_b64_tr_b16 a[254:255], v227 offset:24576
v_mfma_f32_16x16x32_bf16 v[28:31], a[208:211], v[176:179], v[76:79]
v_exp_f32 v48, v48
v_smfmac_f32_16x16x64_bf16 v[80:83], v[232:235], v[96:103], v88
v_cvt_pk_bf16_f32 v119, v46, v47
v_mfma_f32_16x16x32_bf16 v[28:31], a[212:215], v[180:183], v[28:31]
v_exp_f32 v49, v49
v_mfma_f32_16x16x32_bf16 v[28:31], a[216:219], v[184:187], v[28:31]
v_mfma_f32_16x16x32_bf16 v[28:31], a[220:223], v[188:191], v[28:31]
v_exp_f32 v50, v50
v_smfmac_f32_16x16x64_bf16 v[84:87], v[232:235], v[104:111], v88
s_waitcnt lgkmcnt(0)
v_cvt_pk_bf16_f32 v120, v48, v49
v_mfma_f32_16x16x32_bf16 a[0:3], a[224:227], v[96:99], a[0:3]
v_exp_f32 v51, v51
v_mfma_f32_16x16x32_bf16 a[4:7], a[224:227], v[100:103], a[4:7]
v_exp_f32 v52, v52
v_mfma_f32_16x16x32_bf16 a[8:11], a[224:227], v[104:107], a[8:11]
ds_read_b128 a[192:195], v216 offset:16384
v_cvt_pk_bf16_f32 v121, v50, v51
v_mfma_f32_16x16x32_bf16 a[12:15], a[224:227], v[108:111], a[12:15]
v_exp_f32 v53, v53
v_mfma_f32_16x16x32_bf16 a[16:19], a[228:231], v[96:99], a[16:19]
ds_read_b128 a[196:199], v217 offset:16384
ds_read_b128 a[200:203], v218 offset:16384
v_mfma_f32_16x16x32_bf16 a[20:23], a[228:231], v[100:103], a[20:23]
v_exp_f32 v54, v54
v_mfma_f32_16x16x32_bf16 a[24:27], a[228:231], v[104:107], a[24:27]
ds_read_b128 a[204:207], v219 offset:16384
v_cvt_pk_bf16_f32 v122, v52, v53
v_mfma_f32_16x16x32_bf16 a[28:31], a[228:231], v[108:111], a[28:31]
v_exp_f32 v55, v55
v_mfma_f32_16x16x32_bf16 a[32:35], a[232:235], v[96:99], a[32:35]
buffer_load_dwordx4 v231, s[8:11], s24 offen offset:3072  lds
v_mfma_f32_16x16x32_bf16 a[36:39], a[232:235], v[100:103], a[36:39]
s_add_u32 s24, s24, 8192
v_exp_f32 v56, v56
v_mfma_f32_16x16x32_bf16 a[40:43], a[232:235], v[104:107], a[40:43]
ds_read_b128 a[208:211], v216 offset:24576
v_cvt_pk_bf16_f32 v123, v54, v55
v_mfma_f32_16x16x32_bf16 a[44:47], a[232:235], v[108:111], a[44:47]
v_exp_f32 v57, v57
v_mfma_f32_16x16x32_bf16 a[48:51], a[236:239], v[96:99], a[48:51]
ds_read_b128 a[212:215], v217 offset:24576
ds_read_b128 a[216:219], v218 offset:24576
v_mfma_f32_16x16x32_bf16 a[52:55], a[236:239], v[100:103], a[52:55]
v_exp_f32 v58, v58
v_mfma_f32_16x16x32_bf16 a[56:59], a[236:239], v[104:107], a[56:59]
ds_read_b128 a[220:223], v219 offset:24576
v_cvt_pk_bf16_f32 v124, v56, v57
v_mfma_f32_16x16x32_bf16 a[60:63], a[236:239], v[108:111], a[60:63]
v_exp_f32 v59, v59
v_mfma_f32_16x16x32_bf16 a[64:67], a[240:243], v[96:99], a[64:67]
v_mfma_f32_16x16x32_bf16 a[68:71], a[240:243], v[100:103], a[68:71]
v_exp_f32 v60, v60
v_mfma_f32_16x16x32_bf16 a[72:75], a[240:243], v[104:107], a[72:75]
v_cvt_pk_bf16_f32 v125, v58, v59
v_mfma_f32_16x16x32_bf16 a[76:79], a[240:243], v[108:111], a[76:79]
v_exp_f32 v61, v61
v_mfma_f32_16x16x32_bf16 a[80:83], a[244:247], v[96:99], a[80:83]
s_lshl1_add_u32 m0, s26, 16384
v_mfma_f32_16x16x32_bf16 a[84:87], a[244:247], v[100:103], a[84:87]
s_waitcnt vmcnt(11) lgkmcnt(0)
s_barrier
v_mfma_f32_16x16x32_bf16 a[88:91], a[244:247], v[104:107], a[88:91]
buffer_load_dwordx4 v228, s[12:15], s24 offen  lds
v_mfma_f32_16x16x32_bf16 a[92:95], a[244:247], v[108:111], a[92:95]
v_mfma_f32_16x16x32_bf16 a[96:99], a[248:251], v[96:99], a[96:99]
v_exp_f32 v62, v62
v_mfma_f32_16x16x32_bf16 a[100:103], a[248:251], v[100:103], a[100:103]
v_cvt_pk_bf16_f32 v126, v60, v61
v_mfma_f32_16x16x32_bf16 a[104:107], a[248:251], v[104:107], a[104:107]
v_exp_f32 v63, v63
v_mfma_f32_16x16x32_bf16 a[108:111], a[248:251], v[108:111], a[108:111]
v_mfma_f32_16x16x32_bf16 a[112:115], a[252:255], v[96:99], a[112:115]
v_exp_f32 v0, v0
v_mfma_f32_16x16x32_bf16 a[116:119], a[252:255], v[100:103], a[116:119]
v_cvt_pk_bf16_f32 v127, v62, v63
v_mfma_f32_16x16x32_bf16 a[120:123], a[252:255], v[104:107], a[120:123]
v_exp_f32 v1, v1
v_mfma_f32_16x16x32_bf16 a[124:127], a[252:255], v[108:111], a[124:127]
v_mfma_f32_16x16x32_bf16 v[32:35], a[192:195], v[128:131], v[64:67]
v_exp_f32 v2, v2
v_mfma_f32_16x16x32_bf16 v[32:35], a[196:199], v[132:135], v[32:35]
ds_read_b64_tr_b16 a[224:225], v220 offset:32768
v_cvt_pk_bf16_f32 v96, v0, v1
v_mfma_f32_16x16x32_bf16 v[32:35], a[200:203], v[136:139], v[32:35]
v_exp_f32 v3, v3
v_mfma_f32_16x16x32_bf16 v[32:35], a[204:207], v[140:143], v[32:35]
ds_read_b64_tr_b16 a[226:227], v220 offset:40960
ds_read_b64_tr_b16 a[228:229], v221 offset:32768
v_mfma_f32_16x16x32_bf16 v[36:39], a[208:211], v[128:131], v[64:67]
v_exp_f32 v4, v4
v_mfma_f32_16x16x32_bf16 v[36:39], a[212:215], v[132:135], v[36:39]
ds_read_b64_tr_b16 a[230:231], v221 offset:40960
v_cvt_pk_bf16_f32 v97, v2, v3
v_mfma_f32_16x16x32_bf16 v[36:39], a[216:219], v[136:139], v[36:39]
v_exp_f32 v5, v5
v_mfma_f32_16x16x32_bf16 v[36:39], a[220:223], v[140:143], v[36:39]
buffer_load_dwordx4 v229, s[12:15], s24 offen offset:1024  lds
v_mfma_f32_16x16x32_bf16 v[40:43], a[192:195], v[144:147], v[68:71]
v_exp_f32 v6, v6
v_mfma_f32_16x16x32_bf16 v[40:43], a[196:199], v[148:151], v[40:43]
ds_read_b64_tr_b16 a[232:233], v222 offset:32768
v_cvt_pk_bf16_f32 v98, v4, v5
v_mfma_f32_16x16x32_bf16 v[40:43], a[200:203], v[152:155], v[40:43]
v_exp_f32 v7, v7
v_mfma_f32_16x16x32_bf16 v[40:43], a[204:207], v[156:159], v[40:43]
ds_read_b64_tr_b16 a[234:235], v222 offset:40960
ds_read_b64_tr_b16 a[236:237], v223 offset:32768
v_mfma_f32_16x16x32_bf16 v[44:47], a[208:211], v[144:147], v[68:71]
v_exp_f32 v8, v8
v_mfma_f32_16x16x32_bf16 v[44:47], a[212:215], v[148:151], v[44:47]
ds_read_b64_tr_b16 a[238:239], v223 offset:40960
v_cvt_pk_bf16_f32 v99, v6, v7
v_mfma_f32_16x16x32_bf16 v[44:47], a[216:219], v[152:155], v[44:47]
v_exp_f32 v9, v9
v_mfma_f32_16x16x32_bf16 v[44:47], a[220:223], v[156:159], v[44:47]
ds_read_b64_tr_b16 a[240:241], v224 offset:32768
ds_read_b64_tr_b16 a[242:243], v224 offset:40960
v_mfma_f32_16x16x32_bf16 v[48:51], a[192:195], v[160:163], v[72:75]
v_exp_f32 v10, v10
v_mfma_f32_16x16x32_bf16 v[48:51], a[196:199], v[164:167], v[48:51]
ds_read_b64_tr_b16 a[244:245], v225 offset:32768
v_cvt_pk_bf16_f32 v100, v8, v9
v_mfma_f32_16x16x32_bf16 v[48:51], a[200:203], v[168:171], v[48:51]
v_exp_f32 v11, v11
v_mfma_f32_16x16x32_bf16 v[48:51], a[204:207], v[172:175], v[48:51]
ds_read_b64_tr_b16 a[246:247], v225 offset:40960
ds_read_b64_tr_b16 a[248:249], v226 offset:32768
v_mfma_f32_16x16x32_bf16 v[52:55], a[208:211], v[160:163], v[72:75]
v_exp_f32 v12, v12
v_mfma_f32_16x16x32_bf16 v[52:55], a[212:215], v[164:167], v[52:55]
ds_read_b64_tr_b16 a[250:251], v226 offset:40960
v_cvt_pk_bf16_f32 v101, v10, v11
v_mfma_f32_16x16x32_bf16 v[52:55], a[216:219], v[168:171], v[52:55]
v_exp_f32 v13, v13
v_mfma_f32_16x16x32_bf16 v[52:55], a[220:223], v[172:175], v[52:55]
buffer_load_dwordx4 v230, s[8:11], s24 offen offset:2048  lds
v_mfma_f32_16x16x32_bf16 v[56:59], a[192:195], v[176:179], v[76:79]
v_exp_f32 v14, v14
v_mfma_f32_16x16x32_bf16 v[56:59], a[196:199], v[180:183], v[56:59]
ds_read_b64_tr_b16 a[252:253], v227 offset:32768
v_cvt_pk_bf16_f32 v102, v12, v13
v_mfma_f32_16x16x32_bf16 v[56:59], a[200:203], v[184:187], v[56:59]
s_waitcnt vmcnt(6)
v_exp_f32 v15, v15
v_mfma_f32_16x16x32_bf16 v[56:59], a[204:207], v[188:191], v[56:59]
ds_read_b64_tr_b16 a[254:255], v227 offset:40960
v_lshlrev_b32 v200, 16, v192
v_mfma_f32_16x16x32_bf16 v[60:63], a[208:211], v[176:179], v[76:79]
v_exp_f32 v16, v16
v_smfmac_f32_16x16x64_bf16 v[80:83], v[232:235], v[112:119], v88
v_cvt_pk_bf16_f32 v103, v14, v15
v_mfma_f32_16x16x32_bf16 v[60:63], a[212:215], v[180:183], v[60:63]
v_exp_f32 v17, v17
v_mfma_f32_16x16x32_bf16 v[60:63], a[216:219], v[184:187], v[60:63]
v_and_b32 v201, 0xffff0000, v192
v_lshlrev_b32 v202, 16, v193
v_mfma_f32_16x16x32_bf16 v[60:63], a[220:223], v[188:191], v[60:63]
v_exp_f32 v18, v18
v_smfmac_f32_16x16x64_bf16 v[84:87], v[232:235], v[120:127], v88
s_waitcnt lgkmcnt(0)
v_cvt_pk_bf16_f32 v104, v16, v17
v_mfma_f32_16x16x32_bf16 a[0:3], a[224:227], v[112:115], a[0:3]
v_exp_f32 v19, v19
v_mfma_f32_16x16x32_bf16 a[4:7], a[224:227], v[116:119], a[4:7]
v_exp_f32 v20, v20
v_mfma_f32_16x16x32_bf16 a[8:11], a[224:227], v[120:123], a[8:11]
ds_read_b128 a[192:195], v216 offset:32768
v_cvt_pk_bf16_f32 v105, v18, v19
v_mfma_f32_16x16x32_bf16 a[12:15], a[224:227], v[124:127], a[12:15]
v_exp_f32 v21, v21
v_mfma_f32_16x16x32_bf16 a[16:19], a[228:231], v[112:115], a[16:19]
ds_read_b128 a[196:199], v217 offset:32768
ds_read_b128 a[200:203], v218 offset:32768
v_mfma_f32_16x16x32_bf16 a[20:23], a[228:231], v[116:119], a[20:23]
v_exp_f32 v22, v22
v_mfma_f32_16x16x32_bf16 a[24:27], a[228:231], v[120:123], a[24:27]
ds_read_b128 a[204:207], v219 offset:32768
v_cvt_pk_bf16_f32 v106, v20, v21
v_mfma_f32_16x16x32_bf16 a[28:31], a[228:231], v[124:127], a[28:31]
v_exp_f32 v23, v23
v_mfma_f32_16x16x32_bf16 a[32:35], a[232:235], v[112:115], a[32:35]
buffer_load_dwordx4 v231, s[8:11], s24 offen offset:3072  lds
v_mfma_f32_16x16x32_bf16 a[36:39], a[232:235], v[116:119], a[36:39]
s_add_u32 s24, s24, 8192
v_exp_f32 v24, v24
v_mfma_f32_16x16x32_bf16 a[40:43], a[232:235], v[120:123], a[40:43]
ds_read_b128 a[208:211], v216 offset:40960
v_cvt_pk_bf16_f32 v107, v22, v23
v_mfma_f32_16x16x32_bf16 a[44:47], a[232:235], v[124:127], a[44:47]
v_exp_f32 v25, v25
v_mfma_f32_16x16x32_bf16 a[48:51], a[236:239], v[112:115], a[48:51]
ds_read_b128 a[212:215], v217 offset:40960
ds_read_b128 a[216:219], v218 offset:40960
v_mfma_f32_16x16x32_bf16 a[52:55], a[236:239], v[116:119], a[52:55]
v_exp_f32 v26, v26
v_mfma_f32_16x16x32_bf16 a[56:59], a[236:239], v[120:123], a[56:59]
ds_read_b128 a[220:223], v219 offset:40960
v_cvt_pk_bf16_f32 v108, v24, v25
v_mfma_f32_16x16x32_bf16 a[60:63], a[236:239], v[124:127], a[60:63]
v_exp_f32 v27, v27
v_mfma_f32_16x16x32_bf16 a[64:67], a[240:243], v[112:115], a[64:67]
v_and_b32 v203, 0xffff0000, v193
v_lshlrev_b32 v204, 16, v194
v_mfma_f32_16x16x32_bf16 a[68:71], a[240:243], v[116:119], a[68:71]
v_exp_f32 v28, v28
v_mfma_f32_16x16x32_bf16 a[72:75], a[240:243], v[120:123], a[72:75]
v_cvt_pk_bf16_f32 v109, v26, v27
v_and_b32 v205, 0xffff0000, v194
v_mfma_f32_16x16x32_bf16 a[76:79], a[240:243], v[124:127], a[76:79]
v_exp_f32 v29, v29
v_mfma_f32_16x16x32_bf16 a[80:83], a[244:247], v[112:115], a[80:83]
s_lshl1_add_u32 m0, s26, 32768
v_mfma_f32_16x16x32_bf16 a[84:87], a[244:247], v[116:119], a[84:87]
s_waitcnt lgkmcnt(0)
s_barrier
v_mfma_f32_16x16x32_bf16 a[88:91], a[244:247], v[120:123], a[88:91]
buffer_load_dwordx4 v228, s[12:15], s24 offen  lds
v_mfma_f32_16x16x32_bf16 a[92:95], a[244:247], v[124:127], a[92:95]
v_lshlrev_b32 v206, 16, v195
v_and_b32 v207, 0xffff0000, v195
v_mfma_f32_16x16x32_bf16 a[96:99], a[248:251], v[112:115], a[96:99]
v_exp_f32 v30, v30
v_mfma_f32_16x16x32_bf16 a[100:103], a[248:251], v[116:119], a[100:103]
v_cvt_pk_bf16_f32 v110, v28, v29
v_mul_f32 v200, v251, v200
v_mfma_f32_16x16x32_bf16 a[104:107], a[248:251], v[120:123], a[104:107]
v_exp_f32 v31, v31
v_mfma_f32_16x16x32_bf16 a[108:111], a[248:251], v[124:127], a[108:111]
v_mul_f32 v201, v251, v201
v_mul_f32 v202, v251, v202
v_mfma_f32_16x16x32_bf16 a[112:115], a[252:255], v[112:115], a[112:115]
v_exp_f32 v32, v32
v_mfma_f32_16x16x32_bf16 a[116:119], a[252:255], v[116:119], a[116:119]
v_cvt_pk_bf16_f32 v111, v30, v31
v_mul_f32 v203, v251, v203
v_mfma_f32_16x16x32_bf16 a[120:123], a[252:255], v[120:123], a[120:123]
v_exp_f32 v33, v33
v_mfma_f32_16x16x32_bf16 a[124:127], a[252:255], v[124:127], a[124:127]
v_mfma_f32_16x16x32_bf16 v[0:3], a[192:195], v[128:131], v[64:67]
v_exp_f32 v34, v34
v_mfma_f32_16x16x32_bf16 v[0:3], a[196:199], v[132:135], v[0:3]
ds_read_b64_tr_b16 a[224:225], v220 offset:49152
v_cvt_pk_bf16_f32 v112, v32, v33
v_mfma_f32_16x16x32_bf16 v[0:3], a[200:203], v[136:139], v[0:3]
v_exp_f32 v35, v35
v_mfma_f32_16x16x32_bf16 v[0:3], a[204:207], v[140:143], v[0:3]
ds_read_b64_tr_b16 a[226:227], v220 offset:57344
ds_read_b64_tr_b16 a[228:229], v221 offset:49152
v_mfma_f32_16x16x32_bf16 v[4:7], a[208:211], v[128:131], v[64:67]
v_exp_f32 v36, v36
v_mfma_f32_16x16x32_bf16 v[4:7], a[212:215], v[132:135], v[4:7]
ds_read_b64_tr_b16 a[230:231], v221 offset:57344
v_cvt_pk_bf16_f32 v113, v34, v35
v_mfma_f32_16x16x32_bf16 v[4:7], a[216:219], v[136:139], v[4:7]
v_exp_f32 v37, v37
v_mfma_f32_16x16x32_bf16 v[4:7], a[220:223], v[140:143], v[4:7]
buffer_load_dwordx4 v229, s[12:15], s24 offen offset:1024  lds
v_mfma_f32_16x16x32_bf16 v[8:11], a[192:195], v[144:147], v[68:71]
v_exp_f32 v38, v38
v_mfma_f32_16x16x32_bf16 v[8:11], a[196:199], v[148:151], v[8:11]
ds_read_b64_tr_b16 a[232:233], v222 offset:49152
v_cvt_pk_bf16_f32 v114, v36, v37
v_mfma_f32_16x16x32_bf16 v[8:11], a[200:203], v[152:155], v[8:11]
v_exp_f32 v39, v39
v_mfma_f32_16x16x32_bf16 v[8:11], a[204:207], v[156:159], v[8:11]
ds_read_b64_tr_b16 a[234:235], v222 offset:57344
ds_read_b64_tr_b16 a[236:237], v223 offset:49152
v_mfma_f32_16x16x32_bf16 v[12:15], a[208:211], v[144:147], v[68:71]
v_exp_f32 v40, v40
v_mfma_f32_16x16x32_bf16 v[12:15], a[212:215], v[148:151], v[12:15]
ds_read_b64_tr_b16 a[238:239], v223 offset:57344
v_cvt_pk_bf16_f32 v115, v38, v39
v_mfma_f32_16x16x32_bf16 v[12:15], a[216:219], v[152:155], v[12:15]
v_exp_f32 v41, v41
v_mfma_f32_16x16x32_bf16 v[12:15], a[220:223], v[156:159], v[12:15]
ds_read_b64_tr_b16 a[240:241], v224 offset:49152
ds_read_b64_tr_b16 a[242:243], v224 offset:57344
v_mfma_f32_16x16x32_bf16 v[16:19], a[192:195], v[160:163], v[72:75]
v_exp_f32 v42, v42
v_mfma_f32_16x16x32_bf16 v[16:19], a[196:199], v[164:167], v[16:19]
ds_read_b64_tr_b16 a[244:245], v225 offset:49152
v_cvt_pk_bf16_f32 v116, v40, v41
v_mfma_f32_16x16x32_bf16 v[16:19], a[200:203], v[168:171], v[16:19]
v_exp_f32 v43, v43
v_mfma_f32_16x16x32_bf16 v[16:19], a[204:207], v[172:175], v[16:19]
ds_read_b64_tr_b16 a[246:247], v225 offset:57344
ds_read_b64_tr_b16 a[248:249], v226 offset:49152
v_mfma_f32_16x16x32_bf16 v[20:23], a[208:211], v[160:163], v[72:75]
v_exp_f32 v44, v44
v_mfma_f32_16x16x32_bf16 v[20:23], a[212:215], v[164:167], v[20:23]
ds_read_b64_tr_b16 a[250:251], v226 offset:57344
v_cvt_pk_bf16_f32 v117, v42, v43
v_mfma_f32_16x16x32_bf16 v[20:23], a[216:219], v[168:171], v[20:23]
v_exp_f32 v45, v45
v_mfma_f32_16x16x32_bf16 v[20:23], a[220:223], v[172:175], v[20:23]
buffer_load_dwordx4 v230, s[8:11], s24 offen offset:2048  lds
v_mfma_f32_16x16x32_bf16 v[24:27], a[192:195], v[176:179], v[76:79]
v_exp_f32 v46, v46
v_mfma_f32_16x16x32_bf16 v[24:27], a[196:199], v[180:183], v[24:27]
ds_read_b64_tr_b16 a[252:253], v227 offset:49152
v_cvt_pk_bf16_f32 v118, v44, v45
v_mfma_f32_16x16x32_bf16 v[24:27], a[200:203], v[184:187], v[24:27]
v_exp_f32 v47, v47
v_mfma_f32_16x16x32_bf16 v[24:27], a[204:207], v[188:191], v[24:27]
ds_read_b64_tr_b16 a[254:255], v227 offset:57344
v_mul_f32 v204, v251, v204
v_mfma_f32_16x16x32_bf16 v[28:31], a[208:211], v[176:179], v[76:79]
v_exp_f32 v48, v48
v_smfmac_f32_16x16x64_bf16 v[80:83], v[232:235], v[96:103], v88
v_cvt_pk_bf16_f32 v119, v46, v47
v_mfma_f32_16x16x32_bf16 v[28:31], a[212:215], v[180:183], v[28:31]
v_exp_f32 v49, v49
v_mfma_f32_16x16x32_bf16 v[28:31], a[216:219], v[184:187], v[28:31]
v_mul_f32 v205, v251, v205
v_mul_f32 v206, v251, v206
v_mfma_f32_16x16x32_bf16 v[28:31], a[220:223], v[188:191], v[28:31]
v_exp_f32 v50, v50
v_smfmac_f32_16x16x64_bf16 v[84:87], v[232:235], v[104:111], v88
s_waitcnt lgkmcnt(0)
v_cvt_pk_bf16_f32 v120, v48, v49
v_mfma_f32_16x16x32_bf16 a[0:3], a[224:227], v[96:99], a[0:3]
v_exp_f32 v51, v51
v_mfma_f32_16x16x32_bf16 a[4:7], a[224:227], v[100:103], a[4:7]
v_exp_f32 v52, v52
v_mfma_f32_16x16x32_bf16 a[8:11], a[224:227], v[104:107], a[8:11]
ds_read_b128 a[192:195], v216 offset:49152
v_cvt_pk_bf16_f32 v121, v50, v51
v_mfma_f32_16x16x32_bf16 a[12:15], a[224:227], v[108:111], a[12:15]
v_exp_f32 v53, v53
v_mfma_f32_16x16x32_bf16 a[16:19], a[228:231], v[96:99], a[16:19]
ds_read_b128 a[196:199], v217 offset:49152
ds_read_b128 a[200:203], v218 offset:49152
v_mfma_f32_16x16x32_bf16 a[20:23], a[228:231], v[100:103], a[20:23]
v_exp_f32 v54, v54
v_mfma_f32_16x16x32_bf16 a[24:27], a[228:231], v[104:107], a[24:27]
ds_read_b128 a[204:207], v219 offset:49152
v_cvt_pk_bf16_f32 v122, v52, v53
v_mfma_f32_16x16x32_bf16 a[28:31], a[228:231], v[108:111], a[28:31]
v_exp_f32 v55, v55
v_mfma_f32_16x16x32_bf16 a[32:35], a[232:235], v[96:99], a[32:35]
buffer_load_dwordx4 v231, s[8:11], s24 offen offset:3072  lds
v_mfma_f32_16x16x32_bf16 a[36:39], a[232:235], v[100:103], a[36:39]
s_add_u32 s24, s24, 8192
v_exp_f32 v56, v56
v_mfma_f32_16x16x32_bf16 a[40:43], a[232:235], v[104:107], a[40:43]
ds_read_b128 a[208:211], v216 offset:57344
v_cvt_pk_bf16_f32 v123, v54, v55
v_mfma_f32_16x16x32_bf16 a[44:47], a[232:235], v[108:111], a[44:47]
v_exp_f32 v57, v57
v_mfma_f32_16x16x32_bf16 a[48:51], a[236:239], v[96:99], a[48:51]
ds_read_b128 a[212:215], v217 offset:57344
ds_read_b128 a[216:219], v218 offset:57344
v_mfma_f32_16x16x32_bf16 a[52:55], a[236:239], v[100:103], a[52:55]
v_exp_f32 v58, v58
v_mfma_f32_16x16x32_bf16 a[56:59], a[236:239], v[104:107], a[56:59]
ds_read_b128 a[220:223], v219 offset:57344
v_cvt_pk_bf16_f32 v124, v56, v57
v_mfma_f32_16x16x32_bf16 a[60:63], a[236:239], v[108:111], a[60:63]
v_exp_f32 v59, v59
v_mfma_f32_16x16x32_bf16 a[64:67], a[240:243], v[96:99], a[64:67]
v_mul_f32 v207, v251, v207
v_lshlrev_b32 v192, 16, v196
v_mfma_f32_16x16x32_bf16 a[68:71], a[240:243], v[100:103], a[68:71]
v_exp_f32 v60, v60
v_mfma_f32_16x16x32_bf16 a[72:75], a[240:243], v[104:107], a[72:75]
v_cvt_pk_bf16_f32 v125, v58, v59
v_and_b32 v193, 0xffff0000, v196
v_mfma_f32_16x16x32_bf16 a[76:79], a[240:243], v[108:111], a[76:79]
v_exp_f32 v61, v61
v_mfma_f32_16x16x32_bf16 a[80:83], a[244:247], v[96:99], a[80:83]
s_lshl1_add_u32 m0, s26, 49152
v_mfma_f32_16x16x32_bf16 a[84:87], a[244:247], v[100:103], a[84:87]
s_waitcnt vmcnt(8) lgkmcnt(0)
s_barrier
v_mfma_f32_16x16x32_bf16 a[88:91], a[244:247], v[104:107], a[88:91]
buffer_load_dwordx4 v228, s[12:15], s24 offen  lds
v_mfma_f32_16x16x32_bf16 a[92:95], a[244:247], v[108:111], a[92:95]
v_fmac_f32 v200, v252, v192
v_fmac_f32 v201, v252, v193
v_mfma_f32_16x16x32_bf16 a[96:99], a[248:251], v[96:99], a[96:99]
v_exp_f32 v62, v62
v_mfma_f32_16x16x32_bf16 a[100:103], a[248:251], v[100:103], a[100:103]
v_cvt_pk_bf16_f32 v126, v60, v61
v_lshlrev_b32 v192, 16, v197
v_mfma_f32_16x16x32_bf16 a[104:107], a[248:251], v[104:107], a[104:107]
v_exp_f32 v63, v63
v_mfma_f32_16x16x32_bf16 a[108:111], a[248:251], v[108:111], a[108:111]
v_and_b32 v193, 0xffff0000, v197
v_fmac_f32 v202, v252, v192
v_mfma_f32_16x16x32_bf16 a[112:115], a[252:255], v[96:99], a[112:115]
v_exp_f32 v0, v0
v_mfma_f32_16x16x32_bf16 a[116:119], a[252:255], v[100:103], a[116:119]
v_cvt_pk_bf16_f32 v127, v62, v63
v_fmac_f32 v203, v252, v193
v_mfma_f32_16x16x32_bf16 a[120:123], a[252:255], v[104:107], a[120:123]
v_exp_f32 v1, v1
v_mfma_f32_16x16x32_bf16 a[124:127], a[252:255], v[108:111], a[124:127]
v_mfma_f32_16x16x32_bf16 v[32:35], a[192:195], v[128:131], v[64:67]
v_exp_f32 v2, v2
v_mfma_f32_16x16x32_bf16 v[32:35], a[196:199], v[132:135], v[32:35]
ds_read_b64_tr_b16 a[224:225], v220 offset:0
v_cvt_pk_bf16_f32 v96, v0, v1
v_mfma_f32_16x16x32_bf16 v[32:35], a[200:203], v[136:139], v[32:35]
v_exp_f32 v3, v3
v_mfma_f32_16x16x32_bf16 v[32:35], a[204:207], v[140:143], v[32:35]
ds_read_b64_tr_b16 a[226:227], v220 offset:8192
ds_read_b64_tr_b16 a[228:229], v221 offset:0
v_mfma_f32_16x16x32_bf16 v[36:39], a[208:211], v[128:131], v[64:67]
v_exp_f32 v4, v4
v_mfma_f32_16x16x32_bf16 v[36:39], a[212:215], v[132:135], v[36:39]
ds_read_b64_tr_b16 a[230:231], v221 offset:8192
v_cvt_pk_bf16_f32 v97, v2, v3
v_mfma_f32_16x16x32_bf16 v[36:39], a[216:219], v[136:139], v[36:39]
v_exp_f32 v5, v5
v_mfma_f32_16x16x32_bf16 v[36:39], a[220:223], v[140:143], v[36:39]
buffer_load_dwordx4 v229, s[12:15], s24 offen offset:1024  lds
v_mfma_f32_16x16x32_bf16 v[40:43], a[192:195], v[144:147], v[68:71]
v_exp_f32 v6, v6
v_mfma_f32_16x16x32_bf16 v[40:43], a[196:199], v[148:151], v[40:43]
ds_read_b64_tr_b16 a[232:233], v222 offset:0
v_cvt_pk_bf16_f32 v98, v4, v5
v_mfma_f32_16x16x32_bf16 v[40:43], a[200:203], v[152:155], v[40:43]
v_exp_f32 v7, v7
v_mfma_f32_16x16x32_bf16 v[40:43], a[204:207], v[156:159], v[40:43]
ds_read_b64_tr_b16 a[234:235], v222 offset:8192
ds_read_b64_tr_b16 a[236:237], v223 offset:0
v_mfma_f32_16x16x32_bf16 v[44:47], a[208:211], v[144:147], v[68:71]
v_exp_f32 v8, v8
v_mfma_f32_16x16x32_bf16 v[44:47], a[212:215], v[148:151], v[44:47]
ds_read_b64_tr_b16 a[238:239], v223 offset:8192
v_cvt_pk_bf16_f32 v99, v6, v7
v_mfma_f32_16x16x32_bf16 v[44:47], a[216:219], v[152:155], v[44:47]
v_exp_f32 v9, v9
v_mfma_f32_16x16x32_bf16 v[44:47], a[220:223], v[156:159], v[44:47]
ds_read_b64_tr_b16 a[240:241], v224 offset:0
ds_read_b64_tr_b16 a[242:243], v224 offset:8192
v_mfma_f32_16x16x32_bf16 v[48:51], a[192:195], v[160:163], v[72:75]
v_exp_f32 v10, v10
v_mfma_f32_16x16x32_bf16 v[48:51], a[196:199], v[164:167], v[48:51]
ds_read_b64_tr_b16 a[244:245], v225 offset:0
Lpad10:
s_cbranch_execz Lpad14
v_cvt_pk_bf16_f32 v100, v8, v9
v_mfma_f32_16x16x32_bf16 v[48:51], a[200:203], v[168:171], v[48:51]
v_exp_f32 v11, v11
v_mfma_f32_16x16x32_bf16 v[48:51], a[204:207], v[172:175], v[48:51]
ds_read_b64_tr_b16 a[246:247], v225 offset:8192
ds_read_b64_tr_b16 a[248:249], v226 offset:0
v_mfma_f32_16x16x32_bf16 v[52:55], a[208:211], v[160:163], v[72:75]
v_exp_f32 v12, v12
v_mfma_f32_16x16x32_bf16 v[52:55], a[212:215], v[164:167], v[52:55]
ds_read_b64_tr_b16 a[250:251], v226 offset:8192
v_cvt_pk_bf16_f32 v101, v10, v11
v_mfma_f32_16x16x32_bf16 v[52:55], a[216:219], v[168:171], v[52:55]
v_exp_f32 v13, v13
v_mfma_f32_16x16x32_bf16 v[52:55], a[220:223], v[172:175], v[52:55]
buffer_load_dwordx4 v230, s[8:11], s24 offen offset:2048  lds
v_mfma_f32_16x16x32_bf16 v[56:59], a[192:195], v[176:179], v[76:79]
v_exp_f32 v14, v14
v_mfma_f32_16x16x32_bf16 v[56:59], a[196:199], v[180:183], v[56:59]
ds_read_b64_tr_b16 a[252:253], v227 offset:0
v_cvt_pk_bf16_f32 v102, v12, v13
v_mfma_f32_16x16x32_bf16 v[56:59], a[200:203], v[184:187], v[56:59]
v_exp_f32 v15, v15
v_mfma_f32_16x16x32_bf16 v[56:59], a[204:207], v[188:191], v[56:59]
ds_read_b64_tr_b16 a[254:255], v227 offset:8192
v_lshlrev_b32 v192, 16, v198
v_mfma_f32_16x16x32_bf16 v[60:63], a[208:211], v[176:179], v[76:79]
v_exp_f32 v16, v16
v_smfmac_f32_16x16x64_bf16 v[80:83], v[232:235], v[112:119], v88
v_cvt_pk_bf16_f32 v103, v14, v15
v_mfma_f32_16x16x32_bf16 v[60:63], a[212:215], v[180:183], v[60:63]
v_exp_f32 v17, v17
v_mfma_f32_16x16x32_bf16 v[60:63], a[216:219], v[184:187], v[60:63]
v_and_b32 v193, 0xffff0000, v198
v_fmac_f32 v204, v252, v192
v_mfma_f32_16x16x32_bf16 v[60:63], a[220:223], v[188:191], v[60:63]
v_exp_f32 v18, v18
v_smfmac_f32_16x16x64_bf16 v[84:87], v[232:235], v[120:127], v88
s_waitcnt lgkmcnt(0)
v_cvt_pk_bf16_f32 v104, v16, v17
v_mfma_f32_16x16x32_bf16 a[0:3], a[224:227], v[112:115], a[0:3]
v_exp_f32 v19, v19
v_mfma_f32_16x16x32_bf16 a[4:7], a[224:227], v[116:119], a[4:7]
v_exp_f32 v20, v20
v_mfma_f32_16x16x32_bf16 a[8:11], a[224:227], v[120:123], a[8:11]
ds_read_b128 a[192:195], v216 offset:0
v_cvt_pk_bf16_f32 v105, v18, v19
v_mfma_f32_16x16x32_bf16 a[12:15], a[224:227], v[124:127], a[12:15]
v_exp_f32 v21, v21
v_mfma_f32_16x16x32_bf16 a[16:19], a[228:231], v[112:115], a[16:19]
ds_read_b128 a[196:199], v217 offset:0
ds_read_b128 a[200:203], v218 offset:0
v_mfma_f32_16x16x32_bf16 a[20:23], a[228:231], v[116:119], a[20:23]
v_exp_f32 v22, v22
v_mfma_f32_16x16x32_bf16 a[24:27], a[228:231], v[120:123], a[24:27]
ds_read_b128 a[204:207], v219 offset:0
v_cvt_pk_bf16_f32 v106, v20, v21
v_mfma_f32_16x16x32_bf16 a[28:31], a[228:231], v[124:127], a[28:31]
v_exp_f32 v23, v23
v_mfma_f32_16x16x32_bf16 a[32:35], a[232:235], v[112:115], a[32:35]
buffer_load_dwordx4 v231, s[8:11], s24 offen offset:3072  lds
v_mfma_f32_16x16x32_bf16 a[36:39], a[232:235], v[116:119], a[36:39]
s_add_u32 s24, s24, 8192
v_exp_f32 v24, v24
v_mfma_f32_16x16x32_bf16 a[40:43], a[232:235], v[120:123], a[40:43]
ds_read_b128 a[208:211], v216 offset:8192
v_cvt_pk_bf16_f32 v107, v22, v23
v_mfma_f32_16x16x32_bf16 a[44:47], a[232:235], v[124:127], a[44:47]
v_exp_f32 v25, v25
v_mfma_f32_16x16x32_bf16 a[48:51], a[236:239], v[112:115], a[48:51]
ds_read_b128 a[212:215], v217 offset:8192
ds_read_b128 a[216:219], v218 offset:8192
v_mfma_f32_16x16x32_bf16 a[52:55], a[236:239], v[116:119], a[52:55]
v_exp_f32 v26, v26
v_mfma_f32_16x16x32_bf16 a[56:59], a[236:239], v[120:123], a[56:59]
ds_read_b128 a[220:223], v219 offset:8192
v_cvt_pk_bf16_f32 v108, v24, v25
v_mfma_f32_16x16x32_bf16 a[60:63], a[236:239], v[124:127], a[60:63]
v_exp_f32 v27, v27
v_mfma_f32_16x16x32_bf16 a[64:67], a[240:243], v[112:115], a[64:67]
v_fmac_f32 v205, v252, v193
v_lshlrev_b32 v192, 16, v199
v_mfma_f32_16x16x32_bf16 a[68:71], a[240:243], v[116:119], a[68:71]
v_exp_f32 v28, v28
v_mfma_f32_16x16x32_bf16 a[72:75], a[240:243], v[120:123], a[72:75]
v_cvt_pk_bf16_f32 v109, v26, v27
v_and_b32 v193, 0xffff0000, v199
v_mfma_f32_16x16x32_bf16 a[76:79], a[240:243], v[124:127], a[76:79]
v_exp_f32 v29, v29
v_mfma_f32_16x16x32_bf16 a[80:83], a[244:247], v[112:115], a[80:83]
s_lshl1_add_u32 m0, s26, 0
v_mfma_f32_16x16x32_bf16 a[84:87], a[244:247], v[116:119], a[84:87]
s_waitcnt vmcnt(8) lgkmcnt(0)
s_barrier
v_mfma_f32_16x16x32_bf16 a[88:91], a[244:247], v[120:123], a[88:91]
buffer_load_dwordx4 v228, s[12:15], s24 offen  lds
v_mfma_f32_16x16x32_bf16 a[92:95], a[244:247], v[124:127], a[92:95]
v_fmac_f32 v206, v252, v192
v_fmac_f32 v207, v252, v193
v_mfma_f32_16x16x32_bf16 a[96:99], a[248:251], v[112:115], a[96:99]
v_exp_f32 v30, v30
v_mfma_f32_16x16x32_bf16 a[100:103], a[248:251], v[116:119], a[100:103]
v_cvt_pk_bf16_f32 v110, v28, v29
v_permlane32_swap_b32 v200, v204
v_mfma_f32_16x16x32_bf16 a[104:107], a[248:251], v[120:123], a[104:107]
v_exp_f32 v31, v31
v_mfma_f32_16x16x32_bf16 a[108:111], a[248:251], v[124:127], a[108:111]
v_permlane32_swap_b32 v201, v205
v_permlane32_swap_b32 v202, v206
v_mfma_f32_16x16x32_bf16 a[112:115], a[252:255], v[112:115], a[112:115]
v_exp_f32 v32, v32
v_mfma_f32_16x16x32_bf16 a[116:119], a[252:255], v[116:119], a[116:119]
v_cvt_pk_bf16_f32 v111, v30, v31
v_permlane32_swap_b32 v203, v207
v_mfma_f32_16x16x32_bf16 a[120:123], a[252:255], v[120:123], a[120:123]
v_exp_f32 v33, v33
v_mfma_f32_16x16x32_bf16 a[124:127], a[252:255], v[124:127], a[124:127]
v_mfma_f32_16x16x32_bf16 v[0:3], a[192:195], v[128:131], v[64:67]
v_exp_f32 v34, v34
v_mfma_f32_16x16x32_bf16 v[0:3], a[196:199], v[132:135], v[0:3]
ds_read_b64_tr_b16 a[224:225], v220 offset:16384
v_cvt_pk_bf16_f32 v112, v32, v33
v_mfma_f32_16x16x32_bf16 v[0:3], a[200:203], v[136:139], v[0:3]
v_exp_f32 v35, v35
v_mfma_f32_16x16x32_bf16 v[0:3], a[204:207], v[140:143], v[0:3]
ds_read_b64_tr_b16 a[226:227], v220 offset:24576
ds_read_b64_tr_b16 a[228:229], v221 offset:16384
v_mfma_f32_16x16x32_bf16 v[4:7], a[208:211], v[128:131], v[64:67]
v_exp_f32 v36, v36
v_mfma_f32_16x16x32_bf16 v[4:7], a[212:215], v[132:135], v[4:7]
ds_read_b64_tr_b16 a[230:231], v221 offset:24576
v_cvt_pk_bf16_f32 v113, v34, v35
v_mfma_f32_16x16x32_bf16 v[4:7], a[216:219], v[136:139], v[4:7]
v_exp_f32 v37, v37
v_mfma_f32_16x16x32_bf16 v[4:7], a[220:223], v[140:143], v[4:7]
buffer_load_dwordx4 v229, s[12:15], s24 offen offset:1024  lds
v_mfma_f32_16x16x32_bf16 v[8:11], a[192:195], v[144:147], v[68:71]
v_exp_f32 v38, v38
v_mfma_f32_16x16x32_bf16 v[8:11], a[196:199], v[148:151], v[8:11]
ds_read_b64_tr_b16 a[232:233], v222 offset:16384
v_cvt_pk_bf16_f32 v114, v36, v37
v_mfma_f32_16x16x32_bf16 v[8:11], a[200:203], v[152:155], v[8:11]
v_exp_f32 v39, v39
v_mfma_f32_16x16x32_bf16 v[8:11], a[204:207], v[156:159], v[8:11]
ds_read_b64_tr_b16 a[234:235], v222 offset:24576
ds_read_b64_tr_b16 a[236:237], v223 offset:16384
v_mfma_f32_16x16x32_bf16 v[12:15], a[208:211], v[144:147], v[68:71]
v_exp_f32 v40, v40
v_mfma_f32_16x16x32_bf16 v[12:15], a[212:215], v[148:151], v[12:15]
ds_read_b64_tr_b16 a[238:239], v223 offset:24576
v_cvt_pk_bf16_f32 v115, v38, v39
v_mfma_f32_16x16x32_bf16 v[12:15], a[216:219], v[152:155], v[12:15]
v_exp_f32 v41, v41
v_mfma_f32_16x16x32_bf16 v[12:15], a[220:223], v[156:159], v[12:15]
ds_read_b64_tr_b16 a[240:241], v224 offset:16384
ds_read_b64_tr_b16 a[242:243], v224 offset:24576
v_mfma_f32_16x16x32_bf16 v[16:19], a[192:195], v[160:163], v[72:75]
v_exp_f32 v42, v42
v_mfma_f32_16x16x32_bf16 v[16:19], a[196:199], v[164:167], v[16:19]
ds_read_b64_tr_b16 a[244:245], v225 offset:16384
v_cvt_pk_bf16_f32 v116, v40, v41
v_mfma_f32_16x16x32_bf16 v[16:19], a[200:203], v[168:171], v[16:19]
v_exp_f32 v43, v43
v_mfma_f32_16x16x32_bf16 v[16:19], a[204:207], v[172:175], v[16:19]
ds_read_b64_tr_b16 a[246:247], v225 offset:24576
ds_read_b64_tr_b16 a[248:249], v226 offset:16384
v_mfma_f32_16x16x32_bf16 v[20:23], a[208:211], v[160:163], v[72:75]
v_exp_f32 v44, v44
v_mfma_f32_16x16x32_bf16 v[20:23], a[212:215], v[164:167], v[20:23]
ds_read_b64_tr_b16 a[250:251], v226 offset:24576
v_cvt_pk_bf16_f32 v117, v42, v43
v_mfma_f32_16x16x32_bf16 v[20:23], a[216:219], v[168:171], v[20:23]
v_exp_f32 v45, v45
v_mfma_f32_16x16x32_bf16 v[20:23], a[220:223], v[172:175], v[20:23]
buffer_load_dwordx4 v230, s[8:11], s24 offen offset:2048  lds
v_mfma_f32_16x16x32_bf16 v[24:27], a[192:195], v[176:179], v[76:79]
v_exp_f32 v46, v46
v_mfma_f32_16x16x32_bf16 v[24:27], a[196:199], v[180:183], v[24:27]
ds_read_b64_tr_b16 a[252:253], v227 offset:16384
v_cvt_pk_bf16_f32 v118, v44, v45
v_mfma_f32_16x16x32_bf16 v[24:27], a[200:203], v[184:187], v[24:27]
v_exp_f32 v47, v47
v_mfma_f32_16x16x32_bf16 v[24:27], a[204:207], v[188:191], v[24:27]
ds_read_b64_tr_b16 a[254:255], v227 offset:24576
v_add_f32 v200, v200, v204
v_mfma_f32_16x16x32_bf16 v[28:31], a[208:211], v[176:179], v[76:79]
v_exp_f32 v48, v48
v_smfmac_f32_16x16x64_bf16 v[80:83], v[232:235], v[96:103], v88
v_cvt_pk_bf16_f32 v119, v46, v47
v_mfma_f32_16x16x32_bf16 v[28:31], a[212:215], v[180:183], v[28:31]
v_exp_f32 v49, v49
v_mfma_f32_16x16x32_bf16 v[28:31], a[216:219], v[184:187], v[28:31]
v_add_f32 v201, v201, v205
v_add_f32 v202, v202, v206
v_mfma_f32_16x16x32_bf16 v[28:31], a[220:223], v[188:191], v[28:31]
v_exp_f32 v50, v50
v_smfmac_f32_16x16x64_bf16 v[84:87], v[232:235], v[104:111], v88
s_waitcnt lgkmcnt(0)
v_cvt_pk_bf16_f32 v120, v48, v49
v_mfma_f32_16x16x32_bf16 a[0:3], a[224:227], v[96:99], a[0:3]
v_exp_f32 v51, v51
v_mfma_f32_16x16x32_bf16 a[4:7], a[224:227], v[100:103], a[4:7]
v_exp_f32 v52, v52
v_mfma_f32_16x16x32_bf16 a[8:11], a[224:227], v[104:107], a[8:11]
ds_read_b128 a[192:195], v216 offset:16384
v_cvt_pk_bf16_f32 v121, v50, v51
v_mfma_f32_16x16x32_bf16 a[12:15], a[224:227], v[108:111], a[12:15]
v_exp_f32 v53, v53
v_mfma_f32_16x16x32_bf16 a[16:19], a[228:231], v[96:99], a[16:19]
ds_read_b128 a[196:199], v217 offset:16384
ds_read_b128 a[200:203], v218 offset:16384
v_mfma_f32_16x16x32_bf16 a[20:23], a[228:231], v[100:103], a[20:23]
v_exp_f32 v54, v54
v_mfma_f32_16x16x32_bf16 a[24:27], a[228:231], v[104:107], a[24:27]
ds_read_b128 a[204:207], v219 offset:16384
v_cvt_pk_bf16_f32 v122, v52, v53
v_mfma_f32_16x16x32_bf16 a[28:31], a[228:231], v[108:111], a[28:31]
v_exp_f32 v55, v55
v_mfma_f32_16x16x32_bf16 a[32:35], a[232:235], v[96:99], a[32:35]
buffer_load_dwordx4 v231, s[8:11], s24 offen offset:3072  lds
v_mfma_f32_16x16x32_bf16 a[36:39], a[232:235], v[100:103], a[36:39]
s_add_u32 s24, s24, 8192
v_exp_f32 v56, v56
v_mfma_f32_16x16x32_bf16 a[40:43], a[232:235], v[104:107], a[40:43]
ds_read_b128 a[208:211], v216 offset:24576
v_cvt_pk_bf16_f32 v123, v54, v55
v_mfma_f32_16x16x32_bf16 a[44:47], a[232:235], v[108:111], a[44:47]
v_exp_f32 v57, v57
v_mfma_f32_16x16x32_bf16 a[48:51], a[236:239], v[96:99], a[48:51]
ds_read_b128 a[212:215], v217 offset:24576
ds_read_b128 a[216:219], v218 offset:24576
v_mfma_f32_16x16x32_bf16 a[52:55], a[236:239], v[100:103], a[52:55]
v_exp_f32 v58, v58
v_mfma_f32_16x16x32_bf16 a[56:59], a[236:239], v[104:107], a[56:59]
ds_read_b128 a[220:223], v219 offset:24576
v_cvt_pk_bf16_f32 v124, v56, v57
v_mfma_f32_16x16x32_bf16 a[60:63], a[236:239], v[108:111], a[60:63]
v_exp_f32 v59, v59
v_mfma_f32_16x16x32_bf16 a[64:67], a[240:243], v[96:99], a[64:67]
v_add_f32 v203, v203, v207
v_permlane16_swap_b32 v200, v202
v_mfma_f32_16x16x32_bf16 a[68:71], a[240:243], v[100:103], a[68:71]
v_exp_f32 v60, v60
v_mfma_f32_16x16x32_bf16 a[72:75], a[240:243], v[104:107], a[72:75]
v_cvt_pk_bf16_f32 v125, v58, v59
v_permlane16_swap_b32 v201, v203
v_mfma_f32_16x16x32_bf16 a[76:79], a[240:243], v[108:111], a[76:79]
v_exp_f32 v61, v61
v_mfma_f32_16x16x32_bf16 a[80:83], a[244:247], v[96:99], a[80:83]
s_lshl1_add_u32 m0, s26, 16384
v_mfma_f32_16x16x32_bf16 a[84:87], a[244:247], v[100:103], a[84:87]
s_waitcnt vmcnt(8) lgkmcnt(0)
s_barrier
v_mfma_f32_16x16x32_bf16 a[88:91], a[244:247], v[104:107], a[88:91]
buffer_load_dwordx4 v228, s[12:15], s24 offen  lds
v_mfma_f32_16x16x32_bf16 a[92:95], a[244:247], v[108:111], a[92:95]
v_add_f32 v200, v200, v202
v_add_f32 v201, v201, v203
v_mfma_f32_16x16x32_bf16 a[96:99], a[248:251], v[96:99], a[96:99]
v_exp_f32 v62, v62
v_mfma_f32_16x16x32_bf16 a[100:103], a[248:251], v[100:103], a[100:103]
v_cvt_pk_bf16_f32 v126, v60, v61
v_add_f32_dpp v200, v200, v200 quad_perm:[1,0,3,2] row_mask:0xf bank_mask:0xf
v_mfma_f32_16x16x32_bf16 a[104:107], a[248:251], v[104:107], a[104:107]
v_exp_f32 v63, v63
v_mfma_f32_16x16x32_bf16 a[108:111], a[248:251], v[108:111], a[108:111]
v_add_f32_dpp v201, v201, v201 quad_perm:[1,0,3,2] row_mask:0xf bank_mask:0xf
v_add_f32_dpp v200, v200, v200 quad_perm:[2,3,0,1] row_mask:0xf bank_mask:0xf
v_mfma_f32_16x16x32_bf16 a[112:115], a[252:255], v[96:99], a[112:115]
v_exp_f32 v0, v0
v_mfma_f32_16x16x32_bf16 a[116:119], a[252:255], v[100:103], a[116:119]
v_cvt_pk_bf16_f32 v127, v62, v63
v_add_f32_dpp v201, v201, v201 quad_perm:[2,3,0,1] row_mask:0xf bank_mask:0xf
v_mfma_f32_16x16x32_bf16 a[120:123], a[252:255], v[104:107], a[120:123]
v_exp_f32 v1, v1
v_mfma_f32_16x16x32_bf16 a[124:127], a[252:255], v[108:111], a[124:127]
v_mfma_f32_16x16x32_bf16 v[32:35], a[192:195], v[128:131], v[64:67]
v_exp_f32 v2, v2
v_mfma_f32_16x16x32_bf16 v[32:35], a[196:199], v[132:135], v[32:35]
ds_read_b64_tr_b16 a[224:225], v220 offset:32768
v_cvt_pk_bf16_f32 v96, v0, v1
v_mfma_f32_16x16x32_bf16 v[32:35], a[200:203], v[136:139], v[32:35]
v_exp_f32 v3, v3
v_mfma_f32_16x16x32_bf16 v[32:35], a[204:207], v[140:143], v[32:35]
ds_read_b64_tr_b16 a[226:227], v220 offset:40960
ds_read_b64_tr_b16 a[228:229], v221 offset:32768
v_mfma_f32_16x16x32_bf16 v[36:39], a[208:211], v[128:131], v[64:67]
v_exp_f32 v4, v4
v_mfma_f32_16x16x32_bf16 v[36:39], a[212:215], v[132:135], v[36:39]
ds_read_b64_tr_b16 a[230:231], v221 offset:40960
v_cvt_pk_bf16_f32 v97, v2, v3
v_mfma_f32_16x16x32_bf16 v[36:39], a[216:219], v[136:139], v[36:39]
v_exp_f32 v5, v5
v_mfma_f32_16x16x32_bf16 v[36:39], a[220:223], v[140:143], v[36:39]
buffer_load_dwordx4 v229, s[12:15], s24 offen offset:1024  lds
v_mfma_f32_16x16x32_bf16 v[40:43], a[192:195], v[144:147], v[68:71]
v_exp_f32 v6, v6
v_mfma_f32_16x16x32_bf16 v[40:43], a[196:199], v[148:151], v[40:43]
ds_read_b64_tr_b16 a[232:233], v222 offset:32768
v_cvt_pk_bf16_f32 v98, v4, v5
v_mfma_f32_16x16x32_bf16 v[40:43], a[200:203], v[152:155], v[40:43]
v_exp_f32 v7, v7
v_mfma_f32_16x16x32_bf16 v[40:43], a[204:207], v[156:159], v[40:43]
ds_read_b64_tr_b16 a[234:235], v222 offset:40960
ds_read_b64_tr_b16 a[236:237], v223 offset:32768
v_mfma_f32_16x16x32_bf16 v[44:47], a[208:211], v[144:147], v[68:71]
v_exp_f32 v8, v8
v_mfma_f32_16x16x32_bf16 v[44:47], a[212:215], v[148:151], v[44:47]
ds_read_b64_tr_b16 a[238:239], v223 offset:40960
v_cvt_pk_bf16_f32 v99, v6, v7
v_mfma_f32_16x16x32_bf16 v[44:47], a[216:219], v[152:155], v[44:47]
v_exp_f32 v9, v9
v_mfma_f32_16x16x32_bf16 v[44:47], a[220:223], v[156:159], v[44:47]
ds_read_b64_tr_b16 a[240:241], v224 offset:32768
ds_read_b64_tr_b16 a[242:243], v224 offset:40960
v_mfma_f32_16x16x32_bf16 v[48:51], a[192:195], v[160:163], v[72:75]
v_exp_f32 v10, v10
v_mfma_f32_16x16x32_bf16 v[48:51], a[196:199], v[164:167], v[48:51]
ds_read_b64_tr_b16 a[244:245], v225 offset:32768
v_cvt_pk_bf16_f32 v100, v8, v9
v_mfma_f32_16x16x32_bf16 v[48:51], a[200:203], v[168:171], v[48:51]
v_exp_f32 v11, v11
v_mfma_f32_16x16x32_bf16 v[48:51], a[204:207], v[172:175], v[48:51]
ds_read_b64_tr_b16 a[246:247], v225 offset:40960
ds_read_b64_tr_b16 a[248:249], v226 offset:32768
v_mfma_f32_16x16x32_bf16 v[52:55], a[208:211], v[160:163], v[72:75]
v_exp_f32 v12, v12
v_mfma_f32_16x16x32_bf16 v[52:55], a[212:215], v[164:167], v[52:55]
ds_read_b64_tr_b16 a[250:251], v226 offset:40960
v_cvt_pk_bf16_f32 v101, v10, v11
v_mfma_f32_16x16x32_bf16 v[52:55], a[216:219], v[168:171], v[52:55]
v_exp_f32 v13, v13
v_mfma_f32_16x16x32_bf16 v[52:55], a[220:223], v[172:175], v[52:55]
buffer_load_dwordx4 v230, s[8:11], s24 offen offset:2048  lds
v_mfma_f32_16x16x32_bf16 v[56:59], a[192:195], v[176:179], v[76:79]
v_exp_f32 v14, v14
v_mfma_f32_16x16x32_bf16 v[56:59], a[196:199], v[180:183], v[56:59]
ds_read_b64_tr_b16 a[252:253], v227 offset:32768
v_cvt_pk_bf16_f32 v102, v12, v13
v_mfma_f32_16x16x32_bf16 v[56:59], a[200:203], v[184:187], v[56:59]
v_exp_f32 v15, v15
v_mfma_f32_16x16x32_bf16 v[56:59], a[204:207], v[188:191], v[56:59]
ds_read_b64_tr_b16 a[254:255], v227 offset:40960
v_add_f32_dpp v200, v200, v200 row_half_mirror row_mask:0xf bank_mask:0xf
v_mfma_f32_16x16x32_bf16 v[60:63], a[208:211], v[176:179], v[76:79]
v_exp_f32 v16, v16
v_smfmac_f32_16x16x64_bf16 v[80:83], v[232:235], v[112:119], v88
v_cvt_pk_bf16_f32 v103, v14, v15
v_mfma_f32_16x16x32_bf16 v[60:63], a[212:215], v[180:183], v[60:63]
v_exp_f32 v17, v17
v_mfma_f32_16x16x32_bf16 v[60:63], a[216:219], v[184:187], v[60:63]
v_add_f32_dpp v201, v201, v201 row_half_mirror row_mask:0xf bank_mask:0xf
v_add_f32_dpp v200, v200, v200 row_mirror row_mask:0xf bank_mask:0xf
v_mfma_f32_16x16x32_bf16 v[60:63], a[220:223], v[188:191], v[60:63]
v_exp_f32 v18, v18
v_smfmac_f32_16x16x64_bf16 v[84:87], v[232:235], v[120:127], v88
s_waitcnt lgkmcnt(0)
v_cvt_pk_bf16_f32 v104, v16, v17
v_mfma_f32_16x16x32_bf16 a[0:3], a[224:227], v[112:115], a[0:3]
v_exp_f32 v19, v19
v_mfma_f32_16x16x32_bf16 a[4:7], a[224:227], v[116:119], a[4:7]
v_exp_f32 v20, v20
v_mfma_f32_16x16x32_bf16 a[8:11], a[224:227], v[120:123], a[8:11]
ds_read_b128 a[192:195], v216 offset:32768
v_cvt_pk_bf16_f32 v105, v18, v19
v_mfma_f32_16x16x32_bf16 a[12:15], a[224:227], v[124:127], a[12:15]
v_exp_f32 v21, v21
v_mfma_f32_16x16x32_bf16 a[16:19], a[228:231], v[112:115], a[16:19]
ds_read_b128 a[196:199], v217 offset:32768
ds_read_b128 a[200:203], v218 offset:32768
v_mfma_f32_16x16x32_bf16 a[20:23], a[228:231], v[116:119], a[20:23]
v_exp_f32 v22, v22
v_mfma_f32_16x16x32_bf16 a[24:27], a[228:231], v[120:123], a[24:27]
ds_read_b128 a[204:207], v219 offset:32768
v_cvt_pk_bf16_f32 v106, v20, v21
v_mfma_f32_16x16x32_bf16 a[28:31], a[228:231], v[124:127], a[28:31]
v_exp_f32 v23, v23
v_mfma_f32_16x16x32_bf16 a[32:35], a[232:235], v[112:115], a[32:35]
buffer_load_dwordx4 v231, s[8:11], s24 offen offset:3072  lds
v_mfma_f32_16x16x32_bf16 a[36:39], a[232:235], v[116:119], a[36:39]
s_add_u32 s24, s24, 8192
v_exp_f32 v24, v24
v_mfma_f32_16x16x32_bf16 a[40:43], a[232:235], v[120:123], a[40:43]
ds_read_b128 a[208:211], v216 offset:40960
v_cvt_pk_bf16_f32 v107, v22, v23
v_mfma_f32_16x16x32_bf16 a[44:47], a[232:235], v[124:127], a[44:47]
v_exp_f32 v25, v25
v_mfma_f32_16x16x32_bf16 a[48:51], a[236:239], v[112:115], a[48:51]
ds_read_b128 a[212:215], v217 offset:40960
ds_read_b128 a[216:219], v218 offset:40960
v_mfma_f32_16x16x32_bf16 a[52:55], a[236:239], v[116:119], a[52:55]
v_exp_f32 v26, v26
v_mfma_f32_16x16x32_bf16 a[56:59], a[236:239], v[120:123], a[56:59]
ds_read_b128 a[220:223], v219 offset:40960
v_cvt_pk_bf16_f32 v108, v24, v25
v_mfma_f32_16x16x32_bf16 a[60:63], a[236:239], v[124:127], a[60:63]
v_exp_f32 v27, v27
v_mfma_f32_16x16x32_bf16 a[64:67], a[240:243], v[112:115], a[64:67]
v_add_f32_dpp v201, v201, v201 row_mirror row_mask:0xf bank_mask:0xf
v_lshrrev_b32 v192, 4, v248
v_mfma_f32_16x16x32_bf16 a[68:71], a[240:243], v[116:119], a[68:71]
v_exp_f32 v28, v28
v_mfma_f32_16x16x32_bf16 a[72:75], a[240:243], v[120:123], a[72:75]
v_cvt_pk_bf16_f32 v109, v26, v27
v_lshlrev_b32 v192, 3, v192
v_mfma_f32_16x16x32_bf16 a[76:79], a[240:243], v[124:127], a[76:79]
v_exp_f32 v29, v29
v_mfma_f32_16x16x32_bf16 a[80:83], a[244:247], v[112:115], a[80:83]
s_lshl1_add_u32 m0, s26, 32768
v_mfma_f32_16x16x32_bf16 a[84:87], a[244:247], v[116:119], a[84:87]
s_waitcnt vmcnt(8) lgkmcnt(0)
s_barrier
v_mfma_f32_16x16x32_bf16 a[88:91], a[244:247], v[120:123], a[88:91]
buffer_load_dwordx4 v228, s[12:15], s24 offen  lds
v_mfma_f32_16x16x32_bf16 a[92:95], a[244:247], v[124:127], a[92:95]
v_lshl_add_u32 v192, s27, 5, v192
v_add_u32 v192, 155648, v192
v_mfma_f32_16x16x32_bf16 a[96:99], a[248:251], v[112:115], a[96:99]
v_exp_f32 v30, v30
v_mfma_f32_16x16x32_bf16 a[100:103], a[248:251], v[116:119], a[100:103]
v_cvt_pk_bf16_f32 v110, v28, v29
v_and_b32 v193, 7, v248
v_mfma_f32_16x16x32_bf16 a[104:107], a[248:251], v[120:123], a[104:107]
v_exp_f32 v31, v31
v_mfma_f32_16x16x32_bf16 a[108:111], a[248:251], v[124:127], a[108:111]
v_lshlrev_b32 v193, 2, v193
v_add_u32 v194, 155648, v193
v_mfma_f32_16x16x32_bf16 a[112:115], a[252:255], v[112:115], a[112:115]
v_exp_f32 v32, v32
v_mfma_f32_16x16x32_bf16 a[116:119], a[252:255], v[116:119], a[116:119]
v_cvt_pk_bf16_f32 v111, v30, v31
v_mfma_f32_16x16x32_bf16 a[120:123], a[252:255], v[120:123], a[120:123]
v_exp_f32 v33, v33
v_mfma_f32_16x16x32_bf16 a[124:127], a[252:255], v[124:127], a[124:127]
ds_write_b64 v192, v[200:201]
v_mfma_f32_16x16x32_bf16 v[0:3], a[192:195], v[128:131], v[64:67]
v_exp_f32 v34, v34
v_mfma_f32_16x16x32_bf16 v[0:3], a[196:199], v[132:135], v[0:3]
ds_read_b64_tr_b16 a[224:225], v220 offset:49152
v_cvt_pk_bf16_f32 v112, v32, v33
v_mfma_f32_16x16x32_bf16 v[0:3], a[200:203], v[136:139], v[0:3]
v_exp_f32 v35, v35
v_mfma_f32_16x16x32_bf16 v[0:3], a[204:207], v[140:143], v[0:3]
ds_read_b64_tr_b16 a[226:227], v220 offset:57344
ds_read_b64_tr_b16 a[228:229], v221 offset:49152
v_mfma_f32_16x16x32_bf16 v[4:7], a[208:211], v[128:131], v[64:67]
v_exp_f32 v36, v36
v_mfma_f32_16x16x32_bf16 v[4:7], a[212:215], v[132:135], v[4:7]
ds_read_b64_tr_b16 a[230:231], v221 offset:57344
v_cvt_pk_bf16_f32 v113, v34, v35
v_mfma_f32_16x16x32_bf16 v[4:7], a[216:219], v[136:139], v[4:7]
v_exp_f32 v37, v37
v_mfma_f32_16x16x32_bf16 v[4:7], a[220:223], v[140:143], v[4:7]
buffer_load_dwordx4 v229, s[12:15], s24 offen offset:1024  lds
v_mfma_f32_16x16x32_bf16 v[8:11], a[192:195], v[144:147], v[68:71]
v_exp_f32 v38, v38
v_mfma_f32_16x16x32_bf16 v[8:11], a[196:199], v[148:151], v[8:11]
ds_read_b64_tr_b16 a[232:233], v222 offset:49152
v_cvt_pk_bf16_f32 v114, v36, v37
v_mfma_f32_16x16x32_bf16 v[8:11], a[200:203], v[152:155], v[8:11]
v_exp_f32 v39, v39
v_mfma_f32_16x16x32_bf16 v[8:11], a[204:207], v[156:159], v[8:11]
ds_read_b64_tr_b16 a[234:235], v222 offset:57344
ds_read_b64_tr_b16 a[236:237], v223 offset:49152
v_mfma_f32_16x16x32_bf16 v[12:15], a[208:211], v[144:147], v[68:71]
v_exp_f32 v40, v40
v_mfma_f32_16x16x32_bf16 v[12:15], a[212:215], v[148:151], v[12:15]
ds_read_b64_tr_b16 a[238:239], v223 offset:57344
v_cvt_pk_bf16_f32 v115, v38, v39
v_mfma_f32_16x16x32_bf16 v[12:15], a[216:219], v[152:155], v[12:15]
v_exp_f32 v41, v41
v_mfma_f32_16x16x32_bf16 v[12:15], a[220:223], v[156:159], v[12:15]
ds_read_b64_tr_b16 a[240:241], v224 offset:49152
ds_read_b64_tr_b16 a[242:243], v224 offset:57344
v_mfma_f32_16x16x32_bf16 v[16:19], a[192:195], v[160:163], v[72:75]
v_exp_f32 v42, v42
v_mfma_f32_16x16x32_bf16 v[16:19], a[196:199], v[164:167], v[16:19]
ds_read_b64_tr_b16 a[244:245], v225 offset:49152
v_cvt_pk_bf16_f32 v116, v40, v41
v_mfma_f32_16x16x32_bf16 v[16:19], a[200:203], v[168:171], v[16:19]
v_exp_f32 v43, v43
v_mfma_f32_16x16x32_bf16 v[16:19], a[204:207], v[172:175], v[16:19]
ds_read_b64_tr_b16 a[246:247], v225 offset:57344
ds_read_b64_tr_b16 a[248:249], v226 offset:49152
v_mfma_f32_16x16x32_bf16 v[20:23], a[208:211], v[160:163], v[72:75]
v_exp_f32 v44, v44
v_mfma_f32_16x16x32_bf16 v[20:23], a[212:215], v[164:167], v[20:23]
ds_read_b64_tr_b16 a[250:251], v226 offset:57344
v_cvt_pk_bf16_f32 v117, v42, v43
v_mfma_f32_16x16x32_bf16 v[20:23], a[216:219], v[168:171], v[20:23]
v_exp_f32 v45, v45
v_mfma_f32_16x16x32_bf16 v[20:23], a[220:223], v[172:175], v[20:23]
buffer_load_dwordx4 v230, s[8:11], s24 offen offset:2048  lds
v_mfma_f32_16x16x32_bf16 v[24:27], a[192:195], v[176:179], v[76:79]
v_exp_f32 v46, v46
v_mfma_f32_16x16x32_bf16 v[24:27], a[196:199], v[180:183], v[24:27]
ds_read_b64_tr_b16 a[252:253], v227 offset:49152
v_cvt_pk_bf16_f32 v118, v44, v45
v_mfma_f32_16x16x32_bf16 v[24:27], a[200:203], v[184:187], v[24:27]
v_exp_f32 v47, v47
v_mfma_f32_16x16x32_bf16 v[24:27], a[204:207], v[188:191], v[24:27]
ds_read_b64_tr_b16 a[254:255], v227 offset:57344
v_mfma_f32_16x16x32_bf16 v[28:31], a[208:211], v[176:179], v[76:79]
v_exp_f32 v48, v48
v_smfmac_f32_16x16x64_bf16 v[80:83], v[232:235], v[96:103], v88
v_cvt_pk_bf16_f32 v119, v46, v47
v_mfma_f32_16x16x32_bf16 v[28:31], a[212:215], v[180:183], v[28:31]
v_exp_f32 v49, v49
v_mfma_f32_16x16x32_bf16 v[28:31], a[216:219], v[184:187], v[28:31]
v_mfma_f32_16x16x32_bf16 v[28:31], a[220:223], v[188:191], v[28:31]
v_exp_f32 v50, v50
v_smfmac_f32_16x16x64_bf16 v[84:87], v[232:235], v[104:111], v88
s_waitcnt lgkmcnt(0)
v_cvt_pk_bf16_f32 v120, v48, v49
v_mfma_f32_16x16x32_bf16 a[0:3], a[224:227], v[96:99], a[0:3]
v_exp_f32 v51, v51
v_mfma_f32_16x16x32_bf16 a[4:7], a[224:227], v[100:103], a[4:7]
v_exp_f32 v52, v52
v_mfma_f32_16x16x32_bf16 a[8:11], a[224:227], v[104:107], a[8:11]
ds_read_b128 a[192:195], v216 offset:49152
v_cvt_pk_bf16_f32 v121, v50, v51
v_mfma_f32_16x16x32_bf16 a[12:15], a[224:227], v[108:111], a[12:15]
v_exp_f32 v53, v53
v_mfma_f32_16x16x32_bf16 a[16:19], a[228:231], v[96:99], a[16:19]
ds_read_b128 a[196:199], v217 offset:49152
ds_read_b128 a[200:203], v218 offset:49152
v_mfma_f32_16x16x32_bf16 a[20:23], a[228:231], v[100:103], a[20:23]
v_exp_f32 v54, v54
v_mfma_f32_16x16x32_bf16 a[24:27], a[228:231], v[104:107], a[24:27]
ds_read_b128 a[204:207], v219 offset:49152
v_cvt_pk_bf16_f32 v122, v52, v53
v_mfma_f32_16x16x32_bf16 a[28:31], a[228:231], v[108:111], a[28:31]
v_exp_f32 v55, v55
v_mfma_f32_16x16x32_bf16 a[32:35], a[232:235], v[96:99], a[32:35]
buffer_load_dwordx4 v231, s[8:11], s24 offen offset:3072  lds
v_mfma_f32_16x16x32_bf16 a[36:39], a[232:235], v[100:103], a[36:39]
s_add_u32 s24, s24, 8192
v_exp_f32 v56, v56
v_mfma_f32_16x16x32_bf16 a[40:43], a[232:235], v[104:107], a[40:43]
ds_read_b128 a[208:211], v216 offset:57344
v_cvt_pk_bf16_f32 v123, v54, v55
v_mfma_f32_16x16x32_bf16 a[44:47], a[232:235], v[108:111], a[44:47]
v_exp_f32 v57, v57
v_mfma_f32_16x16x32_bf16 a[48:51], a[236:239], v[96:99], a[48:51]
ds_read_b128 a[212:215], v217 offset:57344
ds_read_b128 a[216:219], v218 offset:57344
v_mfma_f32_16x16x32_bf16 a[52:55], a[236:239], v[100:103], a[52:55]
v_exp_f32 v58, v58
v_mfma_f32_16x16x32_bf16 a[56:59], a[236:239], v[104:107], a[56:59]
ds_read_b128 a[220:223], v219 offset:57344
v_cvt_pk_bf16_f32 v124, v56, v57
v_mfma_f32_16x16x32_bf16 a[60:63], a[236:239], v[108:111], a[60:63]
v_exp_f32 v59, v59
v_mfma_f32_16x16x32_bf16 a[64:67], a[240:243], v[96:99], a[64:67]
v_mfma_f32_16x16x32_bf16 a[68:71], a[240:243], v[100:103], a[68:71]
v_exp_f32 v60, v60
v_mfma_f32_16x16x32_bf16 a[72:75], a[240:243], v[104:107], a[72:75]
v_cvt_pk_bf16_f32 v125, v58, v59
v_mfma_f32_16x16x32_bf16 a[76:79], a[240:243], v[108:111], a[76:79]
v_exp_f32 v61, v61
v_mfma_f32_16x16x32_bf16 a[80:83], a[244:247], v[96:99], a[80:83]
s_lshl1_add_u32 m0, s26, 49152
v_mfma_f32_16x16x32_bf16 a[84:87], a[244:247], v[100:103], a[84:87]
s_waitcnt vmcnt(8) lgkmcnt(0)
s_barrier
v_mfma_f32_16x16x32_bf16 a[88:91], a[244:247], v[104:107], a[88:91]
buffer_load_dwordx4 v228, s[12:15], s24 offen  lds
v_mfma_f32_16x16x32_bf16 a[92:95], a[244:247], v[108:111], a[92:95]
ds_read_b32 v200, v194 offset:0
ds_read_b32 v201, v194 offset:32
ds_read_b32 v202, v194 offset:64
ds_read_b32 v203, v194 offset:96
v_mfma_f32_16x16x32_bf16 a[96:99], a[248:251], v[96:99], a[96:99]
s_bfe_u32 s37, s2, 0x20001
v_exp_f32 v62, v62
v_mfma_f32_16x16x32_bf16 a[100:103], a[248:251], v[100:103], a[100:103]
v_cvt_pk_bf16_f32 v126, v60, v61
v_mfma_f32_16x16x32_bf16 a[104:107], a[248:251], v[104:107], a[104:107]
s_cmp_eq_u32 s37, 2
s_cselect_b32 s37, 1.0, 0
v_exp_f32 v63, v63
v_mfma_f32_16x16x32_bf16 a[108:111], a[248:251], v[108:111], a[108:111]
v_mfma_f32_16x16x32_bf16 a[112:115], a[252:255], v[96:99], a[112:115]
s_lshl1_add_u32 s36, s55, 29364224
v_exp_f32 v0, v0
v_mfma_f32_16x16x32_bf16 a[116:119], a[252:255], v[100:103], a[116:119]
v_cvt_pk_bf16_f32 v127, v62, v63
v_mfma_f32_16x16x32_bf16 a[120:123], a[252:255], v[104:107], a[120:123]
v_exp_f32 v1, v1
v_mfma_f32_16x16x32_bf16 a[124:127], a[252:255], v[108:111], a[124:127]
Lpad11:
s_cbranch_execz Lwalk0
v_mfma_f32_16x16x32_bf16 v[32:35], a[192:195], v[128:131], v[64:67]
v_exp_f32 v2, v2
v_mfma_f32_16x16x32_bf16 v[32:35], a[196:199], v[132:135], v[32:35]
ds_read_b64_tr_b16 a[224:225], v220 offset:0
v_cvt_pk_bf16_f32 v96, v0, v1
v_mfma_f32_16x16x32_bf16 v[32:35], a[200:203], v[136:139], v[32:35]
s_load_dwordx2 s[96:97], s[0:1], 48
v_exp_f32 v3, v3
v_mfma_f32_16x16x32_bf16 v[32:35], a[204:207], v[140:143], v[32:35]
ds_read_b64_tr_b16 a[226:227], v220 offset:8192
ds_read_b64_tr_b16 a[228:229], v221 offset:0
v_mfma_f32_16x16x32_bf16 v[36:39], a[208:211], v[128:131], v[64:67]
s_mov_b32 s98, 1024
v_exp_f32 v4, v4
v_mfma_f32_16x16x32_bf16 v[36:39], a[212:215], v[132:135], v[36:39]
ds_read_b64_tr_b16 a[230:231], v221 offset:8192
v_cvt_pk_bf16_f32 v97, v2, v3
v_mfma_f32_16x16x32_bf16 v[36:39], a[216:219], v[136:139], v[36:39]
v_exp_f32 v5, v5
v_mfma_f32_16x16x32_bf16 v[36:39], a[220:223], v[140:143], v[36:39]
buffer_load_dwordx4 v229, s[12:15], s24 offen offset:1024  lds
v_mfma_f32_16x16x32_bf16 v[40:43], a[192:195], v[144:147], v[68:71]
v_exp_f32 v6, v6
v_mfma_f32_16x16x32_bf16 v[40:43], a[196:199], v[148:151], v[40:43]
ds_read_b64_tr_b16 a[232:233], v222 offset:0
v_cvt_pk_bf16_f32 v98, v4, v5
v_mfma_f32_16x16x32_bf16 v[40:43], a[200:203], v[152:155], v[40:43]
v_exp_f32 v7, v7
v_mfma_f32_16x16x32_bf16 v[40:43], a[204:207], v[156:159], v[40:43]
ds_read_b64_tr_b16 a[234:235], v222 offset:8192
ds_read_b64_tr_b16 a[236:237], v223 offset:0
v_mfma_f32_16x16x32_bf16 v[44:47], a[208:211], v[144:147], v[68:71]
v_exp_f32 v8, v8
v_mfma_f32_16x16x32_bf16 v[44:47], a[212:215], v[148:151], v[44:47]
ds_read_b64_tr_b16 a[238:239], v223 offset:8192
v_cvt_pk_bf16_f32 v99, v6, v7
v_mfma_f32_16x16x32_bf16 v[44:47], a[216:219], v[152:155], v[44:47]
v_exp_f32 v9, v9
v_mfma_f32_16x16x32_bf16 v[44:47], a[220:223], v[156:159], v[44:47]
ds_read_b64_tr_b16 a[240:241], v224 offset:0
ds_read_b64_tr_b16 a[242:243], v224 offset:8192
v_mfma_f32_16x16x32_bf16 v[48:51], a[192:195], v[160:163], v[72:75]
v_exp_f32 v10, v10
v_mfma_f32_16x16x32_bf16 v[48:51], a[196:199], v[164:167], v[48:51]
ds_read_b64_tr_b16 a[244:245], v225 offset:0
v_cvt_pk_bf16_f32 v100, v8, v9
v_mfma_f32_16x16x32_bf16 v[48:51], a[200:203], v[168:171], v[48:51]
v_exp_f32 v11, v11
v_mfma_f32_16x16x32_bf16 v[48:51], a[204:207], v[172:175], v[48:51]
ds_read_b64_tr_b16 a[246:247], v225 offset:8192
ds_read_b64_tr_b16 a[248:249], v226 offset:0
v_mfma_f32_16x16x32_bf16 v[52:55], a[208:211], v[160:163], v[72:75]
v_exp_f32 v12, v12
v_mfma_f32_16x16x32_bf16 v[52:55], a[212:215], v[164:167], v[52:55]
ds_read_b64_tr_b16 a[250:251], v226 offset:8192
v_cvt_pk_bf16_f32 v101, v10, v11
v_mfma_f32_16x16x32_bf16 v[52:55], a[216:219], v[168:171], v[52:55]
v_exp_f32 v13, v13
v_mfma_f32_16x16x32_bf16 v[52:55], a[220:223], v[172:175], v[52:55]
buffer_load_dwordx4 v230, s[8:11], s24 offen offset:2048  lds
v_mfma_f32_16x16x32_bf16 v[56:59], a[192:195], v[176:179], v[76:79]
v_exp_f32 v14, v14
v_mfma_f32_16x16x32_bf16 v[56:59], a[196:199], v[180:183], v[56:59]
ds_read_b64_tr_b16 a[252:253], v227 offset:0
v_cvt_pk_bf16_f32 v102, v12, v13
v_mfma_f32_16x16x32_bf16 v[56:59], a[200:203], v[184:187], v[56:59]
v_exp_f32 v15, v15
v_mfma_f32_16x16x32_bf16 v[56:59], a[204:207], v[188:191], v[56:59]
ds_read_b64_tr_b16 a[254:255], v227 offset:8192
v_mfma_f32_16x16x32_bf16 v[60:63], a[208:211], v[176:179], v[76:79]
v_exp_f32 v16, v16
v_smfmac_f32_16x16x64_bf16 v[80:83], v[232:235], v[112:119], v88
v_cvt_pk_bf16_f32 v103, v14, v15
v_mfma_f32_16x16x32_bf16 v[60:63], a[212:215], v[180:183], v[60:63]
v_exp_f32 v17, v17
v_mfma_f32_16x16x32_bf16 v[60:63], a[216:219], v[184:187], v[60:63]
v_mfma_f32_16x16x32_bf16 v[60:63], a[220:223], v[188:191], v[60:63]
v_exp_f32 v18, v18
v_smfmac_f32_16x16x64_bf16 v[84:87], v[232:235], v[120:127], v88
s_waitcnt lgkmcnt(0)
v_cvt_pk_bf16_f32 v104, v16, v17
v_mfma_f32_16x16x32_bf16 a[0:3], a[224:227], v[112:115], a[0:3]
v_exp_f32 v19, v19
v_mfma_f32_16x16x32_bf16 a[4:7], a[224:227], v[116:119], a[4:7]
v_exp_f32 v20, v20
v_mfma_f32_16x16x32_bf16 a[8:11], a[224:227], v[120:123], a[8:11]
ds_read_b128 a[192:195], v216 offset:0
v_cvt_pk_bf16_f32 v105, v18, v19
v_mfma_f32_16x16x32_bf16 a[12:15], a[224:227], v[124:127], a[12:15]
v_exp_f32 v21, v21
v_mfma_f32_16x16x32_bf16 a[16:19], a[228:231], v[112:115], a[16:19]
ds_read_b128 a[196:199], v217 offset:0
ds_read_b128 a[200:203], v218 offset:0
v_mfma_f32_16x16x32_bf16 a[20:23], a[228:231], v[116:119], a[20:23]
v_exp_f32 v22, v22
v_mfma_f32_16x16x32_bf16 a[24:27], a[228:231], v[120:123], a[24:27]
ds_read_b128 a[204:207], v219 offset:0
v_cvt_pk_bf16_f32 v106, v20, v21
v_mfma_f32_16x16x32_bf16 a[28:31], a[228:231], v[124:127], a[28:31]
v_exp_f32 v23, v23
v_mfma_f32_16x16x32_bf16 a[32:35], a[232:235], v[112:115], a[32:35]
buffer_load_dwordx4 v231, s[8:11], s24 offen offset:3072  lds
v_mfma_f32_16x16x32_bf16 a[36:39], a[232:235], v[116:119], a[36:39]
s_add_u32 s24, s24, 8192
v_exp_f32 v24, v24
v_mfma_f32_16x16x32_bf16 a[40:43], a[232:235], v[120:123], a[40:43]
ds_read_b128 a[208:211], v216 offset:8192
v_cvt_pk_bf16_f32 v107, v22, v23
v_mfma_f32_16x16x32_bf16 a[44:47], a[232:235], v[124:127], a[44:47]
v_exp_f32 v25, v25
v_mfma_f32_16x16x32_bf16 a[48:51], a[236:239], v[112:115], a[48:51]
ds_read_b128 a[212:215], v217 offset:8192
ds_read_b128 a[216:219], v218 offset:8192
v_mfma_f32_16x16x32_bf16 a[52:55], a[236:239], v[116:119], a[52:55]
v_exp_f32 v26, v26
v_mfma_f32_16x16x32_bf16 a[56:59], a[236:239], v[120:123], a[56:59]
ds_read_b128 a[220:223], v219 offset:8192
v_cvt_pk_bf16_f32 v108, v24, v25
v_mfma_f32_16x16x32_bf16 a[60:63], a[236:239], v[124:127], a[60:63]
v_exp_f32 v27, v27
v_mfma_f32_16x16x32_bf16 a[64:67], a[240:243], v[112:115], a[64:67]
v_add_f32 v200, v200, v201
v_add_f32 v202, v202, v203
v_mfma_f32_16x16x32_bf16 a[68:71], a[240:243], v[116:119], a[68:71]
v_exp_f32 v28, v28
v_mfma_f32_16x16x32_bf16 a[72:75], a[240:243], v[120:123], a[72:75]
v_cvt_pk_bf16_f32 v109, v26, v27
v_add_f32 v200, v200, v202
v_mfma_f32_16x16x32_bf16 a[76:79], a[240:243], v[124:127], a[76:79]
v_exp_f32 v29, v29
v_mfma_f32_16x16x32_bf16 a[80:83], a[244:247], v[112:115], a[80:83]
s_lshl1_add_u32 m0, s26, 0
v_mfma_f32_16x16x32_bf16 a[84:87], a[244:247], v[116:119], a[84:87]
s_waitcnt vmcnt(8) lgkmcnt(0)
s_barrier
v_mfma_f32_16x16x32_bf16 a[88:91], a[244:247], v[120:123], a[88:91]
buffer_load_dwordx4 v228, s[12:15], s24 offen  lds
v_mfma_f32_16x16x32_bf16 a[92:95], a[244:247], v[124:127], a[92:95]
v_cvt_pk_bf16_f32 v200, v200, v200
v_lshlrev_b32 v200, 16, v200
v_mfma_f32_16x16x32_bf16 a[96:99], a[248:251], v[112:115], a[96:99]
v_exp_f32 v30, v30
v_mfma_f32_16x16x32_bf16 a[100:103], a[248:251], v[116:119], a[100:103]
v_cvt_pk_bf16_f32 v110, v28, v29
v_add_f32 v200, s37, v200
v_mfma_f32_16x16x32_bf16 a[104:107], a[248:251], v[120:123], a[104:107]
v_exp_f32 v31, v31
v_mfma_f32_16x16x32_bf16 a[108:111], a[248:251], v[124:127], a[108:111]
v_cvt_pk_bf16_f32 v200, v200, v200
v_lshlrev_b32 v200, 16, v200
v_mfma_f32_16x16x32_bf16 a[112:115], a[252:255], v[112:115], a[112:115]
v_exp_f32 v32, v32
v_mfma_f32_16x16x32_bf16 a[116:119], a[252:255], v[116:119], a[116:119]
v_cvt_pk_bf16_f32 v111, v30, v31
v_mfma_f32_16x16x32_bf16 a[120:123], a[252:255], v[120:123], a[120:123]
v_exp_f32 v33, v33
v_mfma_f32_16x16x32_bf16 a[124:127], a[252:255], v[124:127], a[124:127]
s_or_b32 s37, s27, s32
s_cbranch_scc1 La_noms
s_mov_b64 exec, 0xff
buffer_store_dword v200, v193, s[16:19], s36 offen sc1
s_mov_b64 exec, -1
La_noms:
v_mfma_f32_16x16x32_bf16 v[0:3], a[192:195], v[128:131], v[64:67]
v_exp_f32 v34, v34
v_mfma_f32_16x16x32_bf16 v[0:3], a[196:199], v[132:135], v[0:3]
ds_read_b64_tr_b16 a[224:225], v220 offset:16384
v_cvt_pk_bf16_f32 v112, v32, v33
v_mfma_f32_16x16x32_bf16 v[0:3], a[200:203], v[136:139], v[0:3]
v_exp_f32 v35, v35
v_mfma_f32_16x16x32_bf16 v[0:3], a[204:207], v[140:143], v[0:3]
ds_read_b64_tr_b16 a[226:227], v220 offset:24576
ds_read_b64_tr_b16 a[228:229], v221 offset:16384
v_mfma_f32_16x16x32_bf16 v[4:7], a[208:211], v[128:131], v[64:67]
v_exp_f32 v36, v36
v_mfma_f32_16x16x32_bf16 v[4:7], a[212:215], v[132:135], v[4:7]
ds_read_b64_tr_b16 a[230:231], v221 offset:24576
v_cvt_pk_bf16_f32 v113, v34, v35
v_mfma_f32_16x16x32_bf16 v[4:7], a[216:219], v[136:139], v[4:7]
v_exp_f32 v37, v37
v_mfma_f32_16x16x32_bf16 v[4:7], a[220:223], v[140:143], v[4:7]
buffer_load_dwordx4 v229, s[12:15], s24 offen offset:1024  lds
v_mfma_f32_16x16x32_bf16 v[8:11], a[192:195], v[144:147], v[68:71]
v_exp_f32 v38, v38
v_mfma_f32_16x16x32_bf16 v[8:11], a[196:199], v[148:151], v[8:11]
ds_read_b64_tr_b16 a[232:233], v222 offset:16384
v_cvt_pk_bf16_f32 v114, v36, v37
v_mfma_f32_16x16x32_bf16 v[8:11], a[200:203], v[152:155], v[8:11]
v_exp_f32 v39, v39
v_mfma_f32_16x16x32_bf16 v[8:11], a[204:207], v[156:159], v[8:11]
ds_read_b64_tr_b16 a[234:235], v222 offset:24576
ds_read_b64_tr_b16 a[236:237], v223 offset:16384
v_mfma_f32_16x16x32_bf16 v[12:15], a[208:211], v[144:147], v[68:71]
v_exp_f32 v40, v40
v_mfma_f32_16x16x32_bf16 v[12:15], a[212:215], v[148:151], v[12:15]
ds_read_b64_tr_b16 a[238:239], v223 offset:24576
v_cvt_pk_bf16_f32 v115, v38, v39
v_mfma_f32_16x16x32_bf16 v[12:15], a[216:219], v[152:155], v[12:15]
v_exp_f32 v41, v41
v_mfma_f32_16x16x32_bf16 v[12:15], a[220:223], v[156:159], v[12:15]
ds_read_b64_tr_b16 a[240:241], v224 offset:16384
ds_read_b64_tr_b16 a[242:243], v224 offset:24576
v_mfma_f32_16x16x32_bf16 v[16:19], a[192:195], v[160:163], v[72:75]
v_exp_f32 v42, v42
v_mfma_f32_16x16x32_bf16 v[16:19], a[196:199], v[164:167], v[16:19]
ds_read_b64_tr_b16 a[244:245], v225 offset:16384
v_cvt_pk_bf16_f32 v116, v40, v41
v_mfma_f32_16x16x32_bf16 v[16:19], a[200:203], v[168:171], v[16:19]
v_exp_f32 v43, v43
v_mfma_f32_16x16x32_bf16 v[16:19], a[204:207], v[172:175], v[16:19]
ds_read_b64_tr_b16 a[246:247], v225 offset:24576
ds_read_b64_tr_b16 a[248:249], v226 offset:16384
v_mfma_f32_16x16x32_bf16 v[20:23], a[208:211], v[160:163], v[72:75]
v_exp_f32 v44, v44
v_mfma_f32_16x16x32_bf16 v[20:23], a[212:215], v[164:167], v[20:23]
ds_read_b64_tr_b16 a[250:251], v226 offset:24576
v_cvt_pk_bf16_f32 v117, v42, v43
v_mfma_f32_16x16x32_bf16 v[20:23], a[216:219], v[168:171], v[20:23]
v_exp_f32 v45, v45
v_mfma_f32_16x16x32_bf16 v[20:23], a[220:223], v[172:175], v[20:23]
buffer_load_dwordx4 v230, s[8:11], s24 offen offset:2048  lds
v_mfma_f32_16x16x32_bf16 v[24:27], a[192:195], v[176:179], v[76:79]
v_exp_f32 v46, v46
v_mfma_f32_16x16x32_bf16 v[24:27], a[196:199], v[180:183], v[24:27]
ds_read_b64_tr_b16 a[252:253], v227 offset:16384
v_cvt_pk_bf16_f32 v118, v44, v45
v_mfma_f32_16x16x32_bf16 v[24:27], a[200:203], v[184:187], v[24:27]
v_exp_f32 v47, v47
v_mfma_f32_16x16x32_bf16 v[24:27], a[204:207], v[188:191], v[24:27]
ds_read_b64_tr_b16 a[254:255], v227 offset:24576
v_mfma_f32_16x16x32_bf16 v[28:31], a[208:211], v[176:179], v[76:79]
v_exp_f32 v48, v48
v_smfmac_f32_16x16x64_bf16 v[80:83], v[232:235], v[96:103], v88
v_cvt_pk_bf16_f32 v119, v46, v47
v_mfma_f32_16x16x32_bf16 v[28:31], a[212:215], v[180:183], v[28:31]
v_exp_f32 v49, v49
v_mfma_f32_16x16x32_bf16 v[28:31], a[216:219], v[184:187], v[28:31]
v_mfma_f32_16x16x32_bf16 v[28:31], a[220:223], v[188:191], v[28:31]
v_exp_f32 v50, v50
v_smfmac_f32_16x16x64_bf16 v[84:87], v[232:235], v[104:111], v88
s_waitcnt lgkmcnt(0)
v_cvt_pk_bf16_f32 v120, v48, v49
v_mfma_f32_16x16x32_bf16 a[0:3], a[224:227], v[96:99], a[0:3]
v_exp_f32 v51, v51
v_mfma_f32_16x16x32_bf16 a[4:7], a[224:227], v[100:103], a[4:7]
v_exp_f32 v52, v52
v_mfma_f32_16x16x32_bf16 a[8:11], a[224:227], v[104:107], a[8:11]
ds_read_b128 a[192:195], v216 offset:16384
v_cvt_pk_bf16_f32 v121, v50, v51
v_mfma_f32_16x16x32_bf16 a[12:15], a[224:227], v[108:111], a[12:15]
v_exp_f32 v53, v53
v_mfma_f32_16x16x32_bf16 a[16:19], a[228:231], v[96:99], a[16:19]
ds_read_b128 a[196:199], v217 offset:16384
ds_read_b128 a[200:203], v218 offset:16384
v_mfma_f32_16x16x32_bf16 a[20:23], a[228:231], v[100:103], a[20:23]
v_exp_f32 v54, v54
v_mfma_f32_16x16x32_bf16 a[24:27], a[228:231], v[104:107], a[24:27]
ds_read_b128 a[204:207], v219 offset:16384
v_cvt_pk_bf16_f32 v122, v52, v53
v_mfma_f32_16x16x32_bf16 a[28:31], a[228:231], v[108:111], a[28:31]
v_exp_f32 v55, v55
v_mfma_f32_16x16x32_bf16 a[32:35], a[232:235], v[96:99], a[32:35]
buffer_load_dwordx4 v231, s[8:11], s24 offen offset:3072  lds
v_mfma_f32_16x16x32_bf16 a[36:39], a[232:235], v[100:103], a[36:39]
s_add_u32 s24, s24, 8192
v_exp_f32 v56, v56
v_mfma_f32_16x16x32_bf16 a[40:43], a[232:235], v[104:107], a[40:43]
ds_read_b128 a[208:211], v216 offset:24576
v_cvt_pk_bf16_f32 v123, v54, v55
v_mfma_f32_16x16x32_bf16 a[44:47], a[232:235], v[108:111], a[44:47]
v_exp_f32 v57, v57
v_mfma_f32_16x16x32_bf16 a[48:51], a[236:239], v[96:99], a[48:51]
ds_read_b128 a[212:215], v217 offset:24576
ds_read_b128 a[216:219], v218 offset:24576
v_mfma_f32_16x16x32_bf16 a[52:55], a[236:239], v[100:103], a[52:55]
v_exp_f32 v58, v58
v_mfma_f32_16x16x32_bf16 a[56:59], a[236:239], v[104:107], a[56:59]
ds_read_b128 a[220:223], v219 offset:24576
v_cvt_pk_bf16_f32 v124, v56, v57
v_mfma_f32_16x16x32_bf16 a[60:63], a[236:239], v[108:111], a[60:63]
v_exp_f32 v59, v59
v_mfma_f32_16x16x32_bf16 a[64:67], a[240:243], v[96:99], a[64:67]
v_mfma_f32_16x16x32_bf16 a[68:71], a[240:243], v[100:103], a[68:71]
v_exp_f32 v60, v60
v_mfma_f32_16x16x32_bf16 a[72:75], a[240:243], v[104:107], a[72:75]
v_cvt_pk_bf16_f32 v125, v58, v59
v_mfma_f32_16x16x32_bf16 a[76:79], a[240:243], v[108:111], a[76:79]
v_exp_f32 v61, v61
v_mfma_f32_16x16x32_bf16 a[80:83], a[244:247], v[96:99], a[80:83]
s_lshl1_add_u32 m0, s26, 16384
v_mfma_f32_16x16x32_bf16 a[84:87], a[244:247], v[100:103], a[84:87]
s_waitcnt vmcnt(8) lgkmcnt(0)
s_barrier
v_mfma_f32_16x16x32_bf16 a[88:91], a[244:247], v[104:107], a[88:91]
buffer_load_dwordx4 v228, s[12:15], s24 offen  lds
v_mfma_f32_16x16x32_bf16 a[92:95], a[244:247], v[108:111], a[92:95]
v_mfma_f32_16x16x32_bf16 a[96:99], a[248:251], v[96:99], a[96:99]
v_exp_f32 v62, v62
v_mfma_f32_16x16x32_bf16 a[100:103], a[248:251], v[100:103], a[100:103]
v_cvt_pk_bf16_f32 v126, v60, v61
v_mfma_f32_16x16x32_bf16 a[104:107], a[248:251], v[104:107], a[104:107]
v_exp_f32 v63, v63
v_mfma_f32_16x16x32_bf16 a[108:111], a[248:251], v[108:111], a[108:111]
v_mfma_f32_16x16x32_bf16 a[112:115], a[252:255], v[96:99], a[112:115]
v_exp_f32 v0, v0
v_mfma_f32_16x16x32_bf16 a[116:119], a[252:255], v[100:103], a[116:119]
v_cvt_pk_bf16_f32 v127, v62, v63
v_mfma_f32_16x16x32_bf16 a[120:123], a[252:255], v[104:107], a[120:123]
v_exp_f32 v1, v1
v_mfma_f32_16x16x32_bf16 a[124:127], a[252:255], v[108:111], a[124:127]
v_mfma_f32_16x16x32_bf16 v[32:35], a[192:195], v[128:131], v[64:67]
v_exp_f32 v2, v2
v_mfma_f32_16x16x32_bf16 v[32:35], a[196:199], v[132:135], v[32:35]
ds_read_b64_tr_b16 a[224:225], v220 offset:32768
v_cvt_pk_bf16_f32 v96, v0, v1
v_mfma_f32_16x16x32_bf16 v[32:35], a[200:203], v[136:139], v[32:35]
v_exp_f32 v3, v3
v_mfma_f32_16x16x32_bf16 v[32:35], a[204:207], v[140:143], v[32:35]
ds_read_b64_tr_b16 a[226:227], v220 offset:40960
ds_read_b64_tr_b16 a[228:229], v221 offset:32768
v_mfma_f32_16x16x32_bf16 v[36:39], a[208:211], v[128:131], v[64:67]
v_exp_f32 v4, v4
v_mfma_f32_16x16x32_bf16 v[36:39], a[212:215], v[132:135], v[36:39]
ds_read_b64_tr_b16 a[230:231], v221 offset:40960
v_cvt_pk_bf16_f32 v97, v2, v3
v_mfma_f32_16x16x32_bf16 v[36:39], a[216:219], v[136:139], v[36:39]
v_exp_f32 v5, v5
v_mfma_f32_16x16x32_bf16 v[36:39], a[220:223], v[140:143], v[36:39]
buffer_load_dwordx4 v229, s[12:15], s24 offen offset:1024  lds
v_mfma_f32_16x16x32_bf16 v[40:43], a[192:195], v[144:147], v[68:71]
v_exp_f32 v6, v6
v_mfma_f32_16x16x32_bf16 v[40:43], a[196:199], v[148:151], v[40:43]
ds_read_b64_tr_b16 a[232:233], v222 offset:32768
v_cvt_pk_bf16_f32 v98, v4, v5
v_mfma_f32_16x16x32_bf16 v[40:43], a[200:203], v[152:155], v[40:43]
v_exp_f32 v7, v7
v_mfma_f32_16x16x32_bf16 v[40:43], a[204:207], v[156:159], v[40:43]
ds_read_b64_tr_b16 a[234:235], v222 offset:40960
ds_read_b64_tr_b16 a[236:237], v223 offset:32768
v_mfma_f32_16x16x32_bf16 v[44:47], a[208:211], v[144:147], v[68:71]
v_exp_f32 v8, v8
v_mfma_f32_16x16x32_bf16 v[44:47], a[212:215], v[148:151], v[44:47]
ds_read_b64_tr_b16 a[238:239], v223 offset:40960
v_cvt_pk_bf16_f32 v99, v6, v7
v_mfma_f32_16x16x32_bf16 v[44:47], a[216:219], v[152:155], v[44:47]
v_exp_f32 v9, v9
v_mfma_f32_16x16x32_bf16 v[44:47], a[220:223], v[156:159], v[44:47]
ds_read_b64_tr_b16 a[240:241], v224 offset:32768
ds_read_b64_tr_b16 a[242:243], v224 offset:40960
v_mfma_f32_16x16x32_bf16 v[48:51], a[192:195], v[160:163], v[72:75]
v_exp_f32 v10, v10
v_mfma_f32_16x16x32_bf16 v[48:51], a[196:199], v[164:167], v[48:51]
ds_read_b64_tr_b16 a[244:245], v225 offset:32768
v_cvt_pk_bf16_f32 v100, v8, v9
v_mfma_f32_16x16x32_bf16 v[48:51], a[200:203], v[168:171], v[48:51]
v_exp_f32 v11, v11
v_mfma_f32_16x16x32_bf16 v[48:51], a[204:207], v[172:175], v[48:51]
ds_read_b64_tr_b16 a[246:247], v225 offset:40960
ds_read_b64_tr_b16 a[248:249], v226 offset:32768
v_mfma_f32_16x16x32_bf16 v[52:55], a[208:211], v[160:163], v[72:75]
v_exp_f32 v12, v12
v_mfma_f32_16x16x32_bf16 v[52:55], a[212:215], v[164:167], v[52:55]
ds_read_b64_tr_b16 a[250:251], v226 offset:40960
v_cvt_pk_bf16_f32 v101, v10, v11
v_mfma_f32_16x16x32_bf16 v[52:55], a[216:219], v[168:171], v[52:55]
v_exp_f32 v13, v13
v_mfma_f32_16x16x32_bf16 v[52:55], a[220:223], v[172:175], v[52:55]
buffer_load_dwordx4 v230, s[8:11], s24 offen offset:2048  lds
v_mfma_f32_16x16x32_bf16 v[56:59], a[192:195], v[176:179], v[76:79]
v_exp_f32 v14, v14
v_mfma_f32_16x16x32_bf16 v[56:59], a[196:199], v[180:183], v[56:59]
ds_read_b64_tr_b16 a[252:253], v227 offset:32768
v_cvt_pk_bf16_f32 v102, v12, v13
v_mfma_f32_16x16x32_bf16 v[56:59], a[200:203], v[184:187], v[56:59]
v_exp_f32 v15, v15
v_mfma_f32_16x16x32_bf16 v[56:59], a[204:207], v[188:191], v[56:59]
ds_read_b64_tr_b16 a[254:255], v227 offset:40960
v_mfma_f32_16x16x32_bf16 v[60:63], a[208:211], v[176:179], v[76:79]
v_exp_f32 v16, v16
v_smfmac_f32_16x16x64_bf16 v[80:83], v[232:235], v[112:119], v88
v_cvt_pk_bf16_f32 v103, v14, v15
v_mfma_f32_16x16x32_bf16 v[60:63], a[212:215], v[180:183], v[60:63]
v_exp_f32 v17, v17
v_mfma_f32_16x16x32_bf16 v[60:63], a[216:219], v[184:187], v[60:63]
v_mfma_f32_16x16x32_bf16 v[60:63], a[220:223], v[188:191], v[60:63]
v_exp_f32 v18, v18
v_smfmac_f32_16x16x64_bf16 v[84:87], v[232:235], v[120:127], v88
s_waitcnt lgkmcnt(0)
v_cvt_pk_bf16_f32 v104, v16, v17
v_mfma_f32_16x16x32_bf16 a[0:3], a[224:227], v[112:115], a[0:3]
v_exp_f32 v19, v19
v_mfma_f32_16x16x32_bf16 a[4:7], a[224:227], v[116:119], a[4:7]
v_exp_f32 v20, v20
v_mfma_f32_16x16x32_bf16 a[8:11], a[224:227], v[120:123], a[8:11]
ds_read_b128 a[192:195], v216 offset:32768
v_cvt_pk_bf16_f32 v105, v18, v19
v_mfma_f32_16x16x32_bf16 a[12:15], a[224:227], v[124:127], a[12:15]
v_exp_f32 v21, v21
v_mfma_f32_16x16x32_bf16 a[16:19], a[228:231], v[112:115], a[16:19]
ds_read_b128 a[196:199], v217 offset:32768
ds_read_b128 a[200:203], v218 offset:32768
v_mfma_f32_16x16x32_bf16 a[20:23], a[228:231], v[116:119], a[20:23]
v_exp_f32 v22, v22
v_mfma_f32_16x16x32_bf16 a[24:27], a[228:231], v[120:123], a[24:27]
ds_read_b128 a[204:207], v219 offset:32768
v_cvt_pk_bf16_f32 v106, v20, v21
v_mfma_f32_16x16x32_bf16 a[28:31], a[228:231], v[124:127], a[28:31]
v_exp_f32 v23, v23
v_mfma_f32_16x16x32_bf16 a[32:35], a[232:235], v[112:115], a[32:35]
buffer_load_dwordx4 v231, s[8:11], s24 offen offset:3072  lds
v_mfma_f32_16x16x32_bf16 a[36:39], a[232:235], v[116:119], a[36:39]
s_add_u32 s24, s24, 8192
v_exp_f32 v24, v24
v_mfma_f32_16x16x32_bf16 a[40:43], a[232:235], v[120:123], a[40:43]
ds_read_b128 a[208:211], v216 offset:40960
v_cvt_pk_bf16_f32 v107, v22, v23
v_mfma_f32_16x16x32_bf16 a[44:47], a[232:235], v[124:127], a[44:47]
v_exp_f32 v25, v25
v_mfma_f32_16x16x32_bf16 a[48:51], a[236:239], v[112:115], a[48:51]
ds_read_b128 a[212:215], v217 offset:40960
ds_read_b128 a[216:219], v218 offset:40960
v_mfma_f32_16x16x32_bf16 a[52:55], a[236:239], v[116:119], a[52:55]
v_exp_f32 v26, v26
v_mfma_f32_16x16x32_bf16 a[56:59], a[236:239], v[120:123], a[56:59]
ds_read_b128 a[220:223], v219 offset:40960
v_cvt_pk_bf16_f32 v108, v24, v25
v_mfma_f32_16x16x32_bf16 a[60:63], a[236:239], v[124:127], a[60:63]
v_exp_f32 v27, v27
v_mfma_f32_16x16x32_bf16 a[64:67], a[240:243], v[112:115], a[64:67]
v_mfma_f32_16x16x32_bf16 a[68:71], a[240:243], v[116:119], a[68:71]
v_exp_f32 v28, v28
v_mfma_f32_16x16x32_bf16 a[72:75], a[240:243], v[120:123], a[72:75]
v_cvt_pk_bf16_f32 v109, v26, v27
v_mfma_f32_16x16x32_bf16 a[76:79], a[240:243], v[124:127], a[76:79]
v_exp_f32 v29, v29
v_mfma_f32_16x16x32_bf16 a[80:83], a[244:247], v[112:115], a[80:83]
s_lshl1_add_u32 m0, s26, 32768
v_mfma_f32_16x16x32_bf16 a[84:87], a[244:247], v[116:119], a[84:87]
s_waitcnt vmcnt(8) lgkmcnt(0)
s_barrier
v_mfma_f32_16x16x32_bf16 a[88:91], a[244:247], v[120:123], a[88:91]
buffer_load_dwordx4 v228, s[12:15], s24 offen  lds
v_mfma_f32_16x16x32_bf16 a[92:95], a[244:247], v[124:127], a[92:95]
v_mfma_f32_16x16x32_bf16 a[96:99], a[248:251], v[112:115], a[96:99]
v_exp_f32 v30, v30
v_mfma_f32_16x16x32_bf16 a[100:103], a[248:251], v[116:119], a[100:103]
v_cvt_pk_bf16_f32 v110, v28, v29
v_mfma_f32_16x16x32_bf16 a[104:107], a[248:251], v[120:123], a[104:107]
v_exp_f32 v31, v31
v_mfma_f32_16x16x32_bf16 a[108:111], a[248:251], v[124:127], a[108:111]
v_mfma_f32_16x16x32_bf16 a[112:115], a[252:255], v[112:115], a[112:115]
v_exp_f32 v32, v32
v_mfma_f32_16x16x32_bf16 a[116:119], a[252:255], v[116:119], a[116:119]
v_cvt_pk_bf16_f32 v111, v30, v31
v_mfma_f32_16x16x32_bf16 a[120:123], a[252:255], v[120:123], a[120:123]
v_exp_f32 v33, v33
v_mfma_f32_16x16x32_bf16 a[124:127], a[252:255], v[124:127], a[124:127]
v_mfma_f32_16x16x32_bf16 v[0:3], a[192:195], v[128:131], v[64:67]
v_exp_f32 v34, v34
v_mfma_f32_16x16x32_bf16 v[0:3], a[196:199], v[132:135], v[0:3]
ds_read_b64_tr_b16 a[224:225], v220 offset:49152
v_cvt_pk_bf16_f32 v112, v32, v33
v_mfma_f32_16x16x32_bf16 v[0:3], a[200:203], v[136:139], v[0:3]
v_exp_f32 v35, v35
v_mfma_f32_16x16x32_bf16 v[0:3], a[204:207], v[140:143], v[0:3]
ds_read_b64_tr_b16 a[226:227], v220 offset:57344
ds_read_b64_tr_b16 a[228:229], v221 offset:49152
v_mfma_f32_16x16x32_bf16 v[4:7], a[208:211], v[128:131], v[64:67]
v_exp_f32 v36, v36
v_mfma_f32_16x16x32_bf16 v[4:7], a[212:215], v[132:135], v[4:7]
ds_read_b64_tr_b16 a[230:231], v221 offset:57344
v_cvt_pk_bf16_f32 v113, v34, v35
v_mfma_f32_16x16x32_bf16 v[4:7], a[216:219], v[136:139], v[4:7]
v_exp_f32 v37, v37
v_mfma_f32_16x16x32_bf16 v[4:7], a[220:223], v[140:143], v[4:7]
buffer_load_dwordx4 v229, s[12:15], s24 offen offset:1024  lds
v_mfma_f32_16x16x32_bf16 v[8:11], a[192:195], v[144:147], v[68:71]
v_exp_f32 v38, v38
v_mfma_f32_16x16x32_bf16 v[8:11], a[196:199], v[148:151], v[8:11]
ds_read_b64_tr_b16 a[232:233], v222 offset:49152
v_cvt_pk_bf16_f32 v114, v36, v37
v_mfma_f32_16x16x32_bf16 v[8:11], a[200:203], v[152:155], v[8:11]
v_exp_f32 v39, v39
v_mfma_f32_16x16x32_bf16 v[8:11], a[204:207], v[156:159], v[8:11]
ds_read_b64_tr_b16 a[234:235], v222 offset:57344
ds_read_b64_tr_b16 a[236:237], v223 offset:49152
v_mfma_f32_16x16x32_bf16 v[12:15], a[208:211], v[144:147], v[68:71]
v_exp_f32 v40, v40
v_mfma_f32_16x16x32_bf16 v[12:15], a[212:215], v[148:151], v[12:15]
ds_read_b64_tr_b16 a[238:239], v223 offset:57344
v_cvt_pk_bf16_f32 v115, v38, v39
v_mfma_f32_16x16x32_bf16 v[12:15], a[216:219], v[152:155], v[12:15]
v_exp_f32 v41, v41
v_mfma_f32_16x16x32_bf16 v[12:15], a[220:223], v[156:159], v[12:15]
ds_read_b64_tr_b16 a[240:241], v224 offset:49152
ds_read_b64_tr_b16 a[242:243], v224 offset:57344
v_mfma_f32_16x16x32_bf16 v[16:19], a[192:195], v[160:163], v[72:75]
v_exp_f32 v42, v42
v_mfma_f32_16x16x32_bf16 v[16:19], a[196:199], v[164:167], v[16:19]
ds_read_b64_tr_b16 a[244:245], v225 offset:49152
v_cvt_pk_bf16_f32 v116, v40, v41
v_mfma_f32_16x16x32_bf16 v[16:19], a[200:203], v[168:171], v[16:19]
v_exp_f32 v43, v43
v_mfma_f32_16x16x32_bf16 v[16:19], a[204:207], v[172:175], v[16:19]
ds_read_b64_tr_b16 a[246:247], v225 offset:57344
ds_read_b64_tr_b16 a[248:249], v226 offset:49152
v_mfma_f32_16x16x32_bf16 v[20:23], a[208:211], v[160:163], v[72:75]
v_exp_f32 v44, v44
v_mfma_f32_16x16x32_bf16 v[20:23], a[212:215], v[164:167], v[20:23]
ds_read_b64_tr_b16 a[250:251], v226 offset:57344
v_cvt_pk_bf16_f32 v117, v42, v43
v_mfma_f32_16x16x32_bf16 v[20:23], a[216:219], v[168:171], v[20:23]
v_exp_f32 v45, v45
v_mfma_f32_16x16x32_bf16 v[20:23], a[220:223], v[172:175], v[20:23]
buffer_load_dwordx4 v230, s[8:11], s24 offen offset:2048  lds
v_mfma_f32_16x16x32_bf16 v[24:27], a[192:195], v[176:179], v[76:79]
v_exp_f32 v46, v46
v_mfma_f32_16x16x32_bf16 v[24:27], a[196:199], v[180:183], v[24:27]
ds_read_b64_tr_b16 a[252:253], v227 offset:49152
v_cvt_pk_bf16_f32 v118, v44, v45
v_mfma_f32_16x16x32_bf16 v[24:27], a[200:203], v[184:187], v[24:27]
v_exp_f32 v47, v47
v_mfma_f32_16x16x32_bf16 v[24:27], a[204:207], v[188:191], v[24:27]
ds_read_b64_tr_b16 a[254:255], v227 offset:57344
v_mfma_f32_16x16x32_bf16 v[28:31], a[208:211], v[176:179], v[76:79]
v_exp_f32 v48, v48
v_smfmac_f32_16x16x64_bf16 v[80:83], v[232:235], v[96:103], v88
v_cvt_pk_bf16_f32 v119, v46, v47
v_mfma_f32_16x16x32_bf16 v[28:31], a[212:215], v[180:183], v[28:31]
v_exp_f32 v49, v49
v_mfma_f32_16x16x32_bf16 v[28:31], a[216:219], v[184:187], v[28:31]
v_mfma_f32_16x16x32_bf16 v[28:31], a[220:223], v[188:191], v[28:31]
v_exp_f32 v50, v50
v_smfmac_f32_16x16x64_bf16 v[84:87], v[232:235], v[104:111], v88
s_waitcnt lgkmcnt(0)
v_cvt_pk_bf16_f32 v120, v48, v49
v_mfma_f32_16x16x32_bf16 a[0:3], a[224:227], v[96:99], a[0:3]
v_exp_f32 v51, v51
v_mfma_f32_16x16x32_bf16 a[4:7], a[224:227], v[100:103], a[4:7]
v_exp_f32 v52, v52
v_mfma_f32_16x16x32_bf16 a[8:11], a[224:227], v[104:107], a[8:11]
ds_read_b128 a[192:195], v216 offset:49152
v_cvt_pk_bf16_f32 v121, v50, v51
v_mfma_f32_16x16x32_bf16 a[12:15], a[224:227], v[108:111], a[12:15]
v_exp_f32 v53, v53
v_mfma_f32_16x16x32_bf16 a[16:19], a[228:231], v[96:99], a[16:19]
ds_read_b128 a[196:199], v217 offset:49152
ds_read_b128 a[200:203], v218 offset:49152
v_mfma_f32_16x16x32_bf16 a[20:23], a[228:231], v[100:103], a[20:23]
v_exp_f32 v54, v54
v_mfma_f32_16x16x32_bf16 a[24:27], a[228:231], v[104:107], a[24:27]
ds_read_b128 a[204:207], v219 offset:49152
v_cvt_pk_bf16_f32 v122, v52, v53
v_mfma_f32_16x16x32_bf16 a[28:31], a[228:231], v[108:111], a[28:31]
v_exp_f32 v55, v55
v_mfma_f32_16x16x32_bf16 a[32:35], a[232:235], v[96:99], a[32:35]
buffer_load_dwordx4 v231, s[8:11], s24 offen offset:3072  lds
v_mfma_f32_16x16x32_bf16 a[36:39], a[232:235], v[100:103], a[36:39]
s_add_u32 s24, s24, 8192
v_exp_f32 v56, v56
v_mfma_f32_16x16x32_bf16 a[40:43], a[232:235], v[104:107], a[40:43]
ds_read_b128 a[208:211], v216 offset:57344
v_cvt_pk_bf16_f32 v123, v54, v55
v_mfma_f32_16x16x32_bf16 a[44:47], a[232:235], v[108:111], a[44:47]
v_exp_f32 v57, v57
v_mfma_f32_16x16x32_bf16 a[48:51], a[236:239], v[96:99], a[48:51]
ds_read_b128 a[212:215], v217 offset:57344
ds_read_b128 a[216:219], v218 offset:57344
v_mfma_f32_16x16x32_bf16 a[52:55], a[236:239], v[100:103], a[52:55]
v_exp_f32 v58, v58
v_mfma_f32_16x16x32_bf16 a[56:59], a[236:239], v[104:107], a[56:59]
ds_read_b128 a[220:223], v219 offset:57344
v_cvt_pk_bf16_f32 v124, v56, v57
v_mfma_f32_16x16x32_bf16 a[60:63], a[236:239], v[108:111], a[60:63]
v_exp_f32 v59, v59
v_mfma_f32_16x16x32_bf16 a[64:67], a[240:243], v[96:99], a[64:67]
v_mfma_f32_16x16x32_bf16 a[68:71], a[240:243], v[100:103], a[68:71]
v_exp_f32 v60, v60
v_mfma_f32_16x16x32_bf16 a[72:75], a[240:243], v[104:107], a[72:75]
v_cvt_pk_bf16_f32 v125, v58, v59
v_mfma_f32_16x16x32_bf16 a[76:79], a[240:243], v[108:111], a[76:79]
v_exp_f32 v61, v61
v_mfma_f32_16x16x32_bf16 a[80:83], a[244:247], v[96:99], a[80:83]
s_lshl1_add_u32 m0, s26, 49152
v_mfma_f32_16x16x32_bf16 a[84:87], a[244:247], v[100:103], a[84:87]
Lpad12:
s_cbranch_execz Lwalk0
s_waitcnt vmcnt(8) lgkmcnt(0)
s_barrier
v_mfma_f32_16x16x32_bf16 a[88:91], a[244:247], v[104:107], a[88:91]
buffer_load_dwordx4 v228, s[12:15], s24 offen  lds
v_mfma_f32_16x16x32_bf16 a[92:95], a[244:247], v[108:111], a[92:95]
v_mfma_f32_16x16x32_bf16 a[96:99], a[248:251], v[96:99], a[96:99]
v_exp_f32 v62, v62
v_mfma_f32_16x16x32_bf16 a[100:103], a[248:251], v[100:103], a[100:103]
v_cvt_pk_bf16_f32 v126, v60, v61
v_mfma_f32_16x16x32_bf16 a[104:107], a[248:251], v[104:107], a[104:107]
v_exp_f32 v63, v63
v_mfma_f32_16x16x32_bf16 a[108:111], a[248:251], v[108:111], a[108:111]
v_mfma_f32_16x16x32_bf16 a[112:115], a[252:255], v[96:99], a[112:115]
v_exp_f32 v0, v0
v_mfma_f32_16x16x32_bf16 a[116:119], a[252:255], v[100:103], a[116:119]
v_cvt_pk_bf16_f32 v127, v62, v63
v_mfma_f32_16x16x32_bf16 a[120:123], a[252:255], v[104:107], a[120:123]
v_exp_f32 v1, v1
v_mfma_f32_16x16x32_bf16 a[124:127], a[252:255], v[108:111], a[124:127]
v_mfma_f32_16x16x32_bf16 v[32:35], a[192:195], v[128:131], v[64:67]
v_exp_f32 v2, v2
v_mfma_f32_16x16x32_bf16 v[32:35], a[196:199], v[132:135], v[32:35]
ds_read_b64_tr_b16 a[224:225], v220 offset:0
v_cvt_pk_bf16_f32 v96, v0, v1
v_mfma_f32_16x16x32_bf16 v[32:35], a[200:203], v[136:139], v[32:35]
v_exp_f32 v3, v3
v_mfma_f32_16x16x32_bf16 v[32:35], a[204:207], v[140:143], v[32:35]
ds_read_b64_tr_b16 a[226:227], v220 offset:8192
ds_read_b64_tr_b16 a[228:229], v221 offset:0
v_mfma_f32_16x16x32_bf16 v[36:39], a[208:211], v[128:131], v[64:67]
v_exp_f32 v4, v4
v_mfma_f32_16x16x32_bf16 v[36:39], a[212:215], v[132:135], v[36:39]
ds_read_b64_tr_b16 a[230:231], v221 offset:8192
v_cvt_pk_bf16_f32 v97, v2, v3
v_mfma_f32_16x16x32_bf16 v[36:39], a[216:219], v[136:139], v[36:39]
v_exp_f32 v5, v5
v_mfma_f32_16x16x32_bf16 v[36:39], a[220:223], v[140:143], v[36:39]
buffer_load_dwordx4 v229, s[12:15], s24 offen offset:1024  lds
v_mfma_f32_16x16x32_bf16 v[40:43], a[192:195], v[144:147], v[68:71]
v_exp_f32 v6, v6
v_mfma_f32_16x16x32_bf16 v[40:43], a[196:199], v[148:151], v[40:43]
ds_read_b64_tr_b16 a[232:233], v222 offset:0
v_cvt_pk_bf16_f32 v98, v4, v5
v_mfma_f32_16x16x32_bf16 v[40:43], a[200:203], v[152:155], v[40:43]
v_exp_f32 v7, v7
v_mfma_f32_16x16x32_bf16 v[40:43], a[204:207], v[156:159], v[40:43]
ds_read_b64_tr_b16 a[234:235], v222 offset:8192
ds_read_b64_tr_b16 a[236:237], v223 offset:0
v_mfma_f32_16x16x32_bf16 v[44:47], a[208:211], v[144:147], v[68:71]
v_exp_f32 v8, v8
v_mfma_f32_16x16x32_bf16 v[44:47], a[212:215], v[148:151], v[44:47]
ds_read_b64_tr_b16 a[238:239], v223 offset:8192
v_cvt_pk_bf16_f32 v99, v6, v7
v_mfma_f32_16x16x32_bf16 v[44:47], a[216:219], v[152:155], v[44:47]
v_exp_f32 v9, v9
v_mfma_f32_16x16x32_bf16 v[44:47], a[220:223], v[156:159], v[44:47]
ds_read_b64_tr_b16 a[240:241], v224 offset:0
ds_read_b64_tr_b16 a[242:243], v224 offset:8192
v_mfma_f32_16x16x32_bf16 v[48:51], a[192:195], v[160:163], v[72:75]
v_exp_f32 v10, v10
v_mfma_f32_16x16x32_bf16 v[48:51], a[196:199], v[164:167], v[48:51]
ds_read_b64_tr_b16 a[244:245], v225 offset:0
v_cvt_pk_bf16_f32 v100, v8, v9
v_mfma_f32_16x16x32_bf16 v[48:51], a[200:203], v[168:171], v[48:51]
v_exp_f32 v11, v11
v_mfma_f32_16x16x32_bf16 v[48:51], a[204:207], v[172:175], v[48:51]
ds_read_b64_tr_b16 a[246:247], v225 offset:8192
ds_read_b64_tr_b16 a[248:249], v226 offset:0
v_mfma_f32_16x16x32_bf16 v[52:55], a[208:211], v[160:163], v[72:75]
v_exp_f32 v12, v12
v_mfma_f32_16x16x32_bf16 v[52:55], a[212:215], v[164:167], v[52:55]
ds_read_b64_tr_b16 a[250:251], v226 offset:8192
v_cvt_pk_bf16_f32 v101, v10, v11
v_mfma_f32_16x16x32_bf16 v[52:55], a[216:219], v[168:171], v[52:55]
v_exp_f32 v13, v13
v_mfma_f32_16x16x32_bf16 v[52:55], a[220:223], v[172:175], v[52:55]
buffer_load_dwordx4 v230, s[8:11], s24 offen offset:2048  lds
v_mfma_f32_16x16x32_bf16 v[56:59], a[192:195], v[176:179], v[76:79]
v_exp_f32 v14, v14
v_mfma_f32_16x16x32_bf16 v[56:59], a[196:199], v[180:183], v[56:59]
ds_read_b64_tr_b16 a[252:253], v227 offset:0
v_cvt_pk_bf16_f32 v102, v12, v13
v_mfma_f32_16x16x32_bf16 v[56:59], a[200:203], v[184:187], v[56:59]
v_exp_f32 v15, v15
v_mfma_f32_16x16x32_bf16 v[56:59], a[204:207], v[188:191], v[56:59]
ds_read_b64_tr_b16 a[254:255], v227 offset:8192
v_mfma_f32_16x16x32_bf16 v[60:63], a[208:211], v[176:179], v[76:79]
v_exp_f32 v16, v16
v_smfmac_f32_16x16x64_bf16 v[80:83], v[232:235], v[112:119], v88
v_cvt_pk_bf16_f32 v103, v14, v15
v_mfma_f32_16x16x32_bf16 v[60:63], a[212:215], v[180:183], v[60:63]
v_exp_f32 v17, v17
v_mfma_f32_16x16x32_bf16 v[60:63], a[216:219], v[184:187], v[60:63]
v_mov_b32 v192, 0
v_mov_b32 v193, 1
v_mfma_f32_16x16x32_bf16 v[60:63], a[220:223], v[188:191], v[60:63]
v_exp_f32 v18, v18
v_smfmac_f32_16x16x64_bf16 v[84:87], v[232:235], v[120:127], v88
s_waitcnt lgkmcnt(0)
v_cvt_pk_bf16_f32 v104, v16, v17
v_mfma_f32_16x16x32_bf16 a[0:3], a[224:227], v[112:115], a[0:3]
v_exp_f32 v19, v19
v_mfma_f32_16x16x32_bf16 a[4:7], a[224:227], v[116:119], a[4:7]
v_exp_f32 v20, v20
v_mfma_f32_16x16x32_bf16 a[8:11], a[224:227], v[120:123], a[8:11]
ds_read_b128 a[192:195], v216 offset:0
v_cvt_pk_bf16_f32 v105, v18, v19
v_mfma_f32_16x16x32_bf16 a[12:15], a[224:227], v[124:127], a[12:15]
v_exp_f32 v21, v21
v_mfma_f32_16x16x32_bf16 a[16:19], a[228:231], v[112:115], a[16:19]
ds_read_b128 a[196:199], v217 offset:0
ds_read_b128 a[200:203], v218 offset:0
v_mfma_f32_16x16x32_bf16 a[20:23], a[228:231], v[116:119], a[20:23]
v_exp_f32 v22, v22
v_mfma_f32_16x16x32_bf16 a[24:27], a[228:231], v[120:123], a[24:27]
ds_read_b128 a[204:207], v219 offset:0
v_cvt_pk_bf16_f32 v106, v20, v21
v_mfma_f32_16x16x32_bf16 a[28:31], a[228:231], v[124:127], a[28:31]
v_exp_f32 v23, v23
v_mfma_f32_16x16x32_bf16 a[32:35], a[232:235], v[112:115], a[32:35]
buffer_load_dwordx4 v231, s[8:11], s24 offen offset:3072  lds
v_mfma_f32_16x16x32_bf16 a[36:39], a[232:235], v[116:119], a[36:39]
s_add_u32 s24, s24, 8192
v_exp_f32 v24, v24
v_mfma_f32_16x16x32_bf16 a[40:43], a[232:235], v[120:123], a[40:43]
ds_read_b128 a[208:211], v216 offset:8192
v_cvt_pk_bf16_f32 v107, v22, v23
v_mfma_f32_16x16x32_bf16 a[44:47], a[232:235], v[124:127], a[44:47]
v_exp_f32 v25, v25
v_mfma_f32_16x16x32_bf16 a[48:51], a[236:239], v[112:115], a[48:51]
ds_read_b128 a[212:215], v217 offset:8192
ds_read_b128 a[216:219], v218 offset:8192
v_mfma_f32_16x16x32_bf16 a[52:55], a[236:239], v[116:119], a[52:55]
v_exp_f32 v26, v26
v_mfma_f32_16x16x32_bf16 a[56:59], a[236:239], v[120:123], a[56:59]
ds_read_b128 a[220:223], v219 offset:8192
v_cvt_pk_bf16_f32 v108, v24, v25
v_mfma_f32_16x16x32_bf16 a[60:63], a[236:239], v[124:127], a[60:63]
v_exp_f32 v27, v27
v_mfma_f32_16x16x32_bf16 a[64:67], a[240:243], v[112:115], a[64:67]
v_mfma_f32_16x16x32_bf16 a[68:71], a[240:243], v[116:119], a[68:71]
v_exp_f32 v28, v28
v_mfma_f32_16x16x32_bf16 a[72:75], a[240:243], v[120:123], a[72:75]
v_cvt_pk_bf16_f32 v109, v26, v27
v_mfma_f32_16x16x32_bf16 a[76:79], a[240:243], v[124:127], a[76:79]
v_exp_f32 v29, v29
v_mfma_f32_16x16x32_bf16 a[80:83], a[244:247], v[112:115], a[80:83]
s_lshl1_add_u32 m0, s26, 0
v_mfma_f32_16x16x32_bf16 a[84:87], a[244:247], v[116:119], a[84:87]
s_waitcnt vmcnt(8) lgkmcnt(0)
s_barrier
v_mfma_f32_16x16x32_bf16 a[88:91], a[244:247], v[120:123], a[88:91]
buffer_load_dwordx4 v228, s[12:15], s24 offen  lds
v_mfma_f32_16x16x32_bf16 a[92:95], a[244:247], v[124:127], a[92:95]
s_or_b32 s36, s32, s27
s_cbranch_scc1 La_nox
s_mov_b64 exec, 1
buffer_atomic_add v193, v192, s[88:91], 0 offen offset:128 sc1
s_mov_b64 exec, -1
La_nox:
v_mfma_f32_16x16x32_bf16 a[96:99], a[248:251], v[112:115], a[96:99]
v_exp_f32 v30, v30
v_mfma_f32_16x16x32_bf16 a[100:103], a[248:251], v[116:119], a[100:103]
v_cvt_pk_bf16_f32 v110, v28, v29
v_mfma_f32_16x16x32_bf16 a[104:107], a[248:251], v[120:123], a[104:107]
v_exp_f32 v31, v31
v_mfma_f32_16x16x32_bf16 a[108:111], a[248:251], v[124:127], a[108:111]
v_mfma_f32_16x16x32_bf16 a[112:115], a[252:255], v[112:115], a[112:115]
v_exp_f32 v32, v32
v_mfma_f32_16x16x32_bf16 a[116:119], a[252:255], v[116:119], a[116:119]
v_cvt_pk_bf16_f32 v111, v30, v31
v_mfma_f32_16x16x32_bf16 a[120:123], a[252:255], v[120:123], a[120:123]
v_exp_f32 v33, v33
v_mfma_f32_16x16x32_bf16 a[124:127], a[252:255], v[124:127], a[124:127]
v_mfma_f32_16x16x32_bf16 v[0:3], a[192:195], v[128:131], v[64:67]
v_exp_f32 v34, v34
v_mfma_f32_16x16x32_bf16 v[0:3], a[196:199], v[132:135], v[0:3]
ds_read_b64_tr_b16 a[224:225], v220 offset:16384
v_cvt_pk_bf16_f32 v112, v32, v33
v_mfma_f32_16x16x32_bf16 v[0:3], a[200:203], v[136:139], v[0:3]
v_exp_f32 v35, v35
v_mfma_f32_16x16x32_bf16 v[0:3], a[204:207], v[140:143], v[0:3]
ds_read_b64_tr_b16 a[226:227], v220 offset:24576
ds_read_b64_tr_b16 a[228:229], v221 offset:16384
v_mfma_f32_16x16x32_bf16 v[4:7], a[208:211], v[128:131], v[64:67]
v_exp_f32 v36, v36
v_mfma_f32_16x16x32_bf16 v[4:7], a[212:215], v[132:135], v[4:7]
ds_read_b64_tr_b16 a[230:231], v221 offset:24576
v_cvt_pk_bf16_f32 v113, v34, v35
v_mfma_f32_16x16x32_bf16 v[4:7], a[216:219], v[136:139], v[4:7]
v_exp_f32 v37, v37
v_mfma_f32_16x16x32_bf16 v[4:7], a[220:223], v[140:143], v[4:7]
buffer_load_dwordx4 v229, s[12:15], s24 offen offset:1024  lds
v_mfma_f32_16x16x32_bf16 v[8:11], a[192:195], v[144:147], v[68:71]
v_exp_f32 v38, v38
v_mfma_f32_16x16x32_bf16 v[8:11], a[196:199], v[148:151], v[8:11]
ds_read_b64_tr_b16 a[232:233], v222 offset:16384
v_cvt_pk_bf16_f32 v114, v36, v37
v_mfma_f32_16x16x32_bf16 v[8:11], a[200:203], v[152:155], v[8:11]
v_exp_f32 v39, v39
v_mfma_f32_16x16x32_bf16 v[8:11], a[204:207], v[156:159], v[8:11]
ds_read_b64_tr_b16 a[234:235], v222 offset:24576
ds_read_b64_tr_b16 a[236:237], v223 offset:16384
v_mfma_f32_16x16x32_bf16 v[12:15], a[208:211], v[144:147], v[68:71]
v_exp_f32 v40, v40
v_mfma_f32_16x16x32_bf16 v[12:15], a[212:215], v[148:151], v[12:15]
ds_read_b64_tr_b16 a[238:239], v223 offset:24576
v_cvt_pk_bf16_f32 v115, v38, v39
v_mfma_f32_16x16x32_bf16 v[12:15], a[216:219], v[152:155], v[12:15]
v_exp_f32 v41, v41
v_mfma_f32_16x16x32_bf16 v[12:15], a[220:223], v[156:159], v[12:15]
ds_read_b64_tr_b16 a[240:241], v224 offset:16384
ds_read_b64_tr_b16 a[242:243], v224 offset:24576
v_mfma_f32_16x16x32_bf16 v[16:19], a[192:195], v[160:163], v[72:75]
v_exp_f32 v42, v42
v_mfma_f32_16x16x32_bf16 v[16:19], a[196:199], v[164:167], v[16:19]
ds_read_b64_tr_b16 a[244:245], v225 offset:16384
v_cvt_pk_bf16_f32 v116, v40, v41
v_mfma_f32_16x16x32_bf16 v[16:19], a[200:203], v[168:171], v[16:19]
v_exp_f32 v43, v43
v_mfma_f32_16x16x32_bf16 v[16:19], a[204:207], v[172:175], v[16:19]
ds_read_b64_tr_b16 a[246:247], v225 offset:24576
ds_read_b64_tr_b16 a[248:249], v226 offset:16384
v_mfma_f32_16x16x32_bf16 v[20:23], a[208:211], v[160:163], v[72:75]
v_exp_f32 v44, v44
v_mfma_f32_16x16x32_bf16 v[20:23], a[212:215], v[164:167], v[20:23]
ds_read_b64_tr_b16 a[250:251], v226 offset:24576
v_cvt_pk_bf16_f32 v117, v42, v43
v_mfma_f32_16x16x32_bf16 v[20:23], a[216:219], v[168:171], v[20:23]
v_exp_f32 v45, v45
v_mfma_f32_16x16x32_bf16 v[20:23], a[220:223], v[172:175], v[20:23]
buffer_load_dwordx4 v230, s[8:11], s24 offen offset:2048  lds
v_mfma_f32_16x16x32_bf16 v[24:27], a[192:195], v[176:179], v[76:79]
v_exp_f32 v46, v46
v_mfma_f32_16x16x32_bf16 v[24:27], a[196:199], v[180:183], v[24:27]
ds_read_b64_tr_b16 a[252:253], v227 offset:16384
v_cvt_pk_bf16_f32 v118, v44, v45
v_mfma_f32_16x16x32_bf16 v[24:27], a[200:203], v[184:187], v[24:27]
v_exp_f32 v47, v47
v_mfma_f32_16x16x32_bf16 v[24:27], a[204:207], v[188:191], v[24:27]
ds_read_b64_tr_b16 a[254:255], v227 offset:24576
v_mfma_f32_16x16x32_bf16 v[28:31], a[208:211], v[176:179], v[76:79]
v_exp_f32 v48, v48
v_smfmac_f32_16x16x64_bf16 v[80:83], v[232:235], v[96:103], v88
v_cvt_pk_bf16_f32 v119, v46, v47
v_mfma_f32_16x16x32_bf16 v[28:31], a[212:215], v[180:183], v[28:31]
v_exp_f32 v49, v49
v_mfma_f32_16x16x32_bf16 v[28:31], a[216:219], v[184:187], v[28:31]
v_mfma_f32_16x16x32_bf16 v[28:31], a[220:223], v[188:191], v[28:31]
v_exp_f32 v50, v50
v_smfmac_f32_16x16x64_bf16 v[84:87], v[232:235], v[104:111], v88
s_waitcnt lgkmcnt(0)
v_cvt_pk_bf16_f32 v120, v48, v49
v_mfma_f32_16x16x32_bf16 a[0:3], a[224:227], v[96:99], a[0:3]
v_exp_f32 v51, v51
v_mfma_f32_16x16x32_bf16 a[4:7], a[224:227], v[100:103], a[4:7]
v_exp_f32 v52, v52
v_mfma_f32_16x16x32_bf16 a[8:11], a[224:227], v[104:107], a[8:11]
ds_read_b128 a[192:195], v216 offset:16384
v_cvt_pk_bf16_f32 v121, v50, v51
v_mfma_f32_16x16x32_bf16 a[12:15], a[224:227], v[108:111], a[12:15]
v_exp_f32 v53, v53
v_mfma_f32_16x16x32_bf16 a[16:19], a[228:231], v[96:99], a[16:19]
ds_read_b128 a[196:199], v217 offset:16384
ds_read_b128 a[200:203], v218 offset:16384
v_mfma_f32_16x16x32_bf16 a[20:23], a[228:231], v[100:103], a[20:23]
v_exp_f32 v54, v54
v_mfma_f32_16x16x32_bf16 a[24:27], a[228:231], v[104:107], a[24:27]
ds_read_b128 a[204:207], v219 offset:16384
v_cvt_pk_bf16_f32 v122, v52, v53
v_mfma_f32_16x16x32_bf16 a[28:31], a[228:231], v[108:111], a[28:31]
v_exp_f32 v55, v55
v_mfma_f32_16x16x32_bf16 a[32:35], a[232:235], v[96:99], a[32:35]
buffer_load_dwordx4 v231, s[8:11], s24 offen offset:3072  lds
v_mfma_f32_16x16x32_bf16 a[36:39], a[232:235], v[100:103], a[36:39]
s_add_u32 s24, s24, 8192
v_exp_f32 v56, v56
v_mfma_f32_16x16x32_bf16 a[40:43], a[232:235], v[104:107], a[40:43]
ds_read_b128 a[208:211], v216 offset:24576
v_cvt_pk_bf16_f32 v123, v54, v55
v_mfma_f32_16x16x32_bf16 a[44:47], a[232:235], v[108:111], a[44:47]
v_exp_f32 v57, v57
v_mfma_f32_16x16x32_bf16 a[48:51], a[236:239], v[96:99], a[48:51]
ds_read_b128 a[212:215], v217 offset:24576
ds_read_b128 a[216:219], v218 offset:24576
v_mfma_f32_16x16x32_bf16 a[52:55], a[236:239], v[100:103], a[52:55]
v_exp_f32 v58, v58
v_mfma_f32_16x16x32_bf16 a[56:59], a[236:239], v[104:107], a[56:59]
ds_read_b128 a[220:223], v219 offset:24576
v_cvt_pk_bf16_f32 v124, v56, v57
v_mfma_f32_16x16x32_bf16 a[60:63], a[236:239], v[108:111], a[60:63]
v_exp_f32 v59, v59
v_mfma_f32_16x16x32_bf16 a[64:67], a[240:243], v[96:99], a[64:67]
v_mfma_f32_16x16x32_bf16 a[68:71], a[240:243], v[100:103], a[68:71]
v_exp_f32 v60, v60
v_mfma_f32_16x16x32_bf16 a[72:75], a[240:243], v[104:107], a[72:75]
v_cvt_pk_bf16_f32 v125, v58, v59
v_mfma_f32_16x16x32_bf16 a[76:79], a[240:243], v[108:111], a[76:79]
v_exp_f32 v61, v61
v_mfma_f32_16x16x32_bf16 a[80:83], a[244:247], v[96:99], a[80:83]
s_lshl1_add_u32 m0, s26, 16384
v_mfma_f32_16x16x32_bf16 a[84:87], a[244:247], v[100:103], a[84:87]
s_waitcnt vmcnt(8) lgkmcnt(0)
s_barrier
v_mfma_f32_16x16x32_bf16 a[88:91], a[244:247], v[104:107], a[88:91]
buffer_load_dwordx4 v228, s[12:15], s24 offen  lds
v_mfma_f32_16x16x32_bf16 a[92:95], a[244:247], v[108:111], a[92:95]
v_mfma_f32_16x16x32_bf16 a[96:99], a[248:251], v[96:99], a[96:99]
v_exp_f32 v62, v62
v_mfma_f32_16x16x32_bf16 a[100:103], a[248:251], v[100:103], a[100:103]
v_cvt_pk_bf16_f32 v126, v60, v61
v_mfma_f32_16x16x32_bf16 a[104:107], a[248:251], v[104:107], a[104:107]
v_exp_f32 v63, v63
v_mfma_f32_16x16x32_bf16 a[108:111], a[248:251], v[108:111], a[108:111]
v_mfma_f32_16x16x32_bf16 a[112:115], a[252:255], v[96:99], a[112:115]
v_exp_f32 v0, v0
v_mfma_f32_16x16x32_bf16 a[116:119], a[252:255], v[100:103], a[116:119]
v_cvt_pk_bf16_f32 v127, v62, v63
v_mfma_f32_16x16x32_bf16 a[120:123], a[252:255], v[104:107], a[120:123]
v_exp_f32 v1, v1
v_mfma_f32_16x16x32_bf16 a[124:127], a[252:255], v[108:111], a[124:127]
v_mfma_f32_16x16x32_bf16 v[32:35], a[192:195], v[128:131], v[64:67]
v_exp_f32 v2, v2
v_mfma_f32_16x16x32_bf16 v[32:35], a[196:199], v[132:135], v[32:35]
ds_read_b64_tr_b16 a[224:225], v220 offset:32768
v_cvt_pk_bf16_f32 v96, v0, v1
v_mfma_f32_16x16x32_bf16 v[32:35], a[200:203], v[136:139], v[32:35]
v_exp_f32 v3, v3
v_mfma_f32_16x16x32_bf16 v[32:35], a[204:207], v[140:143], v[32:35]
ds_read_b64_tr_b16 a[226:227], v220 offset:40960
ds_read_b64_tr_b16 a[228:229], v221 offset:32768
v_mfma_f32_16x16x32_bf16 v[36:39], a[208:211], v[128:131], v[64:67]
v_exp_f32 v4, v4
v_mfma_f32_16x16x32_bf16 v[36:39], a[212:215], v[132:135], v[36:39]
ds_read_b64_tr_b16 a[230:231], v221 offset:40960
v_cvt_pk_bf16_f32 v97, v2, v3
v_mfma_f32_16x16x32_bf16 v[36:39], a[216:219], v[136:139], v[36:39]
v_exp_f32 v5, v5
v_mfma_f32_16x16x32_bf16 v[36:39], a[220:223], v[140:143], v[36:39]
buffer_load_dwordx4 v229, s[12:15], s24 offen offset:1024  lds
v_mfma_f32_16x16x32_bf16 v[40:43], a[192:195], v[144:147], v[68:71]
v_exp_f32 v6, v6
v_mfma_f32_16x16x32_bf16 v[40:43], a[196:199], v[148:151], v[40:43]
ds_read_b64_tr_b16 a[232:233], v222 offset:32768
v_cvt_pk_bf16_f32 v98, v4, v5
v_mfma_f32_16x16x32_bf16 v[40:43], a[200:203], v[152:155], v[40:43]
v_exp_f32 v7, v7
v_mfma_f32_16x16x32_bf16 v[40:43], a[204:207], v[156:159], v[40:43]
ds_read_b64_tr_b16 a[234:235], v222 offset:40960
ds_read_b64_tr_b16 a[236:237], v223 offset:32768
v_mfma_f32_16x16x32_bf16 v[44:47], a[208:211], v[144:147], v[68:71]
v_exp_f32 v8, v8
v_mfma_f32_16x16x32_bf16 v[44:47], a[212:215], v[148:151], v[44:47]
ds_read_b64_tr_b16 a[238:239], v223 offset:40960
v_cvt_pk_bf16_f32 v99, v6, v7
v_mfma_f32_16x16x32_bf16 v[44:47], a[216:219], v[152:155], v[44:47]
v_exp_f32 v9, v9
v_mfma_f32_16x16x32_bf16 v[44:47], a[220:223], v[156:159], v[44:47]
ds_read_b64_tr_b16 a[240:241], v224 offset:32768
ds_read_b64_tr_b16 a[242:243], v224 offset:40960
v_mfma_f32_16x16x32_bf16 v[48:51], a[192:195], v[160:163], v[72:75]
v_exp_f32 v10, v10
v_mfma_f32_16x16x32_bf16 v[48:51], a[196:199], v[164:167], v[48:51]
ds_read_b64_tr_b16 a[244:245], v225 offset:32768
v_cvt_pk_bf16_f32 v100, v8, v9
v_mfma_f32_16x16x32_bf16 v[48:51], a[200:203], v[168:171], v[48:51]
v_exp_f32 v11, v11
v_mfma_f32_16x16x32_bf16 v[48:51], a[204:207], v[172:175], v[48:51]
ds_read_b64_tr_b16 a[246:247], v225 offset:40960
ds_read_b64_tr_b16 a[248:249], v226 offset:32768
v_mfma_f32_16x16x32_bf16 v[52:55], a[208:211], v[160:163], v[72:75]
v_exp_f32 v12, v12
v_mfma_f32_16x16x32_bf16 v[52:55], a[212:215], v[164:167], v[52:55]
ds_read_b64_tr_b16 a[250:251], v226 offset:40960
v_cvt_pk_bf16_f32 v101, v10, v11
v_mfma_f32_16x16x32_bf16 v[52:55], a[216:219], v[168:171], v[52:55]
v_exp_f32 v13, v13
v_mfma_f32_16x16x32_bf16 v[52:55], a[220:223], v[172:175], v[52:55]
buffer_load_dwordx4 v230, s[8:11], s24 offen offset:2048  lds
v_mfma_f32_16x16x32_bf16 v[56:59], a[192:195], v[176:179], v[76:79]
v_exp_f32 v14, v14
v_mfma_f32_16x16x32_bf16 v[56:59], a[196:199], v[180:183], v[56:59]
ds_read_b64_tr_b16 a[252:253], v227 offset:32768
v_cvt_pk_bf16_f32 v102, v12, v13
v_mfma_f32_16x16x32_bf16 v[56:59], a[200:203], v[184:187], v[56:59]
v_exp_f32 v15, v15
v_mfma_f32_16x16x32_bf16 v[56:59], a[204:207], v[188:191], v[56:59]
ds_read_b64_tr_b16 a[254:255], v227 offset:40960
v_mfma_f32_16x16x32_bf16 v[60:63], a[208:211], v[176:179], v[76:79]
v_exp_f32 v16, v16
v_smfmac_f32_16x16x64_bf16 v[80:83], v[232:235], v[112:119], v88
v_cvt_pk_bf16_f32 v103, v14, v15
v_mfma_f32_16x16x32_bf16 v[60:63], a[212:215], v[180:183], v[60:63]
v_exp_f32 v17, v17
v_mfma_f32_16x16x32_bf16 v[60:63], a[216:219], v[184:187], v[60:63]
v_mfma_f32_16x16x32_bf16 v[60:63], a[220:223], v[188:191], v[60:63]
v_exp_f32 v18, v18
v_smfmac_f32_16x16x64_bf16 v[84:87], v[232:235], v[120:127], v88
s_waitcnt lgkmcnt(0)
v_cvt_pk_bf16_f32 v104, v16, v17
v_mfma_f32_16x16x32_bf16 a[0:3], a[224:227], v[112:115], a[0:3]
v_exp_f32 v19, v19
v_mfma_f32_16x16x32_bf16 a[4:7], a[224:227], v[116:119], a[4:7]
s_lshr_b32 s3, s2, 3
v_exp_f32 v20, v20
v_mfma_f32_16x16x32_bf16 a[8:11], a[224:227], v[120:123], a[8:11]
ds_read_b128 a[192:195], v216 offset:32768
v_cvt_pk_bf16_f32 v105, v18, v19
v_mfma_f32_16x16x32_bf16 a[12:15], a[224:227], v[124:127], a[12:15]
s_lshl2_add_u32 s3, s3, s27
v_exp_f32 v21, v21
v_mfma_f32_16x16x32_bf16 a[16:19], a[228:231], v[112:115], a[16:19]
ds_read_b128 a[196:199], v217 offset:32768
ds_read_b128 a[200:203], v218 offset:32768
v_mfma_f32_16x16x32_bf16 a[20:23], a[228:231], v[116:119], a[20:23]
s_mul_i32 s3, s3, 384
v_exp_f32 v22, v22
v_mfma_f32_16x16x32_bf16 a[24:27], a[228:231], v[120:123], a[24:27]
ds_read_b128 a[204:207], v219 offset:32768
v_cvt_pk_bf16_f32 v106, v20, v21
v_mfma_f32_16x16x32_bf16 a[28:31], a[228:231], v[124:127], a[28:31]
s_add_u32 s3, s3, 6144
v_exp_f32 v23, v23
v_mfma_f32_16x16x32_bf16 a[32:35], a[232:235], v[112:115], a[32:35]
buffer_load_dwordx4 v231, s[8:11], s24 offen offset:3072  lds
v_mfma_f32_16x16x32_bf16 a[36:39], a[232:235], v[116:119], a[36:39]
s_add_u32 s24, s24, 8192
v_exp_f32 v24, v24
v_mfma_f32_16x16x32_bf16 a[40:43], a[232:235], v[120:123], a[40:43]
ds_read_b128 a[208:211], v216 offset:40960
v_cvt_pk_bf16_f32 v107, v22, v23
v_mfma_f32_16x16x32_bf16 a[44:47], a[232:235], v[124:127], a[44:47]
v_exp_f32 v25, v25
v_mfma_f32_16x16x32_bf16 a[48:51], a[236:239], v[112:115], a[48:51]
ds_read_b128 a[212:215], v217 offset:40960
ds_read_b128 a[216:219], v218 offset:40960
v_mfma_f32_16x16x32_bf16 a[52:55], a[236:239], v[116:119], a[52:55]
v_exp_f32 v26, v26
v_mfma_f32_16x16x32_bf16 a[56:59], a[236:239], v[120:123], a[56:59]
ds_read_b128 a[220:223], v219 offset:40960
v_cvt_pk_bf16_f32 v108, v24, v25
v_mfma_f32_16x16x32_bf16 a[60:63], a[236:239], v[124:127], a[60:63]
v_exp_f32 v27, v27
v_mfma_f32_16x16x32_bf16 a[64:67], a[240:243], v[112:115], a[64:67]
v_mfma_f32_16x16x32_bf16 a[68:71], a[240:243], v[116:119], a[68:71]
v_exp_f32 v28, v28
v_mfma_f32_16x16x32_bf16 a[72:75], a[240:243], v[120:123], a[72:75]
v_cvt_pk_bf16_f32 v109, v26, v27
v_lshl_add_u32 v214, v248, 7, s3
v_mfma_f32_16x16x32_bf16 a[76:79], a[240:243], v[124:127], a[76:79]
v_exp_f32 v29, v29
v_mfma_f32_16x16x32_bf16 a[80:83], a[244:247], v[112:115], a[80:83]
s_lshl1_add_u32 m0, s26, 32768
v_mfma_f32_16x16x32_bf16 a[84:87], a[244:247], v[116:119], a[84:87]
s_waitcnt vmcnt(8) lgkmcnt(0)
s_barrier
v_mfma_f32_16x16x32_bf16 a[88:91], a[244:247], v[120:123], a[88:91]
buffer_load_dwordx4 v228, s[12:15], s24 offen  lds
v_mfma_f32_16x16x32_bf16 a[92:95], a[244:247], v[124:127], a[92:95]
v_mfma_f32_16x16x32_bf16 a[96:99], a[248:251], v[112:115], a[96:99]
v_exp_f32 v30, v30
v_mfma_f32_16x16x32_bf16 a[100:103], a[248:251], v[116:119], a[100:103]
v_cvt_pk_bf16_f32 v110, v28, v29
v_min_u32 v214, La_last-La_pc0, v214
v_mfma_f32_16x16x32_bf16 a[104:107], a[248:251], v[120:123], a[104:107]
v_exp_f32 v31, v31
v_mfma_f32_16x16x32_bf16 a[108:111], a[248:251], v[124:127], a[108:111]
v_mfma_f32_16x16x32_bf16 a[112:115], a[252:255], v[112:115], a[112:115]
v_exp_f32 v32, v32
v_mfma_f32_16x16x32_bf16 a[116:119], a[252:255], v[116:119], a[116:119]
v_cvt_pk_bf16_f32 v111, v30, v31
v_mfma_f32_16x16x32_bf16 a[120:123], a[252:255], v[120:123], a[120:123]
s_getpc_b64 vcc
La_pc0:
v_exp_f32 v33, v33
v_mfma_f32_16x16x32_bf16 a[124:127], a[252:255], v[124:127], a[124:127]
s_mov_b32 exec_lo, 0x7
s_mov_b32 exec_hi, 0x0
global_load_dword v215, v214, vcc
s_mov_b64 exec, -1
v_mfma_f32_16x16x32_bf16 v[0:3], a[192:195], v[128:131], v[64:67]
v_exp_f32 v34, v34
v_mfma_f32_16x16x32_bf16 v[0:3], a[196:199], v[132:135], v[0:3]
ds_read_b64_tr_b16 a[224:225], v220 offset:49152
v_cvt_pk_bf16_f32 v112, v32, v33
v_mfma_f32_16x16x32_bf16 v[0:3], a[200:203], v[136:139], v[0:3]
v_exp_f32 v35, v35
v_mfma_f32_16x16x32_bf16 v[0:3], a[204:207], v[140:143], v[0:3]
ds_read_b64_tr_b16 a[226:227], v220 offset:57344
ds_read_b64_tr_b16 a[228:229], v221 offset:49152
v_mfma_f32_16x16x32_bf16 v[4:7], a[208:211], v[128:131], v[64:67]
v_exp_f32 v36, v36
v_mfma_f32_16x16x32_bf16 v[4:7], a[212:215], v[132:135], v[4:7]
ds_read_b64_tr_b16 a[230:231], v221 offset:57344
v_cvt_pk_bf16_f32 v113, v34, v35
v_mfma_f32_16x16x32_bf16 v[4:7], a[216:219], v[136:139], v[4:7]
v_exp_f32 v37, v37
v_mfma_f32_16x16x32_bf16 v[4:7], a[220:223], v[140:143], v[4:7]
buffer_load_dwordx4 v229, s[12:15], s24 offen offset:1024  lds
v_mfma_f32_16x16x32_bf16 v[8:11], a[192:195], v[144:147], v[68:71]
v_exp_f32 v38, v38
v_mfma_f32_16x16x32_bf16 v[8:11], a[196:199], v[148:151], v[8:11]
ds_read_b64_tr_b16 a[232:233], v222 offset:49152
v_cvt_pk_bf16_f32 v114, v36, v37
v_mfma_f32_16x16x32_bf16 v[8:11], a[200:203], v[152:155], v[8:11]
v_exp_f32 v39, v39
v_mfma_f32_16x16x32_bf16 v[8:11], a[204:207], v[156:159], v[8:11]
ds_read_b64_tr_b16 a[234:235], v222 offset:57344
ds_read_b64_tr_b16 a[236:237], v223 offset:49152
v_mfma_f32_16x16x32_bf16 v[12:15], a[208:211], v[144:147], v[68:71]
v_exp_f32 v40, v40
v_mfma_f32_16x16x32_bf16 v[12:15], a[212:215], v[148:151], v[12:15]
ds_read_b64_tr_b16 a[238:239], v223 offset:57344
v_cvt_pk_bf16_f32 v115, v38, v39
v_mfma_f32_16x16x32_bf16 v[12:15], a[216:219], v[152:155], v[12:15]
v_exp_f32 v41, v41
v_mfma_f32_16x16x32_bf16 v[12:15], a[220:223], v[156:159], v[12:15]
ds_read_b64_tr_b16 a[240:241], v224 offset:49152
ds_read_b64_tr_b16 a[242:243], v224 offset:57344
v_mfma_f32_16x16x32_bf16 v[16:19], a[192:195], v[160:163], v[72:75]
v_exp_f32 v42, v42
v_mfma_f32_16x16x32_bf16 v[16:19], a[196:199], v[164:167], v[16:19]
ds_read_b64_tr_b16 a[244:245], v225 offset:49152
v_cvt_pk_bf16_f32 v116, v40, v41
v_mfma_f32_16x16x32_bf16 v[16:19], a[200:203], v[168:171], v[16:19]
v_exp_f32 v43, v43
v_mfma_f32_16x16x32_bf16 v[16:19], a[204:207], v[172:175], v[16:19]
ds_read_b64_tr_b16 a[246:247], v225 offset:57344
ds_read_b64_tr_b16 a[248:249], v226 offset:49152
v_mfma_f32_16x16x32_bf16 v[20:23], a[208:211], v[160:163], v[72:75]
v_exp_f32 v44, v44
v_mfma_f32_16x16x32_bf16 v[20:23], a[212:215], v[164:167], v[20:23]
ds_read_b64_tr_b16 a[250:251], v226 offset:57344
v_cvt_pk_bf16_f32 v117, v42, v43
v_mfma_f32_16x16x32_bf16 v[20:23], a[216:219], v[168:171], v[20:23]
v_exp_f32 v45, v45
v_mfma_f32_16x16x32_bf16 v[20:23], a[220:223], v[172:175], v[20:23]
buffer_load_dwordx4 v230, s[8:11], s24 offen offset:2048  lds
v_mfma_f32_16x16x32_bf16 v[24:27], a[192:195], v[176:179], v[76:79]
v_exp_f32 v46, v46
v_mfma_f32_16x16x32_bf16 v[24:27], a[196:199], v[180:183], v[24:27]
ds_read_b64_tr_b16 a[252:253], v227 offset:49152
v_cvt_pk_bf16_f32 v118, v44, v45
v_mfma_f32_16x16x32_bf16 v[24:27], a[200:203], v[184:187], v[24:27]
v_exp_f32 v47, v47
v_mfma_f32_16x16x32_bf16 v[24:27], a[204:207], v[188:191], v[24:27]
ds_read_b64_tr_b16 a[254:255], v227 offset:57344
v_mfma_f32_16x16x32_bf16 v[28:31], a[208:211], v[176:179], v[76:79]
v_exp_f32 v48, v48
v_smfmac_f32_16x16x64_bf16 v[80:83], v[232:235], v[96:103], v88
v_cvt_pk_bf16_f32 v119, v46, v47
v_mfma_f32_16x16x32_bf16 v[28:31], a[212:215], v[180:183], v[28:31]
v_exp_f32 v49, v49
v_mfma_f32_16x16x32_bf16 v[28:31], a[216:219], v[184:187], v[28:31]
v_mfma_f32_16x16x32_bf16 v[28:31], a[220:223], v[188:191], v[28:31]
v_exp_f32 v50, v50
v_smfmac_f32_16x16x64_bf16 v[84:87], v[232:235], v[104:111], v88
s_waitcnt lgkmcnt(0)
v_cvt_pk_bf16_f32 v120, v48, v49
v_mfma_f32_16x16x32_bf16 a[0:3], a[224:227], v[96:99], a[0:3]
v_exp_f32 v51, v51
v_mfma_f32_16x16x32_bf16 a[4:7], a[224:227], v[100:103], a[4:7]
v_exp_f32 v52, v52
v_mfma_f32_16x16x32_bf16 a[8:11], a[224:227], v[104:107], a[8:11]
ds_read_b128 a[192:195], v216 offset:49152
v_cvt_pk_bf16_f32 v121, v50, v51
v_mfma_f32_16x16x32_bf16 a[12:15], a[224:227], v[108:111], a[12:15]
v_exp_f32 v53, v53
v_mfma_f32_16x16x32_bf16 a[16:19], a[228:231], v[96:99], a[16:19]
ds_read_b128 a[196:199], v217 offset:49152
ds_read_b128 a[200:203], v218 offset:49152
v_mfma_f32_16x16x32_bf16 a[20:23], a[228:231], v[100:103], a[20:23]
v_exp_f32 v54, v54
v_mfma_f32_16x16x32_bf16 a[24:27], a[228:231], v[104:107], a[24:27]
ds_read_b128 a[204:207], v219 offset:49152
v_cvt_pk_bf16_f32 v122, v52, v53
v_mfma_f32_16x16x32_bf16 a[28:31], a[228:231], v[108:111], a[28:31]
v_exp_f32 v55, v55
v_mfma_f32_16x16x32_bf16 a[32:35], a[232:235], v[96:99], a[32:35]
buffer_load_dwordx4 v231, s[8:11], s24 offen offset:3072  lds
v_mfma_f32_16x16x32_bf16 a[36:39], a[232:235], v[100:103], a[36:39]
s_add_u32 s24, s24, 8192
v_exp_f32 v56, v56
v_mfma_f32_16x16x32_bf16 a[40:43], a[232:235], v[104:107], a[40:43]
ds_read_b128 a[208:211], v216 offset:57344
v_cvt_pk_bf16_f32 v123, v54, v55
v_mfma_f32_16x16x32_bf16 a[44:47], a[232:235], v[108:111], a[44:47]
Lpad13:
s_cbranch_execz Lwalk0
v_exp_f32 v57, v57
v_mfma_f32_16x16x32_bf16 a[48:51], a[236:239], v[96:99], a[48:51]
ds_read_b128 a[212:215], v217 offset:57344
ds_read_b128 a[216:219], v218 offset:57344
v_mfma_f32_16x16x32_bf16 a[52:55], a[236:239], v[100:103], a[52:55]
v_exp_f32 v58, v58
v_mfma_f32_16x16x32_bf16 a[56:59], a[236:239], v[104:107], a[56:59]
ds_read_b128 a[220:223], v219 offset:57344
v_cvt_pk_bf16_f32 v124, v56, v57
v_mfma_f32_16x16x32_bf16 a[60:63], a[236:239], v[108:111], a[60:63]
v_exp_f32 v59, v59
v_mfma_f32_16x16x32_bf16 a[64:67], a[240:243], v[96:99], a[64:67]
v_mfma_f32_16x16x32_bf16 a[68:71], a[240:243], v[100:103], a[68:71]
v_exp_f32 v60, v60
v_mfma_f32_16x16x32_bf16 a[72:75], a[240:243], v[104:107], a[72:75]
v_cvt_pk_bf16_f32 v125, v58, v59
v_mfma_f32_16x16x32_bf16 a[76:79], a[240:243], v[108:111], a[76:79]
v_exp_f32 v61, v61
v_mfma_f32_16x16x32_bf16 a[80:83], a[244:247], v[96:99], a[80:83]
s_lshl1_add_u32 m0, s26, 49152
v_mfma_f32_16x16x32_bf16 a[84:87], a[244:247], v[100:103], a[84:87]
s_waitcnt vmcnt(9) lgkmcnt(0)
s_barrier
v_mfma_f32_16x16x32_bf16 a[88:91], a[244:247], v[104:107], a[88:91]
buffer_load_dwordx4 v228, s[12:15], s24 offen  lds
v_mfma_f32_16x16x32_bf16 a[92:95], a[244:247], v[108:111], a[92:95]
v_mfma_f32_16x16x32_bf16 a[96:99], a[248:251], v[96:99], a[96:99]
v_exp_f32 v62, v62
v_mfma_f32_16x16x32_bf16 a[100:103], a[248:251], v[100:103], a[100:103]
v_cvt_pk_bf16_f32 v126, v60, v61
v_mfma_f32_16x16x32_bf16 a[104:107], a[248:251], v[104:107], a[104:107]
v_exp_f32 v63, v63
v_mfma_f32_16x16x32_bf16 a[108:111], a[248:251], v[108:111], a[108:111]
v_mfma_f32_16x16x32_bf16 a[112:115], a[252:255], v[96:99], a[112:115]
v_exp_f32 v0, v0
v_mfma_f32_16x16x32_bf16 a[116:119], a[252:255], v[100:103], a[116:119]
v_cvt_pk_bf16_f32 v127, v62, v63
v_mfma_f32_16x16x32_bf16 a[120:123], a[252:255], v[104:107], a[120:123]
v_exp_f32 v1, v1
v_mfma_f32_16x16x32_bf16 a[124:127], a[252:255], v[108:111], a[124:127]
v_mfma_f32_16x16x32_bf16 v[32:35], a[192:195], v[128:131], v[64:67]
v_exp_f32 v2, v2
v_mfma_f32_16x16x32_bf16 v[32:35], a[196:199], v[132:135], v[32:35]
ds_read_b64_tr_b16 a[224:225], v220 offset:0
v_cvt_pk_bf16_f32 v96, v0, v1
v_mfma_f32_16x16x32_bf16 v[32:35], a[200:203], v[136:139], v[32:35]
s_lshl2_add_u32 s31, s100, s27
v_exp_f32 v3, v3
v_mfma_f32_16x16x32_bf16 v[32:35], a[204:207], v[140:143], v[32:35]
ds_read_b64_tr_b16 a[226:227], v220 offset:8192
ds_read_b64_tr_b16 a[228:229], v221 offset:0
v_mfma_f32_16x16x32_bf16 v[36:39], a[208:211], v[128:131], v[64:67]
s_lshl_b32 s34, s31, 14
v_exp_f32 v4, v4
v_mfma_f32_16x16x32_bf16 v[36:39], a[212:215], v[132:135], v[36:39]
ds_read_b64_tr_b16 a[230:231], v221 offset:8192
v_cvt_pk_bf16_f32 v97, v2, v3
v_mfma_f32_16x16x32_bf16 v[36:39], a[216:219], v[136:139], v[36:39]
s_lshl_b32 s35, s101, 7
v_exp_f32 v5, v5
v_mfma_f32_16x16x32_bf16 v[36:39], a[220:223], v[140:143], v[36:39]
buffer_load_dwordx4 v229, s[12:15], s24 offen offset:1024  lds
v_mfma_f32_16x16x32_bf16 v[40:43], a[192:195], v[144:147], v[68:71]
s_add_u32 s34, s34, s35
v_exp_f32 v6, v6
v_mfma_f32_16x16x32_bf16 v[40:43], a[196:199], v[148:151], v[40:43]
ds_read_b64_tr_b16 a[232:233], v222 offset:0
v_cvt_pk_bf16_f32 v98, v4, v5
v_mfma_f32_16x16x32_bf16 v[40:43], a[200:203], v[152:155], v[40:43]
s_lshl_b32 s25, s31, 7
v_exp_f32 v7, v7
v_mfma_f32_16x16x32_bf16 v[40:43], a[204:207], v[156:159], v[40:43]
ds_read_b64_tr_b16 a[234:235], v222 offset:8192
ds_read_b64_tr_b16 a[236:237], v223 offset:0
v_mfma_f32_16x16x32_bf16 v[44:47], a[208:211], v[144:147], v[68:71]
s_add_u32 s25, s25, 30408704
v_exp_f32 v8, v8
v_mfma_f32_16x16x32_bf16 v[44:47], a[212:215], v[148:151], v[44:47]
ds_read_b64_tr_b16 a[238:239], v223 offset:8192
v_cvt_pk_bf16_f32 v99, v6, v7
v_mfma_f32_16x16x32_bf16 v[44:47], a[216:219], v[152:155], v[44:47]
v_exp_f32 v9, v9
v_mfma_f32_16x16x32_bf16 v[44:47], a[220:223], v[156:159], v[44:47]
ds_read_b64_tr_b16 a[240:241], v224 offset:0
ds_read_b64_tr_b16 a[242:243], v224 offset:8192
v_mfma_f32_16x16x32_bf16 v[48:51], a[192:195], v[160:163], v[72:75]
v_exp_f32 v10, v10
v_mfma_f32_16x16x32_bf16 v[48:51], a[196:199], v[164:167], v[48:51]
ds_read_b64_tr_b16 a[244:245], v225 offset:0
v_cvt_pk_bf16_f32 v100, v8, v9
v_mfma_f32_16x16x32_bf16 v[48:51], a[200:203], v[168:171], v[48:51]
v_exp_f32 v11, v11
v_mfma_f32_16x16x32_bf16 v[48:51], a[204:207], v[172:175], v[48:51]
ds_read_b64_tr_b16 a[246:247], v225 offset:8192
ds_read_b64_tr_b16 a[248:249], v226 offset:0
v_mfma_f32_16x16x32_bf16 v[52:55], a[208:211], v[160:163], v[72:75]
v_exp_f32 v12, v12
v_mfma_f32_16x16x32_bf16 v[52:55], a[212:215], v[164:167], v[52:55]
ds_read_b64_tr_b16 a[250:251], v226 offset:8192
v_cvt_pk_bf16_f32 v101, v10, v11
v_mfma_f32_16x16x32_bf16 v[52:55], a[216:219], v[168:171], v[52:55]
v_exp_f32 v13, v13
v_mfma_f32_16x16x32_bf16 v[52:55], a[220:223], v[172:175], v[52:55]
buffer_load_dwordx4 v230, s[8:11], s24 offen offset:2048  lds
v_mfma_f32_16x16x32_bf16 v[56:59], a[192:195], v[176:179], v[76:79]
v_exp_f32 v14, v14
v_mfma_f32_16x16x32_bf16 v[56:59], a[196:199], v[180:183], v[56:59]
ds_read_b64_tr_b16 a[252:253], v227 offset:0
v_cvt_pk_bf16_f32 v102, v12, v13
v_mfma_f32_16x16x32_bf16 v[56:59], a[200:203], v[184:187], v[56:59]
v_exp_f32 v15, v15
v_mfma_f32_16x16x32_bf16 v[56:59], a[204:207], v[188:191], v[56:59]
ds_read_b64_tr_b16 a[254:255], v227 offset:8192
v_and_b32 v192, 15, v248
v_mfma_f32_16x16x32_bf16 v[60:63], a[208:211], v[176:179], v[76:79]
v_exp_f32 v16, v16
v_smfmac_f32_16x16x64_bf16 v[80:83], v[232:235], v[112:119], v88
v_cvt_pk_bf16_f32 v103, v14, v15
v_mfma_f32_16x16x32_bf16 v[60:63], a[212:215], v[180:183], v[60:63]
v_exp_f32 v17, v17
v_mfma_f32_16x16x32_bf16 v[60:63], a[216:219], v[184:187], v[60:63]
v_lshrrev_b32 v193, 4, v248
v_lshl_add_u32 v253, v192, 10, s34
v_mfma_f32_16x16x32_bf16 v[60:63], a[220:223], v[188:191], v[60:63]
v_exp_f32 v18, v18
v_smfmac_f32_16x16x64_bf16 v[84:87], v[232:235], v[120:127], v88
s_waitcnt lgkmcnt(0)
v_cvt_pk_bf16_f32 v104, v16, v17
v_mfma_f32_16x16x32_bf16 a[0:3], a[224:227], v[112:115], a[0:3]
v_exp_f32 v19, v19
v_mfma_f32_16x16x32_bf16 a[4:7], a[224:227], v[116:119], a[4:7]
v_exp_f32 v20, v20
v_mfma_f32_16x16x32_bf16 a[8:11], a[224:227], v[120:123], a[8:11]
ds_read_b128 a[192:195], v216 offset:0
v_cvt_pk_bf16_f32 v105, v18, v19
v_mfma_f32_16x16x32_bf16 a[12:15], a[224:227], v[124:127], a[12:15]
v_exp_f32 v21, v21
v_mfma_f32_16x16x32_bf16 a[16:19], a[228:231], v[112:115], a[16:19]
ds_read_b128 a[196:199], v217 offset:0
ds_read_b128 a[200:203], v218 offset:0
v_mfma_f32_16x16x32_bf16 a[20:23], a[228:231], v[116:119], a[20:23]
v_exp_f32 v22, v22
v_mfma_f32_16x16x32_bf16 a[24:27], a[228:231], v[120:123], a[24:27]
ds_read_b128 a[204:207], v219 offset:0
v_cvt_pk_bf16_f32 v106, v20, v21
v_mfma_f32_16x16x32_bf16 a[28:31], a[228:231], v[124:127], a[28:31]
v_exp_f32 v23, v23
v_mfma_f32_16x16x32_bf16 a[32:35], a[232:235], v[112:115], a[32:35]
buffer_load_dwordx4 v231, s[8:11], s24 offen offset:3072  lds
v_mfma_f32_16x16x32_bf16 a[36:39], a[232:235], v[116:119], a[36:39]
s_add_u32 s24, s24, 8192
v_exp_f32 v24, v24
v_mfma_f32_16x16x32_bf16 a[40:43], a[232:235], v[120:123], a[40:43]
ds_read_b128 a[208:211], v216 offset:8192
v_cvt_pk_bf16_f32 v107, v22, v23
v_mfma_f32_16x16x32_bf16 a[44:47], a[232:235], v[124:127], a[44:47]
v_exp_f32 v25, v25
v_mfma_f32_16x16x32_bf16 a[48:51], a[236:239], v[112:115], a[48:51]
ds_read_b128 a[212:215], v217 offset:8192
ds_read_b128 a[216:219], v218 offset:8192
v_mfma_f32_16x16x32_bf16 a[52:55], a[236:239], v[116:119], a[52:55]
v_exp_f32 v26, v26
v_mfma_f32_16x16x32_bf16 a[56:59], a[236:239], v[120:123], a[56:59]
ds_read_b128 a[220:223], v219 offset:8192
v_cvt_pk_bf16_f32 v108, v24, v25
v_mfma_f32_16x16x32_bf16 a[60:63], a[236:239], v[124:127], a[60:63]
v_exp_f32 v27, v27
v_mfma_f32_16x16x32_bf16 a[64:67], a[240:243], v[112:115], a[64:67]
v_lshl_add_u32 v253, v193, 4, v253
v_lshl_add_u32 v254, v193, 4, s35
v_mfma_f32_16x16x32_bf16 a[68:71], a[240:243], v[116:119], a[68:71]
v_exp_f32 v28, v28
v_mfma_f32_16x16x32_bf16 a[72:75], a[240:243], v[120:123], a[72:75]
v_cvt_pk_bf16_f32 v109, v26, v27
v_lshlrev_b32 v254, 1, v254
v_mfma_f32_16x16x32_bf16 a[76:79], a[240:243], v[124:127], a[76:79]
v_exp_f32 v29, v29
v_mfma_f32_16x16x32_bf16 a[80:83], a[244:247], v[112:115], a[80:83]
s_lshl1_add_u32 m0, s26, 0
v_mfma_f32_16x16x32_bf16 a[84:87], a[244:247], v[116:119], a[84:87]
s_waitcnt vmcnt(9) lgkmcnt(0)
s_barrier
v_mfma_f32_16x16x32_bf16 a[88:91], a[244:247], v[120:123], a[88:91]
buffer_load_dwordx4 v228, s[12:15], s24 offen  lds
v_mfma_f32_16x16x32_bf16 a[92:95], a[244:247], v[124:127], a[92:95]
v_lshlrev_b32 v213, 4, v192
v_lshl_add_u32 v213, v193, 11, v213
v_mfma_f32_16x16x32_bf16 a[96:99], a[248:251], v[112:115], a[96:99]
v_exp_f32 v30, v30
v_mfma_f32_16x16x32_bf16 a[100:103], a[248:251], v[116:119], a[100:103]
v_cvt_pk_bf16_f32 v110, v28, v29
v_lshl_add_u32 v213, s35, 1, v213
v_mfma_f32_16x16x32_bf16 a[104:107], a[248:251], v[120:123], a[104:107]
v_exp_f32 v31, v31
v_mfma_f32_16x16x32_bf16 a[108:111], a[248:251], v[124:127], a[108:111]
v_lshlrev_b32 v214, 1, v255
v_mfma_f32_16x16x32_bf16 a[112:115], a[252:255], v[112:115], a[112:115]
v_exp_f32 v32, v32
v_mfma_f32_16x16x32_bf16 a[116:119], a[252:255], v[116:119], a[116:119]
v_cvt_pk_bf16_f32 v111, v30, v31
v_mfma_f32_16x16x32_bf16 a[120:123], a[252:255], v[120:123], a[120:123]
v_exp_f32 v33, v33
v_mfma_f32_16x16x32_bf16 a[124:127], a[252:255], v[124:127], a[124:127]
v_mfma_f32_16x16x32_bf16 v[0:3], a[192:195], v[128:131], v[64:67]
v_exp_f32 v34, v34
v_mfma_f32_16x16x32_bf16 v[0:3], a[196:199], v[132:135], v[0:3]
ds_read_b64_tr_b16 a[224:225], v220 offset:16384
v_cvt_pk_bf16_f32 v112, v32, v33
v_mfma_f32_16x16x32_bf16 v[0:3], a[200:203], v[136:139], v[0:3]
s_lshl2_add_u32 s30, s29, s27
v_exp_f32 v35, v35
v_mfma_f32_16x16x32_bf16 v[0:3], a[204:207], v[140:143], v[0:3]
ds_read_b64_tr_b16 a[226:227], v220 offset:24576
ds_read_b64_tr_b16 a[228:229], v221 offset:16384
v_mfma_f32_16x16x32_bf16 v[4:7], a[208:211], v[128:131], v[64:67]
s_and_b32 s37, s28, 3
v_exp_f32 v36, v36
v_mfma_f32_16x16x32_bf16 v[4:7], a[212:215], v[132:135], v[4:7]
ds_read_b64_tr_b16 a[230:231], v221 offset:24576
v_cvt_pk_bf16_f32 v113, v34, v35
v_mfma_f32_16x16x32_bf16 v[4:7], a[216:219], v[136:139], v[4:7]
s_lshl2_add_u32 s30, s30, s37
v_exp_f32 v37, v37
v_mfma_f32_16x16x32_bf16 v[4:7], a[220:223], v[140:143], v[4:7]
buffer_load_dwordx4 v229, s[12:15], s24 offen offset:1024  lds
v_mfma_f32_16x16x32_bf16 v[8:11], a[192:195], v[144:147], v[68:71]
s_lshl_b32 s30, s30, 5
v_exp_f32 v38, v38
v_mfma_f32_16x16x32_bf16 v[8:11], a[196:199], v[148:151], v[8:11]
ds_read_b64_tr_b16 a[232:233], v222 offset:16384
v_cvt_pk_bf16_f32 v114, v36, v37
v_mfma_f32_16x16x32_bf16 v[8:11], a[200:203], v[152:155], v[8:11]
s_or_b32 s37, s29, 0
v_exp_f32 v39, v39
v_mfma_f32_16x16x32_bf16 v[8:11], a[204:207], v[156:159], v[8:11]
ds_read_b64_tr_b16 a[234:235], v222 offset:24576
ds_read_b64_tr_b16 a[236:237], v223 offset:16384
v_mfma_f32_16x16x32_bf16 v[12:15], a[208:211], v[144:147], v[68:71]
s_sub_u32 s37, s2, s37
v_exp_f32 v40, v40
v_mfma_f32_16x16x32_bf16 v[12:15], a[212:215], v[148:151], v[12:15]
ds_read_b64_tr_b16 a[238:239], v223 offset:24576
v_cvt_pk_bf16_f32 v115, v38, v39
v_mfma_f32_16x16x32_bf16 v[12:15], a[216:219], v[152:155], v[12:15]
s_sub_u32 s37, s37, 1
v_exp_f32 v41, v41
v_mfma_f32_16x16x32_bf16 v[12:15], a[220:223], v[156:159], v[12:15]
ds_read_b64_tr_b16 a[240:241], v224 offset:16384
ds_read_b64_tr_b16 a[242:243], v224 offset:24576
v_mfma_f32_16x16x32_bf16 v[16:19], a[192:195], v[160:163], v[72:75]
s_and_b32 s37, s37, 7
v_exp_f32 v42, v42
v_mfma_f32_16x16x32_bf16 v[16:19], a[196:199], v[164:167], v[16:19]
ds_read_b64_tr_b16 a[244:245], v225 offset:16384
v_cvt_pk_bf16_f32 v116, v40, v41
v_mfma_f32_16x16x32_bf16 v[16:19], a[200:203], v[168:171], v[16:19]
s_add_u32 s30, s30, s37
v_exp_f32 v43, v43
v_mfma_f32_16x16x32_bf16 v[16:19], a[204:207], v[172:175], v[16:19]
ds_read_b64_tr_b16 a[246:247], v225 offset:24576
ds_read_b64_tr_b16 a[248:249], v226 offset:16384
v_mfma_f32_16x16x32_bf16 v[20:23], a[208:211], v[160:163], v[72:75]
s_lshl2_add_u32 s30, s30, 30408704
v_exp_f32 v44, v44
v_mfma_f32_16x16x32_bf16 v[20:23], a[212:215], v[164:167], v[20:23]
ds_read_b64_tr_b16 a[250:251], v226 offset:24576
v_cvt_pk_bf16_f32 v117, v42, v43
v_mfma_f32_16x16x32_bf16 v[20:23], a[216:219], v[168:171], v[20:23]
v_exp_f32 v45, v45
v_mfma_f32_16x16x32_bf16 v[20:23], a[220:223], v[172:175], v[20:23]
buffer_load_dwordx4 v230, s[8:11], s24 offen offset:2048  lds
v_mfma_f32_16x16x32_bf16 v[24:27], a[192:195], v[176:179], v[76:79]
v_exp_f32 v46, v46
v_mfma_f32_16x16x32_bf16 v[24:27], a[196:199], v[180:183], v[24:27]
ds_read_b64_tr_b16 a[252:253], v227 offset:16384
v_cvt_pk_bf16_f32 v118, v44, v45
v_mfma_f32_16x16x32_bf16 v[24:27], a[200:203], v[184:187], v[24:27]
v_exp_f32 v47, v47
v_mfma_f32_16x16x32_bf16 v[24:27], a[204:207], v[188:191], v[24:27]
ds_read_b64_tr_b16 a[254:255], v227 offset:24576
v_mfma_f32_16x16x32_bf16 v[28:31], a[208:211], v[176:179], v[76:79]
v_exp_f32 v48, v48
v_smfmac_f32_16x16x64_bf16 v[80:83], v[232:235], v[96:103], v88
v_cvt_pk_bf16_f32 v119, v46, v47
v_mfma_f32_16x16x32_bf16 v[28:31], a[212:215], v[180:183], v[28:31]
v_exp_f32 v49, v49
v_mfma_f32_16x16x32_bf16 v[28:31], a[216:219], v[184:187], v[28:31]
buffer_load_dwordx4 v[240:243], v253, s[80:83], 0 offen
v_mfma_f32_16x16x32_bf16 v[28:31], a[220:223], v[188:191], v[28:31]
v_exp_f32 v50, v50
v_smfmac_f32_16x16x64_bf16 v[84:87], v[232:235], v[104:111], v88
s_waitcnt lgkmcnt(0)
v_cvt_pk_bf16_f32 v120, v48, v49
v_mfma_f32_16x16x32_bf16 a[0:3], a[224:227], v[96:99], a[0:3]
v_exp_f32 v51, v51
v_mfma_f32_16x16x32_bf16 a[4:7], a[224:227], v[100:103], a[4:7]
v_exp_f32 v52, v52
v_mfma_f32_16x16x32_bf16 a[8:11], a[224:227], v[104:107], a[8:11]
ds_read_b128 a[192:195], v216 offset:16384
v_cvt_pk_bf16_f32 v121, v50, v51
v_mfma_f32_16x16x32_bf16 a[12:15], a[224:227], v[108:111], a[12:15]
v_exp_f32 v53, v53
v_mfma_f32_16x16x32_bf16 a[16:19], a[228:231], v[96:99], a[16:19]
ds_read_b128 a[196:199], v217 offset:16384
ds_read_b128 a[200:203], v218 offset:16384
v_mfma_f32_16x16x32_bf16 a[20:23], a[228:231], v[100:103], a[20:23]
v_exp_f32 v54, v54
v_mfma_f32_16x16x32_bf16 a[24:27], a[228:231], v[104:107], a[24:27]
ds_read_b128 a[204:207], v219 offset:16384
v_cvt_pk_bf16_f32 v122, v52, v53
v_mfma_f32_16x16x32_bf16 a[28:31], a[228:231], v[108:111], a[28:31]
v_exp_f32 v55, v55
v_mfma_f32_16x16x32_bf16 a[32:35], a[232:235], v[96:99], a[32:35]
buffer_load_dwordx4 v231, s[8:11], s24 offen offset:3072  lds
v_mfma_f32_16x16x32_bf16 a[36:39], a[232:235], v[100:103], a[36:39]
s_add_u32 s24, s24, 8192
v_exp_f32 v56, v56
v_mfma_f32_16x16x32_bf16 a[40:43], a[232:235], v[104:107], a[40:43]
ds_read_b128 a[208:211], v216 offset:24576
v_cvt_pk_bf16_f32 v123, v54, v55
v_mfma_f32_16x16x32_bf16 a[44:47], a[232:235], v[108:111], a[44:47]
v_exp_f32 v57, v57
v_mfma_f32_16x16x32_bf16 a[48:51], a[236:239], v[96:99], a[48:51]
ds_read_b128 a[212:215], v217 offset:24576
ds_read_b128 a[216:219], v218 offset:24576
v_mfma_f32_16x16x32_bf16 a[52:55], a[236:239], v[100:103], a[52:55]
v_exp_f32 v58, v58
v_mfma_f32_16x16x32_bf16 a[56:59], a[236:239], v[104:107], a[56:59]
ds_read_b128 a[220:223], v219 offset:24576
v_cvt_pk_bf16_f32 v124, v56, v57
v_mfma_f32_16x16x32_bf16 a[60:63], a[236:239], v[108:111], a[60:63]
v_exp_f32 v59, v59
v_mfma_f32_16x16x32_bf16 a[64:67], a[240:243], v[96:99], a[64:67]
v_mfma_f32_16x16x32_bf16 a[68:71], a[240:243], v[100:103], a[68:71]
v_exp_f32 v60, v60
v_mfma_f32_16x16x32_bf16 a[72:75], a[240:243], v[104:107], a[72:75]
v_cvt_pk_bf16_f32 v125, v58, v59
v_mfma_f32_16x16x32_bf16 a[76:79], a[240:243], v[108:111], a[76:79]
v_exp_f32 v61, v61
v_mfma_f32_16x16x32_bf16 a[80:83], a[244:247], v[96:99], a[80:83]
s_lshl1_add_u32 m0, s26, 16384
v_mfma_f32_16x16x32_bf16 a[84:87], a[244:247], v[100:103], a[84:87]
s_waitcnt vmcnt(9) lgkmcnt(0)
s_barrier
v_mfma_f32_16x16x32_bf16 a[88:91], a[244:247], v[104:107], a[88:91]
buffer_load_dwordx4 v228, s[12:15], s24 offen  lds
v_mfma_f32_16x16x32_bf16 a[92:95], a[244:247], v[108:111], a[92:95]
s_buffer_load_dword s48, s[88:91], 128
v_mfma_f32_16x16x32_bf16 a[96:99], a[248:251], v[96:99], a[96:99]
v_exp_f32 v62, v62
v_mfma_f32_16x16x32_bf16 a[100:103], a[248:251], v[100:103], a[100:103]
v_cvt_pk_bf16_f32 v126, v60, v61
v_mfma_f32_16x16x32_bf16 a[104:107], a[248:251], v[104:107], a[104:107]
v_exp_f32 v63, v63
v_mfma_f32_16x16x32_bf16 a[108:111], a[248:251], v[108:111], a[108:111]
buffer_load_dwordx4 v[244:247], v253, s[80:83], 0 offen offset:64
v_mfma_f32_16x16x32_bf16 a[112:115], a[252:255], v[96:99], a[112:115]
v_exp_f32 v0, v0
v_mfma_f32_16x16x32_bf16 a[116:119], a[252:255], v[100:103], a[116:119]
v_cvt_pk_bf16_f32 v127, v62, v63
v_mfma_f32_16x16x32_bf16 a[120:123], a[252:255], v[104:107], a[120:123]
v_exp_f32 v1, v1
v_mfma_f32_16x16x32_bf16 a[124:127], a[252:255], v[108:111], a[124:127]
v_mfma_f32_16x16x32_bf16 v[32:35], a[192:195], v[128:131], v[64:67]
v_exp_f32 v2, v2
v_mfma_f32_16x16x32_bf16 v[32:35], a[196:199], v[132:135], v[32:35]
ds_read_b64_tr_b16 a[224:225], v220 offset:32768
v_cvt_pk_bf16_f32 v96, v0, v1
v_mfma_f32_16x16x32_bf16 v[32:35], a[200:203], v[136:139], v[32:35]
v_exp_f32 v3, v3
v_mfma_f32_16x16x32_bf16 v[32:35], a[204:207], v[140:143], v[32:35]
ds_read_b64_tr_b16 a[226:227], v220 offset:40960
ds_read_b64_tr_b16 a[228:229], v221 offset:32768
v_mfma_f32_16x16x32_bf16 v[36:39], a[208:211], v[128:131], v[64:67]
v_exp_f32 v4, v4
v_mfma_f32_16x16x32_bf16 v[36:39], a[212:215], v[132:135], v[36:39]
ds_read_b64_tr_b16 a[230:231], v221 offset:40960
v_cvt_pk_bf16_f32 v97, v2, v3
v_mfma_f32_16x16x32_bf16 v[36:39], a[216:219], v[136:139], v[36:39]
v_exp_f32 v5, v5
v_mfma_f32_16x16x32_bf16 v[36:39], a[220:223], v[140:143], v[36:39]
buffer_load_dwordx4 v229, s[12:15], s24 offen offset:1024  lds
v_mfma_f32_16x16x32_bf16 v[40:43], a[192:195], v[144:147], v[68:71]
v_exp_f32 v6, v6
v_mfma_f32_16x16x32_bf16 v[40:43], a[196:199], v[148:151], v[40:43]
ds_read_b64_tr_b16 a[232:233], v222 offset:32768
v_cvt_pk_bf16_f32 v98, v4, v5
v_mfma_f32_16x16x32_bf16 v[40:43], a[200:203], v[152:155], v[40:43]
v_exp_f32 v7, v7
v_mfma_f32_16x16x32_bf16 v[40:43], a[204:207], v[156:159], v[40:43]
ds_read_b64_tr_b16 a[234:235], v222 offset:40960
ds_read_b64_tr_b16 a[236:237], v223 offset:32768
v_mfma_f32_16x16x32_bf16 v[44:47], a[208:211], v[144:147], v[68:71]
v_exp_f32 v8, v8
v_mfma_f32_16x16x32_bf16 v[44:47], a[212:215], v[148:151], v[44:47]
ds_read_b64_tr_b16 a[238:239], v223 offset:40960
v_cvt_pk_bf16_f32 v99, v6, v7
v_mfma_f32_16x16x32_bf16 v[44:47], a[216:219], v[152:155], v[44:47]
v_exp_f32 v9, v9
v_mfma_f32_16x16x32_bf16 v[44:47], a[220:223], v[156:159], v[44:47]
ds_read_b64_tr_b16 a[240:241], v224 offset:32768
ds_read_b64_tr_b16 a[242:243], v224 offset:40960
v_mfma_f32_16x16x32_bf16 v[48:51], a[192:195], v[160:163], v[72:75]
v_exp_f32 v10, v10
v_mfma_f32_16x16x32_bf16 v[48:51], a[196:199], v[164:167], v[48:51]
ds_read_b64_tr_b16 a[244:245], v225 offset:32768
v_cvt_pk_bf16_f32 v100, v8, v9
v_mfma_f32_16x16x32_bf16 v[48:51], a[200:203], v[168:171], v[48:51]
v_exp_f32 v11, v11
v_mfma_f32_16x16x32_bf16 v[48:51], a[204:207], v[172:175], v[48:51]
ds_read_b64_tr_b16 a[246:247], v225 offset:40960
ds_read_b64_tr_b16 a[248:249], v226 offset:32768
v_mfma_f32_16x16x32_bf16 v[52:55], a[208:211], v[160:163], v[72:75]
v_exp_f32 v12, v12
v_mfma_f32_16x16x32_bf16 v[52:55], a[212:215], v[164:167], v[52:55]
ds_read_b64_tr_b16 a[250:251], v226 offset:40960
v_cvt_pk_bf16_f32 v101, v10, v11
v_mfma_f32_16x16x32_bf16 v[52:55], a[216:219], v[168:171], v[52:55]
v_exp_f32 v13, v13
v_mfma_f32_16x16x32_bf16 v[52:55], a[220:223], v[172:175], v[52:55]
buffer_load_dwordx4 v230, s[8:11], s24 offen offset:2048  lds
v_mfma_f32_16x16x32_bf16 v[56:59], a[192:195], v[176:179], v[76:79]
v_exp_f32 v14, v14
v_mfma_f32_16x16x32_bf16 v[56:59], a[196:199], v[180:183], v[56:59]
ds_read_b64_tr_b16 a[252:253], v227 offset:32768
v_cvt_pk_bf16_f32 v102, v12, v13
v_mfma_f32_16x16x32_bf16 v[56:59], a[200:203], v[184:187], v[56:59]
v_exp_f32 v15, v15
v_mfma_f32_16x16x32_bf16 v[56:59], a[204:207], v[188:191], v[56:59]
ds_read_b64_tr_b16 a[254:255], v227 offset:40960
v_mfma_f32_16x16x32_bf16 v[60:63], a[208:211], v[176:179], v[76:79]
v_exp_f32 v16, v16
v_smfmac_f32_16x16x64_bf16 v[80:83], v[232:235], v[112:119], v88
v_cvt_pk_bf16_f32 v103, v14, v15
v_mfma_f32_16x16x32_bf16 v[60:63], a[212:215], v[180:183], v[60:63]
v_exp_f32 v17, v17
v_mfma_f32_16x16x32_bf16 v[60:63], a[216:219], v[184:187], v[60:63]
v_mfma_f32_16x16x32_bf16 v[60:63], a[220:223], v[188:191], v[60:63]
v_exp_f32 v18, v18
v_smfmac_f32_16x16x64_bf16 v[84:87], v[232:235], v[120:127], v88
s_waitcnt lgkmcnt(0)
v_cvt_pk_bf16_f32 v104, v16, v17
v_mfma_f32_16x16x32_bf16 a[0:3], a[224:227], v[112:115], a[0:3]
v_exp_f32 v19, v19
v_mfma_f32_16x16x32_bf16 a[4:7], a[224:227], v[116:119], a[4:7]
s_cmp_ge_u32 s48, 256
s_cbranch_scc0 La_xwait
La_xok:
v_exp_f32 v20, v20
v_mfma_f32_16x16x32_bf16 a[8:11], a[224:227], v[120:123], a[8:11]
ds_read_b128 a[192:195], v216 offset:32768
v_cvt_pk_bf16_f32 v105, v18, v19
v_mfma_f32_16x16x32_bf16 a[12:15], a[224:227], v[124:127], a[12:15]
v_exp_f32 v21, v21
v_mfma_f32_16x16x32_bf16 a[16:19], a[228:231], v[112:115], a[16:19]
ds_read_b128 a[196:199], v217 offset:32768
ds_read_b128 a[200:203], v218 offset:32768
v_mfma_f32_16x16x32_bf16 a[20:23], a[228:231], v[116:119], a[20:23]
v_exp_f32 v22, v22
v_mfma_f32_16x16x32_bf16 a[24:27], a[228:231], v[120:123], a[24:27]
ds_read_b128 a[204:207], v219 offset:32768
v_cvt_pk_bf16_f32 v106, v20, v21
v_mfma_f32_16x16x32_bf16 a[28:31], a[228:231], v[124:127], a[28:31]
v_exp_f32 v23, v23
v_mfma_f32_16x16x32_bf16 a[32:35], a[232:235], v[112:115], a[32:35]
buffer_load_dwordx4 v231, s[8:11], s24 offen offset:3072  lds
v_mfma_f32_16x16x32_bf16 a[36:39], a[232:235], v[116:119], a[36:39]
s_add_u32 s24, s24, 8192
v_exp_f32 v24, v24
v_mfma_f32_16x16x32_bf16 a[40:43], a[232:235], v[120:123], a[40:43]
ds_read_b128 a[208:211], v216 offset:40960
v_cvt_pk_bf16_f32 v107, v22, v23
v_mfma_f32_16x16x32_bf16 a[44:47], a[232:235], v[124:127], a[44:47]
v_exp_f32 v25, v25
v_mfma_f32_16x16x32_bf16 a[48:51], a[236:239], v[112:115], a[48:51]
ds_read_b128 a[212:215], v217 offset:40960
ds_read_b128 a[216:219], v218 offset:40960
v_mfma_f32_16x16x32_bf16 a[52:55], a[236:239], v[116:119], a[52:55]
v_exp_f32 v26, v26
v_mfma_f32_16x16x32_bf16 a[56:59], a[236:239], v[120:123], a[56:59]
ds_read_b128 a[220:223], v219 offset:40960
v_cvt_pk_bf16_f32 v108, v24, v25
v_mfma_f32_16x16x32_bf16 a[60:63], a[236:239], v[124:127], a[60:63]
v_exp_f32 v27, v27
v_mfma_f32_16x16x32_bf16 a[64:67], a[240:243], v[112:115], a[64:67]
v_mfma_f32_16x16x32_bf16 a[68:71], a[240:243], v[116:119], a[68:71]
v_exp_f32 v28, v28
v_mfma_f32_16x16x32_bf16 a[72:75], a[240:243], v[120:123], a[72:75]
v_cvt_pk_bf16_f32 v109, v26, v27
v_mfma_f32_16x16x32_bf16 a[76:79], a[240:243], v[124:127], a[76:79]
v_exp_f32 v29, v29
v_mfma_f32_16x16x32_bf16 a[80:83], a[244:247], v[112:115], a[80:83]
s_lshl1_add_u32 m0, s26, 32768
v_mfma_f32_16x16x32_bf16 a[84:87], a[244:247], v[116:119], a[84:87]
s_waitcnt vmcnt(10) lgkmcnt(0)
s_barrier
v_mfma_f32_16x16x32_bf16 a[88:91], a[244:247], v[120:123], a[88:91]
buffer_load_dwordx4 v228, s[12:15], s24 offen  lds
v_mfma_f32_16x16x32_bf16 a[92:95], a[244:247], v[124:127], a[92:95]
v_mfma_f32_16x16x32_bf16 a[96:99], a[248:251], v[112:115], a[96:99]
v_exp_f32 v30, v30
v_mfma_f32_16x16x32_bf16 a[100:103], a[248:251], v[116:119], a[100:103]
v_cvt_pk_bf16_f32 v110, v28, v29
v_mfma_f32_16x16x32_bf16 a[104:107], a[248:251], v[120:123], a[104:107]
v_exp_f32 v31, v31
v_mfma_f32_16x16x32_bf16 a[108:111], a[248:251], v[124:127], a[108:111]
v_mfma_f32_16x16x32_bf16 a[112:115], a[252:255], v[112:115], a[112:115]
v_exp_f32 v32, v32
v_mfma_f32_16x16x32_bf16 a[116:119], a[252:255], v[116:119], a[116:119]
v_cvt_pk_bf16_f32 v111, v30, v31
v_mfma_f32_16x16x32_bf16 a[120:123], a[252:255], v[120:123], a[120:123]
v_exp_f32 v33, v33
v_mfma_f32_16x16x32_bf16 a[124:127], a[252:255], v[124:127], a[124:127]
v_mfma_f32_16x16x32_bf16 v[0:3], a[192:195], v[128:131], v[64:67]
v_exp_f32 v34, v34
v_mfma_f32_16x16x32_bf16 v[0:3], a[196:199], v[132:135], v[0:3]
ds_read_b64_tr_b16 a[224:225], v220 offset:49152
v_cvt_pk_bf16_f32 v112, v32, v33
v_mfma_f32_16x16x32_bf16 v[0:3], a[200:203], v[136:139], v[0:3]
v_exp_f32 v35, v35
v_mfma_f32_16x16x32_bf16 v[0:3], a[204:207], v[140:143], v[0:3]
ds_read_b64_tr_b16 a[226:227], v220 offset:57344
ds_read_b64_tr_b16 a[228:229], v221 offset:49152
v_mfma_f32_16x16x32_bf16 v[4:7], a[208:211], v[128:131], v[64:67]
v_exp_f32 v36, v36
v_mfma_f32_16x16x32_bf16 v[4:7], a[212:215], v[132:135], v[4:7]
ds_read_b64_tr_b16 a[230:231], v221 offset:57344
v_cvt_pk_bf16_f32 v113, v34, v35
v_mfma_f32_16x16x32_bf16 v[4:7], a[216:219], v[136:139], v[4:7]
v_exp_f32 v37, v37
v_mfma_f32_16x16x32_bf16 v[4:7], a[220:223], v[140:143], v[4:7]
buffer_load_dwordx4 v229, s[12:15], s24 offen offset:1024  lds
v_mfma_f32_16x16x32_bf16 v[8:11], a[192:195], v[144:147], v[68:71]
v_exp_f32 v38, v38
v_mfma_f32_16x16x32_bf16 v[8:11], a[196:199], v[148:151], v[8:11]
ds_read_b64_tr_b16 a[232:233], v222 offset:49152
v_cvt_pk_bf16_f32 v114, v36, v37
v_mfma_f32_16x16x32_bf16 v[8:11], a[200:203], v[152:155], v[8:11]
v_exp_f32 v39, v39
v_mfma_f32_16x16x32_bf16 v[8:11], a[204:207], v[156:159], v[8:11]
ds_read_b64_tr_b16 a[234:235], v222 offset:57344
ds_read_b64_tr_b16 a[236:237], v223 offset:49152
v_mfma_f32_16x16x32_bf16 v[12:15], a[208:211], v[144:147], v[68:71]
v_exp_f32 v40, v40
v_mfma_f32_16x16x32_bf16 v[12:15], a[212:215], v[148:151], v[12:15]
ds_read_b64_tr_b16 a[238:239], v223 offset:57344
v_cvt_pk_bf16_f32 v115, v38, v39
v_mfma_f32_16x16x32_bf16 v[12:15], a[216:219], v[152:155], v[12:15]
v_exp_f32 v41, v41
v_mfma_f32_16x16x32_bf16 v[12:15], a[220:223], v[156:159], v[12:15]
ds_read_b64_tr_b16 a[240:241], v224 offset:49152
ds_read_b64_tr_b16 a[242:243], v224 offset:57344
v_mfma_f32_16x16x32_bf16 v[16:19], a[192:195], v[160:163], v[72:75]
v_exp_f32 v42, v42
v_mfma_f32_16x16x32_bf16 v[16:19], a[196:199], v[164:167], v[16:19]
ds_read_b64_tr_b16 a[244:245], v225 offset:49152
v_cvt_pk_bf16_f32 v116, v40, v41
v_mfma_f32_16x16x32_bf16 v[16:19], a[200:203], v[168:171], v[16:19]
v_exp_f32 v43, v43
v_mfma_f32_16x16x32_bf16 v[16:19], a[204:207], v[172:175], v[16:19]
ds_read_b64_tr_b16 a[246:247], v225 offset:57344
ds_read_b64_tr_b16 a[248:249], v226 offset:49152
v_mfma_f32_16x16x32_bf16 v[20:23], a[208:211], v[160:163], v[72:75]
v_exp_f32 v44, v44
v_mfma_f32_16x16x32_bf16 v[20:23], a[212:215], v[164:167], v[20:23]
ds_read_b64_tr_b16 a[250:251], v226 offset:57344
v_cvt_pk_bf16_f32 v117, v42, v43
v_mfma_f32_16x16x32_bf16 v[20:23], a[216:219], v[168:171], v[20:23]
v_exp_f32 v45, v45
v_mfma_f32_16x16x32_bf16 v[20:23], a[220:223], v[172:175], v[20:23]
buffer_load_dwordx4 v230, s[8:11], s24 offen offset:2048  lds
v_mfma_f32_16x16x32_bf16 v[24:27], a[192:195], v[176:179], v[76:79]
v_exp_f32 v46, v46
v_mfma_f32_16x16x32_bf16 v[24:27], a[196:199], v[180:183], v[24:27]
ds_read_b64_tr_b16 a[252:253], v227 offset:49152
v_cvt_pk_bf16_f32 v118, v44, v45
v_mfma_f32_16x16x32_bf16 v[24:27], a[200:203], v[184:187], v[24:27]
v_exp_f32 v47, v47
v_mfma_f32_16x16x32_bf16 v[24:27], a[204:207], v[188:191], v[24:27]
ds_read_b64_tr_b16 a[254:255], v227 offset:57344
v_mfma_f32_16x16x32_bf16 v[28:31], a[208:211], v[176:179], v[76:79]
s_mov_b32 s37, 29364224
v_exp_f32 v48, v48
v_smfmac_f32_16x16x64_bf16 v[80:83], v[232:235], v[96:103], v88
v_cvt_pk_bf16_f32 v119, v46, v47
v_mfma_f32_16x16x32_bf16 v[28:31], a[212:215], v[180:183], v[28:31]
s_mov_b32 m0, 156672
v_exp_f32 v49, v49
v_mfma_f32_16x16x32_bf16 v[28:31], a[216:219], v[184:187], v[28:31]
Lpad14:
s_cbranch_execz Lwalk0
buffer_load_dwordx4 v213, s[16:19], s37 offen sc1 lds
v_mfma_f32_16x16x32_bf16 v[28:31], a[220:223], v[188:191], v[28:31]
s_mov_b32 m0, 157696
v_exp_f32 v50, v50
v_smfmac_f32_16x16x64_bf16 v[84:87], v[232:235], v[104:111], v88
s_waitcnt lgkmcnt(0)
v_cvt_pk_bf16_f32 v120, v48, v49
v_mfma_f32_16x16x32_bf16 a[0:3], a[224:227], v[96:99], a[0:3]
v_exp_f32 v51, v51
v_mfma_f32_16x16x32_bf16 a[4:7], a[224:227], v[100:103], a[4:7]
s_mov_b32 exec_lo, 0xff
s_mov_b32 exec_hi, 0x0
buffer_load_dwordx4 v255, s[96:99], s35 offen lds
s_mov_b64 exec, -1
s_lshl1_add_u32 m0, s26, 32768
v_exp_f32 v52, v52
v_mfma_f32_16x16x32_bf16 a[8:11], a[224:227], v[104:107], a[8:11]
ds_read_b128 a[192:195], v216 offset:49152
v_cvt_pk_bf16_f32 v121, v50, v51
v_mfma_f32_16x16x32_bf16 a[12:15], a[224:227], v[108:111], a[12:15]
v_exp_f32 v53, v53
v_mfma_f32_16x16x32_bf16 a[16:19], a[228:231], v[96:99], a[16:19]
ds_read_b128 a[196:199], v217 offset:49152
ds_read_b128 a[200:203], v218 offset:49152
v_mfma_f32_16x16x32_bf16 a[20:23], a[228:231], v[100:103], a[20:23]
v_exp_f32 v54, v54
v_mfma_f32_16x16x32_bf16 a[24:27], a[228:231], v[104:107], a[24:27]
ds_read_b128 a[204:207], v219 offset:49152
v_cvt_pk_bf16_f32 v122, v52, v53
v_mfma_f32_16x16x32_bf16 a[28:31], a[228:231], v[108:111], a[28:31]
v_exp_f32 v55, v55
v_mfma_f32_16x16x32_bf16 a[32:35], a[232:235], v[96:99], a[32:35]
buffer_load_dwordx4 v231, s[8:11], s24 offen offset:3072  lds
v_mfma_f32_16x16x32_bf16 a[36:39], a[232:235], v[100:103], a[36:39]
s_add_u32 s24, s24, 8192
v_exp_f32 v56, v56
v_mfma_f32_16x16x32_bf16 a[40:43], a[232:235], v[104:107], a[40:43]
ds_read_b128 a[208:211], v216 offset:57344
v_cvt_pk_bf16_f32 v123, v54, v55
v_mfma_f32_16x16x32_bf16 a[44:47], a[232:235], v[108:111], a[44:47]
v_exp_f32 v57, v57
v_mfma_f32_16x16x32_bf16 a[48:51], a[236:239], v[96:99], a[48:51]
ds_read_b128 a[212:215], v217 offset:57344
ds_read_b128 a[216:219], v218 offset:57344
v_mfma_f32_16x16x32_bf16 a[52:55], a[236:239], v[100:103], a[52:55]
v_exp_f32 v58, v58
v_mfma_f32_16x16x32_bf16 a[56:59], a[236:239], v[104:107], a[56:59]
ds_read_b128 a[220:223], v219 offset:57344
v_cvt_pk_bf16_f32 v124, v56, v57
v_mfma_f32_16x16x32_bf16 a[60:63], a[236:239], v[108:111], a[60:63]
v_exp_f32 v59, v59
v_mfma_f32_16x16x32_bf16 a[64:67], a[240:243], v[96:99], a[64:67]
v_mfma_f32_16x16x32_bf16 a[68:71], a[240:243], v[100:103], a[68:71]
v_exp_f32 v60, v60
v_mfma_f32_16x16x32_bf16 a[72:75], a[240:243], v[104:107], a[72:75]
v_cvt_pk_bf16_f32 v125, v58, v59
v_mfma_f32_16x16x32_bf16 a[76:79], a[240:243], v[108:111], a[76:79]
v_exp_f32 v61, v61
v_mfma_f32_16x16x32_bf16 a[80:83], a[244:247], v[96:99], a[80:83]
s_lshl1_add_u32 m0, s26, 49152
v_mfma_f32_16x16x32_bf16 a[84:87], a[244:247], v[100:103], a[84:87]
s_waitcnt vmcnt(11) lgkmcnt(0)
s_barrier
v_mfma_f32_16x16x32_bf16 a[88:91], a[244:247], v[104:107], a[88:91]
buffer_load_dwordx4 v228, s[12:15], s24 offen  lds
v_mfma_f32_16x16x32_bf16 a[92:95], a[244:247], v[108:111], a[92:95]
s_add_u32 s36, s40, 0
buffer_load_dwordx4 a[128:131], v249, s[16:19], s36 offen offset:0 sc1
v_mfma_f32_16x16x32_bf16 a[96:99], a[248:251], v[96:99], a[96:99]
v_exp_f32 v62, v62
v_mfma_f32_16x16x32_bf16 a[100:103], a[248:251], v[100:103], a[100:103]
v_cvt_pk_bf16_f32 v126, v60, v61
v_mfma_f32_16x16x32_bf16 a[104:107], a[248:251], v[104:107], a[104:107]
v_exp_f32 v63, v63
v_mfma_f32_16x16x32_bf16 a[108:111], a[248:251], v[108:111], a[108:111]
buffer_load_dwordx4 a[132:135], v249, s[16:19], s36 offen offset:1024 sc1
v_mfma_f32_16x16x32_bf16 a[112:115], a[252:255], v[96:99], a[112:115]
v_exp_f32 v0, v0
v_mfma_f32_16x16x32_bf16 a[116:119], a[252:255], v[100:103], a[116:119]
v_cvt_pk_bf16_f32 v127, v62, v63
v_mfma_f32_16x16x32_bf16 a[120:123], a[252:255], v[104:107], a[120:123]
v_exp_f32 v1, v1
v_mfma_f32_16x16x32_bf16 a[124:127], a[252:255], v[108:111], a[124:127]
v_mfma_f32_16x16x32_bf16 v[32:35], a[192:195], v[128:131], v[64:67]
v_exp_f32 v2, v2
v_mfma_f32_16x16x32_bf16 v[32:35], a[196:199], v[132:135], v[32:35]
ds_read_b64_tr_b16 a[224:225], v220 offset:0
v_cvt_pk_bf16_f32 v96, v0, v1
v_mfma_f32_16x16x32_bf16 v[32:35], a[200:203], v[136:139], v[32:35]
v_exp_f32 v3, v3
v_mfma_f32_16x16x32_bf16 v[32:35], a[204:207], v[140:143], v[32:35]
ds_read_b64_tr_b16 a[226:227], v220 offset:8192
ds_read_b64_tr_b16 a[228:229], v221 offset:0
v_mfma_f32_16x16x32_bf16 v[36:39], a[208:211], v[128:131], v[64:67]
v_exp_f32 v4, v4
v_mfma_f32_16x16x32_bf16 v[36:39], a[212:215], v[132:135], v[36:39]
ds_read_b64_tr_b16 a[230:231], v221 offset:8192
v_cvt_pk_bf16_f32 v97, v2, v3
v_mfma_f32_16x16x32_bf16 v[36:39], a[216:219], v[136:139], v[36:39]
v_exp_f32 v5, v5
v_mfma_f32_16x16x32_bf16 v[36:39], a[220:223], v[140:143], v[36:39]
buffer_load_dwordx4 v229, s[12:15], s24 offen offset:1024  lds
v_mfma_f32_16x16x32_bf16 v[40:43], a[192:195], v[144:147], v[68:71]
v_exp_f32 v6, v6
v_mfma_f32_16x16x32_bf16 v[40:43], a[196:199], v[148:151], v[40:43]
ds_read_b64_tr_b16 a[232:233], v222 offset:0
v_cvt_pk_bf16_f32 v98, v4, v5
v_mfma_f32_16x16x32_bf16 v[40:43], a[200:203], v[152:155], v[40:43]
v_exp_f32 v7, v7
v_mfma_f32_16x16x32_bf16 v[40:43], a[204:207], v[156:159], v[40:43]
ds_read_b64_tr_b16 a[234:235], v222 offset:8192
ds_read_b64_tr_b16 a[236:237], v223 offset:0
v_mfma_f32_16x16x32_bf16 v[44:47], a[208:211], v[144:147], v[68:71]
v_exp_f32 v8, v8
v_mfma_f32_16x16x32_bf16 v[44:47], a[212:215], v[148:151], v[44:47]
ds_read_b64_tr_b16 a[238:239], v223 offset:8192
v_cvt_pk_bf16_f32 v99, v6, v7
v_mfma_f32_16x16x32_bf16 v[44:47], a[216:219], v[152:155], v[44:47]
v_exp_f32 v9, v9
v_mfma_f32_16x16x32_bf16 v[44:47], a[220:223], v[156:159], v[44:47]
ds_read_b64_tr_b16 a[240:241], v224 offset:0
ds_read_b64_tr_b16 a[242:243], v224 offset:8192
v_mfma_f32_16x16x32_bf16 v[48:51], a[192:195], v[160:163], v[72:75]
v_exp_f32 v10, v10
v_mfma_f32_16x16x32_bf16 v[48:51], a[196:199], v[164:167], v[48:51]
ds_read_b64_tr_b16 a[244:245], v225 offset:0
v_cvt_pk_bf16_f32 v100, v8, v9
v_mfma_f32_16x16x32_bf16 v[48:51], a[200:203], v[168:171], v[48:51]
v_exp_f32 v11, v11
v_mfma_f32_16x16x32_bf16 v[48:51], a[204:207], v[172:175], v[48:51]
ds_read_b64_tr_b16 a[246:247], v225 offset:8192
ds_read_b64_tr_b16 a[248:249], v226 offset:0
v_mfma_f32_16x16x32_bf16 v[52:55], a[208:211], v[160:163], v[72:75]
v_exp_f32 v12, v12
v_mfma_f32_16x16x32_bf16 v[52:55], a[212:215], v[164:167], v[52:55]
ds_read_b64_tr_b16 a[250:251], v226 offset:8192
v_cvt_pk_bf16_f32 v101, v10, v11
v_mfma_f32_16x16x32_bf16 v[52:55], a[216:219], v[168:171], v[52:55]
v_exp_f32 v13, v13
v_mfma_f32_16x16x32_bf16 v[52:55], a[220:223], v[172:175], v[52:55]
buffer_load_dwordx4 v230, s[8:11], s24 offen offset:2048  lds
v_mfma_f32_16x16x32_bf16 v[56:59], a[192:195], v[176:179], v[76:79]
v_exp_f32 v14, v14
v_mfma_f32_16x16x32_bf16 v[56:59], a[196:199], v[180:183], v[56:59]
ds_read_b64_tr_b16 a[252:253], v227 offset:0
v_cvt_pk_bf16_f32 v102, v12, v13
v_mfma_f32_16x16x32_bf16 v[56:59], a[200:203], v[184:187], v[56:59]
v_exp_f32 v15, v15
v_mfma_f32_16x16x32_bf16 v[56:59], a[204:207], v[188:191], v[56:59]
ds_read_b64_tr_b16 a[254:255], v227 offset:8192
v_mfma_f32_16x16x32_bf16 v[60:63], a[208:211], v[176:179], v[76:79]
v_exp_f32 v16, v16
v_smfmac_f32_16x16x64_bf16 v[80:83], v[232:235], v[112:119], v88
v_cvt_pk_bf16_f32 v103, v14, v15
v_mfma_f32_16x16x32_bf16 v[60:63], a[212:215], v[180:183], v[60:63]
v_exp_f32 v17, v17
v_mfma_f32_16x16x32_bf16 v[60:63], a[216:219], v[184:187], v[60:63]
buffer_load_dwordx4 v[192:195], v214, s[16:19], s37 offen offset:2048 sc1
v_mfma_f32_16x16x32_bf16 v[60:63], a[220:223], v[188:191], v[60:63]
v_exp_f32 v18, v18
v_smfmac_f32_16x16x64_bf16 v[84:87], v[232:235], v[120:127], v88
s_waitcnt lgkmcnt(0)
v_cvt_pk_bf16_f32 v104, v16, v17
v_mfma_f32_16x16x32_bf16 a[0:3], a[224:227], v[112:115], a[0:3]
v_exp_f32 v19, v19
v_mfma_f32_16x16x32_bf16 a[4:7], a[224:227], v[116:119], a[4:7]
v_exp_f32 v20, v20
v_mfma_f32_16x16x32_bf16 a[8:11], a[224:227], v[120:123], a[8:11]
ds_read_b128 a[192:195], v216 offset:0
v_cvt_pk_bf16_f32 v105, v18, v19
v_mfma_f32_16x16x32_bf16 a[12:15], a[224:227], v[124:127], a[12:15]
v_exp_f32 v21, v21
v_mfma_f32_16x16x32_bf16 a[16:19], a[228:231], v[112:115], a[16:19]
ds_read_b128 a[196:199], v217 offset:0
ds_read_b128 a[200:203], v218 offset:0
v_mfma_f32_16x16x32_bf16 a[20:23], a[228:231], v[116:119], a[20:23]
v_exp_f32 v22, v22
v_mfma_f32_16x16x32_bf16 a[24:27], a[228:231], v[120:123], a[24:27]
ds_read_b128 a[204:207], v219 offset:0
v_cvt_pk_bf16_f32 v106, v20, v21
v_mfma_f32_16x16x32_bf16 a[28:31], a[228:231], v[124:127], a[28:31]
v_exp_f32 v23, v23
v_mfma_f32_16x16x32_bf16 a[32:35], a[232:235], v[112:115], a[32:35]
buffer_load_dwordx4 v231, s[8:11], s24 offen offset:3072  lds
v_mfma_f32_16x16x32_bf16 a[36:39], a[232:235], v[116:119], a[36:39]
s_add_u32 s24, s24, 8192
v_exp_f32 v24, v24
v_mfma_f32_16x16x32_bf16 a[40:43], a[232:235], v[120:123], a[40:43]
ds_read_b128 a[208:211], v216 offset:8192
v_cvt_pk_bf16_f32 v107, v22, v23
v_mfma_f32_16x16x32_bf16 a[44:47], a[232:235], v[124:127], a[44:47]
v_exp_f32 v25, v25
v_mfma_f32_16x16x32_bf16 a[48:51], a[236:239], v[112:115], a[48:51]
ds_read_b128 a[212:215], v217 offset:8192
ds_read_b128 a[216:219], v218 offset:8192
v_mfma_f32_16x16x32_bf16 a[52:55], a[236:239], v[116:119], a[52:55]
v_exp_f32 v26, v26
v_mfma_f32_16x16x32_bf16 a[56:59], a[236:239], v[120:123], a[56:59]
ds_read_b128 a[220:223], v219 offset:8192
v_cvt_pk_bf16_f32 v108, v24, v25
v_mfma_f32_16x16x32_bf16 a[60:63], a[236:239], v[124:127], a[60:63]
v_exp_f32 v27, v27
v_mfma_f32_16x16x32_bf16 a[64:67], a[240:243], v[112:115], a[64:67]
buffer_load_dwordx4 v[196:199], v214, s[16:19], s37 offen offset:2064 sc1
v_mfma_f32_16x16x32_bf16 a[68:71], a[240:243], v[116:119], a[68:71]
v_exp_f32 v28, v28
v_mfma_f32_16x16x32_bf16 a[72:75], a[240:243], v[120:123], a[72:75]
v_cvt_pk_bf16_f32 v109, v26, v27
v_mfma_f32_16x16x32_bf16 a[76:79], a[240:243], v[124:127], a[76:79]
v_exp_f32 v29, v29
v_mfma_f32_16x16x32_bf16 a[80:83], a[244:247], v[112:115], a[80:83]
s_lshl1_add_u32 m0, s26, 0
v_mfma_f32_16x16x32_bf16 a[84:87], a[244:247], v[116:119], a[84:87]
s_waitcnt vmcnt(14) lgkmcnt(0)
s_barrier
v_mfma_f32_16x16x32_bf16 a[88:91], a[244:247], v[120:123], a[88:91]
buffer_load_dwordx4 v228, s[12:15], s24 offen  lds
v_mfma_f32_16x16x32_bf16 a[92:95], a[244:247], v[124:127], a[92:95]
s_add_u32 s36, s40, 0
buffer_load_dwordx4 a[136:139], v249, s[16:19], s36 offen offset:2048 sc1
v_mfma_f32_16x16x32_bf16 a[96:99], a[248:251], v[112:115], a[96:99]
s_add_u32 s37, s37, 2048
v_exp_f32 v30, v30
v_mfma_f32_16x16x32_bf16 a[100:103], a[248:251], v[116:119], a[100:103]
v_cvt_pk_bf16_f32 v110, v28, v29
v_mfma_f32_16x16x32_bf16 a[104:107], a[248:251], v[120:123], a[104:107]
v_exp_f32 v31, v31
v_mfma_f32_16x16x32_bf16 a[108:111], a[248:251], v[124:127], a[108:111]
buffer_load_dwordx4 a[140:143], v249, s[16:19], s36 offen offset:3072 sc1
v_mfma_f32_16x16x32_bf16 a[112:115], a[252:255], v[112:115], a[112:115]
v_exp_f32 v32, v32
v_mfma_f32_16x16x32_bf16 a[116:119], a[252:255], v[116:119], a[116:119]
v_cvt_pk_bf16_f32 v111, v30, v31
v_mfma_f32_16x16x32_bf16 a[120:123], a[252:255], v[120:123], a[120:123]
v_exp_f32 v33, v33
v_mfma_f32_16x16x32_bf16 a[124:127], a[252:255], v[124:127], a[124:127]
s_mov_b64 exec, 0
s_cmp_eq_u32 s27, 0
s_cbranch_scc1 Lpad15
s_cmp_eq_u32 s27, 1
s_cbranch_scc1 Lpad16
s_cmp_eq_u32 s27, 2
s_cbranch_scc1 Lpad17
s_branch Lpad18
Lwalk1:
s_mov_b64 exec, -1
v_mfma_f32_16x16x32_bf16 v[0:3], a[192:195], v[128:131], v[64:67]
v_exp_f32 v34, v34
v_mfma_f32_16x16x32_bf16 v[0:3], a[196:199], v[132:135], v[0:3]
ds_read_b64_tr_b16 a[224:225], v220 offset:16384
v_cvt_pk_bf16_f32 v112, v32, v33
v_mfma_f32_16x16x32_bf16 v[0:3], a[200:203], v[136:139], v[0:3]
v_exp_f32 v35, v35
v_mfma_f32_16x16x32_bf16 v[0:3], a[204:207], v[140:143], v[0:3]
ds_read_b64_tr_b16 a[226:227], v220 offset:24576
ds_read_b64_tr_b16 a[228:229], v221 offset:16384
v_mfma_f32_16x16x32_bf16 v[4:7], a[208:211], v[128:131], v[64:67]
v_exp_f32 v36, v36
v_mfma_f32_16x16x32_bf16 v[4:7], a[212:215], v[132:135], v[4:7]
ds_read_b64_tr_b16 a[230:231], v221 offset:24576
v_cvt_pk_bf16_f32 v113, v34, v35
v_mfma_f32_16x16x32_bf16 v[4:7], a[216:219], v[136:139], v[4:7]
v_exp_f32 v37, v37
v_mfma_f32_16x16x32_bf16 v[4:7], a[220:223], v[140:143], v[4:7]
buffer_load_dwordx4 v229, s[12:15], s24 offen offset:1024  lds
v_mfma_f32_16x16x32_bf16 v[8:11], a[192:195], v[144:147], v[68:71]
v_exp_f32 v38, v38
v_mfma_f32_16x16x32_bf16 v[8:11], a[196:199], v[148:151], v[8:11]
ds_read_b64_tr_b16 a[232:233], v222 offset:16384
v_cvt_pk_bf16_f32 v114, v36, v37
v_mfma_f32_16x16x32_bf16 v[8:11], a[200:203], v[152:155], v[8:11]
v_exp_f32 v39, v39
v_mfma_f32_16x16x32_bf16 v[8:11], a[204:207], v[156:159], v[8:11]
ds_read_b64_tr_b16 a[234:235], v222 offset:24576
ds_read_b64_tr_b16 a[236:237], v223 offset:16384
v_mfma_f32_16x16x32_bf16 v[12:15], a[208:211], v[144:147], v[68:71]
v_exp_f32 v40, v40
v_mfma_f32_16x16x32_bf16 v[12:15], a[212:215], v[148:151], v[12:15]
ds_read_b64_tr_b16 a[238:239], v223 offset:24576
v_cvt_pk_bf16_f32 v115, v38, v39
v_mfma_f32_16x16x32_bf16 v[12:15], a[216:219], v[152:155], v[12:15]
v_exp_f32 v41, v41
v_mfma_f32_16x16x32_bf16 v[12:15], a[220:223], v[156:159], v[12:15]
ds_read_b64_tr_b16 a[240:241], v224 offset:16384
ds_read_b64_tr_b16 a[242:243], v224 offset:24576
v_mfma_f32_16x16x32_bf16 v[16:19], a[192:195], v[160:163], v[72:75]
v_exp_f32 v42, v42
v_mfma_f32_16x16x32_bf16 v[16:19], a[196:199], v[164:167], v[16:19]
ds_read_b64_tr_b16 a[244:245], v225 offset:16384
v_cvt_pk_bf16_f32 v116, v40, v41
v_mfma_f32_16x16x32_bf16 v[16:19], a[200:203], v[168:171], v[16:19]
v_exp_f32 v43, v43
v_mfma_f32_16x16x32_bf16 v[16:19], a[204:207], v[172:175], v[16:19]
ds_read_b64_tr_b16 a[246:247], v225 offset:24576
ds_read_b64_tr_b16 a[248:249], v226 offset:16384
v_mfma_f32_16x16x32_bf16 v[20:23], a[208:211], v[160:163], v[72:75]
v_exp_f32 v44, v44
v_mfma_f32_16x16x32_bf16 v[20:23], a[212:215], v[164:167], v[20:23]
ds_read_b64_tr_b16 a[250:251], v226 offset:24576
v_cvt_pk_bf16_f32 v117, v42, v43
v_mfma_f32_16x16x32_bf16 v[20:23], a[216:219], v[168:171], v[20:23]
v_exp_f32 v45, v45
v_mfma_f32_16x16x32_bf16 v[20:23], a[220:223], v[172:175], v[20:23]
buffer_load_dwordx4 v230, s[8:11], s24 offen offset:2048  lds
v_mfma_f32_16x16x32_bf16 v[24:27], a[192:195], v[176:179], v[76:79]
v_exp_f32 v46, v46
v_mfma_f32_16x16x32_bf16 v[24:27], a[196:199], v[180:183], v[24:27]
ds_read_b64_tr_b16 a[252:253], v227 offset:16384
v_cvt_pk_bf16_f32 v118, v44, v45
v_mfma_f32_16x16x32_bf16 v[24:27], a[200:203], v[184:187], v[24:27]
v_exp_f32 v47, v47
v_mfma_f32_16x16x32_bf16 v[24:27], a[204:207], v[188:191], v[24:27]
ds_read_b64_tr_b16 a[254:255], v227 offset:24576
v_mfma_f32_16x16x32_bf16 v[28:31], a[208:211], v[176:179], v[76:79]
v_exp_f32 v48, v48
v_smfmac_f32_16x16x64_bf16 v[80:83], v[232:235], v[96:103], v88
v_cvt_pk_bf16_f32 v119, v46, v47
v_mfma_f32_16x16x32_bf16 v[28:31], a[212:215], v[180:183], v[28:31]
v_exp_f32 v49, v49
v_mfma_f32_16x16x32_bf16 v[28:31], a[216:219], v[184:187], v[28:31]
buffer_load_dwordx4 v[200:203], v214, s[16:19], s37 offen offset:2048 sc1
v_mfma_f32_16x16x32_bf16 v[28:31], a[220:223], v[188:191], v[28:31]
v_exp_f32 v50, v50
v_smfmac_f32_16x16x64_bf16 v[84:87], v[232:235], v[104:111], v88
s_waitcnt lgkmcnt(0)
v_cvt_pk_bf16_f32 v120, v48, v49
v_mfma_f32_16x16x32_bf16 a[0:3], a[224:227], v[96:99], a[0:3]
v_exp_f32 v51, v51
v_mfma_f32_16x16x32_bf16 a[4:7], a[224:227], v[100:103], a[4:7]
v_exp_f32 v52, v52
v_mfma_f32_16x16x32_bf16 a[8:11], a[224:227], v[104:107], a[8:11]
ds_read_b128 a[192:195], v216 offset:16384
v_cvt_pk_bf16_f32 v121, v50, v51
v_mfma_f32_16x16x32_bf16 a[12:15], a[224:227], v[108:111], a[12:15]
v_exp_f32 v53, v53
v_mfma_f32_16x16x32_bf16 a[16:19], a[228:231], v[96:99], a[16:19]
ds_read_b128 a[196:199], v217 offset:16384
ds_read_b128 a[200:203], v218 offset:16384
v_mfma_f32_16x16x32_bf16 a[20:23], a[228:231], v[100:103], a[20:23]
v_exp_f32 v54, v54
v_mfma_f32_16x16x32_bf16 a[24:27], a[228:231], v[104:107], a[24:27]
ds_read_b128 a[204:207], v219 offset:16384
v_cvt_pk_bf16_f32 v122, v52, v53
v_mfma_f32_16x16x32_bf16 a[28:31], a[228:231], v[108:111], a[28:31]
v_exp_f32 v55, v55
v_mfma_f32_16x16x32_bf16 a[32:35], a[232:235], v[96:99], a[32:35]
buffer_load_dwordx4 v231, s[8:11], s24 offen offset:3072  lds
v_mfma_f32_16x16x32_bf16 a[36:39], a[232:235], v[100:103], a[36:39]
s_add_u32 s24, s24, 8192
v_exp_f32 v56, v56
v_mfma_f32_16x16x32_bf16 a[40:43], a[232:235], v[104:107], a[40:43]
ds_read_b128 a[208:211], v216 offset:24576
v_cvt_pk_bf16_f32 v123, v54, v55
v_mfma_f32_16x16x32_bf16 a[44:47], a[232:235], v[108:111], a[44:47]
v_exp_f32 v57, v57
v_mfma_f32_16x16x32_bf16 a[48:51], a[236:239], v[96:99], a[48:51]
ds_read_b128 a[212:215], v217 offset:24576
ds_read_b128 a[216:219], v218 offset:24576
v_mfma_f32_16x16x32_bf16 a[52:55], a[236:239], v[100:103], a[52:55]
v_exp_f32 v58, v58
v_mfma_f32_16x16x32_bf16 a[56:59], a[236:239], v[104:107], a[56:59]
ds_read_b128 a[220:223], v219 offset:24576
v_cvt_pk_bf16_f32 v124, v56, v57
v_mfma_f32_16x16x32_bf16 a[60:63], a[236:239], v[108:111], a[60:63]
v_exp_f32 v59, v59
v_mfma_f32_16x16x32_bf16 a[64:67], a[240:243], v[96:99], a[64:67]
buffer_load_dwordx4 v[204:207], v214, s[16:19], s37 offen offset:2064 sc1
v_mfma_f32_16x16x32_bf16 a[68:71], a[240:243], v[100:103], a[68:71]
v_exp_f32 v60, v60
v_mfma_f32_16x16x32_bf16 a[72:75], a[240:243], v[104:107], a[72:75]
v_cvt_pk_bf16_f32 v125, v58, v59
v_mfma_f32_16x16x32_bf16 a[76:79], a[240:243], v[108:111], a[76:79]
v_exp_f32 v61, v61
v_mfma_f32_16x16x32_bf16 a[80:83], a[244:247], v[96:99], a[80:83]
s_lshl1_add_u32 m0, s26, 16384
v_mfma_f32_16x16x32_bf16 a[84:87], a[244:247], v[100:103], a[84:87]
s_waitcnt vmcnt(16) lgkmcnt(0)
s_barrier
v_mfma_f32_16x16x32_bf16 a[88:91], a[244:247], v[104:107], a[88:91]
buffer_load_dwordx4 v228, s[12:15], s24 offen  lds
v_mfma_f32_16x16x32_bf16 a[92:95], a[244:247], v[108:111], a[92:95]
s_add_u32 s36, s40, 4096
buffer_load_dwordx4 a[144:147], v249, s[16:19], s36 offen offset:0 sc1
v_mfma_f32_16x16x32_bf16 a[96:99], a[248:251], v[96:99], a[96:99]
v_exp_f32 v62, v62
v_mfma_f32_16x16x32_bf16 a[100:103], a[248:251], v[100:103], a[100:103]
v_cvt_pk_bf16_f32 v126, v60, v61
v_mfma_f32_16x16x32_bf16 a[104:107], a[248:251], v[104:107], a[104:107]
v_exp_f32 v63, v63
v_mfma_f32_16x16x32_bf16 a[108:111], a[248:251], v[108:111], a[108:111]
buffer_load_dwordx4 a[148:151], v249, s[16:19], s36 offen offset:1024 sc1
v_mfma_f32_16x16x32_bf16 a[112:115], a[252:255], v[96:99], a[112:115]
v_exp_f32 v0, v0
v_mfma_f32_16x16x32_bf16 a[116:119], a[252:255], v[100:103], a[116:119]
v_cvt_pk_bf16_f32 v127, v62, v63
v_mfma_f32_16x16x32_bf16 a[120:123], a[252:255], v[104:107], a[120:123]
v_exp_f32 v1, v1
v_mfma_f32_16x16x32_bf16 a[124:127], a[252:255], v[108:111], a[124:127]
v_mfma_f32_16x16x32_bf16 v[32:35], a[192:195], v[128:131], v[64:67]
v_exp_f32 v2, v2
v_mfma_f32_16x16x32_bf16 v[32:35], a[196:199], v[132:135], v[32:35]
ds_read_b64_tr_b16 a[224:225], v220 offset:32768
v_cvt_pk_bf16_f32 v96, v0, v1
v_mfma_f32_16x16x32_bf16 v[32:35], a[200:203], v[136:139], v[32:35]
v_exp_f32 v3, v3
v_mfma_f32_16x16x32_bf16 v[32:35], a[204:207], v[140:143], v[32:35]
ds_read_b64_tr_b16 a[226:227], v220 offset:40960
ds_read_b64_tr_b16 a[228:229], v221 offset:32768
v_mfma_f32_16x16x32_bf16 v[36:39], a[208:211], v[128:131], v[64:67]
v_exp_f32 v4, v4
v_mfma_f32_16x16x32_bf16 v[36:39], a[212:215], v[132:135], v[36:39]
ds_read_b64_tr_b16 a[230:231], v221 offset:40960
v_cvt_pk_bf16_f32 v97, v2, v3
v_mfma_f32_16x16x32_bf16 v[36:39], a[216:219], v[136:139], v[36:39]
v_exp_f32 v5, v5
v_mfma_f32_16x16x32_bf16 v[36:39], a[220:223], v[140:143], v[36:39]
buffer_load_dwordx4 v229, s[12:15], s24 offen offset:1024  lds
v_mfma_f32_16x16x32_bf16 v[40:43], a[192:195], v[144:147], v[68:71]
v_exp_f32 v6, v6
v_mfma_f32_16x16x32_bf16 v[40:43], a[196:199], v[148:151], v[40:43]
ds_read_b64_tr_b16 a[232:233], v222 offset:32768
v_cvt_pk_bf16_f32 v98, v4, v5
v_mfma_f32_16x16x32_bf16 v[40:43], a[200:203], v[152:155], v[40:43]
v_exp_f32 v7, v7
v_mfma_f32_16x16x32_bf16 v[40:43], a[204:207], v[156:159], v[40:43]
ds_read_b64_tr_b16 a[234:235], v222 offset:40960
ds_read_b64_tr_b16 a[236:237], v223 offset:32768
v_mfma_f32_16x16x32_bf16 v[44:47], a[208:211], v[144:147], v[68:71]
v_exp_f32 v8, v8
v_mfma_f32_16x16x32_bf16 v[44:47], a[212:215], v[148:151], v[44:47]
ds_read_b64_tr_b16 a[238:239], v223 offset:40960
v_cvt_pk_bf16_f32 v99, v6, v7
v_mfma_f32_16x16x32_bf16 v[44:47], a[216:219], v[152:155], v[44:47]
v_exp_f32 v9, v9
v_mfma_f32_16x16x32_bf16 v[44:47], a[220:223], v[156:159], v[44:47]
ds_read_b64_tr_b16 a[240:241], v224 offset:32768
ds_read_b64_tr_b16 a[242:243], v224 offset:40960
v_mfma_f32_16x16x32_bf16 v[48:51], a[192:195], v[160:163], v[72:75]
v_exp_f32 v10, v10
v_mfma_f32_16x16x32_bf16 v[48:51], a[196:199], v[164:167], v[48:51]
ds_read_b64_tr_b16 a[244:245], v225 offset:32768
v_cvt_pk_bf16_f32 v100, v8, v9
v_mfma_f32_16x16x32_bf16 v[48:51], a[200:203], v[168:171], v[48:51]
v_exp_f32 v11, v11
v_mfma_f32_16x16x32_bf16 v[48:51], a[204:207], v[172:175], v[48:51]
ds_read_b64_tr_b16 a[246:247], v225 offset:40960
ds_read_b64_tr_b16 a[248:249], v226 offset:32768
v_mfma_f32_16x16x32_bf16 v[52:55], a[208:211], v[160:163], v[72:75]
v_exp_f32 v12, v12
v_mfma_f32_16x16x32_bf16 v[52:55], a[212:215], v[164:167], v[52:55]
ds_read_b64_tr_b16 a[250:251], v226 offset:40960
v_cvt_pk_bf16_f32 v101, v10, v11
v_mfma_f32_16x16x32_bf16 v[52:55], a[216:219], v[168:171], v[52:55]
v_exp_f32 v13, v13
v_mfma_f32_16x16x32_bf16 v[52:55], a[220:223], v[172:175], v[52:55]
buffer_load_dwordx4 v230, s[8:11], s24 offen offset:2048  lds
v_mfma_f32_16x16x32_bf16 v[56:59], a[192:195], v[176:179], v[76:79]
v_exp_f32 v14, v14
v_mfma_f32_16x16x32_bf16 v[56:59], a[196:199], v[180:183], v[56:59]
ds_read_b64_tr_b16 a[252:253], v227 offset:32768
v_cvt_pk_bf16_f32 v102, v12, v13
v_mfma_f32_16x16x32_bf16 v[56:59], a[200:203], v[184:187], v[56:59]
v_exp_f32 v15, v15
v_mfma_f32_16x16x32_bf16 v[56:59], a[204:207], v[188:191], v[56:59]
ds_read_b64_tr_b16 a[254:255], v227 offset:40960
v_mfma_f32_16x16x32_bf16 v[60:63], a[208:211], v[176:179], v[76:79]
v_exp_f32 v16, v16
v_smfmac_f32_16x16x64_bf16 v[80:83], v[232:235], v[112:119], v88
v_cvt_pk_bf16_f32 v103, v14, v15
v_mfma_f32_16x16x32_bf16 v[60:63], a[212:215], v[180:183], v[60:63]
v_exp_f32 v17, v17
v_mfma_f32_16x16x32_bf16 v[60:63], a[216:219], v[184:187], v[60:63]
buffer_load_dwordx4 v[208:211], v255, s[96:99], 0 offen
v_mfma_f32_16x16x32_bf16 v[60:63], a[220:223], v[188:191], v[60:63]
v_exp_f32 v18, v18
v_smfmac_f32_16x16x64_bf16 v[84:87], v[232:235], v[120:127], v88
s_waitcnt lgkmcnt(0)
v_cvt_pk_bf16_f32 v104, v16, v17
v_mfma_f32_16x16x32_bf16 a[0:3], a[224:227], v[112:115], a[0:3]
v_exp_f32 v19, v19
v_mfma_f32_16x16x32_bf16 a[4:7], a[224:227], v[116:119], a[4:7]
v_exp_f32 v20, v20
v_mfma_f32_16x16x32_bf16 a[8:11], a[224:227], v[120:123], a[8:11]
ds_read_b128 a[192:195], v216 offset:32768
v_cvt_pk_bf16_f32 v105, v18, v19
v_mfma_f32_16x16x32_bf16 a[12:15], a[224:227], v[124:127], a[12:15]
v_exp_f32 v21, v21
v_mfma_f32_16x16x32_bf16 a[16:19], a[228:231], v[112:115], a[16:19]
ds_read_b128 a[196:199], v217 offset:32768
ds_read_b128 a[200:203], v218 offset:32768
v_mfma_f32_16x16x32_bf16 a[20:23], a[228:231], v[116:119], a[20:23]
v_exp_f32 v22, v22
v_mfma_f32_16x16x32_bf16 a[24:27], a[228:231], v[120:123], a[24:27]
ds_read_b128 a[204:207], v219 offset:32768
v_cvt_pk_bf16_f32 v106, v20, v21
v_mfma_f32_16x16x32_bf16 a[28:31], a[228:231], v[124:127], a[28:31]
v_exp_f32 v23, v23
v_mfma_f32_16x16x32_bf16 a[32:35], a[232:235], v[112:115], a[32:35]
buffer_load_dwordx4 v231, s[8:11], s24 offen offset:3072  lds
v_mfma_f32_16x16x32_bf16 a[36:39], a[232:235], v[116:119], a[36:39]
s_add_u32 s24, s24, 8192
v_exp_f32 v24, v24
v_mfma_f32_16x16x32_bf16 a[40:43], a[232:235], v[120:123], a[40:43]
ds_read_b128 a[208:211], v216 offset:40960
v_cvt_pk_bf16_f32 v107, v22, v23
v_mfma_f32_16x16x32_bf16 a[44:47], a[232:235], v[124:127], a[44:47]
v_exp_f32 v25, v25
v_mfma_f32_16x16x32_bf16 a[48:51], a[236:239], v[112:115], a[48:51]
ds_read_b128 a[212:215], v217 offset:40960
ds_read_b128 a[216:219], v218 offset:40960
v_mfma_f32_16x16x32_bf16 a[52:55], a[236:239], v[116:119], a[52:55]
v_exp_f32 v26, v26
v_mfma_f32_16x16x32_bf16 a[56:59], a[236:239], v[120:123], a[56:59]
ds_read_b128 a[220:223], v219 offset:40960
v_cvt_pk_bf16_f32 v108, v24, v25
v_mfma_f32_16x16x32_bf16 a[60:63], a[236:239], v[124:127], a[60:63]
v_exp_f32 v27, v27
v_mfma_f32_16x16x32_bf16 a[64:67], a[240:243], v[112:115], a[64:67]
v_mfma_f32_16x16x32_bf16 a[68:71], a[240:243], v[116:119], a[68:71]
v_exp_f32 v28, v28
v_mfma_f32_16x16x32_bf16 a[72:75], a[240:243], v[120:123], a[72:75]
v_cvt_pk_bf16_f32 v109, v26, v27
v_mfma_f32_16x16x32_bf16 a[76:79], a[240:243], v[124:127], a[76:79]
v_exp_f32 v29, v29
v_mfma_f32_16x16x32_bf16 a[80:83], a[244:247], v[112:115], a[80:83]
s_lshl1_add_u32 m0, s26, 32768
v_mfma_f32_16x16x32_bf16 a[84:87], a[244:247], v[116:119], a[84:87]
s_waitcnt vmcnt(16) lgkmcnt(0)
s_barrier
v_mfma_f32_16x16x32_bf16 a[88:91], a[244:247], v[120:123], a[88:91]
buffer_load_dwordx4 v228, s[12:15], s24 offen  lds
v_mfma_f32_16x16x32_bf16 a[92:95], a[244:247], v[124:127], a[92:95]
s_add_u32 s36, s40, 4096
buffer_load_dwordx4 a[152:155], v249, s[16:19], s36 offen offset:2048 sc1
v_mfma_f32_16x16x32_bf16 a[96:99], a[248:251], v[112:115], a[96:99]
v_exp_f32 v30, v30
v_mfma_f32_16x16x32_bf16 a[100:103], a[248:251], v[116:119], a[100:103]
v_cvt_pk_bf16_f32 v110, v28, v29
v_mfma_f32_16x16x32_bf16 a[104:107], a[248:251], v[120:123], a[104:107]
v_exp_f32 v31, v31
v_mfma_f32_16x16x32_bf16 a[108:111], a[248:251], v[124:127], a[108:111]
buffer_load_dwordx4 a[156:159], v249, s[16:19], s36 offen offset:3072 sc1
v_mfma_f32_16x16x32_bf16 a[112:115], a[252:255], v[112:115], a[112:115]
v_exp_f32 v32, v32
v_mfma_f32_16x16x32_bf16 a[116:119], a[252:255], v[116:119], a[116:119]
v_cvt_pk_bf16_f32 v111, v30, v31
v_mfma_f32_16x16x32_bf16 a[120:123], a[252:255], v[120:123], a[120:123]
v_exp_f32 v33, v33
v_mfma_f32_16x16x32_bf16 a[124:127], a[252:255], v[124:127], a[124:127]
v_mfma_f32_16x16x32_bf16 v[0:3], a[192:195], v[128:131], v[64:67]
v_exp_f32 v34, v34
v_mfma_f32_16x16x32_bf16 v[0:3], a[196:199], v[132:135], v[0:3]
ds_read_b64_tr_b16 a[224:225], v220 offset:49152
v_cvt_pk_bf16_f32 v112, v32, v33
v_mfma_f32_16x16x32_bf16 v[0:3], a[200:203], v[136:139], v[0:3]
v_exp_f32 v35, v35
v_mfma_f32_16x16x32_bf16 v[0:3], a[204:207], v[140:143], v[0:3]
ds_read_b64_tr_b16 a[226:227], v220 offset:57344
ds_read_b64_tr_b16 a[228:229], v221 offset:49152
v_mfma_f32_16x16x32_bf16 v[4:7], a[208:211], v[128:131], v[64:67]
v_exp_f32 v36, v36
v_mfma_f32_16x16x32_bf16 v[4:7], a[212:215], v[132:135], v[4:7]
ds_read_b64_tr_b16 a[230:231], v221 offset:57344
v_cvt_pk_bf16_f32 v113, v34, v35
v_mfma_f32_16x16x32_bf16 v[4:7], a[216:219], v[136:139], v[4:7]
v_exp_f32 v37, v37
v_mfma_f32_16x16x32_bf16 v[4:7], a[220:223], v[140:143], v[4:7]
buffer_load_dwordx4 v229, s[12:15], s24 offen offset:1024  lds
v_mfma_f32_16x16x32_bf16 v[8:11], a[192:195], v[144:147], v[68:71]
v_exp_f32 v38, v38
v_mfma_f32_16x16x32_bf16 v[8:11], a[196:199], v[148:151], v[8:11]
ds_read_b64_tr_b16 a[232:233], v222 offset:49152
v_cvt_pk_bf16_f32 v114, v36, v37
v_mfma_f32_16x16x32_bf16 v[8:11], a[200:203], v[152:155], v[8:11]
v_exp_f32 v39, v39
v_mfma_f32_16x16x32_bf16 v[8:11], a[204:207], v[156:159], v[8:11]
ds_read_b64_tr_b16 a[234:235], v222 offset:57344
ds_read_b64_tr_b16 a[236:237], v223 offset:49152
v_mfma_f32_16x16x32_bf16 v[12:15], a[208:211], v[144:147], v[68:71]
v_exp_f32 v40, v40
v_mfma_f32_16x16x32_bf16 v[12:15], a[212:215], v[148:151], v[12:15]
ds_read_b64_tr_b16 a[238:239], v223 offset:57344
v_cvt_pk_bf16_f32 v115, v38, v39
v_mfma_f32_16x16x32_bf16 v[12:15], a[216:219], v[152:155], v[12:15]
v_exp_f32 v41, v41
v_mfma_f32_16x16x32_bf16 v[12:15], a[220:223], v[156:159], v[12:15]
Lpad15:
s_cbranch_execz Lpad19
ds_read_b64_tr_b16 a[240:241], v224 offset:49152
ds_read_b64_tr_b16 a[242:243], v224 offset:57344
v_mfma_f32_16x16x32_bf16 v[16:19], a[192:195], v[160:163], v[72:75]
v_exp_f32 v42, v42
v_mfma_f32_16x16x32_bf16 v[16:19], a[196:199], v[164:167], v[16:19]
ds_read_b64_tr_b16 a[244:245], v225 offset:49152
v_cvt_pk_bf16_f32 v116, v40, v41
v_mfma_f32_16x16x32_bf16 v[16:19], a[200:203], v[168:171], v[16:19]
v_exp_f32 v43, v43
v_mfma_f32_16x16x32_bf16 v[16:19], a[204:207], v[172:175], v[16:19]
ds_read_b64_tr_b16 a[246:247], v225 offset:57344
ds_read_b64_tr_b16 a[248:249], v226 offset:49152
v_mfma_f32_16x16x32_bf16 v[20:23], a[208:211], v[160:163], v[72:75]
v_exp_f32 v44, v44
v_mfma_f32_16x16x32_bf16 v[20:23], a[212:215], v[164:167], v[20:23]
ds_read_b64_tr_b16 a[250:251], v226 offset:57344
v_cvt_pk_bf16_f32 v117, v42, v43
v_mfma_f32_16x16x32_bf16 v[20:23], a[216:219], v[168:171], v[20:23]
v_exp_f32 v45, v45
v_mfma_f32_16x16x32_bf16 v[20:23], a[220:223], v[172:175], v[20:23]
buffer_load_dwordx4 v230, s[8:11], s24 offen offset:2048  lds
v_mfma_f32_16x16x32_bf16 v[24:27], a[192:195], v[176:179], v[76:79]
v_exp_f32 v46, v46
v_mfma_f32_16x16x32_bf16 v[24:27], a[196:199], v[180:183], v[24:27]
ds_read_b64_tr_b16 a[252:253], v227 offset:49152
v_cvt_pk_bf16_f32 v118, v44, v45
v_mfma_f32_16x16x32_bf16 v[24:27], a[200:203], v[184:187], v[24:27]
v_exp_f32 v47, v47
v_mfma_f32_16x16x32_bf16 v[24:27], a[204:207], v[188:191], v[24:27]
ds_read_b64_tr_b16 a[254:255], v227 offset:57344
v_mfma_f32_16x16x32_bf16 v[28:31], a[208:211], v[176:179], v[76:79]
v_exp_f32 v48, v48
v_smfmac_f32_16x16x64_bf16 v[80:83], v[232:235], v[96:103], v88
v_cvt_pk_bf16_f32 v119, v46, v47
v_mfma_f32_16x16x32_bf16 v[28:31], a[212:215], v[180:183], v[28:31]
v_exp_f32 v49, v49
v_mfma_f32_16x16x32_bf16 v[28:31], a[216:219], v[184:187], v[28:31]
v_mfma_f32_16x16x32_bf16 v[28:31], a[220:223], v[188:191], v[28:31]
v_exp_f32 v50, v50
v_smfmac_f32_16x16x64_bf16 v[84:87], v[232:235], v[104:111], v88
s_waitcnt lgkmcnt(0)
v_cvt_pk_bf16_f32 v120, v48, v49
v_mfma_f32_16x16x32_bf16 a[0:3], a[224:227], v[96:99], a[0:3]
v_exp_f32 v51, v51
v_mfma_f32_16x16x32_bf16 a[4:7], a[224:227], v[100:103], a[4:7]
v_exp_f32 v52, v52
v_mfma_f32_16x16x32_bf16 a[8:11], a[224:227], v[104:107], a[8:11]
ds_read_b128 a[192:195], v216 offset:49152
v_cvt_pk_bf16_f32 v121, v50, v51
v_mfma_f32_16x16x32_bf16 a[12:15], a[224:227], v[108:111], a[12:15]
v_exp_f32 v53, v53
v_mfma_f32_16x16x32_bf16 a[16:19], a[228:231], v[96:99], a[16:19]
ds_read_b128 a[196:199], v217 offset:49152
ds_read_b128 a[200:203], v218 offset:49152
v_mfma_f32_16x16x32_bf16 a[20:23], a[228:231], v[100:103], a[20:23]
v_exp_f32 v54, v54
v_mfma_f32_16x16x32_bf16 a[24:27], a[228:231], v[104:107], a[24:27]
ds_read_b128 a[204:207], v219 offset:49152
v_cvt_pk_bf16_f32 v122, v52, v53
v_mfma_f32_16x16x32_bf16 a[28:31], a[228:231], v[108:111], a[28:31]
v_exp_f32 v55, v55
v_mfma_f32_16x16x32_bf16 a[32:35], a[232:235], v[96:99], a[32:35]
buffer_load_dwordx4 v231, s[8:11], s24 offen offset:3072  lds
v_mfma_f32_16x16x32_bf16 a[36:39], a[232:235], v[100:103], a[36:39]
s_add_u32 s24, s24, 8192
v_exp_f32 v56, v56
v_mfma_f32_16x16x32_bf16 a[40:43], a[232:235], v[104:107], a[40:43]
ds_read_b128 a[208:211], v216 offset:57344
v_cvt_pk_bf16_f32 v123, v54, v55
v_mfma_f32_16x16x32_bf16 a[44:47], a[232:235], v[108:111], a[44:47]
v_exp_f32 v57, v57
v_mfma_f32_16x16x32_bf16 a[48:51], a[236:239], v[96:99], a[48:51]
ds_read_b128 a[212:215], v217 offset:57344
ds_read_b128 a[216:219], v218 offset:57344
v_mfma_f32_16x16x32_bf16 a[52:55], a[236:239], v[100:103], a[52:55]
v_exp_f32 v58, v58
v_mfma_f32_16x16x32_bf16 a[56:59], a[236:239], v[104:107], a[56:59]
ds_read_b128 a[220:223], v219 offset:57344
v_cvt_pk_bf16_f32 v124, v56, v57
v_mfma_f32_16x16x32_bf16 a[60:63], a[236:239], v[108:111], a[60:63]
v_exp_f32 v59, v59
v_mfma_f32_16x16x32_bf16 a[64:67], a[240:243], v[96:99], a[64:67]
v_mfma_f32_16x16x32_bf16 a[68:71], a[240:243], v[100:103], a[68:71]
v_exp_f32 v60, v60
v_mfma_f32_16x16x32_bf16 a[72:75], a[240:243], v[104:107], a[72:75]
v_cvt_pk_bf16_f32 v125, v58, v59
v_mfma_f32_16x16x32_bf16 a[76:79], a[240:243], v[108:111], a[76:79]
v_exp_f32 v61, v61
v_mfma_f32_16x16x32_bf16 a[80:83], a[244:247], v[96:99], a[80:83]
s_lshl1_add_u32 m0, s26, 49152
v_mfma_f32_16x16x32_bf16 a[84:87], a[244:247], v[100:103], a[84:87]
s_waitcnt vmcnt(14) lgkmcnt(0)
s_barrier
v_mfma_f32_16x16x32_bf16 a[88:91], a[244:247], v[104:107], a[88:91]
buffer_load_dwordx4 v228, s[12:15], s24 offen  lds
v_mfma_f32_16x16x32_bf16 a[92:95], a[244:247], v[108:111], a[92:95]
s_add_u32 s36, s40, 8192
buffer_load_dwordx4 a[160:163], v249, s[16:19], s36 offen offset:0 sc1
v_mfma_f32_16x16x32_bf16 a[96:99], a[248:251], v[96:99], a[96:99]
v_exp_f32 v62, v62
v_mfma_f32_16x16x32_bf16 a[100:103], a[248:251], v[100:103], a[100:103]
v_cvt_pk_bf16_f32 v126, v60, v61
v_mfma_f32_16x16x32_bf16 a[104:107], a[248:251], v[104:107], a[104:107]
v_exp_f32 v63, v63
v_mfma_f32_16x16x32_bf16 a[108:111], a[248:251], v[108:111], a[108:111]
buffer_load_dwordx4 a[164:167], v249, s[16:19], s36 offen offset:1024 sc1
v_mfma_f32_16x16x32_bf16 a[112:115], a[252:255], v[96:99], a[112:115]
v_exp_f32 v0, v0
v_mfma_f32_16x16x32_bf16 a[116:119], a[252:255], v[100:103], a[116:119]
v_cvt_pk_bf16_f32 v127, v62, v63
v_mfma_f32_16x16x32_bf16 a[120:123], a[252:255], v[104:107], a[120:123]
v_exp_f32 v1, v1
v_mfma_f32_16x16x32_bf16 a[124:127], a[252:255], v[108:111], a[124:127]
v_mfma_f32_16x16x32_bf16 v[32:35], a[192:195], v[128:131], v[64:67]
v_exp_f32 v2, v2
v_mfma_f32_16x16x32_bf16 v[32:35], a[196:199], v[132:135], v[32:35]
ds_read_b64_tr_b16 a[224:225], v220 offset:0
v_cvt_pk_bf16_f32 v96, v0, v1
v_mfma_f32_16x16x32_bf16 v[32:35], a[200:203], v[136:139], v[32:35]
v_exp_f32 v3, v3
v_mfma_f32_16x16x32_bf16 v[32:35], a[204:207], v[140:143], v[32:35]
ds_read_b64_tr_b16 a[226:227], v220 offset:8192
ds_read_b64_tr_b16 a[228:229], v221 offset:0
v_mfma_f32_16x16x32_bf16 v[36:39], a[208:211], v[128:131], v[64:67]
v_exp_f32 v4, v4
v_mfma_f32_16x16x32_bf16 v[36:39], a[212:215], v[132:135], v[36:39]
ds_read_b64_tr_b16 a[230:231], v221 offset:8192
v_cvt_pk_bf16_f32 v97, v2, v3
v_mfma_f32_16x16x32_bf16 v[36:39], a[216:219], v[136:139], v[36:39]
v_exp_f32 v5, v5
v_mfma_f32_16x16x32_bf16 v[36:39], a[220:223], v[140:143], v[36:39]
buffer_load_dwordx4 v229, s[12:15], s24 offen offset:1024  lds
v_mfma_f32_16x16x32_bf16 v[40:43], a[192:195], v[144:147], v[68:71]
v_exp_f32 v6, v6
v_mfma_f32_16x16x32_bf16 v[40:43], a[196:199], v[148:151], v[40:43]
ds_read_b64_tr_b16 a[232:233], v222 offset:0
v_cvt_pk_bf16_f32 v98, v4, v5
v_mfma_f32_16x16x32_bf16 v[40:43], a[200:203], v[152:155], v[40:43]
v_exp_f32 v7, v7
v_mfma_f32_16x16x32_bf16 v[40:43], a[204:207], v[156:159], v[40:43]
ds_read_b64_tr_b16 a[234:235], v222 offset:8192
ds_read_b64_tr_b16 a[236:237], v223 offset:0
v_mfma_f32_16x16x32_bf16 v[44:47], a[208:211], v[144:147], v[68:71]
v_exp_f32 v8, v8
v_mfma_f32_16x16x32_bf16 v[44:47], a[212:215], v[148:151], v[44:47]
ds_read_b64_tr_b16 a[238:239], v223 offset:8192
v_cvt_pk_bf16_f32 v99, v6, v7
v_mfma_f32_16x16x32_bf16 v[44:47], a[216:219], v[152:155], v[44:47]
v_exp_f32 v9, v9
v_mfma_f32_16x16x32_bf16 v[44:47], a[220:223], v[156:159], v[44:47]
ds_read_b64_tr_b16 a[240:241], v224 offset:0
ds_read_b64_tr_b16 a[242:243], v224 offset:8192
v_mfma_f32_16x16x32_bf16 v[48:51], a[192:195], v[160:163], v[72:75]
v_exp_f32 v10, v10
v_mfma_f32_16x16x32_bf16 v[48:51], a[196:199], v[164:167], v[48:51]
ds_read_b64_tr_b16 a[244:245], v225 offset:0
v_cvt_pk_bf16_f32 v100, v8, v9
v_mfma_f32_16x16x32_bf16 v[48:51], a[200:203], v[168:171], v[48:51]
v_exp_f32 v11, v11
v_mfma_f32_16x16x32_bf16 v[48:51], a[204:207], v[172:175], v[48:51]
ds_read_b64_tr_b16 a[246:247], v225 offset:8192
ds_read_b64_tr_b16 a[248:249], v226 offset:0
v_mfma_f32_16x16x32_bf16 v[52:55], a[208:211], v[160:163], v[72:75]
v_exp_f32 v12, v12
v_mfma_f32_16x16x32_bf16 v[52:55], a[212:215], v[164:167], v[52:55]
ds_read_b64_tr_b16 a[250:251], v226 offset:8192
v_cvt_pk_bf16_f32 v101, v10, v11
v_mfma_f32_16x16x32_bf16 v[52:55], a[216:219], v[168:171], v[52:55]
v_exp_f32 v13, v13
v_mfma_f32_16x16x32_bf16 v[52:55], a[220:223], v[172:175], v[52:55]
buffer_load_dwordx4 v230, s[8:11], s24 offen offset:2048  lds
v_mfma_f32_16x16x32_bf16 v[56:59], a[192:195], v[176:179], v[76:79]
v_exp_f32 v14, v14
v_mfma_f32_16x16x32_bf16 v[56:59], a[196:199], v[180:183], v[56:59]
ds_read_b64_tr_b16 a[252:253], v227 offset:0
v_cvt_pk_bf16_f32 v102, v12, v13
v_mfma_f32_16x16x32_bf16 v[56:59], a[200:203], v[184:187], v[56:59]
s_waitcnt vmcnt(12)
v_exp_f32 v15, v15
v_mfma_f32_16x16x32_bf16 v[56:59], a[204:207], v[188:191], v[56:59]
ds_read_b64_tr_b16 a[254:255], v227 offset:8192
v_lshlrev_b32 v212, 16, v208
v_mfma_f32_16x16x32_bf16 v[60:63], a[208:211], v[176:179], v[76:79]
v_exp_f32 v16, v16
v_smfmac_f32_16x16x64_bf16 v[80:83], v[232:235], v[112:119], v88
v_cvt_pk_bf16_f32 v103, v14, v15
v_mfma_f32_16x16x32_bf16 v[60:63], a[212:215], v[180:183], v[60:63]
v_exp_f32 v17, v17
v_mfma_f32_16x16x32_bf16 v[60:63], a[216:219], v[184:187], v[60:63]
v_and_b32 v213, 0xffff0000, v208
v_mul_f32 v251, v200, v212
v_mfma_f32_16x16x32_bf16 v[60:63], a[220:223], v[188:191], v[60:63]
v_exp_f32 v18, v18
v_smfmac_f32_16x16x64_bf16 v[84:87], v[232:235], v[120:127], v88
s_waitcnt lgkmcnt(0)
v_cvt_pk_bf16_f32 v104, v16, v17
v_mfma_f32_16x16x32_bf16 a[0:3], a[224:227], v[112:115], a[0:3]
v_exp_f32 v19, v19
v_mfma_f32_16x16x32_bf16 a[4:7], a[224:227], v[116:119], a[4:7]
v_exp_f32 v20, v20
v_mfma_f32_16x16x32_bf16 a[8:11], a[224:227], v[120:123], a[8:11]
ds_read_b128 a[192:195], v216 offset:0
v_cvt_pk_bf16_f32 v105, v18, v19
v_mfma_f32_16x16x32_bf16 a[12:15], a[224:227], v[124:127], a[12:15]
v_exp_f32 v21, v21
v_mfma_f32_16x16x32_bf16 a[16:19], a[228:231], v[112:115], a[16:19]
ds_read_b128 a[196:199], v217 offset:0
ds_read_b128 a[200:203], v218 offset:0
v_mfma_f32_16x16x32_bf16 a[20:23], a[228:231], v[116:119], a[20:23]
v_exp_f32 v22, v22
v_mfma_f32_16x16x32_bf16 a[24:27], a[228:231], v[120:123], a[24:27]
ds_read_b128 a[204:207], v219 offset:0
v_cvt_pk_bf16_f32 v106, v20, v21
v_mfma_f32_16x16x32_bf16 a[28:31], a[228:231], v[124:127], a[28:31]
v_exp_f32 v23, v23
v_mfma_f32_16x16x32_bf16 a[32:35], a[232:235], v[112:115], a[32:35]
buffer_load_dwordx4 v231, s[8:11], s24 offen offset:3072  lds
v_mfma_f32_16x16x32_bf16 a[36:39], a[232:235], v[116:119], a[36:39]
s_add_u32 s24, s24, 8192
v_exp_f32 v24, v24
v_mfma_f32_16x16x32_bf16 a[40:43], a[232:235], v[120:123], a[40:43]
ds_read_b128 a[208:211], v216 offset:8192
v_cvt_pk_bf16_f32 v107, v22, v23
v_mfma_f32_16x16x32_bf16 a[44:47], a[232:235], v[124:127], a[44:47]
v_exp_f32 v25, v25
v_mfma_f32_16x16x32_bf16 a[48:51], a[236:239], v[112:115], a[48:51]
ds_read_b128 a[212:215], v217 offset:8192
ds_read_b128 a[216:219], v218 offset:8192
v_mfma_f32_16x16x32_bf16 a[52:55], a[236:239], v[116:119], a[52:55]
v_exp_f32 v26, v26
v_mfma_f32_16x16x32_bf16 a[56:59], a[236:239], v[120:123], a[56:59]
ds_read_b128 a[220:223], v219 offset:8192
v_cvt_pk_bf16_f32 v108, v24, v25
v_mfma_f32_16x16x32_bf16 a[60:63], a[236:239], v[124:127], a[60:63]
v_exp_f32 v27, v27
v_mfma_f32_16x16x32_bf16 a[64:67], a[240:243], v[112:115], a[64:67]
v_mul_f32 v252, v192, v212
v_fmac_f32 v251, v201, v213
v_mfma_f32_16x16x32_bf16 a[68:71], a[240:243], v[116:119], a[68:71]
v_exp_f32 v28, v28
v_mfma_f32_16x16x32_bf16 a[72:75], a[240:243], v[120:123], a[72:75]
v_cvt_pk_bf16_f32 v109, v26, v27
v_fmac_f32 v252, v193, v213
v_mfma_f32_16x16x32_bf16 a[76:79], a[240:243], v[124:127], a[76:79]
v_exp_f32 v29, v29
v_mfma_f32_16x16x32_bf16 a[80:83], a[244:247], v[112:115], a[80:83]
s_lshl1_add_u32 m0, s26, 0
v_mfma_f32_16x16x32_bf16 a[84:87], a[244:247], v[116:119], a[84:87]
s_waitcnt vmcnt(12) lgkmcnt(0)
s_barrier
v_mfma_f32_16x16x32_bf16 a[88:91], a[244:247], v[120:123], a[88:91]
buffer_load_dwordx4 v228, s[12:15], s24 offen  lds
v_mfma_f32_16x16x32_bf16 a[92:95], a[244:247], v[124:127], a[92:95]
s_add_u32 s36, s40, 8192
buffer_load_dwordx4 a[168:171], v249, s[16:19], s36 offen offset:2048 sc1
v_mfma_f32_16x16x32_bf16 a[96:99], a[248:251], v[112:115], a[96:99]
v_exp_f32 v30, v30
v_mfma_f32_16x16x32_bf16 a[100:103], a[248:251], v[116:119], a[100:103]
v_cvt_pk_bf16_f32 v110, v28, v29
v_lshlrev_b32 v212, 16, v209
v_mfma_f32_16x16x32_bf16 a[104:107], a[248:251], v[120:123], a[104:107]
v_exp_f32 v31, v31
v_mfma_f32_16x16x32_bf16 a[108:111], a[248:251], v[124:127], a[108:111]
buffer_load_dwordx4 a[172:175], v249, s[16:19], s36 offen offset:3072 sc1
v_mfma_f32_16x16x32_bf16 a[112:115], a[252:255], v[112:115], a[112:115]
v_exp_f32 v32, v32
v_mfma_f32_16x16x32_bf16 a[116:119], a[252:255], v[116:119], a[116:119]
v_cvt_pk_bf16_f32 v111, v30, v31
v_and_b32 v213, 0xffff0000, v209
v_mfma_f32_16x16x32_bf16 a[120:123], a[252:255], v[120:123], a[120:123]
v_exp_f32 v33, v33
v_mfma_f32_16x16x32_bf16 a[124:127], a[252:255], v[124:127], a[124:127]
v_fmac_f32 v251, v202, v212
v_mfma_f32_16x16x32_bf16 v[0:3], a[192:195], v[128:131], v[64:67]
v_exp_f32 v34, v34
v_mfma_f32_16x16x32_bf16 v[0:3], a[196:199], v[132:135], v[0:3]
ds_read_b64_tr_b16 a[224:225], v220 offset:16384
v_cvt_pk_bf16_f32 v112, v32, v33
v_mfma_f32_16x16x32_bf16 v[0:3], a[200:203], v[136:139], v[0:3]
v_exp_f32 v35, v35
v_mfma_f32_16x16x32_bf16 v[0:3], a[204:207], v[140:143], v[0:3]
ds_read_b64_tr_b16 a[226:227], v220 offset:24576
ds_read_b64_tr_b16 a[228:229], v221 offset:16384
v_mfma_f32_16x16x32_bf16 v[4:7], a[208:211], v[128:131], v[64:67]
v_exp_f32 v36, v36
v_mfma_f32_16x16x32_bf16 v[4:7], a[212:215], v[132:135], v[4:7]
ds_read_b64_tr_b16 a[230:231], v221 offset:24576
v_cvt_pk_bf16_f32 v113, v34, v35
v_mfma_f32_16x16x32_bf16 v[4:7], a[216:219], v[136:139], v[4:7]
v_exp_f32 v37, v37
v_mfma_f32_16x16x32_bf16 v[4:7], a[220:223], v[140:143], v[4:7]
buffer_load_dwordx4 v229, s[12:15], s24 offen offset:1024  lds
v_mfma_f32_16x16x32_bf16 v[8:11], a[192:195], v[144:147], v[68:71]
v_exp_f32 v38, v38
v_mfma_f32_16x16x32_bf16 v[8:11], a[196:199], v[148:151], v[8:11]
ds_read_b64_tr_b16 a[232:233], v222 offset:16384
v_cvt_pk_bf16_f32 v114, v36, v37
v_mfma_f32_16x16x32_bf16 v[8:11], a[200:203], v[152:155], v[8:11]
v_exp_f32 v39, v39
v_mfma_f32_16x16x32_bf16 v[8:11], a[204:207], v[156:159], v[8:11]
ds_read_b64_tr_b16 a[234:235], v222 offset:24576
ds_read_b64_tr_b16 a[236:237], v223 offset:16384
v_mfma_f32_16x16x32_bf16 v[12:15], a[208:211], v[144:147], v[68:71]
v_exp_f32 v40, v40
v_mfma_f32_16x16x32_bf16 v[12:15], a[212:215], v[148:151], v[12:15]
ds_read_b64_tr_b16 a[238:239], v223 offset:24576
v_cvt_pk_bf16_f32 v115, v38, v39
v_mfma_f32_16x16x32_bf16 v[12:15], a[216:219], v[152:155], v[12:15]
v_exp_f32 v41, v41
v_mfma_f32_16x16x32_bf16 v[12:15], a[220:223], v[156:159], v[12:15]
ds_read_b64_tr_b16 a[240:241], v224 offset:16384
ds_read_b64_tr_b16 a[242:243], v224 offset:24576
v_mfma_f32_16x16x32_bf16 v[16:19], a[192:195], v[160:163], v[72:75]
v_exp_f32 v42, v42
v_mfma_f32_16x16x32_bf16 v[16:19], a[196:199], v[164:167], v[16:19]
ds_read_b64_tr_b16 a[244:245], v225 offset:16384
v_cvt_pk_bf16_f32 v116, v40, v41
v_mfma_f32_16x16x32_bf16 v[16:19], a[200:203], v[168:171], v[16:19]
v_exp_f32 v43, v43
v_mfma_f32_16x16x32_bf16 v[16:19], a[204:207], v[172:175], v[16:19]
ds_read_b64_tr_b16 a[246:247], v225 offset:24576
ds_read_b64_tr_b16 a[248:249], v226 offset:16384
v_mfma_f32_16x16x32_bf16 v[20:23], a[208:211], v[160:163], v[72:75]
v_exp_f32 v44, v44
v_mfma_f32_16x16x32_bf16 v[20:23], a[212:215], v[164:167], v[20:23]
ds_read_b64_tr_b16 a[250:251], v226 offset:24576
v_cvt_pk_bf16_f32 v117, v42, v43
v_mfma_f32_16x16x32_bf16 v[20:23], a[216:219], v[168:171], v[20:23]
v_exp_f32 v45, v45
v_mfma_f32_16x16x32_bf16 v[20:23], a[220:223], v[172:175], v[20:23]
buffer_load_dwordx4 v230, s[8:11], s24 offen offset:2048  lds
v_mfma_f32_16x16x32_bf16 v[24:27], a[192:195], v[176:179], v[76:79]
v_exp_f32 v46, v46
v_mfma_f32_16x16x32_bf16 v[24:27], a[196:199], v[180:183], v[24:27]
ds_read_b64_tr_b16 a[252:253], v227 offset:16384
v_cvt_pk_bf16_f32 v118, v44, v45
v_mfma_f32_16x16x32_bf16 v[24:27], a[200:203], v[184:187], v[24:27]
v_exp_f32 v47, v47
v_mfma_f32_16x16x32_bf16 v[24:27], a[204:207], v[188:191], v[24:27]
ds_read_b64_tr_b16 a[254:255], v227 offset:24576
v_fmac_f32 v252, v194, v212
v_mfma_f32_16x16x32_bf16 v[28:31], a[208:211], v[176:179], v[76:79]
v_exp_f32 v48, v48
v_smfmac_f32_16x16x64_bf16 v[80:83], v[232:235], v[96:103], v88
v_cvt_pk_bf16_f32 v119, v46, v47
v_mfma_f32_16x16x32_bf16 v[28:31], a[212:215], v[180:183], v[28:31]
v_exp_f32 v49, v49
v_mfma_f32_16x16x32_bf16 v[28:31], a[216:219], v[184:187], v[28:31]
v_fmac_f32 v251, v203, v213
v_fmac_f32 v252, v195, v213
v_mfma_f32_16x16x32_bf16 v[28:31], a[220:223], v[188:191], v[28:31]
v_exp_f32 v50, v50
v_smfmac_f32_16x16x64_bf16 v[84:87], v[232:235], v[104:111], v88
s_waitcnt lgkmcnt(0)
v_cvt_pk_bf16_f32 v120, v48, v49
v_mfma_f32_16x16x32_bf16 a[0:3], a[224:227], v[96:99], a[0:3]
v_exp_f32 v51, v51
v_mfma_f32_16x16x32_bf16 a[4:7], a[224:227], v[100:103], a[4:7]
v_exp_f32 v52, v52
v_mfma_f32_16x16x32_bf16 a[8:11], a[224:227], v[104:107], a[8:11]
ds_read_b128 a[192:195], v216 offset:16384
v_cvt_pk_bf16_f32 v121, v50, v51
v_mfma_f32_16x16x32_bf16 a[12:15], a[224:227], v[108:111], a[12:15]
v_exp_f32 v53, v53
v_mfma_f32_16x16x32_bf16 a[16:19], a[228:231], v[96:99], a[16:19]
ds_read_b128 a[196:199], v217 offset:16384
ds_read_b128 a[200:203], v218 offset:16384
v_mfma_f32_16x16x32_bf16 a[20:23], a[228:231], v[100:103], a[20:23]
v_exp_f32 v54, v54
v_mfma_f32_16x16x32_bf16 a[24:27], a[228:231], v[104:107], a[24:27]
ds_read_b128 a[204:207], v219 offset:16384
v_cvt_pk_bf16_f32 v122, v52, v53
v_mfma_f32_16x16x32_bf16 a[28:31], a[228:231], v[108:111], a[28:31]
v_exp_f32 v55, v55
v_mfma_f32_16x16x32_bf16 a[32:35], a[232:235], v[96:99], a[32:35]
buffer_load_dwordx4 v231, s[8:11], s24 offen offset:3072  lds
v_mfma_f32_16x16x32_bf16 a[36:39], a[232:235], v[100:103], a[36:39]
s_add_u32 s24, s24, 8192
v_exp_f32 v56, v56
v_mfma_f32_16x16x32_bf16 a[40:43], a[232:235], v[104:107], a[40:43]
ds_read_b128 a[208:211], v216 offset:24576
v_cvt_pk_bf16_f32 v123, v54, v55
v_mfma_f32_16x16x32_bf16 a[44:47], a[232:235], v[108:111], a[44:47]
v_exp_f32 v57, v57
v_mfma_f32_16x16x32_bf16 a[48:51], a[236:239], v[96:99], a[48:51]
ds_read_b128 a[212:215], v217 offset:24576
ds_read_b128 a[216:219], v218 offset:24576
v_mfma_f32_16x16x32_bf16 a[52:55], a[236:239], v[100:103], a[52:55]
v_exp_f32 v58, v58
v_mfma_f32_16x16x32_bf16 a[56:59], a[236:239], v[104:107], a[56:59]
ds_read_b128 a[220:223], v219 offset:24576
v_cvt_pk_bf16_f32 v124, v56, v57
v_mfma_f32_16x16x32_bf16 a[60:63], a[236:239], v[108:111], a[60:63]
v_exp_f32 v59, v59
v_mfma_f32_16x16x32_bf16 a[64:67], a[240:243], v[96:99], a[64:67]
v_lshlrev_b32 v212, 16, v210
v_and_b32 v213, 0xffff0000, v210
v_mfma_f32_16x16x32_bf16 a[68:71], a[240:243], v[100:103], a[68:71]
v_exp_f32 v60, v60
v_mfma_f32_16x16x32_bf16 a[72:75], a[240:243], v[104:107], a[72:75]
v_cvt_pk_bf16_f32 v125, v58, v59
v_fmac_f32 v251, v204, v212
v_mfma_f32_16x16x32_bf16 a[76:79], a[240:243], v[108:111], a[76:79]
v_exp_f32 v61, v61
v_mfma_f32_16x16x32_bf16 a[80:83], a[244:247], v[96:99], a[80:83]
s_lshl1_add_u32 m0, s26, 16384
v_mfma_f32_16x16x32_bf16 a[84:87], a[244:247], v[100:103], a[84:87]
s_waitcnt vmcnt(12) lgkmcnt(0)
s_barrier
v_mfma_f32_16x16x32_bf16 a[88:91], a[244:247], v[104:107], a[88:91]
buffer_load_dwordx4 v228, s[12:15], s24 offen  lds
v_mfma_f32_16x16x32_bf16 a[92:95], a[244:247], v[108:111], a[92:95]
s_add_u32 s36, s40, 12288
buffer_load_dwordx4 a[176:179], v249, s[16:19], s36 offen offset:0 sc1
v_mfma_f32_16x16x32_bf16 a[96:99], a[248:251], v[96:99], a[96:99]
v_exp_f32 v62, v62
v_mfma_f32_16x16x32_bf16 a[100:103], a[248:251], v[100:103], a[100:103]
v_cvt_pk_bf16_f32 v126, v60, v61
v_fmac_f32 v252, v196, v212
v_mfma_f32_16x16x32_bf16 a[104:107], a[248:251], v[104:107], a[104:107]
v_exp_f32 v63, v63
v_mfma_f32_16x16x32_bf16 a[108:111], a[248:251], v[108:111], a[108:111]
buffer_load_dwordx4 a[180:183], v249, s[16:19], s36 offen offset:1024 sc1
v_mfma_f32_16x16x32_bf16 a[112:115], a[252:255], v[96:99], a[112:115]
v_exp_f32 v0, v0
v_mfma_f32_16x16x32_bf16 a[116:119], a[252:255], v[100:103], a[116:119]
v_cvt_pk_bf16_f32 v127, v62, v63
v_fmac_f32 v251, v205, v213
v_mfma_f32_16x16x32_bf16 a[120:123], a[252:255], v[104:107], a[120:123]
v_exp_f32 v1, v1
v_mfma_f32_16x16x32_bf16 a[124:127], a[252:255], v[108:111], a[124:127]
v_fmac_f32 v252, v197, v213
v_mfma_f32_16x16x32_bf16 v[32:35], a[192:195], v[128:131], v[64:67]
v_exp_f32 v2, v2
v_mfma_f32_16x16x32_bf16 v[32:35], a[196:199], v[132:135], v[32:35]
ds_read_b64_tr_b16 a[224:225], v220 offset:32768
v_cvt_pk_bf16_f32 v96, v0, v1
v_mfma_f32_16x16x32_bf16 v[32:35], a[200:203], v[136:139], v[32:35]
v_exp_f32 v3, v3
v_mfma_f32_16x16x32_bf16 v[32:35], a[204:207], v[140:143], v[32:35]
ds_read_b64_tr_b16 a[226:227], v220 offset:40960
ds_read_b64_tr_b16 a[228:229], v221 offset:32768
v_mfma_f32_16x16x32_bf16 v[36:39], a[208:211], v[128:131], v[64:67]
v_exp_f32 v4, v4
v_mfma_f32_16x16x32_bf16 v[36:39], a[212:215], v[132:135], v[36:39]
ds_read_b64_tr_b16 a[230:231], v221 offset:40960
v_cvt_pk_bf16_f32 v97, v2, v3
v_mfma_f32_16x16x32_bf16 v[36:39], a[216:219], v[136:139], v[36:39]
v_exp_f32 v5, v5
v_mfma_f32_16x16x32_bf16 v[36:39], a[220:223], v[140:143], v[36:39]
buffer_load_dwordx4 v229, s[12:15], s24 offen offset:1024  lds
v_mfma_f32_16x16x32_bf16 v[40:43], a[192:195], v[144:147], v[68:71]
v_exp_f32 v6, v6
v_mfma_f32_16x16x32_bf16 v[40:43], a[196:199], v[148:151], v[40:43]
ds_read_b64_tr_b16 a[232:233], v222 offset:32768
v_cvt_pk_bf16_f32 v98, v4, v5
v_mfma_f32_16x16x32_bf16 v[40:43], a[200:203], v[152:155], v[40:43]
v_exp_f32 v7, v7
v_mfma_f32_16x16x32_bf16 v[40:43], a[204:207], v[156:159], v[40:43]
ds_read_b64_tr_b16 a[234:235], v222 offset:40960
ds_read_b64_tr_b16 a[236:237], v223 offset:32768
v_mfma_f32_16x16x32_bf16 v[44:47], a[208:211], v[144:147], v[68:71]
v_exp_f32 v8, v8
v_mfma_f32_16x16x32_bf16 v[44:47], a[212:215], v[148:151], v[44:47]
ds_read_b64_tr_b16 a[238:239], v223 offset:40960
v_cvt_pk_bf16_f32 v99, v6, v7
v_mfma_f32_16x16x32_bf16 v[44:47], a[216:219], v[152:155], v[44:47]
v_exp_f32 v9, v9
v_mfma_f32_16x16x32_bf16 v[44:47], a[220:223], v[156:159], v[44:47]
ds_read_b64_tr_b16 a[240:241], v224 offset:32768
ds_read_b64_tr_b16 a[242:243], v224 offset:40960
v_mfma_f32_16x16x32_bf16 v[48:51], a[192:195], v[160:163], v[72:75]
v_exp_f32 v10, v10
v_mfma_f32_16x16x32_bf16 v[48:51], a[196:199], v[164:167], v[48:51]
ds_read_b64_tr_b16 a[244:245], v225 offset:32768
v_cvt_pk_bf16_f32 v100, v8, v9
v_mfma_f32_16x16x32_bf16 v[48:51], a[200:203], v[168:171], v[48:51]
v_exp_f32 v11, v11
v_mfma_f32_16x16x32_bf16 v[48:51], a[204:207], v[172:175], v[48:51]
ds_read_b64_tr_b16 a[246:247], v225 offset:40960
ds_read_b64_tr_b16 a[248:249], v226 offset:32768
v_mfma_f32_16x16x32_bf16 v[52:55], a[208:211], v[160:163], v[72:75]
v_exp_f32 v12, v12
v_mfma_f32_16x16x32_bf16 v[52:55], a[212:215], v[164:167], v[52:55]
ds_read_b64_tr_b16 a[250:251], v226 offset:40960
v_cvt_pk_bf16_f32 v101, v10, v11
v_mfma_f32_16x16x32_bf16 v[52:55], a[216:219], v[168:171], v[52:55]
v_exp_f32 v13, v13
v_mfma_f32_16x16x32_bf16 v[52:55], a[220:223], v[172:175], v[52:55]
buffer_load_dwordx4 v230, s[8:11], s24 offen offset:2048  lds
v_mfma_f32_16x16x32_bf16 v[56:59], a[192:195], v[176:179], v[76:79]
v_exp_f32 v14, v14
v_mfma_f32_16x16x32_bf16 v[56:59], a[196:199], v[180:183], v[56:59]
ds_read_b64_tr_b16 a[252:253], v227 offset:32768
v_cvt_pk_bf16_f32 v102, v12, v13
v_mfma_f32_16x16x32_bf16 v[56:59], a[200:203], v[184:187], v[56:59]
v_exp_f32 v15, v15
v_mfma_f32_16x16x32_bf16 v[56:59], a[204:207], v[188:191], v[56:59]
ds_read_b64_tr_b16 a[254:255], v227 offset:40960
v_lshlrev_b32 v212, 16, v211
v_mfma_f32_16x16x32_bf16 v[60:63], a[208:211], v[176:179], v[76:79]
v_exp_f32 v16, v16
v_smfmac_f32_16x16x64_bf16 v[80:83], v[232:235], v[112:119], v88
v_cvt_pk_bf16_f32 v103, v14, v15
v_mfma_f32_16x16x32_bf16 v[60:63], a[212:215], v[180:183], v[60:63]
v_exp_f32 v17, v17
v_mfma_f32_16x16x32_bf16 v[60:63], a[216:219], v[184:187], v[60:63]
v_and_b32 v213, 0xffff0000, v211
v_fmac_f32 v251, v206, v212
v_mfma_f32_16x16x32_bf16 v[60:63], a[220:223], v[188:191], v[60:63]
v_exp_f32 v18, v18
v_smfmac_f32_16x16x64_bf16 v[84:87], v[232:235], v[120:127], v88
s_waitcnt lgkmcnt(0)
v_cvt_pk_bf16_f32 v104, v16, v17
v_mfma_f32_16x16x32_bf16 a[0:3], a[224:227], v[112:115], a[0:3]
v_exp_f32 v19, v19
v_mfma_f32_16x16x32_bf16 a[4:7], a[224:227], v[116:119], a[4:7]
v_exp_f32 v20, v20
v_mfma_f32_16x16x32_bf16 a[8:11], a[224:227], v[120:123], a[8:11]
ds_read_b128 a[192:195], v216 offset:32768
v_cvt_pk_bf16_f32 v105, v18, v19
v_mfma_f32_16x16x32_bf16 a[12:15], a[224:227], v[124:127], a[12:15]
v_exp_f32 v21, v21
v_mfma_f32_16x16x32_bf16 a[16:19], a[228:231], v[112:115], a[16:19]
ds_read_b128 a[196:199], v217 offset:32768
ds_read_b128 a[200:203], v218 offset:32768
v_mfma_f32_16x16x32_bf16 a[20:23], a[228:231], v[116:119], a[20:23]
v_exp_f32 v22, v22
v_mfma_f32_16x16x32_bf16 a[24:27], a[228:231], v[120:123], a[24:27]
ds_read_b128 a[204:207], v219 offset:32768
v_cvt_pk_bf16_f32 v106, v20, v21
v_mfma_f32_16x16x32_bf16 a[28:31], a[228:231], v[124:127], a[28:31]
v_exp_f32 v23, v23
v_mfma_f32_16x16x32_bf16 a[32:35], a[232:235], v[112:115], a[32:35]
buffer_load_dwordx4 v231, s[8:11], s24 offen offset:3072  lds
v_mfma_f32_16x16x32_bf16 a[36:39], a[232:235], v[116:119], a[36:39]
s_add_u32 s24, s24, 8192
v_exp_f32 v24, v24
v_mfma_f32_16x16x32_bf16 a[40:43], a[232:235], v[120:123], a[40:43]
ds_read_b128 a[208:211], v216 offset:40960
v_cvt_pk_bf16_f32 v107, v22, v23
v_mfma_f32_16x16x32_bf16 a[44:47], a[232:235], v[124:127], a[44:47]
v_exp_f32 v25, v25
v_mfma_f32_16x16x32_bf16 a[48:51], a[236:239], v[112:115], a[48:51]
ds_read_b128 a[212:215], v217 offset:40960
ds_read_b128 a[216:219], v218 offset:40960
v_mfma_f32_16x16x32_bf16 a[52:55], a[236:239], v[116:119], a[52:55]
v_exp_f32 v26, v26
v_mfma_f32_16x16x32_bf16 a[56:59], a[236:239], v[120:123], a[56:59]
ds_read_b128 a[220:223], v219 offset:40960
v_cvt_pk_bf16_f32 v108, v24, v25
v_mfma_f32_16x16x32_bf16 a[60:63], a[236:239], v[124:127], a[60:63]
v_exp_f32 v27, v27
v_mfma_f32_16x16x32_bf16 a[64:67], a[240:243], v[112:115], a[64:67]
v_fmac_f32 v252, v198, v212
v_fmac_f32 v251, v207, v213
v_mfma_f32_16x16x32_bf16 a[68:71], a[240:243], v[116:119], a[68:71]
v_exp_f32 v28, v28
v_mfma_f32_16x16x32_bf16 a[72:75], a[240:243], v[120:123], a[72:75]
v_cvt_pk_bf16_f32 v109, v26, v27
v_fmac_f32 v252, v199, v213
v_mfma_f32_16x16x32_bf16 a[76:79], a[240:243], v[124:127], a[76:79]
v_exp_f32 v29, v29
v_mfma_f32_16x16x32_bf16 a[80:83], a[244:247], v[112:115], a[80:83]
s_lshl1_add_u32 m0, s26, 32768
v_mfma_f32_16x16x32_bf16 a[84:87], a[244:247], v[116:119], a[84:87]
s_waitcnt vmcnt(12) lgkmcnt(0)
s_barrier
v_mfma_f32_16x16x32_bf16 a[88:91], a[244:247], v[120:123], a[88:91]
buffer_load_dwordx4 v228, s[12:15], s24 offen  lds
v_mfma_f32_16x16x32_bf16 a[92:95], a[244:247], v[124:127], a[92:95]
s_add_u32 s36, s40, 12288
buffer_load_dwordx4 a[184:187], v249, s[16:19], s36 offen offset:2048 sc1
v_mfma_f32_16x16x32_bf16 a[96:99], a[248:251], v[112:115], a[96:99]
v_exp_f32 v30, v30
v_mfma_f32_16x16x32_bf16 a[100:103], a[248:251], v[116:119], a[100:103]
v_cvt_pk_bf16_f32 v110, v28, v29
v_add_f32_dpp v251, v251, v251 quad_perm:[1,0,3,2] row_mask:0xf bank_mask:0xf
v_mfma_f32_16x16x32_bf16 a[104:107], a[248:251], v[120:123], a[104:107]
v_exp_f32 v31, v31
v_mfma_f32_16x16x32_bf16 a[108:111], a[248:251], v[124:127], a[108:111]
buffer_load_dwordx4 a[188:191], v249, s[16:19], s36 offen offset:3072 sc1
v_mfma_f32_16x16x32_bf16 a[112:115], a[252:255], v[112:115], a[112:115]
v_exp_f32 v32, v32
v_mfma_f32_16x16x32_bf16 a[116:119], a[252:255], v[116:119], a[116:119]
v_cvt_pk_bf16_f32 v111, v30, v31
v_add_f32_dpp v252, v252, v252 quad_perm:[1,0,3,2] row_mask:0xf bank_mask:0xf
v_mfma_f32_16x16x32_bf16 a[120:123], a[252:255], v[120:123], a[120:123]
Lpad16:
s_cbranch_execz Lpad20
v_exp_f32 v33, v33
v_mfma_f32_16x16x32_bf16 a[124:127], a[252:255], v[124:127], a[124:127]
v_add_f32_dpp v251, v251, v251 quad_perm:[2,3,0,1] row_mask:0xf bank_mask:0xf
v_mfma_f32_16x16x32_bf16 v[0:3], a[192:195], v[128:131], v[64:67]
v_exp_f32 v34, v34
v_mfma_f32_16x16x32_bf16 v[0:3], a[196:199], v[132:135], v[0:3]
ds_read_b64_tr_b16 a[224:225], v220 offset:49152
v_cvt_pk_bf16_f32 v112, v32, v33
v_mfma_f32_16x16x32_bf16 v[0:3], a[200:203], v[136:139], v[0:3]
v_exp_f32 v35, v35
v_mfma_f32_16x16x32_bf16 v[0:3], a[204:207], v[140:143], v[0:3]
ds_read_b64_tr_b16 a[226:227], v220 offset:57344
ds_read_b64_tr_b16 a[228:229], v221 offset:49152
v_mfma_f32_16x16x32_bf16 v[4:7], a[208:211], v[128:131], v[64:67]
v_exp_f32 v36, v36
v_mfma_f32_16x16x32_bf16 v[4:7], a[212:215], v[132:135], v[4:7]
ds_read_b64_tr_b16 a[230:231], v221 offset:57344
v_cvt_pk_bf16_f32 v113, v34, v35
v_mfma_f32_16x16x32_bf16 v[4:7], a[216:219], v[136:139], v[4:7]
v_exp_f32 v37, v37
v_mfma_f32_16x16x32_bf16 v[4:7], a[220:223], v[140:143], v[4:7]
buffer_load_dwordx4 v229, s[12:15], s24 offen offset:1024  lds
v_mfma_f32_16x16x32_bf16 v[8:11], a[192:195], v[144:147], v[68:71]
v_exp_f32 v38, v38
v_mfma_f32_16x16x32_bf16 v[8:11], a[196:199], v[148:151], v[8:11]
ds_read_b64_tr_b16 a[232:233], v222 offset:49152
v_cvt_pk_bf16_f32 v114, v36, v37
v_mfma_f32_16x16x32_bf16 v[8:11], a[200:203], v[152:155], v[8:11]
v_exp_f32 v39, v39
v_mfma_f32_16x16x32_bf16 v[8:11], a[204:207], v[156:159], v[8:11]
ds_read_b64_tr_b16 a[234:235], v222 offset:57344
ds_read_b64_tr_b16 a[236:237], v223 offset:49152
v_mfma_f32_16x16x32_bf16 v[12:15], a[208:211], v[144:147], v[68:71]
v_exp_f32 v40, v40
v_mfma_f32_16x16x32_bf16 v[12:15], a[212:215], v[148:151], v[12:15]
ds_read_b64_tr_b16 a[238:239], v223 offset:57344
v_cvt_pk_bf16_f32 v115, v38, v39
v_mfma_f32_16x16x32_bf16 v[12:15], a[216:219], v[152:155], v[12:15]
v_exp_f32 v41, v41
v_mfma_f32_16x16x32_bf16 v[12:15], a[220:223], v[156:159], v[12:15]
ds_read_b64_tr_b16 a[240:241], v224 offset:49152
ds_read_b64_tr_b16 a[242:243], v224 offset:57344
v_mfma_f32_16x16x32_bf16 v[16:19], a[192:195], v[160:163], v[72:75]
v_exp_f32 v42, v42
v_mfma_f32_16x16x32_bf16 v[16:19], a[196:199], v[164:167], v[16:19]
ds_read_b64_tr_b16 a[244:245], v225 offset:49152
v_cvt_pk_bf16_f32 v116, v40, v41
v_mfma_f32_16x16x32_bf16 v[16:19], a[200:203], v[168:171], v[16:19]
v_exp_f32 v43, v43
v_mfma_f32_16x16x32_bf16 v[16:19], a[204:207], v[172:175], v[16:19]
ds_read_b64_tr_b16 a[246:247], v225 offset:57344
ds_read_b64_tr_b16 a[248:249], v226 offset:49152
v_mfma_f32_16x16x32_bf16 v[20:23], a[208:211], v[160:163], v[72:75]
v_exp_f32 v44, v44
v_mfma_f32_16x16x32_bf16 v[20:23], a[212:215], v[164:167], v[20:23]
ds_read_b64_tr_b16 a[250:251], v226 offset:57344
v_cvt_pk_bf16_f32 v117, v42, v43
v_mfma_f32_16x16x32_bf16 v[20:23], a[216:219], v[168:171], v[20:23]
v_exp_f32 v45, v45
v_mfma_f32_16x16x32_bf16 v[20:23], a[220:223], v[172:175], v[20:23]
buffer_load_dwordx4 v230, s[8:11], s24 offen offset:2048  lds
v_mfma_f32_16x16x32_bf16 v[24:27], a[192:195], v[176:179], v[76:79]
v_exp_f32 v46, v46
v_mfma_f32_16x16x32_bf16 v[24:27], a[196:199], v[180:183], v[24:27]
ds_read_b64_tr_b16 a[252:253], v227 offset:49152
v_cvt_pk_bf16_f32 v118, v44, v45
v_mfma_f32_16x16x32_bf16 v[24:27], a[200:203], v[184:187], v[24:27]
v_exp_f32 v47, v47
v_mfma_f32_16x16x32_bf16 v[24:27], a[204:207], v[188:191], v[24:27]
ds_read_b64_tr_b16 a[254:255], v227 offset:57344
v_add_f32_dpp v252, v252, v252 quad_perm:[2,3,0,1] row_mask:0xf bank_mask:0xf
v_mfma_f32_16x16x32_bf16 v[28:31], a[208:211], v[176:179], v[76:79]
v_exp_f32 v48, v48
v_smfmac_f32_16x16x64_bf16 v[80:83], v[232:235], v[96:103], v88
v_cvt_pk_bf16_f32 v119, v46, v47
v_mfma_f32_16x16x32_bf16 v[28:31], a[212:215], v[180:183], v[28:31]
v_exp_f32 v49, v49
v_mfma_f32_16x16x32_bf16 v[28:31], a[216:219], v[184:187], v[28:31]
v_add_f32_dpp v251, v251, v251 row_half_mirror row_mask:0xf bank_mask:0xf
v_add_f32_dpp v252, v252, v252 row_half_mirror row_mask:0xf bank_mask:0xf
v_mfma_f32_16x16x32_bf16 v[28:31], a[220:223], v[188:191], v[28:31]
v_exp_f32 v50, v50
v_smfmac_f32_16x16x64_bf16 v[84:87], v[232:235], v[104:111], v88
s_waitcnt lgkmcnt(0)
v_cvt_pk_bf16_f32 v120, v48, v49
v_mfma_f32_16x16x32_bf16 a[0:3], a[224:227], v[96:99], a[0:3]
v_exp_f32 v51, v51
v_mfma_f32_16x16x32_bf16 a[4:7], a[224:227], v[100:103], a[4:7]
v_exp_f32 v52, v52
v_mfma_f32_16x16x32_bf16 a[8:11], a[224:227], v[104:107], a[8:11]
ds_read_b128 a[192:195], v216 offset:49152
v_cvt_pk_bf16_f32 v121, v50, v51
v_mfma_f32_16x16x32_bf16 a[12:15], a[224:227], v[108:111], a[12:15]
v_exp_f32 v53, v53
v_mfma_f32_16x16x32_bf16 a[16:19], a[228:231], v[96:99], a[16:19]
ds_read_b128 a[196:199], v217 offset:49152
ds_read_b128 a[200:203], v218 offset:49152
v_mfma_f32_16x16x32_bf16 a[20:23], a[228:231], v[100:103], a[20:23]
v_exp_f32 v54, v54
v_mfma_f32_16x16x32_bf16 a[24:27], a[228:231], v[104:107], a[24:27]
ds_read_b128 a[204:207], v219 offset:49152
v_cvt_pk_bf16_f32 v122, v52, v53
v_mfma_f32_16x16x32_bf16 a[28:31], a[228:231], v[108:111], a[28:31]
v_exp_f32 v55, v55
v_mfma_f32_16x16x32_bf16 a[32:35], a[232:235], v[96:99], a[32:35]
buffer_load_dwordx4 v231, s[8:11], s24 offen offset:3072  lds
v_mfma_f32_16x16x32_bf16 a[36:39], a[232:235], v[100:103], a[36:39]
s_add_u32 s24, s24, 8192
v_exp_f32 v56, v56
v_mfma_f32_16x16x32_bf16 a[40:43], a[232:235], v[104:107], a[40:43]
ds_read_b128 a[208:211], v216 offset:57344
v_cvt_pk_bf16_f32 v123, v54, v55
v_mfma_f32_16x16x32_bf16 a[44:47], a[232:235], v[108:111], a[44:47]
v_exp_f32 v57, v57
v_mfma_f32_16x16x32_bf16 a[48:51], a[236:239], v[96:99], a[48:51]
ds_read_b128 a[212:215], v217 offset:57344
ds_read_b128 a[216:219], v218 offset:57344
v_mfma_f32_16x16x32_bf16 a[52:55], a[236:239], v[100:103], a[52:55]
v_exp_f32 v58, v58
v_mfma_f32_16x16x32_bf16 a[56:59], a[236:239], v[104:107], a[56:59]
ds_read_b128 a[220:223], v219 offset:57344
v_cvt_pk_bf16_f32 v124, v56, v57
v_mfma_f32_16x16x32_bf16 a[60:63], a[236:239], v[108:111], a[60:63]
v_exp_f32 v59, v59
v_mfma_f32_16x16x32_bf16 a[64:67], a[240:243], v[96:99], a[64:67]
v_add_f32_dpp v251, v251, v251 row_mirror row_mask:0xf bank_mask:0xf
v_add_f32_dpp v252, v252, v252 row_mirror row_mask:0xf bank_mask:0xf
v_mfma_f32_16x16x32_bf16 a[68:71], a[240:243], v[100:103], a[68:71]
v_exp_f32 v60, v60
v_mfma_f32_16x16x32_bf16 a[72:75], a[240:243], v[104:107], a[72:75]
v_cvt_pk_bf16_f32 v125, v58, v59
v_mov_b32 v192, v251
v_mfma_f32_16x16x32_bf16 a[76:79], a[240:243], v[108:111], a[76:79]
v_exp_f32 v61, v61
v_mfma_f32_16x16x32_bf16 a[80:83], a[244:247], v[96:99], a[80:83]
s_lshl1_add_u32 m0, s26, 49152
v_mfma_f32_16x16x32_bf16 a[84:87], a[244:247], v[100:103], a[84:87]
s_waitcnt vmcnt(12) lgkmcnt(0)
s_barrier
v_mfma_f32_16x16x32_bf16 a[88:91], a[244:247], v[104:107], a[88:91]
buffer_load_dwordx4 v228, s[12:15], s24 offen  lds
v_mfma_f32_16x16x32_bf16 a[92:95], a[244:247], v[108:111], a[92:95]
s_add_u32 m0, s39, 65536
s_add_u32 s36, s41, 0
buffer_load_dwordx4 v249, s[16:19], s36 offen offset:0 sc1 lds
v_mfma_f32_16x16x32_bf16 a[96:99], a[248:251], v[96:99], a[96:99]
v_exp_f32 v62, v62
v_mfma_f32_16x16x32_bf16 a[100:103], a[248:251], v[100:103], a[100:103]
v_cvt_pk_bf16_f32 v126, v60, v61
v_mov_b32 v193, v252
v_mfma_f32_16x16x32_bf16 a[104:107], a[248:251], v[104:107], a[104:107]
v_exp_f32 v63, v63
v_mfma_f32_16x16x32_bf16 a[108:111], a[248:251], v[108:111], a[108:111]
buffer_load_dwordx4 v249, s[16:19], s36 offen offset:1024 sc1 lds
v_mfma_f32_16x16x32_bf16 a[112:115], a[252:255], v[96:99], a[112:115]
s_lshl1_add_u32 m0, s26, 49152
v_exp_f32 v0, v0
v_mfma_f32_16x16x32_bf16 a[116:119], a[252:255], v[100:103], a[116:119]
v_cvt_pk_bf16_f32 v127, v62, v63
v_permlane16_swap_b32 v251, v192
v_mfma_f32_16x16x32_bf16 a[120:123], a[252:255], v[104:107], a[120:123]
v_exp_f32 v1, v1
v_mfma_f32_16x16x32_bf16 a[124:127], a[252:255], v[108:111], a[124:127]
v_permlane16_swap_b32 v252, v193
v_mfma_f32_16x16x32_bf16 v[32:35], a[192:195], v[128:131], v[64:67]
v_exp_f32 v2, v2
v_mfma_f32_16x16x32_bf16 v[32:35], a[196:199], v[132:135], v[32:35]
ds_read_b64_tr_b16 a[224:225], v220 offset:0
v_cvt_pk_bf16_f32 v96, v0, v1
v_mfma_f32_16x16x32_bf16 v[32:35], a[200:203], v[136:139], v[32:35]
v_exp_f32 v3, v3
v_mfma_f32_16x16x32_bf16 v[32:35], a[204:207], v[140:143], v[32:35]
ds_read_b64_tr_b16 a[226:227], v220 offset:8192
ds_read_b64_tr_b16 a[228:229], v221 offset:0
v_mfma_f32_16x16x32_bf16 v[36:39], a[208:211], v[128:131], v[64:67]
v_exp_f32 v4, v4
v_mfma_f32_16x16x32_bf16 v[36:39], a[212:215], v[132:135], v[36:39]
ds_read_b64_tr_b16 a[230:231], v221 offset:8192
v_cvt_pk_bf16_f32 v97, v2, v3
v_mfma_f32_16x16x32_bf16 v[36:39], a[216:219], v[136:139], v[36:39]
v_exp_f32 v5, v5
v_mfma_f32_16x16x32_bf16 v[36:39], a[220:223], v[140:143], v[36:39]
buffer_load_dwordx4 v229, s[12:15], s24 offen offset:1024  lds
v_mfma_f32_16x16x32_bf16 v[40:43], a[192:195], v[144:147], v[68:71]
v_exp_f32 v6, v6
v_mfma_f32_16x16x32_bf16 v[40:43], a[196:199], v[148:151], v[40:43]
ds_read_b64_tr_b16 a[232:233], v222 offset:0
v_cvt_pk_bf16_f32 v98, v4, v5
v_mfma_f32_16x16x32_bf16 v[40:43], a[200:203], v[152:155], v[40:43]
v_exp_f32 v7, v7
v_mfma_f32_16x16x32_bf16 v[40:43], a[204:207], v[156:159], v[40:43]
ds_read_b64_tr_b16 a[234:235], v222 offset:8192
ds_read_b64_tr_b16 a[236:237], v223 offset:0
v_mfma_f32_16x16x32_bf16 v[44:47], a[208:211], v[144:147], v[68:71]
v_exp_f32 v8, v8
v_mfma_f32_16x16x32_bf16 v[44:47], a[212:215], v[148:151], v[44:47]
ds_read_b64_tr_b16 a[238:239], v223 offset:8192
v_cvt_pk_bf16_f32 v99, v6, v7
v_mfma_f32_16x16x32_bf16 v[44:47], a[216:219], v[152:155], v[44:47]
v_exp_f32 v9, v9
v_mfma_f32_16x16x32_bf16 v[44:47], a[220:223], v[156:159], v[44:47]
ds_read_b64_tr_b16 a[240:241], v224 offset:0
ds_read_b64_tr_b16 a[242:243], v224 offset:8192
v_mfma_f32_16x16x32_bf16 v[48:51], a[192:195], v[160:163], v[72:75]
v_exp_f32 v10, v10
v_mfma_f32_16x16x32_bf16 v[48:51], a[196:199], v[164:167], v[48:51]
ds_read_b64_tr_b16 a[244:245], v225 offset:0
v_cvt_pk_bf16_f32 v100, v8, v9
v_mfma_f32_16x16x32_bf16 v[48:51], a[200:203], v[168:171], v[48:51]
v_exp_f32 v11, v11
v_mfma_f32_16x16x32_bf16 v[48:51], a[204:207], v[172:175], v[48:51]
ds_read_b64_tr_b16 a[246:247], v225 offset:8192
ds_read_b64_tr_b16 a[248:249], v226 offset:0
v_mfma_f32_16x16x32_bf16 v[52:55], a[208:211], v[160:163], v[72:75]
v_exp_f32 v12, v12
v_mfma_f32_16x16x32_bf16 v[52:55], a[212:215], v[164:167], v[52:55]
ds_read_b64_tr_b16 a[250:251], v226 offset:8192
v_cvt_pk_bf16_f32 v101, v10, v11
v_mfma_f32_16x16x32_bf16 v[52:55], a[216:219], v[168:171], v[52:55]
v_exp_f32 v13, v13
v_mfma_f32_16x16x32_bf16 v[52:55], a[220:223], v[172:175], v[52:55]
buffer_load_dwordx4 v230, s[8:11], s24 offen offset:2048  lds
v_mfma_f32_16x16x32_bf16 v[56:59], a[192:195], v[176:179], v[76:79]
v_exp_f32 v14, v14
v_mfma_f32_16x16x32_bf16 v[56:59], a[196:199], v[180:183], v[56:59]
ds_read_b64_tr_b16 a[252:253], v227 offset:0
v_cvt_pk_bf16_f32 v102, v12, v13
v_mfma_f32_16x16x32_bf16 v[56:59], a[200:203], v[184:187], v[56:59]
s_and_b32 s37, s28, 3
v_exp_f32 v15, v15
v_mfma_f32_16x16x32_bf16 v[56:59], a[204:207], v[188:191], v[56:59]
ds_read_b64_tr_b16 a[254:255], v227 offset:8192
v_and_b32 v196, 15, v248
v_mfma_f32_16x16x32_bf16 v[60:63], a[208:211], v[176:179], v[76:79]
s_lshl_b32 s37, s37, 12
v_exp_f32 v16, v16
v_smfmac_f32_16x16x64_bf16 v[80:83], v[232:235], v[112:119], v88
v_cvt_pk_bf16_f32 v103, v14, v15
v_lshlrev_b32 v196, 7, v196
v_mfma_f32_16x16x32_bf16 v[60:63], a[212:215], v[180:183], v[60:63]
v_exp_f32 v17, v17
v_mfma_f32_16x16x32_bf16 v[60:63], a[216:219], v[184:187], v[60:63]
v_add3_u32 v196, v196, s37, v249
v_sub_u32 v196, v196, v255
v_mfma_f32_16x16x32_bf16 v[60:63], a[220:223], v[188:191], v[60:63]
v_exp_f32 v18, v18
v_smfmac_f32_16x16x64_bf16 v[84:87], v[232:235], v[120:127], v88
s_waitcnt lgkmcnt(0)
v_cvt_pk_bf16_f32 v104, v16, v17
v_mfma_f32_16x16x32_bf16 a[0:3], a[224:227], v[112:115], a[0:3]
v_exp_f32 v19, v19
v_mfma_f32_16x16x32_bf16 a[4:7], a[224:227], v[116:119], a[4:7]
v_exp_f32 v20, v20
v_mfma_f32_16x16x32_bf16 a[8:11], a[224:227], v[120:123], a[8:11]
ds_read_b128 a[192:195], v216 offset:0
v_cvt_pk_bf16_f32 v105, v18, v19
v_mfma_f32_16x16x32_bf16 a[12:15], a[224:227], v[124:127], a[12:15]
v_exp_f32 v21, v21
v_mfma_f32_16x16x32_bf16 a[16:19], a[228:231], v[112:115], a[16:19]
ds_read_b128 a[196:199], v217 offset:0
ds_read_b128 a[200:203], v218 offset:0
v_mfma_f32_16x16x32_bf16 a[20:23], a[228:231], v[116:119], a[20:23]
v_exp_f32 v22, v22
v_mfma_f32_16x16x32_bf16 a[24:27], a[228:231], v[120:123], a[24:27]
ds_read_b128 a[204:207], v219 offset:0
v_cvt_pk_bf16_f32 v106, v20, v21
v_mfma_f32_16x16x32_bf16 a[28:31], a[228:231], v[124:127], a[28:31]
v_exp_f32 v23, v23
v_mfma_f32_16x16x32_bf16 a[32:35], a[232:235], v[112:115], a[32:35]
buffer_load_dwordx4 v231, s[8:11], s24 offen offset:3072  lds
v_mfma_f32_16x16x32_bf16 a[36:39], a[232:235], v[116:119], a[36:39]
s_add_u32 s24, s24, 8192
v_exp_f32 v24, v24
v_mfma_f32_16x16x32_bf16 a[40:43], a[232:235], v[120:123], a[40:43]
ds_read_b128 a[208:211], v216 offset:8192
v_cvt_pk_bf16_f32 v107, v22, v23
v_mfma_f32_16x16x32_bf16 a[44:47], a[232:235], v[124:127], a[44:47]
v_exp_f32 v25, v25
v_mfma_f32_16x16x32_bf16 a[48:51], a[236:239], v[112:115], a[48:51]
ds_read_b128 a[212:215], v217 offset:8192
ds_read_b128 a[216:219], v218 offset:8192
v_mfma_f32_16x16x32_bf16 a[52:55], a[236:239], v[116:119], a[52:55]
v_exp_f32 v26, v26
v_mfma_f32_16x16x32_bf16 a[56:59], a[236:239], v[120:123], a[56:59]
ds_read_b128 a[220:223], v219 offset:8192
v_cvt_pk_bf16_f32 v108, v24, v25
v_mfma_f32_16x16x32_bf16 a[60:63], a[236:239], v[124:127], a[60:63]
v_exp_f32 v27, v27
v_mfma_f32_16x16x32_bf16 a[64:67], a[240:243], v[112:115], a[64:67]
v_mfma_f32_16x16x32_bf16 a[68:71], a[240:243], v[116:119], a[68:71]
v_exp_f32 v28, v28
v_mfma_f32_16x16x32_bf16 a[72:75], a[240:243], v[120:123], a[72:75]
v_cvt_pk_bf16_f32 v109, v26, v27
v_mfma_f32_16x16x32_bf16 a[76:79], a[240:243], v[124:127], a[76:79]
v_exp_f32 v29, v29
v_mfma_f32_16x16x32_bf16 a[80:83], a[244:247], v[112:115], a[80:83]
s_lshl1_add_u32 m0, s26, 0
v_mfma_f32_16x16x32_bf16 a[84:87], a[244:247], v[116:119], a[84:87]
s_waitcnt vmcnt(12) lgkmcnt(0)
s_barrier
v_mfma_f32_16x16x32_bf16 a[88:91], a[244:247], v[120:123], a[88:91]
buffer_load_dwordx4 v228, s[12:15], s24 offen  lds
v_mfma_f32_16x16x32_bf16 a[92:95], a[244:247], v[124:127], a[92:95]
s_add_u32 m0, s39, 65536
s_add_u32 s36, s41, 0
buffer_load_dwordx4 v249, s[16:19], s36 offen offset:2048 sc1 lds
v_mfma_f32_16x16x32_bf16 a[96:99], a[248:251], v[112:115], a[96:99]
v_exp_f32 v30, v30
v_mfma_f32_16x16x32_bf16 a[100:103], a[248:251], v[116:119], a[100:103]
v_cvt_pk_bf16_f32 v110, v28, v29
v_mfma_f32_16x16x32_bf16 a[104:107], a[248:251], v[120:123], a[104:107]
v_exp_f32 v31, v31
v_mfma_f32_16x16x32_bf16 a[108:111], a[248:251], v[124:127], a[108:111]
buffer_load_dwordx4 v249, s[16:19], s36 offen offset:3072 sc1 lds
v_mfma_f32_16x16x32_bf16 a[112:115], a[252:255], v[112:115], a[112:115]
s_lshl1_add_u32 m0, s26, 0
v_exp_f32 v32, v32
v_mfma_f32_16x16x32_bf16 a[116:119], a[252:255], v[116:119], a[116:119]
v_cvt_pk_bf16_f32 v111, v30, v31
v_mfma_f32_16x16x32_bf16 a[120:123], a[252:255], v[120:123], a[120:123]
v_exp_f32 v33, v33
v_mfma_f32_16x16x32_bf16 a[124:127], a[252:255], v[124:127], a[124:127]
v_mfma_f32_16x16x32_bf16 v[0:3], a[192:195], v[128:131], v[64:67]
v_exp_f32 v34, v34
v_mfma_f32_16x16x32_bf16 v[0:3], a[196:199], v[132:135], v[0:3]
ds_read_b64_tr_b16 a[224:225], v220 offset:16384
v_cvt_pk_bf16_f32 v112, v32, v33
v_mfma_f32_16x16x32_bf16 v[0:3], a[200:203], v[136:139], v[0:3]
v_exp_f32 v35, v35
v_mfma_f32_16x16x32_bf16 v[0:3], a[204:207], v[140:143], v[0:3]
ds_read_b64_tr_b16 a[226:227], v220 offset:24576
ds_read_b64_tr_b16 a[228:229], v221 offset:16384
v_mfma_f32_16x16x32_bf16 v[4:7], a[208:211], v[128:131], v[64:67]
v_exp_f32 v36, v36
v_mfma_f32_16x16x32_bf16 v[4:7], a[212:215], v[132:135], v[4:7]
ds_read_b64_tr_b16 a[230:231], v221 offset:24576
v_cvt_pk_bf16_f32 v113, v34, v35
v_mfma_f32_16x16x32_bf16 v[4:7], a[216:219], v[136:139], v[4:7]
v_exp_f32 v37, v37
v_mfma_f32_16x16x32_bf16 v[4:7], a[220:223], v[140:143], v[4:7]
buffer_load_dwordx4 v229, s[12:15], s24 offen offset:1024  lds
v_mfma_f32_16x16x32_bf16 v[8:11], a[192:195], v[144:147], v[68:71]
v_exp_f32 v38, v38
v_mfma_f32_16x16x32_bf16 v[8:11], a[196:199], v[148:151], v[8:11]
ds_read_b64_tr_b16 a[232:233], v222 offset:16384
v_cvt_pk_bf16_f32 v114, v36, v37
v_mfma_f32_16x16x32_bf16 v[8:11], a[200:203], v[152:155], v[8:11]
v_exp_f32 v39, v39
v_mfma_f32_16x16x32_bf16 v[8:11], a[204:207], v[156:159], v[8:11]
ds_read_b64_tr_b16 a[234:235], v222 offset:24576
ds_read_b64_tr_b16 a[236:237], v223 offset:16384
v_mfma_f32_16x16x32_bf16 v[12:15], a[208:211], v[144:147], v[68:71]
v_exp_f32 v40, v40
v_mfma_f32_16x16x32_bf16 v[12:15], a[212:215], v[148:151], v[12:15]
ds_read_b64_tr_b16 a[238:239], v223 offset:24576
v_cvt_pk_bf16_f32 v115, v38, v39
v_mfma_f32_16x16x32_bf16 v[12:15], a[216:219], v[152:155], v[12:15]
v_exp_f32 v41, v41
v_mfma_f32_16x16x32_bf16 v[12:15], a[220:223], v[156:159], v[12:15]
ds_read_b64_tr_b16 a[240:241], v224 offset:16384
ds_read_b64_tr_b16 a[242:243], v224 offset:24576
v_mfma_f32_16x16x32_bf16 v[16:19], a[192:195], v[160:163], v[72:75]
v_exp_f32 v42, v42
v_mfma_f32_16x16x32_bf16 v[16:19], a[196:199], v[164:167], v[16:19]
ds_read_b64_tr_b16 a[244:245], v225 offset:16384
v_cvt_pk_bf16_f32 v116, v40, v41
v_mfma_f32_16x16x32_bf16 v[16:19], a[200:203], v[168:171], v[16:19]
v_exp_f32 v43, v43
v_mfma_f32_16x16x32_bf16 v[16:19], a[204:207], v[172:175], v[16:19]
ds_read_b64_tr_b16 a[246:247], v225 offset:24576
ds_read_b64_tr_b16 a[248:249], v226 offset:16384
v_mfma_f32_16x16x32_bf16 v[20:23], a[208:211], v[160:163], v[72:75]
v_exp_f32 v44, v44
v_mfma_f32_16x16x32_bf16 v[20:23], a[212:215], v[164:167], v[20:23]
ds_read_b64_tr_b16 a[250:251], v226 offset:24576
v_cvt_pk_bf16_f32 v117, v42, v43
v_mfma_f32_16x16x32_bf16 v[20:23], a[216:219], v[168:171], v[20:23]
v_exp_f32 v45, v45
v_mfma_f32_16x16x32_bf16 v[20:23], a[220:223], v[172:175], v[20:23]
buffer_load_dwordx4 v230, s[8:11], s24 offen offset:2048  lds
v_mfma_f32_16x16x32_bf16 v[24:27], a[192:195], v[176:179], v[76:79]
v_exp_f32 v46, v46
v_mfma_f32_16x16x32_bf16 v[24:27], a[196:199], v[180:183], v[24:27]
ds_read_b64_tr_b16 a[252:253], v227 offset:16384
v_cvt_pk_bf16_f32 v118, v44, v45
v_mfma_f32_16x16x32_bf16 v[24:27], a[200:203], v[184:187], v[24:27]
v_exp_f32 v47, v47
v_mfma_f32_16x16x32_bf16 v[24:27], a[204:207], v[188:191], v[24:27]
ds_read_b64_tr_b16 a[254:255], v227 offset:24576
v_add_f32 v251, v251, v192
v_mfma_f32_16x16x32_bf16 v[28:31], a[208:211], v[176:179], v[76:79]
v_exp_f32 v48, v48
v_smfmac_f32_16x16x64_bf16 v[80:83], v[232:235], v[96:103], v88
v_cvt_pk_bf16_f32 v119, v46, v47
v_mfma_f32_16x16x32_bf16 v[28:31], a[212:215], v[180:183], v[28:31]
v_exp_f32 v49, v49
v_mfma_f32_16x16x32_bf16 v[28:31], a[216:219], v[184:187], v[28:31]
s_mov_b32 exec_lo, 0xffff
s_mov_b32 exec_hi, 0x0
buffer_load_dword v215, v196, s[16:19], s42 offen offset:0 sc1
s_mov_b64 exec, -1
v_add_f32 v252, v252, v193
v_mov_b32 v192, v251
v_mfma_f32_16x16x32_bf16 v[28:31], a[220:223], v[188:191], v[28:31]
v_exp_f32 v50, v50
v_smfmac_f32_16x16x64_bf16 v[84:87], v[232:235], v[104:111], v88
s_waitcnt lgkmcnt(0)
v_cvt_pk_bf16_f32 v120, v48, v49
v_mfma_f32_16x16x32_bf16 a[0:3], a[224:227], v[96:99], a[0:3]
v_exp_f32 v51, v51
v_mfma_f32_16x16x32_bf16 a[4:7], a[224:227], v[100:103], a[4:7]
v_exp_f32 v52, v52
v_mfma_f32_16x16x32_bf16 a[8:11], a[224:227], v[104:107], a[8:11]
ds_read_b128 a[192:195], v216 offset:16384
v_cvt_pk_bf16_f32 v121, v50, v51
v_mfma_f32_16x16x32_bf16 a[12:15], a[224:227], v[108:111], a[12:15]
v_exp_f32 v53, v53
v_mfma_f32_16x16x32_bf16 a[16:19], a[228:231], v[96:99], a[16:19]
ds_read_b128 a[196:199], v217 offset:16384
ds_read_b128 a[200:203], v218 offset:16384
v_mfma_f32_16x16x32_bf16 a[20:23], a[228:231], v[100:103], a[20:23]
v_exp_f32 v54, v54
v_mfma_f32_16x16x32_bf16 a[24:27], a[228:231], v[104:107], a[24:27]
ds_read_b128 a[204:207], v219 offset:16384
v_cvt_pk_bf16_f32 v122, v52, v53
v_mfma_f32_16x16x32_bf16 a[28:31], a[228:231], v[108:111], a[28:31]
v_exp_f32 v55, v55
v_mfma_f32_16x16x32_bf16 a[32:35], a[232:235], v[96:99], a[32:35]
buffer_load_dwordx4 v231, s[8:11], s24 offen offset:3072  lds
v_mfma_f32_16x16x32_bf16 a[36:39], a[232:235], v[100:103], a[36:39]
s_add_u32 s24, s24, 8192
v_exp_f32 v56, v56
v_mfma_f32_16x16x32_bf16 a[40:43], a[232:235], v[104:107], a[40:43]
ds_read_b128 a[208:211], v216 offset:24576
v_cvt_pk_bf16_f32 v123, v54, v55
v_mfma_f32_16x16x32_bf16 a[44:47], a[232:235], v[108:111], a[44:47]
v_exp_f32 v57, v57
v_mfma_f32_16x16x32_bf16 a[48:51], a[236:239], v[96:99], a[48:51]
ds_read_b128 a[212:215], v217 offset:24576
ds_read_b128 a[216:219], v218 offset:24576
v_mfma_f32_16x16x32_bf16 a[52:55], a[236:239], v[100:103], a[52:55]
v_exp_f32 v58, v58
v_mfma_f32_16x16x32_bf16 a[56:59], a[236:239], v[104:107], a[56:59]
ds_read_b128 a[220:223], v219 offset:24576
v_cvt_pk_bf16_f32 v124, v56, v57
v_mfma_f32_16x16x32_bf16 a[60:63], a[236:239], v[108:111], a[60:63]
v_exp_f32 v59, v59
v_mfma_f32_16x16x32_bf16 a[64:67], a[240:243], v[96:99], a[64:67]
v_mov_b32 v193, v252
v_permlane32_swap_b32 v251, v192
v_mfma_f32_16x16x32_bf16 a[68:71], a[240:243], v[100:103], a[68:71]
v_exp_f32 v60, v60
v_mfma_f32_16x16x32_bf16 a[72:75], a[240:243], v[104:107], a[72:75]
v_cvt_pk_bf16_f32 v125, v58, v59
v_permlane32_swap_b32 v252, v193
v_mfma_f32_16x16x32_bf16 a[76:79], a[240:243], v[108:111], a[76:79]
v_exp_f32 v61, v61
v_mfma_f32_16x16x32_bf16 a[80:83], a[244:247], v[96:99], a[80:83]
s_lshl1_add_u32 m0, s26, 16384
v_mfma_f32_16x16x32_bf16 a[84:87], a[244:247], v[100:103], a[84:87]
s_waitcnt vmcnt(13) lgkmcnt(0)
s_barrier
v_mfma_f32_16x16x32_bf16 a[88:91], a[244:247], v[104:107], a[88:91]
buffer_load_dwordx4 v228, s[12:15], s24 offen  lds
v_mfma_f32_16x16x32_bf16 a[92:95], a[244:247], v[108:111], a[92:95]
s_add_u32 m0, s39, 69632
s_add_u32 s36, s41, 4096
buffer_load_dwordx4 v249, s[16:19], s36 offen offset:0 sc1 lds
v_mfma_f32_16x16x32_bf16 a[96:99], a[248:251], v[96:99], a[96:99]
v_exp_f32 v62, v62
v_mfma_f32_16x16x32_bf16 a[100:103], a[248:251], v[100:103], a[100:103]
v_cvt_pk_bf16_f32 v126, v60, v61
v_add_f32 v251, v251, v192
v_mfma_f32_16x16x32_bf16 a[104:107], a[248:251], v[104:107], a[104:107]
v_exp_f32 v63, v63
v_mfma_f32_16x16x32_bf16 a[108:111], a[248:251], v[108:111], a[108:111]
buffer_load_dwordx4 v249, s[16:19], s36 offen offset:1024 sc1 lds
v_mfma_f32_16x16x32_bf16 a[112:115], a[252:255], v[96:99], a[112:115]
s_lshl1_add_u32 m0, s26, 16384
v_exp_f32 v0, v0
v_mfma_f32_16x16x32_bf16 a[116:119], a[252:255], v[100:103], a[116:119]
v_cvt_pk_bf16_f32 v127, v62, v63
v_add_f32 v252, v252, v193
v_mfma_f32_16x16x32_bf16 a[120:123], a[252:255], v[104:107], a[120:123]
v_exp_f32 v1, v1
v_mfma_f32_16x16x32_bf16 a[124:127], a[252:255], v[108:111], a[124:127]
v_mfma_f32_16x16x32_bf16 v[32:35], a[192:195], v[128:131], v[64:67]
v_exp_f32 v2, v2
v_mfma_f32_16x16x32_bf16 v[32:35], a[196:199], v[132:135], v[32:35]
ds_read_b64_tr_b16 a[224:225], v220 offset:32768
v_cvt_pk_bf16_f32 v96, v0, v1
v_mfma_f32_16x16x32_bf16 v[32:35], a[200:203], v[136:139], v[32:35]
v_exp_f32 v3, v3
v_mfma_f32_16x16x32_bf16 v[32:35], a[204:207], v[140:143], v[32:35]
ds_read_b64_tr_b16 a[226:227], v220 offset:40960
ds_read_b64_tr_b16 a[228:229], v221 offset:32768
v_mfma_f32_16x16x32_bf16 v[36:39], a[208:211], v[128:131], v[64:67]
v_exp_f32 v4, v4
v_mfma_f32_16x16x32_bf16 v[36:39], a[212:215], v[132:135], v[36:39]
ds_read_b64_tr_b16 a[230:231], v221 offset:40960
v_cvt_pk_bf16_f32 v97, v2, v3
v_mfma_f32_16x16x32_bf16 v[36:39], a[216:219], v[136:139], v[36:39]
v_exp_f32 v5, v5
v_mfma_f32_16x16x32_bf16 v[36:39], a[220:223], v[140:143], v[36:39]
buffer_load_dwordx4 v229, s[12:15], s24 offen offset:1024  lds
v_mfma_f32_16x16x32_bf16 v[40:43], a[192:195], v[144:147], v[68:71]
v_exp_f32 v6, v6
v_mfma_f32_16x16x32_bf16 v[40:43], a[196:199], v[148:151], v[40:43]
ds_read_b64_tr_b16 a[232:233], v222 offset:32768
v_cvt_pk_bf16_f32 v98, v4, v5
v_mfma_f32_16x16x32_bf16 v[40:43], a[200:203], v[152:155], v[40:43]
v_exp_f32 v7, v7
v_mfma_f32_16x16x32_bf16 v[40:43], a[204:207], v[156:159], v[40:43]
ds_read_b64_tr_b16 a[234:235], v222 offset:40960
ds_read_b64_tr_b16 a[236:237], v223 offset:32768
v_mfma_f32_16x16x32_bf16 v[44:47], a[208:211], v[144:147], v[68:71]
v_exp_f32 v8, v8
v_mfma_f32_16x16x32_bf16 v[44:47], a[212:215], v[148:151], v[44:47]
ds_read_b64_tr_b16 a[238:239], v223 offset:40960
v_cvt_pk_bf16_f32 v99, v6, v7
v_mfma_f32_16x16x32_bf16 v[44:47], a[216:219], v[152:155], v[44:47]
v_exp_f32 v9, v9
v_mfma_f32_16x16x32_bf16 v[44:47], a[220:223], v[156:159], v[44:47]
ds_read_b64_tr_b16 a[240:241], v224 offset:32768
ds_read_b64_tr_b16 a[242:243], v224 offset:40960
v_mfma_f32_16x16x32_bf16 v[48:51], a[192:195], v[160:163], v[72:75]
v_exp_f32 v10, v10
v_mfma_f32_16x16x32_bf16 v[48:51], a[196:199], v[164:167], v[48:51]
ds_read_b64_tr_b16 a[244:245], v225 offset:32768
v_cvt_pk_bf16_f32 v100, v8, v9
v_mfma_f32_16x16x32_bf16 v[48:51], a[200:203], v[168:171], v[48:51]
v_exp_f32 v11, v11
v_mfma_f32_16x16x32_bf16 v[48:51], a[204:207], v[172:175], v[48:51]
ds_read_b64_tr_b16 a[246:247], v225 offset:40960
ds_read_b64_tr_b16 a[248:249], v226 offset:32768
v_mfma_f32_16x16x32_bf16 v[52:55], a[208:211], v[160:163], v[72:75]
v_exp_f32 v12, v12
v_mfma_f32_16x16x32_bf16 v[52:55], a[212:215], v[164:167], v[52:55]
ds_read_b64_tr_b16 a[250:251], v226 offset:40960
v_cvt_pk_bf16_f32 v101, v10, v11
v_mfma_f32_16x16x32_bf16 v[52:55], a[216:219], v[168:171], v[52:55]
v_exp_f32 v13, v13
v_mfma_f32_16x16x32_bf16 v[52:55], a[220:223], v[172:175], v[52:55]
buffer_load_dwordx4 v230, s[8:11], s24 offen offset:2048  lds
v_mfma_f32_16x16x32_bf16 v[56:59], a[192:195], v[176:179], v[76:79]
v_exp_f32 v14, v14
v_mfma_f32_16x16x32_bf16 v[56:59], a[196:199], v[180:183], v[56:59]
ds_read_b64_tr_b16 a[252:253], v227 offset:32768
v_cvt_pk_bf16_f32 v102, v12, v13
v_mfma_f32_16x16x32_bf16 v[56:59], a[200:203], v[184:187], v[56:59]
v_exp_f32 v15, v15
v_mfma_f32_16x16x32_bf16 v[56:59], a[204:207], v[188:191], v[56:59]
ds_read_b64_tr_b16 a[254:255], v227 offset:40960
v_mfma_f32_16x16x32_bf16 v[60:63], a[208:211], v[176:179], v[76:79]
v_exp_f32 v16, v16
v_smfmac_f32_16x16x64_bf16 v[80:83], v[232:235], v[112:119], v88
v_cvt_pk_bf16_f32 v103, v14, v15
v_mfma_f32_16x16x32_bf16 v[60:63], a[212:215], v[180:183], v[60:63]
v_exp_f32 v17, v17
v_mfma_f32_16x16x32_bf16 v[60:63], a[216:219], v[184:187], v[60:63]
s_mov_b32 exec_lo, 0xffff
s_mov_b32 exec_hi, 0x0
buffer_load_dword v215, v196, s[16:19], s42 offen offset:2048 sc1
s_mov_b64 exec, -1
v_mfma_f32_16x16x32_bf16 v[60:63], a[220:223], v[188:191], v[60:63]
v_exp_f32 v18, v18
v_smfmac_f32_16x16x64_bf16 v[84:87], v[232:235], v[120:127], v88
s_waitcnt lgkmcnt(0)
v_cvt_pk_bf16_f32 v104, v16, v17
v_mfma_f32_16x16x32_bf16 a[0:3], a[224:227], v[112:115], a[0:3]
v_exp_f32 v19, v19
v_mfma_f32_16x16x32_bf16 a[4:7], a[224:227], v[116:119], a[4:7]
v_exp_f32 v20, v20
v_mfma_f32_16x16x32_bf16 a[8:11], a[224:227], v[120:123], a[8:11]
ds_read_b128 a[192:195], v216 offset:32768
v_cvt_pk_bf16_f32 v105, v18, v19
v_mfma_f32_16x16x32_bf16 a[12:15], a[224:227], v[124:127], a[12:15]
v_exp_f32 v21, v21
v_mfma_f32_16x16x32_bf16 a[16:19], a[228:231], v[112:115], a[16:19]
ds_read_b128 a[196:199], v217 offset:32768
ds_read_b128 a[200:203], v218 offset:32768
v_mfma_f32_16x16x32_bf16 a[20:23], a[228:231], v[116:119], a[20:23]
v_exp_f32 v22, v22
v_mfma_f32_16x16x32_bf16 a[24:27], a[228:231], v[120:123], a[24:27]
ds_read_b128 a[204:207], v219 offset:32768
v_cvt_pk_bf16_f32 v106, v20, v21
v_mfma_f32_16x16x32_bf16 a[28:31], a[228:231], v[124:127], a[28:31]
v_exp_f32 v23, v23
Lpad17:
s_cbranch_execz Lpad21
v_mfma_f32_16x16x32_bf16 a[32:35], a[232:235], v[112:115], a[32:35]
buffer_load_dwordx4 v231, s[8:11], s24 offen offset:3072  lds
v_mfma_f32_16x16x32_bf16 a[36:39], a[232:235], v[116:119], a[36:39]
s_add_u32 s24, s24, 8192
v_exp_f32 v24, v24
v_mfma_f32_16x16x32_bf16 a[40:43], a[232:235], v[120:123], a[40:43]
ds_read_b128 a[208:211], v216 offset:40960
v_cvt_pk_bf16_f32 v107, v22, v23
v_mfma_f32_16x16x32_bf16 a[44:47], a[232:235], v[124:127], a[44:47]
v_exp_f32 v25, v25
v_mfma_f32_16x16x32_bf16 a[48:51], a[236:239], v[112:115], a[48:51]
ds_read_b128 a[212:215], v217 offset:40960
ds_read_b128 a[216:219], v218 offset:40960
v_mfma_f32_16x16x32_bf16 a[52:55], a[236:239], v[116:119], a[52:55]
v_exp_f32 v26, v26
v_mfma_f32_16x16x32_bf16 a[56:59], a[236:239], v[120:123], a[56:59]
ds_read_b128 a[220:223], v219 offset:40960
v_cvt_pk_bf16_f32 v108, v24, v25
v_mfma_f32_16x16x32_bf16 a[60:63], a[236:239], v[124:127], a[60:63]
v_exp_f32 v27, v27
v_mfma_f32_16x16x32_bf16 a[64:67], a[240:243], v[112:115], a[64:67]
v_mfma_f32_16x16x32_bf16 a[68:71], a[240:243], v[116:119], a[68:71]
v_exp_f32 v28, v28
v_mfma_f32_16x16x32_bf16 a[72:75], a[240:243], v[120:123], a[72:75]
v_cvt_pk_bf16_f32 v109, v26, v27
v_mfma_f32_16x16x32_bf16 a[76:79], a[240:243], v[124:127], a[76:79]
v_exp_f32 v29, v29
v_mfma_f32_16x16x32_bf16 a[80:83], a[244:247], v[112:115], a[80:83]
s_lshl1_add_u32 m0, s26, 32768
v_mfma_f32_16x16x32_bf16 a[84:87], a[244:247], v[116:119], a[84:87]
s_waitcnt vmcnt(14) lgkmcnt(0)
s_barrier
v_mfma_f32_16x16x32_bf16 a[88:91], a[244:247], v[120:123], a[88:91]
buffer_load_dwordx4 v228, s[12:15], s24 offen  lds
v_mfma_f32_16x16x32_bf16 a[92:95], a[244:247], v[124:127], a[92:95]
s_add_u32 m0, s39, 69632
s_add_u32 s36, s41, 4096
buffer_load_dwordx4 v249, s[16:19], s36 offen offset:2048 sc1 lds
v_mfma_f32_16x16x32_bf16 a[96:99], a[248:251], v[112:115], a[96:99]
v_exp_f32 v30, v30
v_mfma_f32_16x16x32_bf16 a[100:103], a[248:251], v[116:119], a[100:103]
v_cvt_pk_bf16_f32 v110, v28, v29
v_mfma_f32_16x16x32_bf16 a[104:107], a[248:251], v[120:123], a[104:107]
v_exp_f32 v31, v31
v_mfma_f32_16x16x32_bf16 a[108:111], a[248:251], v[124:127], a[108:111]
buffer_load_dwordx4 v249, s[16:19], s36 offen offset:3072 sc1 lds
v_mfma_f32_16x16x32_bf16 a[112:115], a[252:255], v[112:115], a[112:115]
s_lshl1_add_u32 m0, s26, 32768
v_exp_f32 v32, v32
v_mfma_f32_16x16x32_bf16 a[116:119], a[252:255], v[116:119], a[116:119]
v_cvt_pk_bf16_f32 v111, v30, v31
v_mfma_f32_16x16x32_bf16 a[120:123], a[252:255], v[120:123], a[120:123]
v_exp_f32 v33, v33
v_mfma_f32_16x16x32_bf16 a[124:127], a[252:255], v[124:127], a[124:127]
v_mfma_f32_16x16x32_bf16 v[0:3], a[192:195], v[128:131], v[64:67]
v_exp_f32 v34, v34
v_mfma_f32_16x16x32_bf16 v[0:3], a[196:199], v[132:135], v[0:3]
ds_read_b64_tr_b16 a[224:225], v220 offset:49152
v_cvt_pk_bf16_f32 v112, v32, v33
v_mfma_f32_16x16x32_bf16 v[0:3], a[200:203], v[136:139], v[0:3]
v_exp_f32 v35, v35
v_mfma_f32_16x16x32_bf16 v[0:3], a[204:207], v[140:143], v[0:3]
ds_read_b64_tr_b16 a[226:227], v220 offset:57344
ds_read_b64_tr_b16 a[228:229], v221 offset:49152
v_mfma_f32_16x16x32_bf16 v[4:7], a[208:211], v[128:131], v[64:67]
v_exp_f32 v36, v36
v_mfma_f32_16x16x32_bf16 v[4:7], a[212:215], v[132:135], v[4:7]
ds_read_b64_tr_b16 a[230:231], v221 offset:57344
v_cvt_pk_bf16_f32 v113, v34, v35
v_mfma_f32_16x16x32_bf16 v[4:7], a[216:219], v[136:139], v[4:7]
v_exp_f32 v37, v37
v_mfma_f32_16x16x32_bf16 v[4:7], a[220:223], v[140:143], v[4:7]
buffer_load_dwordx4 v229, s[12:15], s24 offen offset:1024  lds
v_mfma_f32_16x16x32_bf16 v[8:11], a[192:195], v[144:147], v[68:71]
v_exp_f32 v38, v38
v_mfma_f32_16x16x32_bf16 v[8:11], a[196:199], v[148:151], v[8:11]
ds_read_b64_tr_b16 a[232:233], v222 offset:49152
v_cvt_pk_bf16_f32 v114, v36, v37
v_mfma_f32_16x16x32_bf16 v[8:11], a[200:203], v[152:155], v[8:11]
v_exp_f32 v39, v39
v_mfma_f32_16x16x32_bf16 v[8:11], a[204:207], v[156:159], v[8:11]
ds_read_b64_tr_b16 a[234:235], v222 offset:57344
ds_read_b64_tr_b16 a[236:237], v223 offset:49152
v_mfma_f32_16x16x32_bf16 v[12:15], a[208:211], v[144:147], v[68:71]
v_exp_f32 v40, v40
v_mfma_f32_16x16x32_bf16 v[12:15], a[212:215], v[148:151], v[12:15]
ds_read_b64_tr_b16 a[238:239], v223 offset:57344
v_cvt_pk_bf16_f32 v115, v38, v39
v_mfma_f32_16x16x32_bf16 v[12:15], a[216:219], v[152:155], v[12:15]
v_exp_f32 v41, v41
v_mfma_f32_16x16x32_bf16 v[12:15], a[220:223], v[156:159], v[12:15]
ds_read_b64_tr_b16 a[240:241], v224 offset:49152
ds_read_b64_tr_b16 a[242:243], v224 offset:57344
v_mfma_f32_16x16x32_bf16 v[16:19], a[192:195], v[160:163], v[72:75]
v_exp_f32 v42, v42
v_mfma_f32_16x16x32_bf16 v[16:19], a[196:199], v[164:167], v[16:19]
ds_read_b64_tr_b16 a[244:245], v225 offset:49152
v_cvt_pk_bf16_f32 v116, v40, v41
v_mfma_f32_16x16x32_bf16 v[16:19], a[200:203], v[168:171], v[16:19]
v_exp_f32 v43, v43
v_mfma_f32_16x16x32_bf16 v[16:19], a[204:207], v[172:175], v[16:19]
ds_read_b64_tr_b16 a[246:247], v225 offset:57344
ds_read_b64_tr_b16 a[248:249], v226 offset:49152
v_mfma_f32_16x16x32_bf16 v[20:23], a[208:211], v[160:163], v[72:75]
v_exp_f32 v44, v44
v_mfma_f32_16x16x32_bf16 v[20:23], a[212:215], v[164:167], v[20:23]
ds_read_b64_tr_b16 a[250:251], v226 offset:57344
v_cvt_pk_bf16_f32 v117, v42, v43
v_mfma_f32_16x16x32_bf16 v[20:23], a[216:219], v[168:171], v[20:23]
v_exp_f32 v45, v45
v_mfma_f32_16x16x32_bf16 v[20:23], a[220:223], v[172:175], v[20:23]
buffer_load_dwordx4 v230, s[8:11], s24 offen offset:2048  lds
v_mfma_f32_16x16x32_bf16 v[24:27], a[192:195], v[176:179], v[76:79]
v_exp_f32 v46, v46
v_mfma_f32_16x16x32_bf16 v[24:27], a[196:199], v[180:183], v[24:27]
ds_read_b64_tr_b16 a[252:253], v227 offset:49152
v_cvt_pk_bf16_f32 v118, v44, v45
v_mfma_f32_16x16x32_bf16 v[24:27], a[200:203], v[184:187], v[24:27]
v_exp_f32 v47, v47
v_mfma_f32_16x16x32_bf16 v[24:27], a[204:207], v[188:191], v[24:27]
ds_read_b64_tr_b16 a[254:255], v227 offset:57344
v_mfma_f32_16x16x32_bf16 v[28:31], a[208:211], v[176:179], v[76:79]
v_exp_f32 v48, v48
v_smfmac_f32_16x16x64_bf16 v[80:83], v[232:235], v[96:103], v88
v_cvt_pk_bf16_f32 v119, v46, v47
v_mfma_f32_16x16x32_bf16 v[28:31], a[212:215], v[180:183], v[28:31]
v_exp_f32 v49, v49
v_mfma_f32_16x16x32_bf16 v[28:31], a[216:219], v[184:187], v[28:31]
s_mov_b32 exec_lo, 0xffff
s_mov_b32 exec_hi, 0x0
buffer_load_dword v215, v196, s[16:19], s43 offen offset:0 sc1
s_mov_b64 exec, -1
v_mfma_f32_16x16x32_bf16 v[28:31], a[220:223], v[188:191], v[28:31]
v_exp_f32 v50, v50
v_smfmac_f32_16x16x64_bf16 v[84:87], v[232:235], v[104:111], v88
s_waitcnt lgkmcnt(0)
v_cvt_pk_bf16_f32 v120, v48, v49
v_mfma_f32_16x16x32_bf16 a[0:3], a[224:227], v[96:99], a[0:3]
v_exp_f32 v51, v51
v_mfma_f32_16x16x32_bf16 a[4:7], a[224:227], v[100:103], a[4:7]
v_exp_f32 v52, v52
v_mfma_f32_16x16x32_bf16 a[8:11], a[224:227], v[104:107], a[8:11]
ds_read_b128 a[192:195], v216 offset:49152
v_cvt_pk_bf16_f32 v121, v50, v51
v_mfma_f32_16x16x32_bf16 a[12:15], a[224:227], v[108:111], a[12:15]
v_exp_f32 v53, v53
v_mfma_f32_16x16x32_bf16 a[16:19], a[228:231], v[96:99], a[16:19]
ds_read_b128 a[196:199], v217 offset:49152
ds_read_b128 a[200:203], v218 offset:49152
v_mfma_f32_16x16x32_bf16 a[20:23], a[228:231], v[100:103], a[20:23]
v_exp_f32 v54, v54
v_mfma_f32_16x16x32_bf16 a[24:27], a[228:231], v[104:107], a[24:27]
ds_read_b128 a[204:207], v219 offset:49152
v_cvt_pk_bf16_f32 v122, v52, v53
v_mfma_f32_16x16x32_bf16 a[28:31], a[228:231], v[108:111], a[28:31]
v_exp_f32 v55, v55
v_mfma_f32_16x16x32_bf16 a[32:35], a[232:235], v[96:99], a[32:35]
buffer_load_dwordx4 v231, s[8:11], s24 offen offset:3072  lds
v_mfma_f32_16x16x32_bf16 a[36:39], a[232:235], v[100:103], a[36:39]
s_add_u32 s24, s24, 8192
v_exp_f32 v56, v56
v_mfma_f32_16x16x32_bf16 a[40:43], a[232:235], v[104:107], a[40:43]
ds_read_b128 a[208:211], v216 offset:57344
v_cvt_pk_bf16_f32 v123, v54, v55
v_mfma_f32_16x16x32_bf16 a[44:47], a[232:235], v[108:111], a[44:47]
v_exp_f32 v57, v57
v_mfma_f32_16x16x32_bf16 a[48:51], a[236:239], v[96:99], a[48:51]
ds_read_b128 a[212:215], v217 offset:57344
ds_read_b128 a[216:219], v218 offset:57344
v_mfma_f32_16x16x32_bf16 a[52:55], a[236:239], v[100:103], a[52:55]
v_exp_f32 v58, v58
v_mfma_f32_16x16x32_bf16 a[56:59], a[236:239], v[104:107], a[56:59]
ds_read_b128 a[220:223], v219 offset:57344
v_cvt_pk_bf16_f32 v124, v56, v57
v_mfma_f32_16x16x32_bf16 a[60:63], a[236:239], v[108:111], a[60:63]
v_exp_f32 v59, v59
v_mfma_f32_16x16x32_bf16 a[64:67], a[240:243], v[96:99], a[64:67]
v_mfma_f32_16x16x32_bf16 a[68:71], a[240:243], v[100:103], a[68:71]
v_exp_f32 v60, v60
v_mfma_f32_16x16x32_bf16 a[72:75], a[240:243], v[104:107], a[72:75]
v_cvt_pk_bf16_f32 v125, v58, v59
v_mfma_f32_16x16x32_bf16 a[76:79], a[240:243], v[108:111], a[76:79]
v_exp_f32 v61, v61
v_mfma_f32_16x16x32_bf16 a[80:83], a[244:247], v[96:99], a[80:83]
s_lshl1_add_u32 m0, s26, 49152
v_mfma_f32_16x16x32_bf16 a[84:87], a[244:247], v[100:103], a[84:87]
s_waitcnt vmcnt(14) lgkmcnt(0)
s_barrier
v_mfma_f32_16x16x32_bf16 a[88:91], a[244:247], v[104:107], a[88:91]
buffer_load_dwordx4 v228, s[12:15], s24 offen  lds
v_mfma_f32_16x16x32_bf16 a[92:95], a[244:247], v[108:111], a[92:95]
s_add_u32 m0, s39, 73728
s_add_u32 s36, s41, 8192
buffer_load_dwordx4 v249, s[16:19], s36 offen offset:0 sc1 lds
v_mfma_f32_16x16x32_bf16 a[96:99], a[248:251], v[96:99], a[96:99]
v_exp_f32 v62, v62
v_mfma_f32_16x16x32_bf16 a[100:103], a[248:251], v[100:103], a[100:103]
v_cvt_pk_bf16_f32 v126, v60, v61
v_mfma_f32_16x16x32_bf16 a[104:107], a[248:251], v[104:107], a[104:107]
v_exp_f32 v63, v63
v_mfma_f32_16x16x32_bf16 a[108:111], a[248:251], v[108:111], a[108:111]
buffer_load_dwordx4 v249, s[16:19], s36 offen offset:1024 sc1 lds
v_mfma_f32_16x16x32_bf16 a[112:115], a[252:255], v[96:99], a[112:115]
s_lshl1_add_u32 m0, s26, 49152
v_exp_f32 v0, v0
v_mfma_f32_16x16x32_bf16 a[116:119], a[252:255], v[100:103], a[116:119]
v_cvt_pk_bf16_f32 v127, v62, v63
v_mfma_f32_16x16x32_bf16 a[120:123], a[252:255], v[104:107], a[120:123]
v_exp_f32 v1, v1
v_mfma_f32_16x16x32_bf16 a[124:127], a[252:255], v[108:111], a[124:127]
v_mfma_f32_16x16x32_bf16 v[32:35], a[192:195], v[128:131], v[64:67]
v_exp_f32 v2, v2
v_mfma_f32_16x16x32_bf16 v[32:35], a[196:199], v[132:135], v[32:35]
ds_read_b64_tr_b16 a[224:225], v220 offset:0
v_cvt_pk_bf16_f32 v96, v0, v1
v_mfma_f32_16x16x32_bf16 v[32:35], a[200:203], v[136:139], v[32:35]
v_exp_f32 v3, v3
v_mfma_f32_16x16x32_bf16 v[32:35], a[204:207], v[140:143], v[32:35]
ds_read_b64_tr_b16 a[226:227], v220 offset:8192
ds_read_b64_tr_b16 a[228:229], v221 offset:0
v_mfma_f32_16x16x32_bf16 v[36:39], a[208:211], v[128:131], v[64:67]
v_exp_f32 v4, v4
v_mfma_f32_16x16x32_bf16 v[36:39], a[212:215], v[132:135], v[36:39]
ds_read_b64_tr_b16 a[230:231], v221 offset:8192
v_cvt_pk_bf16_f32 v97, v2, v3
v_mfma_f32_16x16x32_bf16 v[36:39], a[216:219], v[136:139], v[36:39]
v_exp_f32 v5, v5
v_mfma_f32_16x16x32_bf16 v[36:39], a[220:223], v[140:143], v[36:39]
buffer_load_dwordx4 v229, s[12:15], s24 offen offset:1024  lds
v_mfma_f32_16x16x32_bf16 v[40:43], a[192:195], v[144:147], v[68:71]
v_exp_f32 v6, v6
v_mfma_f32_16x16x32_bf16 v[40:43], a[196:199], v[148:151], v[40:43]
ds_read_b64_tr_b16 a[232:233], v222 offset:0
v_cvt_pk_bf16_f32 v98, v4, v5
v_mfma_f32_16x16x32_bf16 v[40:43], a[200:203], v[152:155], v[40:43]
v_exp_f32 v7, v7
v_mfma_f32_16x16x32_bf16 v[40:43], a[204:207], v[156:159], v[40:43]
ds_read_b64_tr_b16 a[234:235], v222 offset:8192
ds_read_b64_tr_b16 a[236:237], v223 offset:0
v_mfma_f32_16x16x32_bf16 v[44:47], a[208:211], v[144:147], v[68:71]
v_exp_f32 v8, v8
v_mfma_f32_16x16x32_bf16 v[44:47], a[212:215], v[148:151], v[44:47]
ds_read_b64_tr_b16 a[238:239], v223 offset:8192
v_cvt_pk_bf16_f32 v99, v6, v7
v_mfma_f32_16x16x32_bf16 v[44:47], a[216:219], v[152:155], v[44:47]
v_exp_f32 v9, v9
v_mfma_f32_16x16x32_bf16 v[44:47], a[220:223], v[156:159], v[44:47]
ds_read_b64_tr_b16 a[240:241], v224 offset:0
ds_read_b64_tr_b16 a[242:243], v224 offset:8192
v_mfma_f32_16x16x32_bf16 v[48:51], a[192:195], v[160:163], v[72:75]
v_exp_f32 v10, v10
v_mfma_f32_16x16x32_bf16 v[48:51], a[196:199], v[164:167], v[48:51]
ds_read_b64_tr_b16 a[244:245], v225 offset:0
v_cvt_pk_bf16_f32 v100, v8, v9
v_mfma_f32_16x16x32_bf16 v[48:51], a[200:203], v[168:171], v[48:51]
v_exp_f32 v11, v11
v_mfma_f32_16x16x32_bf16 v[48:51], a[204:207], v[172:175], v[48:51]
ds_read_b64_tr_b16 a[246:247], v225 offset:8192
ds_read_b64_tr_b16 a[248:249], v226 offset:0
v_mfma_f32_16x16x32_bf16 v[52:55], a[208:211], v[160:163], v[72:75]
v_exp_f32 v12, v12
v_mfma_f32_16x16x32_bf16 v[52:55], a[212:215], v[164:167], v[52:55]
ds_read_b64_tr_b16 a[250:251], v226 offset:8192
v_cvt_pk_bf16_f32 v101, v10, v11
v_mfma_f32_16x16x32_bf16 v[52:55], a[216:219], v[168:171], v[52:55]
v_exp_f32 v13, v13
v_mfma_f32_16x16x32_bf16 v[52:55], a[220:223], v[172:175], v[52:55]
buffer_load_dwordx4 v230, s[8:11], s24 offen offset:2048  lds
v_mfma_f32_16x16x32_bf16 v[56:59], a[192:195], v[176:179], v[76:79]
v_exp_f32 v14, v14
v_mfma_f32_16x16x32_bf16 v[56:59], a[196:199], v[180:183], v[56:59]
ds_read_b64_tr_b16 a[252:253], v227 offset:0
v_cvt_pk_bf16_f32 v102, v12, v13
v_mfma_f32_16x16x32_bf16 v[56:59], a[200:203], v[184:187], v[56:59]
v_exp_f32 v15, v15
v_mfma_f32_16x16x32_bf16 v[56:59], a[204:207], v[188:191], v[56:59]
ds_read_b64_tr_b16 a[254:255], v227 offset:8192
v_mfma_f32_16x16x32_bf16 v[60:63], a[208:211], v[176:179], v[76:79]
v_exp_f32 v16, v16
v_smfmac_f32_16x16x64_bf16 v[80:83], v[232:235], v[112:119], v88
v_cvt_pk_bf16_f32 v103, v14, v15
v_mfma_f32_16x16x32_bf16 v[60:63], a[212:215], v[180:183], v[60:63]
v_exp_f32 v17, v17
v_mfma_f32_16x16x32_bf16 v[60:63], a[216:219], v[184:187], v[60:63]
s_mov_b32 exec_lo, 0xffff
s_mov_b32 exec_hi, 0x0
buffer_load_dword v215, v196, s[16:19], s43 offen offset:2048 sc1
s_mov_b64 exec, -1
v_mfma_f32_16x16x32_bf16 v[60:63], a[220:223], v[188:191], v[60:63]
v_exp_f32 v18, v18
v_smfmac_f32_16x16x64_bf16 v[84:87], v[232:235], v[120:127], v88
s_waitcnt lgkmcnt(0)
v_cvt_pk_bf16_f32 v104, v16, v17
v_mfma_f32_16x16x32_bf16 a[0:3], a[224:227], v[112:115], a[0:3]
v_exp_f32 v19, v19
v_mfma_f32_16x16x32_bf16 a[4:7], a[224:227], v[116:119], a[4:7]
v_exp_f32 v20, v20
v_mfma_f32_16x16x32_bf16 a[8:11], a[224:227], v[120:123], a[8:11]
ds_read_b128 a[192:195], v216 offset:0
v_cvt_pk_bf16_f32 v105, v18, v19
v_mfma_f32_16x16x32_bf16 a[12:15], a[224:227], v[124:127], a[12:15]
v_exp_f32 v21, v21
v_mfma_f32_16x16x32_bf16 a[16:19], a[228:231], v[112:115], a[16:19]
ds_read_b128 a[196:199], v217 offset:0
ds_read_b128 a[200:203], v218 offset:0
v_mfma_f32_16x16x32_bf16 a[20:23], a[228:231], v[116:119], a[20:23]
v_exp_f32 v22, v22
v_mfma_f32_16x16x32_bf16 a[24:27], a[228:231], v[120:123], a[24:27]
ds_read_b128 a[204:207], v219 offset:0
v_cvt_pk_bf16_f32 v106, v20, v21
v_mfma_f32_16x16x32_bf16 a[28:31], a[228:231], v[124:127], a[28:31]
v_exp_f32 v23, v23
v_mfma_f32_16x16x32_bf16 a[32:35], a[232:235], v[112:115], a[32:35]
buffer_load_dwordx4 v231, s[8:11], s24 offen offset:3072  lds
v_mfma_f32_16x16x32_bf16 a[36:39], a[232:235], v[116:119], a[36:39]
s_add_u32 s24, s24, 8192
v_exp_f32 v24, v24
v_mfma_f32_16x16x32_bf16 a[40:43], a[232:235], v[120:123], a[40:43]
ds_read_b128 a[208:211], v216 offset:8192
v_cvt_pk_bf16_f32 v107, v22, v23
v_mfma_f32_16x16x32_bf16 a[44:47], a[232:235], v[124:127], a[44:47]
v_exp_f32 v25, v25
v_mfma_f32_16x16x32_bf16 a[48:51], a[236:239], v[112:115], a[48:51]
ds_read_b128 a[212:215], v217 offset:8192
ds_read_b128 a[216:219], v218 offset:8192
v_mfma_f32_16x16x32_bf16 a[52:55], a[236:239], v[116:119], a[52:55]
v_exp_f32 v26, v26
v_mfma_f32_16x16x32_bf16 a[56:59], a[236:239], v[120:123], a[56:59]
ds_read_b128 a[220:223], v219 offset:8192
v_cvt_pk_bf16_f32 v108, v24, v25
v_mfma_f32_16x16x32_bf16 a[60:63], a[236:239], v[124:127], a[60:63]
v_exp_f32 v27, v27
v_mfma_f32_16x16x32_bf16 a[64:67], a[240:243], v[112:115], a[64:67]
v_mfma_f32_16x16x32_bf16 a[68:71], a[240:243], v[116:119], a[68:71]
v_exp_f32 v28, v28
v_mfma_f32_16x16x32_bf16 a[72:75], a[240:243], v[120:123], a[72:75]
v_cvt_pk_bf16_f32 v109, v26, v27
v_mfma_f32_16x16x32_bf16 a[76:79], a[240:243], v[124:127], a[76:79]
v_exp_f32 v29, v29
v_mfma_f32_16x16x32_bf16 a[80:83], a[244:247], v[112:115], a[80:83]
s_lshl1_add_u32 m0, s26, 0
v_mfma_f32_16x16x32_bf16 a[84:87], a[244:247], v[116:119], a[84:87]
s_waitcnt vmcnt(14) lgkmcnt(0)
s_barrier
v_mfma_f32_16x16x32_bf16 a[88:91], a[244:247], v[120:123], a[88:91]
buffer_load_dwordx4 v228, s[12:15], s24 offen  lds
v_mfma_f32_16x16x32_bf16 a[92:95], a[244:247], v[124:127], a[92:95]
s_add_u32 m0, s39, 73728
s_add_u32 s36, s41, 8192
buffer_load_dwordx4 v249, s[16:19], s36 offen offset:2048 sc1 lds
v_mfma_f32_16x16x32_bf16 a[96:99], a[248:251], v[112:115], a[96:99]
v_exp_f32 v30, v30
v_mfma_f32_16x16x32_bf16 a[100:103], a[248:251], v[116:119], a[100:103]
v_cvt_pk_bf16_f32 v110, v28, v29
v_mfma_f32_16x16x32_bf16 a[104:107], a[248:251], v[120:123], a[104:107]
v_exp_f32 v31, v31
v_mfma_f32_16x16x32_bf16 a[108:111], a[248:251], v[124:127], a[108:111]
buffer_load_dwordx4 v249, s[16:19], s36 offen offset:3072 sc1 lds
v_mfma_f32_16x16x32_bf16 a[112:115], a[252:255], v[112:115], a[112:115]
s_lshl1_add_u32 m0, s26, 0
v_exp_f32 v32, v32
v_mfma_f32_16x16x32_bf16 a[116:119], a[252:255], v[116:119], a[116:119]
v_cvt_pk_bf16_f32 v111, v30, v31
v_mfma_f32_16x16x32_bf16 a[120:123], a[252:255], v[120:123], a[120:123]
v_exp_f32 v33, v33
v_mfma_f32_16x16x32_bf16 a[124:127], a[252:255], v[124:127], a[124:127]
v_mfma_f32_16x16x32_bf16 v[0:3], a[192:195], v[128:131], v[64:67]
v_exp_f32 v34, v34
v_mfma_f32_16x16x32_bf16 v[0:3], a[196:199], v[132:135], v[0:3]
ds_read_b64_tr_b16 a[224:225], v220 offset:16384
v_cvt_pk_bf16_f32 v112, v32, v33
v_mfma_f32_16x16x32_bf16 v[0:3], a[200:203], v[136:139], v[0:3]
v_exp_f32 v35, v35
v_mfma_f32_16x16x32_bf16 v[0:3], a[204:207], v[140:143], v[0:3]
ds_read_b64_tr_b16 a[226:227], v220 offset:24576
ds_read_b64_tr_b16 a[228:229], v221 offset:16384
v_mfma_f32_16x16x32_bf16 v[4:7], a[208:211], v[128:131], v[64:67]
v_exp_f32 v36, v36
v_mfma_f32_16x16x32_bf16 v[4:7], a[212:215], v[132:135], v[4:7]
ds_read_b64_tr_b16 a[230:231], v221 offset:24576
v_cvt_pk_bf16_f32 v113, v34, v35
v_mfma_f32_16x16x32_bf16 v[4:7], a[216:219], v[136:139], v[4:7]
v_exp_f32 v37, v37
v_mfma_f32_16x16x32_bf16 v[4:7], a[220:223], v[140:143], v[4:7]
buffer_load_dwordx4 v229, s[12:15], s24 offen offset:1024  lds
v_mfma_f32_16x16x32_bf16 v[8:11], a[192:195], v[144:147], v[68:71]
v_exp_f32 v38, v38
v_mfma_f32_16x16x32_bf16 v[8:11], a[196:199], v[148:151], v[8:11]
ds_read_b64_tr_b16 a[232:233], v222 offset:16384
v_cvt_pk_bf16_f32 v114, v36, v37
v_mfma_f32_16x16x32_bf16 v[8:11], a[200:203], v[152:155], v[8:11]
v_exp_f32 v39, v39
v_mfma_f32_16x16x32_bf16 v[8:11], a[204:207], v[156:159], v[8:11]
ds_read_b64_tr_b16 a[234:235], v222 offset:24576
ds_read_b64_tr_b16 a[236:237], v223 offset:16384
v_mfma_f32_16x16x32_bf16 v[12:15], a[208:211], v[144:147], v[68:71]
v_exp_f32 v40, v40
v_mfma_f32_16x16x32_bf16 v[12:15], a[212:215], v[148:151], v[12:15]
ds_read_b64_tr_b16 a[238:239], v223 offset:24576
v_cvt_pk_bf16_f32 v115, v38, v39
v_mfma_f32_16x16x32_bf16 v[12:15], a[216:219], v[152:155], v[12:15]
v_exp_f32 v41, v41
v_mfma_f32_16x16x32_bf16 v[12:15], a[220:223], v[156:159], v[12:15]
ds_read_b64_tr_b16 a[240:241], v224 offset:16384
ds_read_b64_tr_b16 a[242:243], v224 offset:24576
v_mfma_f32_16x16x32_bf16 v[16:19], a[192:195], v[160:163], v[72:75]
v_exp_f32 v42, v42
v_mfma_f32_16x16x32_bf16 v[16:19], a[196:199], v[164:167], v[16:19]
ds_read_b64_tr_b16 a[244:245], v225 offset:16384
v_cvt_pk_bf16_f32 v116, v40, v41
v_mfma_f32_16x16x32_bf16 v[16:19], a[200:203], v[168:171], v[16:19]
v_exp_f32 v43, v43
v_mfma_f32_16x16x32_bf16 v[16:19], a[204:207], v[172:175], v[16:19]
ds_read_b64_tr_b16 a[246:247], v225 offset:24576
ds_read_b64_tr_b16 a[248:249], v226 offset:16384
v_mfma_f32_16x16x32_bf16 v[20:23], a[208:211], v[160:163], v[72:75]
v_exp_f32 v44, v44
v_mfma_f32_16x16x32_bf16 v[20:23], a[212:215], v[164:167], v[20:23]
ds_read_b64_tr_b16 a[250:251], v226 offset:24576
v_cvt_pk_bf16_f32 v117, v42, v43
v_mfma_f32_16x16x32_bf16 v[20:23], a[216:219], v[168:171], v[20:23]
v_exp_f32 v45, v45
v_mfma_f32_16x16x32_bf16 v[20:23], a[220:223], v[172:175], v[20:23]
buffer_load_dwordx4 v230, s[8:11], s24 offen offset:2048  lds
v_mfma_f32_16x16x32_bf16 v[24:27], a[192:195], v[176:179], v[76:79]
v_exp_f32 v46, v46
v_mfma_f32_16x16x32_bf16 v[24:27], a[196:199], v[180:183], v[24:27]
ds_read_b64_tr_b16 a[252:253], v227 offset:16384
v_cvt_pk_bf16_f32 v118, v44, v45
v_mfma_f32_16x16x32_bf16 v[24:27], a[200:203], v[184:187], v[24:27]
v_exp_f32 v47, v47
v_mfma_f32_16x16x32_bf16 v[24:27], a[204:207], v[188:191], v[24:27]
ds_read_b64_tr_b16 a[254:255], v227 offset:24576
v_mfma_f32_16x16x32_bf16 v[28:31], a[208:211], v[176:179], v[76:79]
v_exp_f32 v48, v48
v_smfmac_f32_16x16x64_bf16 v[80:83], v[232:235], v[96:103], v88
v_cvt_pk_bf16_f32 v119, v46, v47
v_mfma_f32_16x16x32_bf16 v[28:31], a[212:215], v[180:183], v[28:31]
v_exp_f32 v49, v49
v_mfma_f32_16x16x32_bf16 v[28:31], a[216:219], v[184:187], v[28:31]
s_mov_b32 exec_lo, 0xffff
s_mov_b32 exec_hi, 0x0
buffer_load_dword v215, v196, s[16:19], s44 offen offset:0 sc1
s_mov_b64 exec, -1
v_mfma_f32_16x16x32_bf16 v[28:31], a[220:223], v[188:191], v[28:31]
v_exp_f32 v50, v50
v_smfmac_f32_16x16x64_bf16 v[84:87], v[232:235], v[104:111], v88
s_waitcnt lgkmcnt(0)
v_cvt_pk_bf16_f32 v120, v48, v49
v_mfma_f32_16x16x32_bf16 a[0:3], a[224:227], v[96:99], a[0:3]
v_exp_f32 v51, v51
v_mfma_f32_16x16x32_bf16 a[4:7], a[224:227], v[100:103], a[4:7]
v_exp_f32 v52, v52
v_mfma_f32_16x16x32_bf16 a[8:11], a[224:227], v[104:107], a[8:11]
ds_read_b128 a[192:195], v216 offset:16384
v_cvt_pk_bf16_f32 v121, v50, v51
v_mfma_f32_16x16x32_bf16 a[12:15], a[224:227], v[108:111], a[12:15]
v_exp_f32 v53, v53
v_mfma_f32_16x16x32_bf16 a[16:19], a[228:231], v[96:99], a[16:19]
ds_read_b128 a[196:199], v217 offset:16384
ds_read_b128 a[200:203], v218 offset:16384
v_mfma_f32_16x16x32_bf16 a[20:23], a[228:231], v[100:103], a[20:23]
v_exp_f32 v54, v54
v_mfma_f32_16x16x32_bf16 a[24:27], a[228:231], v[104:107], a[24:27]
ds_read_b128 a[204:207], v219 offset:16384
v_cvt_pk_bf16_f32 v122, v52, v53
v_mfma_f32_16x16x32_bf16 a[28:31], a[228:231], v[108:111], a[28:31]
v_exp_f32 v55, v55
v_mfma_f32_16x16x32_bf16 a[32:35], a[232:235], v[96:99], a[32:35]
buffer_load_dwordx4 v231, s[8:11], s24 offen offset:3072  lds
v_mfma_f32_16x16x32_bf16 a[36:39], a[232:235], v[100:103], a[36:39]
s_add_u32 s24, s24, 8192
v_exp_f32 v56, v56
v_mfma_f32_16x16x32_bf16 a[40:43], a[232:235], v[104:107], a[40:43]
ds_read_b128 a[208:211], v216 offset:24576
v_cvt_pk_bf16_f32 v123, v54, v55
v_mfma_f32_16x16x32_bf16 a[44:47], a[232:235], v[108:111], a[44:47]
v_exp_f32 v57, v57
v_mfma_f32_16x16x32_bf16 a[48:51], a[236:239], v[96:99], a[48:51]
ds_read_b128 a[212:215], v217 offset:24576
ds_read_b128 a[216:219], v218 offset:24576
v_mfma_f32_16x16x32_bf16 a[52:55], a[236:239], v[100:103], a[52:55]
v_exp_f32 v58, v58
v_mfma_f32_16x16x32_bf16 a[56:59], a[236:239], v[104:107], a[56:59]
ds_read_b128 a[220:223], v219 offset:24576
v_cvt_pk_bf16_f32 v124, v56, v57
v_mfma_f32_16x16x32_bf16 a[60:63], a[236:239], v[108:111], a[60:63]
v_exp_f32 v59, v59
v_mfma_f32_16x16x32_bf16 a[64:67], a[240:243], v[96:99], a[64:67]
v_mfma_f32_16x16x32_bf16 a[68:71], a[240:243], v[100:103], a[68:71]
v_exp_f32 v60, v60
v_mfma_f32_16x16x32_bf16 a[72:75], a[240:243], v[104:107], a[72:75]
v_cvt_pk_bf16_f32 v125, v58, v59
v_mfma_f32_16x16x32_bf16 a[76:79], a[240:243], v[108:111], a[76:79]
v_exp_f32 v61, v61
v_mfma_f32_16x16x32_bf16 a[80:83], a[244:247], v[96:99], a[80:83]
s_lshl1_add_u32 m0, s26, 16384
v_mfma_f32_16x16x32_bf16 a[84:87], a[244:247], v[100:103], a[84:87]
s_waitcnt vmcnt(14) lgkmcnt(0)
s_barrier
v_mfma_f32_16x16x32_bf16 a[88:91], a[244:247], v[104:107], a[88:91]
buffer_load_dwordx4 v228, s[12:15], s24 offen  lds
v_mfma_f32_16x16x32_bf16 a[92:95], a[244:247], v[108:111], a[92:95]
s_add_u32 m0, s39, 77824
s_add_u32 s36, s41, 12288
buffer_load_dwordx4 v249, s[16:19], s36 offen offset:0 sc1 lds
v_mfma_f32_16x16x32_bf16 a[96:99], a[248:251], v[96:99], a[96:99]
v_exp_f32 v62, v62
v_mfma_f32_16x16x32_bf16 a[100:103], a[248:251], v[100:103], a[100:103]
v_cvt_pk_bf16_f32 v126, v60, v61
v_mfma_f32_16x16x32_bf16 a[104:107], a[248:251], v[104:107], a[104:107]
v_exp_f32 v63, v63
v_mfma_f32_16x16x32_bf16 a[108:111], a[248:251], v[108:111], a[108:111]
buffer_load_dwordx4 v249, s[16:19], s36 offen offset:1024 sc1 lds
v_mfma_f32_16x16x32_bf16 a[112:115], a[252:255], v[96:99], a[112:115]
s_lshl1_add_u32 m0, s26, 16384
v_exp_f32 v0, v0
v_mfma_f32_16x16x32_bf16 a[116:119], a[252:255], v[100:103], a[116:119]
v_cvt_pk_bf16_f32 v127, v62, v63
v_mfma_f32_16x16x32_bf16 a[120:123], a[252:255], v[104:107], a[120:123]
v_exp_f32 v1, v1
v_mfma_f32_16x16x32_bf16 a[124:127], a[252:255], v[108:111], a[124:127]
v_mfma_f32_16x16x32_bf16 v[32:35], a[192:195], v[128:131], v[64:67]
v_exp_f32 v2, v2
v_mfma_f32_16x16x32_bf16 v[32:35], a[196:199], v[132:135], v[32:35]
ds_read_b64_tr_b16 a[224:225], v220 offset:32768
v_cvt_pk_bf16_f32 v96, v0, v1
v_mfma_f32_16x16x32_bf16 v[32:35], a[200:203], v[136:139], v[32:35]
v_exp_f32 v3, v3
v_mfma_f32_16x16x32_bf16 v[32:35], a[204:207], v[140:143], v[32:35]
ds_read_b64_tr_b16 a[226:227], v220 offset:40960
ds_read_b64_tr_b16 a[228:229], v221 offset:32768
v_mfma_f32_16x16x32_bf16 v[36:39], a[208:211], v[128:131], v[64:67]
v_exp_f32 v4, v4
v_mfma_f32_16x16x32_bf16 v[36:39], a[212:215], v[132:135], v[36:39]
ds_read_b64_tr_b16 a[230:231], v221 offset:40960
v_cvt_pk_bf16_f32 v97, v2, v3
v_mfma_f32_16x16x32_bf16 v[36:39], a[216:219], v[136:139], v[36:39]
v_exp_f32 v5, v5
v_mfma_f32_16x16x32_bf16 v[36:39], a[220:223], v[140:143], v[36:39]
buffer_load_dwordx4 v229, s[12:15], s24 offen offset:1024  lds
v_mfma_f32_16x16x32_bf16 v[40:43], a[192:195], v[144:147], v[68:71]
v_exp_f32 v6, v6
v_mfma_f32_16x16x32_bf16 v[40:43], a[196:199], v[148:151], v[40:43]
ds_read_b64_tr_b16 a[232:233], v222 offset:32768
v_cvt_pk_bf16_f32 v98, v4, v5
v_mfma_f32_16x16x32_bf16 v[40:43], a[200:203], v[152:155], v[40:43]
v_exp_f32 v7, v7
v_mfma_f32_16x16x32_bf16 v[40:43], a[204:207], v[156:159], v[40:43]
ds_read_b64_tr_b16 a[234:235], v222 offset:40960
ds_read_b64_tr_b16 a[236:237], v223 offset:32768
v_mfma_f32_16x16x32_bf16 v[44:47], a[208:211], v[144:147], v[68:71]
v_exp_f32 v8, v8
v_mfma_f32_16x16x32_bf16 v[44:47], a[212:215], v[148:151], v[44:47]
ds_read_b64_tr_b16 a[238:239], v223 offset:40960
v_cvt_pk_bf16_f32 v99, v6, v7
v_mfma_f32_16x16x32_bf16 v[44:47], a[216:219], v[152:155], v[44:47]
v_exp_f32 v9, v9
v_mfma_f32_16x16x32_bf16 v[44:47], a[220:223], v[156:159], v[44:47]
ds_read_b64_tr_b16 a[240:241], v224 offset:32768
ds_read_b64_tr_b16 a[242:243], v224 offset:40960
v_mfma_f32_16x16x32_bf16 v[48:51], a[192:195], v[160:163], v[72:75]
v_exp_f32 v10, v10
v_mfma_f32_16x16x32_bf16 v[48:51], a[196:199], v[164:167], v[48:51]
ds_read_b64_tr_b16 a[244:245], v225 offset:32768
v_cvt_pk_bf16_f32 v100, v8, v9
v_mfma_f32_16x16x32_bf16 v[48:51], a[200:203], v[168:171], v[48:51]
v_exp_f32 v11, v11
v_mfma_f32_16x16x32_bf16 v[48:51], a[204:207], v[172:175], v[48:51]
ds_read_b64_tr_b16 a[246:247], v225 offset:40960
ds_read_b64_tr_b16 a[248:249], v226 offset:32768
v_mfma_f32_16x16x32_bf16 v[52:55], a[208:211], v[160:163], v[72:75]
v_exp_f32 v12, v12
v_mfma_f32_16x16x32_bf16 v[52:55], a[212:215], v[164:167], v[52:55]
ds_read_b64_tr_b16 a[250:251], v226 offset:40960
v_cvt_pk_bf16_f32 v101, v10, v11
v_mfma_f32_16x16x32_bf16 v[52:55], a[216:219], v[168:171], v[52:55]
v_exp_f32 v13, v13
v_mfma_f32_16x16x32_bf16 v[52:55], a[220:223], v[172:175], v[52:55]
buffer_load_dwordx4 v230, s[8:11], s24 offen offset:2048  lds
Lpad18:
s_cbranch_execz Lpad22
v_mfma_f32_16x16x32_bf16 v[56:59], a[192:195], v[176:179], v[76:79]
v_exp_f32 v14, v14
v_mfma_f32_16x16x32_bf16 v[56:59], a[196:199], v[180:183], v[56:59]
ds_read_b64_tr_b16 a[252:253], v227 offset:32768
v_cvt_pk_bf16_f32 v102, v12, v13
v_mfma_f32_16x16x32_bf16 v[56:59], a[200:203], v[184:187], v[56:59]
v_exp_f32 v15, v15
v_mfma_f32_16x16x32_bf16 v[56:59], a[204:207], v[188:191], v[56:59]
ds_read_b64_tr_b16 a[254:255], v227 offset:40960
v_mfma_f32_16x16x32_bf16 v[60:63], a[208:211], v[176:179], v[76:79]
v_exp_f32 v16, v16
v_smfmac_f32_16x16x64_bf16 v[80:83], v[232:235], v[112:119], v88
v_cvt_pk_bf16_f32 v103, v14, v15
v_mfma_f32_16x16x32_bf16 v[60:63], a[212:215], v[180:183], v[60:63]
v_exp_f32 v17, v17
v_mfma_f32_16x16x32_bf16 v[60:63], a[216:219], v[184:187], v[60:63]
s_mov_b32 exec_lo, 0xffff
s_mov_b32 exec_hi, 0x0
buffer_load_dword v215, v196, s[16:19], s44 offen offset:2048 sc1
s_mov_b64 exec, -1
v_mfma_f32_16x16x32_bf16 v[60:63], a[220:223], v[188:191], v[60:63]
v_exp_f32 v18, v18
v_smfmac_f32_16x16x64_bf16 v[84:87], v[232:235], v[120:127], v88
s_waitcnt lgkmcnt(0)
v_cvt_pk_bf16_f32 v104, v16, v17
v_mfma_f32_16x16x32_bf16 a[0:3], a[224:227], v[112:115], a[0:3]
v_exp_f32 v19, v19
v_mfma_f32_16x16x32_bf16 a[4:7], a[224:227], v[116:119], a[4:7]
v_exp_f32 v20, v20
v_mfma_f32_16x16x32_bf16 a[8:11], a[224:227], v[120:123], a[8:11]
ds_read_b128 a[192:195], v216 offset:32768
v_cvt_pk_bf16_f32 v105, v18, v19
v_mfma_f32_16x16x32_bf16 a[12:15], a[224:227], v[124:127], a[12:15]
v_exp_f32 v21, v21
v_mfma_f32_16x16x32_bf16 a[16:19], a[228:231], v[112:115], a[16:19]
ds_read_b128 a[196:199], v217 offset:32768
ds_read_b128 a[200:203], v218 offset:32768
v_mfma_f32_16x16x32_bf16 a[20:23], a[228:231], v[116:119], a[20:23]
v_exp_f32 v22, v22
v_mfma_f32_16x16x32_bf16 a[24:27], a[228:231], v[120:123], a[24:27]
ds_read_b128 a[204:207], v219 offset:32768
v_cvt_pk_bf16_f32 v106, v20, v21
v_mfma_f32_16x16x32_bf16 a[28:31], a[228:231], v[124:127], a[28:31]
v_exp_f32 v23, v23
v_mfma_f32_16x16x32_bf16 a[32:35], a[232:235], v[112:115], a[32:35]
buffer_load_dwordx4 v231, s[8:11], s24 offen offset:3072  lds
v_mfma_f32_16x16x32_bf16 a[36:39], a[232:235], v[116:119], a[36:39]
s_add_u32 s24, s24, 8192
v_exp_f32 v24, v24
v_mfma_f32_16x16x32_bf16 a[40:43], a[232:235], v[120:123], a[40:43]
ds_read_b128 a[208:211], v216 offset:40960
v_cvt_pk_bf16_f32 v107, v22, v23
v_mfma_f32_16x16x32_bf16 a[44:47], a[232:235], v[124:127], a[44:47]
v_exp_f32 v25, v25
v_mfma_f32_16x16x32_bf16 a[48:51], a[236:239], v[112:115], a[48:51]
ds_read_b128 a[212:215], v217 offset:40960
ds_read_b128 a[216:219], v218 offset:40960
v_mfma_f32_16x16x32_bf16 a[52:55], a[236:239], v[116:119], a[52:55]
v_exp_f32 v26, v26
v_mfma_f32_16x16x32_bf16 a[56:59], a[236:239], v[120:123], a[56:59]
ds_read_b128 a[220:223], v219 offset:40960
v_cvt_pk_bf16_f32 v108, v24, v25
v_mfma_f32_16x16x32_bf16 a[60:63], a[236:239], v[124:127], a[60:63]
v_exp_f32 v27, v27
v_mfma_f32_16x16x32_bf16 a[64:67], a[240:243], v[112:115], a[64:67]
v_mfma_f32_16x16x32_bf16 a[68:71], a[240:243], v[116:119], a[68:71]
v_exp_f32 v28, v28
v_mfma_f32_16x16x32_bf16 a[72:75], a[240:243], v[120:123], a[72:75]
v_cvt_pk_bf16_f32 v109, v26, v27
v_mfma_f32_16x16x32_bf16 a[76:79], a[240:243], v[124:127], a[76:79]
v_exp_f32 v29, v29
v_mfma_f32_16x16x32_bf16 a[80:83], a[244:247], v[112:115], a[80:83]
s_lshl1_add_u32 m0, s26, 32768
v_mfma_f32_16x16x32_bf16 a[84:87], a[244:247], v[116:119], a[84:87]
s_waitcnt vmcnt(14) lgkmcnt(0)
s_barrier
v_mfma_f32_16x16x32_bf16 a[88:91], a[244:247], v[120:123], a[88:91]
buffer_load_dwordx4 v228, s[12:15], s24 offen  lds
v_mfma_f32_16x16x32_bf16 a[92:95], a[244:247], v[124:127], a[92:95]
s_add_u32 m0, s39, 77824
s_add_u32 s36, s41, 12288
buffer_load_dwordx4 v249, s[16:19], s36 offen offset:2048 sc1 lds
v_mfma_f32_16x16x32_bf16 a[96:99], a[248:251], v[112:115], a[96:99]
v_exp_f32 v30, v30
v_mfma_f32_16x16x32_bf16 a[100:103], a[248:251], v[116:119], a[100:103]
v_cvt_pk_bf16_f32 v110, v28, v29
v_mfma_f32_16x16x32_bf16 a[104:107], a[248:251], v[120:123], a[104:107]
v_exp_f32 v31, v31
v_mfma_f32_16x16x32_bf16 a[108:111], a[248:251], v[124:127], a[108:111]
buffer_load_dwordx4 v249, s[16:19], s36 offen offset:3072 sc1 lds
v_mfma_f32_16x16x32_bf16 a[112:115], a[252:255], v[112:115], a[112:115]
s_lshl1_add_u32 m0, s26, 32768
v_exp_f32 v32, v32
v_mfma_f32_16x16x32_bf16 a[116:119], a[252:255], v[116:119], a[116:119]
v_cvt_pk_bf16_f32 v111, v30, v31
v_mfma_f32_16x16x32_bf16 a[120:123], a[252:255], v[120:123], a[120:123]
v_exp_f32 v33, v33
v_mfma_f32_16x16x32_bf16 a[124:127], a[252:255], v[124:127], a[124:127]
v_mfma_f32_16x16x32_bf16 v[0:3], a[192:195], v[128:131], v[64:67]
v_exp_f32 v34, v34
v_mfma_f32_16x16x32_bf16 v[0:3], a[196:199], v[132:135], v[0:3]
ds_read_b64_tr_b16 a[224:225], v220 offset:49152
v_cvt_pk_bf16_f32 v112, v32, v33
v_mfma_f32_16x16x32_bf16 v[0:3], a[200:203], v[136:139], v[0:3]
v_exp_f32 v35, v35
v_mfma_f32_16x16x32_bf16 v[0:3], a[204:207], v[140:143], v[0:3]
ds_read_b64_tr_b16 a[226:227], v220 offset:57344
ds_read_b64_tr_b16 a[228:229], v221 offset:49152
v_mfma_f32_16x16x32_bf16 v[4:7], a[208:211], v[128:131], v[64:67]
v_exp_f32 v36, v36
v_mfma_f32_16x16x32_bf16 v[4:7], a[212:215], v[132:135], v[4:7]
ds_read_b64_tr_b16 a[230:231], v221 offset:57344
v_cvt_pk_bf16_f32 v113, v34, v35
v_mfma_f32_16x16x32_bf16 v[4:7], a[216:219], v[136:139], v[4:7]
v_exp_f32 v37, v37
v_mfma_f32_16x16x32_bf16 v[4:7], a[220:223], v[140:143], v[4:7]
buffer_load_dwordx4 v229, s[12:15], s24 offen offset:1024  lds
v_mfma_f32_16x16x32_bf16 v[8:11], a[192:195], v[144:147], v[68:71]
v_exp_f32 v38, v38
v_mfma_f32_16x16x32_bf16 v[8:11], a[196:199], v[148:151], v[8:11]
ds_read_b64_tr_b16 a[232:233], v222 offset:49152
v_cvt_pk_bf16_f32 v114, v36, v37
v_mfma_f32_16x16x32_bf16 v[8:11], a[200:203], v[152:155], v[8:11]
v_exp_f32 v39, v39
v_mfma_f32_16x16x32_bf16 v[8:11], a[204:207], v[156:159], v[8:11]
ds_read_b64_tr_b16 a[234:235], v222 offset:57344
ds_read_b64_tr_b16 a[236:237], v223 offset:49152
v_mfma_f32_16x16x32_bf16 v[12:15], a[208:211], v[144:147], v[68:71]
v_exp_f32 v40, v40
v_mfma_f32_16x16x32_bf16 v[12:15], a[212:215], v[148:151], v[12:15]
ds_read_b64_tr_b16 a[238:239], v223 offset:57344
v_cvt_pk_bf16_f32 v115, v38, v39
v_mfma_f32_16x16x32_bf16 v[12:15], a[216:219], v[152:155], v[12:15]
v_exp_f32 v41, v41
v_mfma_f32_16x16x32_bf16 v[12:15], a[220:223], v[156:159], v[12:15]
ds_read_b64_tr_b16 a[240:241], v224 offset:49152
ds_read_b64_tr_b16 a[242:243], v224 offset:57344
v_mfma_f32_16x16x32_bf16 v[16:19], a[192:195], v[160:163], v[72:75]
v_exp_f32 v42, v42
v_mfma_f32_16x16x32_bf16 v[16:19], a[196:199], v[164:167], v[16:19]
ds_read_b64_tr_b16 a[244:245], v225 offset:49152
v_cvt_pk_bf16_f32 v116, v40, v41
v_mfma_f32_16x16x32_bf16 v[16:19], a[200:203], v[168:171], v[16:19]
v_exp_f32 v43, v43
v_mfma_f32_16x16x32_bf16 v[16:19], a[204:207], v[172:175], v[16:19]
ds_read_b64_tr_b16 a[246:247], v225 offset:57344
ds_read_b64_tr_b16 a[248:249], v226 offset:49152
v_mfma_f32_16x16x32_bf16 v[20:23], a[208:211], v[160:163], v[72:75]
v_exp_f32 v44, v44
v_mfma_f32_16x16x32_bf16 v[20:23], a[212:215], v[164:167], v[20:23]
ds_read_b64_tr_b16 a[250:251], v226 offset:57344
v_cvt_pk_bf16_f32 v117, v42, v43
v_mfma_f32_16x16x32_bf16 v[20:23], a[216:219], v[168:171], v[20:23]
v_exp_f32 v45, v45
v_mfma_f32_16x16x32_bf16 v[20:23], a[220:223], v[172:175], v[20:23]
buffer_load_dwordx4 v230, s[8:11], s24 offen offset:2048  lds
v_mfma_f32_16x16x32_bf16 v[24:27], a[192:195], v[176:179], v[76:79]
v_exp_f32 v46, v46
v_mfma_f32_16x16x32_bf16 v[24:27], a[196:199], v[180:183], v[24:27]
ds_read_b64_tr_b16 a[252:253], v227 offset:49152
v_cvt_pk_bf16_f32 v118, v44, v45
v_mfma_f32_16x16x32_bf16 v[24:27], a[200:203], v[184:187], v[24:27]
v_exp_f32 v47, v47
v_mfma_f32_16x16x32_bf16 v[24:27], a[204:207], v[188:191], v[24:27]
ds_read_b64_tr_b16 a[254:255], v227 offset:57344
v_mfma_f32_16x16x32_bf16 v[28:31], a[208:211], v[176:179], v[76:79]
v_exp_f32 v48, v48
v_smfmac_f32_16x16x64_bf16 v[80:83], v[232:235], v[96:103], v88
v_cvt_pk_bf16_f32 v119, v46, v47
v_mfma_f32_16x16x32_bf16 v[28:31], a[212:215], v[180:183], v[28:31]
v_exp_f32 v49, v49
v_mfma_f32_16x16x32_bf16 v[28:31], a[216:219], v[184:187], v[28:31]
s_mov_b32 exec_lo, 0xffff
s_mov_b32 exec_hi, 0x0
buffer_load_dword v215, v196, s[16:19], s45 offen offset:0 sc1
s_mov_b64 exec, -1
v_mfma_f32_16x16x32_bf16 v[28:31], a[220:223], v[188:191], v[28:31]
v_exp_f32 v50, v50
v_smfmac_f32_16x16x64_bf16 v[84:87], v[232:235], v[104:111], v88
s_waitcnt lgkmcnt(0)
v_cvt_pk_bf16_f32 v120, v48, v49
v_mfma_f32_16x16x32_bf16 a[0:3], a[224:227], v[96:99], a[0:3]
v_exp_f32 v51, v51
v_mfma_f32_16x16x32_bf16 a[4:7], a[224:227], v[100:103], a[4:7]
v_exp_f32 v52, v52
v_mfma_f32_16x16x32_bf16 a[8:11], a[224:227], v[104:107], a[8:11]
ds_read_b128 a[192:195], v216 offset:49152
v_cvt_pk_bf16_f32 v121, v50, v51
v_mfma_f32_16x16x32_bf16 a[12:15], a[224:227], v[108:111], a[12:15]
v_exp_f32 v53, v53
v_mfma_f32_16x16x32_bf16 a[16:19], a[228:231], v[96:99], a[16:19]
ds_read_b128 a[196:199], v217 offset:49152
ds_read_b128 a[200:203], v218 offset:49152
v_mfma_f32_16x16x32_bf16 a[20:23], a[228:231], v[100:103], a[20:23]
v_exp_f32 v54, v54
v_mfma_f32_16x16x32_bf16 a[24:27], a[228:231], v[104:107], a[24:27]
ds_read_b128 a[204:207], v219 offset:49152
v_cvt_pk_bf16_f32 v122, v52, v53
v_mfma_f32_16x16x32_bf16 a[28:31], a[228:231], v[108:111], a[28:31]
v_exp_f32 v55, v55
v_mfma_f32_16x16x32_bf16 a[32:35], a[232:235], v[96:99], a[32:35]
buffer_load_dwordx4 v231, s[8:11], s24 offen offset:3072  lds
v_mfma_f32_16x16x32_bf16 a[36:39], a[232:235], v[100:103], a[36:39]
s_add_u32 s24, s24, 8192
v_exp_f32 v56, v56
v_mfma_f32_16x16x32_bf16 a[40:43], a[232:235], v[104:107], a[40:43]
ds_read_b128 a[208:211], v216 offset:57344
v_cvt_pk_bf16_f32 v123, v54, v55
v_mfma_f32_16x16x32_bf16 a[44:47], a[232:235], v[108:111], a[44:47]
v_exp_f32 v57, v57
v_mfma_f32_16x16x32_bf16 a[48:51], a[236:239], v[96:99], a[48:51]
ds_read_b128 a[212:215], v217 offset:57344
ds_read_b128 a[216:219], v218 offset:57344
v_mfma_f32_16x16x32_bf16 a[52:55], a[236:239], v[100:103], a[52:55]
v_exp_f32 v58, v58
v_mfma_f32_16x16x32_bf16 a[56:59], a[236:239], v[104:107], a[56:59]
ds_read_b128 a[220:223], v219 offset:57344
v_cvt_pk_bf16_f32 v124, v56, v57
v_mfma_f32_16x16x32_bf16 a[60:63], a[236:239], v[108:111], a[60:63]
v_exp_f32 v59, v59
v_mfma_f32_16x16x32_bf16 a[64:67], a[240:243], v[96:99], a[64:67]
v_mfma_f32_16x16x32_bf16 a[68:71], a[240:243], v[100:103], a[68:71]
v_exp_f32 v60, v60
v_mfma_f32_16x16x32_bf16 a[72:75], a[240:243], v[104:107], a[72:75]
v_cvt_pk_bf16_f32 v125, v58, v59
v_mfma_f32_16x16x32_bf16 a[76:79], a[240:243], v[108:111], a[76:79]
v_exp_f32 v61, v61
v_mfma_f32_16x16x32_bf16 a[80:83], a[244:247], v[96:99], a[80:83]
s_lshl1_add_u32 m0, s26, 49152
v_mfma_f32_16x16x32_bf16 a[84:87], a[244:247], v[100:103], a[84:87]
s_waitcnt vmcnt(14) lgkmcnt(0)
s_barrier
v_mfma_f32_16x16x32_bf16 a[88:91], a[244:247], v[104:107], a[88:91]
buffer_load_dwordx4 v228, s[12:15], s24 offen  lds
v_mfma_f32_16x16x32_bf16 a[92:95], a[244:247], v[108:111], a[92:95]
v_mfma_f32_16x16x32_bf16 a[96:99], a[248:251], v[96:99], a[96:99]
v_exp_f32 v62, v62
v_mfma_f32_16x16x32_bf16 a[100:103], a[248:251], v[100:103], a[100:103]
v_cvt_pk_bf16_f32 v126, v60, v61
v_mfma_f32_16x16x32_bf16 a[104:107], a[248:251], v[104:107], a[104:107]
v_exp_f32 v63, v63
v_mfma_f32_16x16x32_bf16 a[108:111], a[248:251], v[108:111], a[108:111]
v_mfma_f32_16x16x32_bf16 a[112:115], a[252:255], v[96:99], a[112:115]
v_exp_f32 v0, v0
v_mfma_f32_16x16x32_bf16 a[116:119], a[252:255], v[100:103], a[116:119]
v_cvt_pk_bf16_f32 v127, v62, v63
v_mfma_f32_16x16x32_bf16 a[120:123], a[252:255], v[104:107], a[120:123]
v_exp_f32 v1, v1
v_mfma_f32_16x16x32_bf16 a[124:127], a[252:255], v[108:111], a[124:127]
v_mfma_f32_16x16x32_bf16 v[32:35], a[192:195], v[128:131], v[64:67]
v_exp_f32 v2, v2
v_mfma_f32_16x16x32_bf16 v[32:35], a[196:199], v[132:135], v[32:35]
ds_read_b64_tr_b16 a[224:225], v220 offset:0
v_cvt_pk_bf16_f32 v96, v0, v1
v_mfma_f32_16x16x32_bf16 v[32:35], a[200:203], v[136:139], v[32:35]
v_exp_f32 v3, v3
v_mfma_f32_16x16x32_bf16 v[32:35], a[204:207], v[140:143], v[32:35]
ds_read_b64_tr_b16 a[226:227], v220 offset:8192
ds_read_b64_tr_b16 a[228:229], v221 offset:0
v_mfma_f32_16x16x32_bf16 v[36:39], a[208:211], v[128:131], v[64:67]
v_exp_f32 v4, v4
v_mfma_f32_16x16x32_bf16 v[36:39], a[212:215], v[132:135], v[36:39]
ds_read_b64_tr_b16 a[230:231], v221 offset:8192
v_cvt_pk_bf16_f32 v97, v2, v3
v_mfma_f32_16x16x32_bf16 v[36:39], a[216:219], v[136:139], v[36:39]
v_exp_f32 v5, v5
v_mfma_f32_16x16x32_bf16 v[36:39], a[220:223], v[140:143], v[36:39]
buffer_load_dwordx4 v229, s[12:15], s24 offen offset:1024  lds
v_mfma_f32_16x16x32_bf16 v[40:43], a[192:195], v[144:147], v[68:71]
v_exp_f32 v6, v6
v_mfma_f32_16x16x32_bf16 v[40:43], a[196:199], v[148:151], v[40:43]
ds_read_b64_tr_b16 a[232:233], v222 offset:0
v_cvt_pk_bf16_f32 v98, v4, v5
v_mfma_f32_16x16x32_bf16 v[40:43], a[200:203], v[152:155], v[40:43]
v_exp_f32 v7, v7
v_mfma_f32_16x16x32_bf16 v[40:43], a[204:207], v[156:159], v[40:43]
ds_read_b64_tr_b16 a[234:235], v222 offset:8192
ds_read_b64_tr_b16 a[236:237], v223 offset:0
v_mfma_f32_16x16x32_bf16 v[44:47], a[208:211], v[144:147], v[68:71]
v_exp_f32 v8, v8
v_mfma_f32_16x16x32_bf16 v[44:47], a[212:215], v[148:151], v[44:47]
ds_read_b64_tr_b16 a[238:239], v223 offset:8192
v_cvt_pk_bf16_f32 v99, v6, v7
v_mfma_f32_16x16x32_bf16 v[44:47], a[216:219], v[152:155], v[44:47]
v_exp_f32 v9, v9
v_mfma_f32_16x16x32_bf16 v[44:47], a[220:223], v[156:159], v[44:47]
ds_read_b64_tr_b16 a[240:241], v224 offset:0
ds_read_b64_tr_b16 a[242:243], v224 offset:8192
v_mfma_f32_16x16x32_bf16 v[48:51], a[192:195], v[160:163], v[72:75]
v_exp_f32 v10, v10
v_mfma_f32_16x16x32_bf16 v[48:51], a[196:199], v[164:167], v[48:51]
ds_read_b64_tr_b16 a[244:245], v225 offset:0
v_cvt_pk_bf16_f32 v100, v8, v9
v_mfma_f32_16x16x32_bf16 v[48:51], a[200:203], v[168:171], v[48:51]
v_exp_f32 v11, v11
v_mfma_f32_16x16x32_bf16 v[48:51], a[204:207], v[172:175], v[48:51]
ds_read_b64_tr_b16 a[246:247], v225 offset:8192
ds_read_b64_tr_b16 a[248:249], v226 offset:0
v_mfma_f32_16x16x32_bf16 v[52:55], a[208:211], v[160:163], v[72:75]
v_exp_f32 v12, v12
v_mfma_f32_16x16x32_bf16 v[52:55], a[212:215], v[164:167], v[52:55]
ds_read_b64_tr_b16 a[250:251], v226 offset:8192
v_cvt_pk_bf16_f32 v101, v10, v11
v_mfma_f32_16x16x32_bf16 v[52:55], a[216:219], v[168:171], v[52:55]
v_exp_f32 v13, v13
v_mfma_f32_16x16x32_bf16 v[52:55], a[220:223], v[172:175], v[52:55]
buffer_load_dwordx4 v230, s[8:11], s24 offen offset:2048  lds
v_mfma_f32_16x16x32_bf16 v[56:59], a[192:195], v[176:179], v[76:79]
v_exp_f32 v14, v14
v_mfma_f32_16x16x32_bf16 v[56:59], a[196:199], v[180:183], v[56:59]
ds_read_b64_tr_b16 a[252:253], v227 offset:0
v_cvt_pk_bf16_f32 v102, v12, v13
v_mfma_f32_16x16x32_bf16 v[56:59], a[200:203], v[184:187], v[56:59]
v_exp_f32 v15, v15
v_mfma_f32_16x16x32_bf16 v[56:59], a[204:207], v[188:191], v[56:59]
ds_read_b64_tr_b16 a[254:255], v227 offset:8192
v_mfma_f32_16x16x32_bf16 v[60:63], a[208:211], v[176:179], v[76:79]
v_exp_f32 v16, v16
v_smfmac_f32_16x16x64_bf16 v[80:83], v[232:235], v[112:119], v88
v_cvt_pk_bf16_f32 v103, v14, v15
v_mfma_f32_16x16x32_bf16 v[60:63], a[212:215], v[180:183], v[60:63]
v_exp_f32 v17, v17
v_mfma_f32_16x16x32_bf16 v[60:63], a[216:219], v[184:187], v[60:63]
s_mov_b32 exec_lo, 0xffff
s_mov_b32 exec_hi, 0x0
buffer_load_dword v215, v196, s[16:19], s45 offen offset:2048 sc1
s_mov_b64 exec, -1
v_mfma_f32_16x16x32_bf16 v[60:63], a[220:223], v[188:191], v[60:63]
v_exp_f32 v18, v18
v_smfmac_f32_16x16x64_bf16 v[84:87], v[232:235], v[120:127], v88
s_waitcnt lgkmcnt(0)
v_cvt_pk_bf16_f32 v104, v16, v17
v_mfma_f32_16x16x32_bf16 a[0:3], a[224:227], v[112:115], a[0:3]
v_exp_f32 v19, v19
v_mfma_f32_16x16x32_bf16 a[4:7], a[224:227], v[116:119], a[4:7]
v_exp_f32 v20, v20
v_mfma_f32_16x16x32_bf16 a[8:11], a[224:227], v[120:123], a[8:11]
ds_read_b128 a[192:195], v216 offset:0
v_cvt_pk_bf16_f32 v105, v18, v19
v_mfma_f32_16x16x32_bf16 a[12:15], a[224:227], v[124:127], a[12:15]
v_exp_f32 v21, v21
v_mfma_f32_16x16x32_bf16 a[16:19], a[228:231], v[112:115], a[16:19]
ds_read_b128 a[196:199], v217 offset:0
ds_read_b128 a[200:203], v218 offset:0
v_mfma_f32_16x16x32_bf16 a[20:23], a[228:231], v[116:119], a[20:23]
v_exp_f32 v22, v22
v_mfma_f32_16x16x32_bf16 a[24:27], a[228:231], v[120:123], a[24:27]
ds_read_b128 a[204:207], v219 offset:0
v_cvt_pk_bf16_f32 v106, v20, v21
v_mfma_f32_16x16x32_bf16 a[28:31], a[228:231], v[124:127], a[28:31]
v_exp_f32 v23, v23
v_mfma_f32_16x16x32_bf16 a[32:35], a[232:235], v[112:115], a[32:35]
buffer_load_dwordx4 v231, s[8:11], s24 offen offset:3072  lds
v_mfma_f32_16x16x32_bf16 a[36:39], a[232:235], v[116:119], a[36:39]
s_add_u32 s24, s24, 8192
v_exp_f32 v24, v24
v_mfma_f32_16x16x32_bf16 a[40:43], a[232:235], v[120:123], a[40:43]
ds_read_b128 a[208:211], v216 offset:8192
v_cvt_pk_bf16_f32 v107, v22, v23
v_mfma_f32_16x16x32_bf16 a[44:47], a[232:235], v[124:127], a[44:47]
v_exp_f32 v25, v25
v_mfma_f32_16x16x32_bf16 a[48:51], a[236:239], v[112:115], a[48:51]
ds_read_b128 a[212:215], v217 offset:8192
ds_read_b128 a[216:219], v218 offset:8192
v_mfma_f32_16x16x32_bf16 a[52:55], a[236:239], v[116:119], a[52:55]
v_exp_f32 v26, v26
v_mfma_f32_16x16x32_bf16 a[56:59], a[236:239], v[120:123], a[56:59]
ds_read_b128 a[220:223], v219 offset:8192
v_cvt_pk_bf16_f32 v108, v24, v25
v_mfma_f32_16x16x32_bf16 a[60:63], a[236:239], v[124:127], a[60:63]
v_exp_f32 v27, v27
v_mfma_f32_16x16x32_bf16 a[64:67], a[240:243], v[112:115], a[64:67]
v_mfma_f32_16x16x32_bf16 a[68:71], a[240:243], v[116:119], a[68:71]
v_exp_f32 v28, v28
v_mfma_f32_16x16x32_bf16 a[72:75], a[240:243], v[120:123], a[72:75]
v_cvt_pk_bf16_f32 v109, v26, v27
v_mfma_f32_16x16x32_bf16 a[76:79], a[240:243], v[124:127], a[76:79]
v_exp_f32 v29, v29
v_mfma_f32_16x16x32_bf16 a[80:83], a[244:247], v[112:115], a[80:83]
s_lshl1_add_u32 m0, s26, 0
v_mfma_f32_16x16x32_bf16 a[84:87], a[244:247], v[116:119], a[84:87]
s_waitcnt vmcnt(12) lgkmcnt(0)
s_barrier
v_mfma_f32_16x16x32_bf16 a[88:91], a[244:247], v[120:123], a[88:91]
buffer_load_dwordx4 v228, s[12:15], s24 offen  lds
v_mfma_f32_16x16x32_bf16 a[92:95], a[244:247], v[124:127], a[92:95]
v_mfma_f32_16x16x32_bf16 a[96:99], a[248:251], v[112:115], a[96:99]
v_exp_f32 v30, v30
v_mfma_f32_16x16x32_bf16 a[100:103], a[248:251], v[116:119], a[100:103]
v_cvt_pk_bf16_f32 v110, v28, v29
v_mfma_f32_16x16x32_bf16 a[104:107], a[248:251], v[120:123], a[104:107]
v_exp_f32 v31, v31
v_mfma_f32_16x16x32_bf16 a[108:111], a[248:251], v[124:127], a[108:111]
v_mfma_f32_16x16x32_bf16 a[112:115], a[252:255], v[112:115], a[112:115]
v_exp_f32 v32, v32
v_mfma_f32_16x16x32_bf16 a[116:119], a[252:255], v[116:119], a[116:119]
v_cvt_pk_bf16_f32 v111, v30, v31
v_mfma_f32_16x16x32_bf16 a[120:123], a[252:255], v[120:123], a[120:123]
v_exp_f32 v33, v33
v_mfma_f32_16x16x32_bf16 a[124:127], a[252:255], v[124:127], a[124:127]
v_mfma_f32_16x16x32_bf16 v[0:3], a[192:195], v[128:131], v[64:67]
v_exp_f32 v34, v34
v_mfma_f32_16x16x32_bf16 v[0:3], a[196:199], v[132:135], v[0:3]
ds_read_b64_tr_b16 a[224:225], v220 offset:16384
v_cvt_pk_bf16_f32 v112, v32, v33
v_mfma_f32_16x16x32_bf16 v[0:3], a[200:203], v[136:139], v[0:3]
v_exp_f32 v35, v35
v_mfma_f32_16x16x32_bf16 v[0:3], a[204:207], v[140:143], v[0:3]
ds_read_b64_tr_b16 a[226:227], v220 offset:24576
ds_read_b64_tr_b16 a[228:229], v221 offset:16384
v_mfma_f32_16x16x32_bf16 v[4:7], a[208:211], v[128:131], v[64:67]
v_exp_f32 v36, v36
v_mfma_f32_16x16x32_bf16 v[4:7], a[212:215], v[132:135], v[4:7]
ds_read_b64_tr_b16 a[230:231], v221 offset:24576
v_cvt_pk_bf16_f32 v113, v34, v35
v_mfma_f32_16x16x32_bf16 v[4:7], a[216:219], v[136:139], v[4:7]
v_exp_f32 v37, v37
v_mfma_f32_16x16x32_bf16 v[4:7], a[220:223], v[140:143], v[4:7]
buffer_load_dwordx4 v229, s[12:15], s24 offen offset:1024  lds
v_mfma_f32_16x16x32_bf16 v[8:11], a[192:195], v[144:147], v[68:71]
v_exp_f32 v38, v38
v_mfma_f32_16x16x32_bf16 v[8:11], a[196:199], v[148:151], v[8:11]
ds_read_b64_tr_b16 a[232:233], v222 offset:16384
v_cvt_pk_bf16_f32 v114, v36, v37
v_mfma_f32_16x16x32_bf16 v[8:11], a[200:203], v[152:155], v[8:11]
v_exp_f32 v39, v39
v_mfma_f32_16x16x32_bf16 v[8:11], a[204:207], v[156:159], v[8:11]
ds_read_b64_tr_b16 a[234:235], v222 offset:24576
ds_read_b64_tr_b16 a[236:237], v223 offset:16384
v_mfma_f32_16x16x32_bf16 v[12:15], a[208:211], v[144:147], v[68:71]
v_exp_f32 v40, v40
v_mfma_f32_16x16x32_bf16 v[12:15], a[212:215], v[148:151], v[12:15]
ds_read_b64_tr_b16 a[238:239], v223 offset:24576
v_cvt_pk_bf16_f32 v115, v38, v39
v_mfma_f32_16x16x32_bf16 v[12:15], a[216:219], v[152:155], v[12:15]
v_exp_f32 v41, v41
v_mfma_f32_16x16x32_bf16 v[12:15], a[220:223], v[156:159], v[12:15]
ds_read_b64_tr_b16 a[240:241], v224 offset:16384
ds_read_b64_tr_b16 a[242:243], v224 offset:24576
v_mfma_f32_16x16x32_bf16 v[16:19], a[192:195], v[160:163], v[72:75]
v_exp_f32 v42, v42
v_mfma_f32_16x16x32_bf16 v[16:19], a[196:199], v[164:167], v[16:19]
ds_read_b64_tr_b16 a[244:245], v225 offset:16384
v_cvt_pk_bf16_f32 v116, v40, v41
v_mfma_f32_16x16x32_bf16 v[16:19], a[200:203], v[168:171], v[16:19]
v_exp_f32 v43, v43
v_mfma_f32_16x16x32_bf16 v[16:19], a[204:207], v[172:175], v[16:19]
ds_read_b64_tr_b16 a[246:247], v225 offset:24576
ds_read_b64_tr_b16 a[248:249], v226 offset:16384
v_mfma_f32_16x16x32_bf16 v[20:23], a[208:211], v[160:163], v[72:75]
v_exp_f32 v44, v44
v_mfma_f32_16x16x32_bf16 v[20:23], a[212:215], v[164:167], v[20:23]
ds_read_b64_tr_b16 a[250:251], v226 offset:24576
v_cvt_pk_bf16_f32 v117, v42, v43
v_mfma_f32_16x16x32_bf16 v[20:23], a[216:219], v[168:171], v[20:23]
v_exp_f32 v45, v45
v_mfma_f32_16x16x32_bf16 v[20:23], a[220:223], v[172:175], v[20:23]
buffer_load_dwordx4 v230, s[8:11], s24 offen offset:2048  lds
v_mfma_f32_16x16x32_bf16 v[24:27], a[192:195], v[176:179], v[76:79]
v_exp_f32 v46, v46
v_mfma_f32_16x16x32_bf16 v[24:27], a[196:199], v[180:183], v[24:27]
ds_read_b64_tr_b16 a[252:253], v227 offset:16384
v_cvt_pk_bf16_f32 v118, v44, v45
v_mfma_f32_16x16x32_bf16 v[24:27], a[200:203], v[184:187], v[24:27]
v_exp_f32 v47, v47
v_mfma_f32_16x16x32_bf16 v[24:27], a[204:207], v[188:191], v[24:27]
ds_read_b64_tr_b16 a[254:255], v227 offset:24576
v_mfma_f32_16x16x32_bf16 v[28:31], a[208:211], v[176:179], v[76:79]
v_exp_f32 v48, v48
v_smfmac_f32_16x16x64_bf16 v[80:83], v[232:235], v[96:103], v88
v_cvt_pk_bf16_f32 v119, v46, v47
v_mfma_f32_16x16x32_bf16 v[28:31], a[212:215], v[180:183], v[28:31]
v_exp_f32 v49, v49
v_mfma_f32_16x16x32_bf16 v[28:31], a[216:219], v[184:187], v[28:31]
s_mov_b32 exec_lo, 0xffff
s_mov_b32 exec_hi, 0x0
buffer_load_dword v215, v196, s[16:19], s46 offen offset:0 sc1
s_mov_b64 exec, -1
v_mfma_f32_16x16x32_bf16 v[28:31], a[220:223], v[188:191], v[28:31]
v_exp_f32 v50, v50
v_smfmac_f32_16x16x64_bf16 v[84:87], v[232:235], v[104:111], v88
s_waitcnt lgkmcnt(0)
v_cvt_pk_bf16_f32 v120, v48, v49
v_mfma_f32_16x16x32_bf16 a[0:3], a[224:227], v[96:99], a[0:3]
v_exp_f32 v51, v51
v_mfma_f32_16x16x32_bf16 a[4:7], a[224:227], v[100:103], a[4:7]
v_exp_f32 v52, v52
v_mfma_f32_16x16x32_bf16 a[8:11], a[224:227], v[104:107], a[8:11]
ds_read_b128 a[192:195], v216 offset:16384
v_cvt_pk_bf16_f32 v121, v50, v51
v_mfma_f32_16x16x32_bf16 a[12:15], a[224:227], v[108:111], a[12:15]
v_exp_f32 v53, v53
v_mfma_f32_16x16x32_bf16 a[16:19], a[228:231], v[96:99], a[16:19]
ds_read_b128 a[196:199], v217 offset:16384
ds_read_b128 a[200:203], v218 offset:16384
v_mfma_f32_16x16x32_bf16 a[20:23], a[228:231], v[100:103], a[20:23]
v_exp_f32 v54, v54
v_mfma_f32_16x16x32_bf16 a[24:27], a[228:231], v[104:107], a[24:27]
ds_read_b128 a[204:207], v219 offset:16384
v_cvt_pk_bf16_f32 v122, v52, v53
v_mfma_f32_16x16x32_bf16 a[28:31], a[228:231], v[108:111], a[28:31]
v_exp_f32 v55, v55
v_mfma_f32_16x16x32_bf16 a[32:35], a[232:235], v[96:99], a[32:35]
buffer_load_dwordx4 v231, s[8:11], s24 offen offset:3072  lds
v_mfma_f32_16x16x32_bf16 a[36:39], a[232:235], v[100:103], a[36:39]
s_add_u32 s24, s24, 8192
v_exp_f32 v56, v56
v_mfma_f32_16x16x32_bf16 a[40:43], a[232:235], v[104:107], a[40:43]
ds_read_b128 a[208:211], v216 offset:24576
v_cvt_pk_bf16_f32 v123, v54, v55
v_mfma_f32_16x16x32_bf16 a[44:47], a[232:235], v[108:111], a[44:47]
v_exp_f32 v57, v57
v_mfma_f32_16x16x32_bf16 a[48:51], a[236:239], v[96:99], a[48:51]
ds_read_b128 a[212:215], v217 offset:24576
ds_read_b128 a[216:219], v218 offset:24576
v_mfma_f32_16x16x32_bf16 a[52:55], a[236:239], v[100:103], a[52:55]
v_exp_f32 v58, v58
v_mfma_f32_16x16x32_bf16 a[56:59], a[236:239], v[104:107], a[56:59]
ds_read_b128 a[220:223], v219 offset:24576
v_cvt_pk_bf16_f32 v124, v56, v57
v_mfma_f32_16x16x32_bf16 a[60:63], a[236:239], v[108:111], a[60:63]
v_exp_f32 v59, v59
v_mfma_f32_16x16x32_bf16 a[64:67], a[240:243], v[96:99], a[64:67]
v_mfma_f32_16x16x32_bf16 a[68:71], a[240:243], v[100:103], a[68:71]
v_exp_f32 v60, v60
v_mfma_f32_16x16x32_bf16 a[72:75], a[240:243], v[104:107], a[72:75]
v_cvt_pk_bf16_f32 v125, v58, v59
v_mfma_f32_16x16x32_bf16 a[76:79], a[240:243], v[108:111], a[76:79]
v_exp_f32 v61, v61
v_mfma_f32_16x16x32_bf16 a[80:83], a[244:247], v[96:99], a[80:83]
s_lshl1_add_u32 m0, s26, 16384
v_mfma_f32_16x16x32_bf16 a[84:87], a[244:247], v[100:103], a[84:87]
s_waitcnt vmcnt(10) lgkmcnt(0)
s_barrier
v_mfma_f32_16x16x32_bf16 a[88:91], a[244:247], v[104:107], a[88:91]
buffer_load_dwordx4 v228, s[12:15], s24 offen  lds
v_mfma_f32_16x16x32_bf16 a[92:95], a[244:247], v[108:111], a[92:95]
v_mfma_f32_16x16x32_bf16 a[96:99], a[248:251], v[96:99], a[96:99]
v_exp_f32 v62, v62
v_mfma_f32_16x16x32_bf16 a[100:103], a[248:251], v[100:103], a[100:103]
v_cvt_pk_bf16_f32 v126, v60, v61
v_mfma_f32_16x16x32_bf16 a[104:107], a[248:251], v[104:107], a[104:107]
v_exp_f32 v63, v63
v_mfma_f32_16x16x32_bf16 a[108:111], a[248:251], v[108:111], a[108:111]
v_mfma_f32_16x16x32_bf16 a[112:115], a[252:255], v[96:99], a[112:115]
v_exp_f32 v0, v0
v_mfma_f32_16x16x32_bf16 a[116:119], a[252:255], v[100:103], a[116:119]
v_cvt_pk_bf16_f32 v127, v62, v63
v_mfma_f32_16x16x32_bf16 a[120:123], a[252:255], v[104:107], a[120:123]
v_exp_f32 v1, v1
v_mfma_f32_16x16x32_bf16 a[124:127], a[252:255], v[108:111], a[124:127]
v_mfma_f32_16x16x32_bf16 v[32:35], a[192:195], v[128:131], v[64:67]
v_exp_f32 v2, v2
v_mfma_f32_16x16x32_bf16 v[32:35], a[196:199], v[132:135], v[32:35]
ds_read_b64_tr_b16 a[224:225], v220 offset:32768
v_cvt_pk_bf16_f32 v96, v0, v1
v_mfma_f32_16x16x32_bf16 v[32:35], a[200:203], v[136:139], v[32:35]
s_sub_u32 s4, 3, s28
v_exp_f32 v3, v3
v_mfma_f32_16x16x32_bf16 v[32:35], a[204:207], v[140:143], v[32:35]
ds_read_b64_tr_b16 a[226:227], v220 offset:40960
ds_read_b64_tr_b16 a[228:229], v221 offset:32768
v_mfma_f32_16x16x32_bf16 v[36:39], a[208:211], v[128:131], v[64:67]
s_and_b32 s4, s4, 3
v_exp_f32 v4, v4
v_mfma_f32_16x16x32_bf16 v[36:39], a[212:215], v[132:135], v[36:39]
ds_read_b64_tr_b16 a[230:231], v221 offset:40960
v_cvt_pk_bf16_f32 v97, v2, v3
v_mfma_f32_16x16x32_bf16 v[36:39], a[216:219], v[136:139], v[36:39]
s_lshl_b32 s4, s4, 10
v_exp_f32 v5, v5
v_mfma_f32_16x16x32_bf16 v[36:39], a[220:223], v[140:143], v[36:39]
buffer_load_dwordx4 v229, s[12:15], s24 offen offset:1024  lds
v_mfma_f32_16x16x32_bf16 v[40:43], a[192:195], v[144:147], v[68:71]
s_add_u32 s4, s4, s33
v_exp_f32 v6, v6
v_mfma_f32_16x16x32_bf16 v[40:43], a[196:199], v[148:151], v[40:43]
ds_read_b64_tr_b16 a[232:233], v222 offset:32768
v_cvt_pk_bf16_f32 v98, v4, v5
v_mfma_f32_16x16x32_bf16 v[40:43], a[200:203], v[152:155], v[40:43]
s_sub_u32 s5, 4, s28
v_exp_f32 v7, v7
v_mfma_f32_16x16x32_bf16 v[40:43], a[204:207], v[156:159], v[40:43]
ds_read_b64_tr_b16 a[234:235], v222 offset:40960
ds_read_b64_tr_b16 a[236:237], v223 offset:32768
v_mfma_f32_16x16x32_bf16 v[44:47], a[208:211], v[144:147], v[68:71]
Lpad19:
s_cbranch_execz Lwalk1
s_and_b32 s5, s5, 3
v_exp_f32 v8, v8
v_mfma_f32_16x16x32_bf16 v[44:47], a[212:215], v[148:151], v[44:47]
ds_read_b64_tr_b16 a[238:239], v223 offset:40960
v_cvt_pk_bf16_f32 v99, v6, v7
v_mfma_f32_16x16x32_bf16 v[44:47], a[216:219], v[152:155], v[44:47]
s_lshl_b32 s5, s5, 10
v_exp_f32 v9, v9
v_mfma_f32_16x16x32_bf16 v[44:47], a[220:223], v[156:159], v[44:47]
ds_read_b64_tr_b16 a[240:241], v224 offset:32768
ds_read_b64_tr_b16 a[242:243], v224 offset:40960
v_mfma_f32_16x16x32_bf16 v[48:51], a[192:195], v[160:163], v[72:75]
s_add_u32 s5, s5, s33
v_exp_f32 v10, v10
v_mfma_f32_16x16x32_bf16 v[48:51], a[196:199], v[164:167], v[48:51]
ds_read_b64_tr_b16 a[244:245], v225 offset:32768
v_cvt_pk_bf16_f32 v100, v8, v9
v_mfma_f32_16x16x32_bf16 v[48:51], a[200:203], v[168:171], v[48:51]
s_sub_u32 s6, 5, s28
v_exp_f32 v11, v11
v_mfma_f32_16x16x32_bf16 v[48:51], a[204:207], v[172:175], v[48:51]
ds_read_b64_tr_b16 a[246:247], v225 offset:40960
ds_read_b64_tr_b16 a[248:249], v226 offset:32768
v_mfma_f32_16x16x32_bf16 v[52:55], a[208:211], v[160:163], v[72:75]
s_and_b32 s6, s6, 3
v_exp_f32 v12, v12
v_mfma_f32_16x16x32_bf16 v[52:55], a[212:215], v[164:167], v[52:55]
ds_read_b64_tr_b16 a[250:251], v226 offset:40960
v_cvt_pk_bf16_f32 v101, v10, v11
v_mfma_f32_16x16x32_bf16 v[52:55], a[216:219], v[168:171], v[52:55]
s_lshl_b32 s6, s6, 10
v_exp_f32 v13, v13
v_mfma_f32_16x16x32_bf16 v[52:55], a[220:223], v[172:175], v[52:55]
buffer_load_dwordx4 v230, s[8:11], s24 offen offset:2048  lds
v_mfma_f32_16x16x32_bf16 v[56:59], a[192:195], v[176:179], v[76:79]
s_add_u32 s6, s6, s33
v_exp_f32 v14, v14
v_mfma_f32_16x16x32_bf16 v[56:59], a[196:199], v[180:183], v[56:59]
ds_read_b64_tr_b16 a[252:253], v227 offset:32768
v_cvt_pk_bf16_f32 v102, v12, v13
v_mfma_f32_16x16x32_bf16 v[56:59], a[200:203], v[184:187], v[56:59]
s_sub_u32 s7, 6, s28
v_exp_f32 v15, v15
v_mfma_f32_16x16x32_bf16 v[56:59], a[204:207], v[188:191], v[56:59]
ds_read_b64_tr_b16 a[254:255], v227 offset:40960
v_mfma_f32_16x16x32_bf16 v[60:63], a[208:211], v[176:179], v[76:79]
s_and_b32 s7, s7, 3
v_exp_f32 v16, v16
v_smfmac_f32_16x16x64_bf16 v[80:83], v[232:235], v[112:119], v88
v_cvt_pk_bf16_f32 v103, v14, v15
v_mfma_f32_16x16x32_bf16 v[60:63], a[212:215], v[180:183], v[60:63]
s_lshl_b32 s7, s7, 10
v_exp_f32 v17, v17
v_mfma_f32_16x16x32_bf16 v[60:63], a[216:219], v[184:187], v[60:63]
s_mov_b32 exec_lo, 0xffff
s_mov_b32 exec_hi, 0x0
buffer_load_dword v215, v196, s[16:19], s46 offen offset:2048 sc1
s_mov_b64 exec, -1
v_mfma_f32_16x16x32_bf16 v[60:63], a[220:223], v[188:191], v[60:63]
s_add_u32 s7, s7, s33
v_exp_f32 v18, v18
v_smfmac_f32_16x16x64_bf16 v[84:87], v[232:235], v[120:127], v88
s_waitcnt lgkmcnt(0)
v_cvt_pk_bf16_f32 v104, v16, v17
v_mfma_f32_16x16x32_bf16 a[0:3], a[224:227], v[112:115], a[0:3]
v_exp_f32 v19, v19
v_mfma_f32_16x16x32_bf16 a[4:7], a[224:227], v[116:119], a[4:7]
v_exp_f32 v20, v20
v_mfma_f32_16x16x32_bf16 a[8:11], a[224:227], v[120:123], a[8:11]
ds_read_b128 a[192:195], v216 offset:32768
v_cvt_pk_bf16_f32 v105, v18, v19
v_mfma_f32_16x16x32_bf16 a[12:15], a[224:227], v[124:127], a[12:15]
v_exp_f32 v21, v21
v_mfma_f32_16x16x32_bf16 a[16:19], a[228:231], v[112:115], a[16:19]
ds_read_b128 a[196:199], v217 offset:32768
ds_read_b128 a[200:203], v218 offset:32768
v_mfma_f32_16x16x32_bf16 a[20:23], a[228:231], v[116:119], a[20:23]
v_exp_f32 v22, v22
v_mfma_f32_16x16x32_bf16 a[24:27], a[228:231], v[120:123], a[24:27]
ds_read_b128 a[204:207], v219 offset:32768
v_cvt_pk_bf16_f32 v106, v20, v21
v_mfma_f32_16x16x32_bf16 a[28:31], a[228:231], v[124:127], a[28:31]
v_exp_f32 v23, v23
v_mfma_f32_16x16x32_bf16 a[32:35], a[232:235], v[112:115], a[32:35]
buffer_load_dwordx4 v231, s[8:11], s24 offen offset:3072  lds
v_mfma_f32_16x16x32_bf16 a[36:39], a[232:235], v[116:119], a[36:39]
s_add_u32 s24, s24, 8192
v_exp_f32 v24, v24
v_mfma_f32_16x16x32_bf16 a[40:43], a[232:235], v[120:123], a[40:43]
ds_read_b128 a[208:211], v216 offset:40960
v_cvt_pk_bf16_f32 v107, v22, v23
v_mfma_f32_16x16x32_bf16 a[44:47], a[232:235], v[124:127], a[44:47]
v_exp_f32 v25, v25
v_mfma_f32_16x16x32_bf16 a[48:51], a[236:239], v[112:115], a[48:51]
ds_read_b128 a[212:215], v217 offset:40960
ds_read_b128 a[216:219], v218 offset:40960
v_mfma_f32_16x16x32_bf16 a[52:55], a[236:239], v[116:119], a[52:55]
v_exp_f32 v26, v26
v_mfma_f32_16x16x32_bf16 a[56:59], a[236:239], v[120:123], a[56:59]
ds_read_b128 a[220:223], v219 offset:40960
v_cvt_pk_bf16_f32 v108, v24, v25
v_mfma_f32_16x16x32_bf16 a[60:63], a[236:239], v[124:127], a[60:63]
v_exp_f32 v27, v27
v_mfma_f32_16x16x32_bf16 a[64:67], a[240:243], v[112:115], a[64:67]
v_mfma_f32_16x16x32_bf16 a[68:71], a[240:243], v[116:119], a[68:71]
v_exp_f32 v28, v28
v_mfma_f32_16x16x32_bf16 a[72:75], a[240:243], v[120:123], a[72:75]
v_cvt_pk_bf16_f32 v109, v26, v27
v_mfma_f32_16x16x32_bf16 a[76:79], a[240:243], v[124:127], a[76:79]
v_exp_f32 v29, v29
v_mfma_f32_16x16x32_bf16 a[80:83], a[244:247], v[112:115], a[80:83]
s_lshl1_add_u32 m0, s26, 32768
v_mfma_f32_16x16x32_bf16 a[84:87], a[244:247], v[116:119], a[84:87]
s_waitcnt vmcnt(10) lgkmcnt(0)
s_barrier
v_mfma_f32_16x16x32_bf16 a[88:91], a[244:247], v[120:123], a[88:91]
buffer_load_dwordx4 v228, s[12:15], s24 offen  lds
v_mfma_f32_16x16x32_bf16 a[92:95], a[244:247], v[124:127], a[92:95]
v_mfma_f32_16x16x32_bf16 a[96:99], a[248:251], v[112:115], a[96:99]
v_exp_f32 v30, v30
v_mfma_f32_16x16x32_bf16 a[100:103], a[248:251], v[116:119], a[100:103]
v_cvt_pk_bf16_f32 v110, v28, v29
v_mfma_f32_16x16x32_bf16 a[104:107], a[248:251], v[120:123], a[104:107]
v_exp_f32 v31, v31
v_mfma_f32_16x16x32_bf16 a[108:111], a[248:251], v[124:127], a[108:111]
v_mfma_f32_16x16x32_bf16 a[112:115], a[252:255], v[112:115], a[112:115]
v_exp_f32 v32, v32
v_mfma_f32_16x16x32_bf16 a[116:119], a[252:255], v[116:119], a[116:119]
v_cvt_pk_bf16_f32 v111, v30, v31
v_mfma_f32_16x16x32_bf16 a[120:123], a[252:255], v[120:123], a[120:123]
v_exp_f32 v33, v33
v_mfma_f32_16x16x32_bf16 a[124:127], a[252:255], v[124:127], a[124:127]
v_mfma_f32_16x16x32_bf16 v[0:3], a[192:195], v[128:131], v[64:67]
v_exp_f32 v34, v34
v_mfma_f32_16x16x32_bf16 v[0:3], a[196:199], v[132:135], v[0:3]
ds_read_b64_tr_b16 a[224:225], v220 offset:49152
v_cvt_pk_bf16_f32 v112, v32, v33
v_mfma_f32_16x16x32_bf16 v[0:3], a[200:203], v[136:139], v[0:3]
v_exp_f32 v35, v35
v_mfma_f32_16x16x32_bf16 v[0:3], a[204:207], v[140:143], v[0:3]
ds_read_b64_tr_b16 a[226:227], v220 offset:57344
ds_read_b64_tr_b16 a[228:229], v221 offset:49152
v_mfma_f32_16x16x32_bf16 v[4:7], a[208:211], v[128:131], v[64:67]
v_exp_f32 v36, v36
v_mfma_f32_16x16x32_bf16 v[4:7], a[212:215], v[132:135], v[4:7]
ds_read_b64_tr_b16 a[230:231], v221 offset:57344
v_cvt_pk_bf16_f32 v113, v34, v35
v_mfma_f32_16x16x32_bf16 v[4:7], a[216:219], v[136:139], v[4:7]
v_exp_f32 v37, v37
v_mfma_f32_16x16x32_bf16 v[4:7], a[220:223], v[140:143], v[4:7]
buffer_load_dwordx4 v229, s[12:15], s24 offen offset:1024  lds
v_mfma_f32_16x16x32_bf16 v[8:11], a[192:195], v[144:147], v[68:71]
v_exp_f32 v38, v38
v_mfma_f32_16x16x32_bf16 v[8:11], a[196:199], v[148:151], v[8:11]
ds_read_b64_tr_b16 a[232:233], v222 offset:49152
v_cvt_pk_bf16_f32 v114, v36, v37
v_mfma_f32_16x16x32_bf16 v[8:11], a[200:203], v[152:155], v[8:11]
v_exp_f32 v39, v39
v_mfma_f32_16x16x32_bf16 v[8:11], a[204:207], v[156:159], v[8:11]
ds_read_b64_tr_b16 a[234:235], v222 offset:57344
ds_read_b64_tr_b16 a[236:237], v223 offset:49152
v_mfma_f32_16x16x32_bf16 v[12:15], a[208:211], v[144:147], v[68:71]
v_exp_f32 v40, v40
v_mfma_f32_16x16x32_bf16 v[12:15], a[212:215], v[148:151], v[12:15]
ds_read_b64_tr_b16 a[238:239], v223 offset:57344
v_cvt_pk_bf16_f32 v115, v38, v39
v_mfma_f32_16x16x32_bf16 v[12:15], a[216:219], v[152:155], v[12:15]
v_exp_f32 v41, v41
v_mfma_f32_16x16x32_bf16 v[12:15], a[220:223], v[156:159], v[12:15]
ds_read_b64_tr_b16 a[240:241], v224 offset:49152
ds_read_b64_tr_b16 a[242:243], v224 offset:57344
v_mfma_f32_16x16x32_bf16 v[16:19], a[192:195], v[160:163], v[72:75]
v_exp_f32 v42, v42
v_mfma_f32_16x16x32_bf16 v[16:19], a[196:199], v[164:167], v[16:19]
ds_read_b64_tr_b16 a[244:245], v225 offset:49152
v_cvt_pk_bf16_f32 v116, v40, v41
v_mfma_f32_16x16x32_bf16 v[16:19], a[200:203], v[168:171], v[16:19]
v_exp_f32 v43, v43
v_mfma_f32_16x16x32_bf16 v[16:19], a[204:207], v[172:175], v[16:19]
ds_read_b64_tr_b16 a[246:247], v225 offset:57344
ds_read_b64_tr_b16 a[248:249], v226 offset:49152
v_mfma_f32_16x16x32_bf16 v[20:23], a[208:211], v[160:163], v[72:75]
v_exp_f32 v44, v44
v_mfma_f32_16x16x32_bf16 v[20:23], a[212:215], v[164:167], v[20:23]
ds_read_b64_tr_b16 a[250:251], v226 offset:57344
v_cvt_pk_bf16_f32 v117, v42, v43
v_mfma_f32_16x16x32_bf16 v[20:23], a[216:219], v[168:171], v[20:23]
v_exp_f32 v45, v45
v_mfma_f32_16x16x32_bf16 v[20:23], a[220:223], v[172:175], v[20:23]
buffer_load_dwordx4 v230, s[8:11], s24 offen offset:2048  lds
v_mfma_f32_16x16x32_bf16 v[24:27], a[192:195], v[176:179], v[76:79]
v_exp_f32 v46, v46
v_mfma_f32_16x16x32_bf16 v[24:27], a[196:199], v[180:183], v[24:27]
ds_read_b64_tr_b16 a[252:253], v227 offset:49152
v_cvt_pk_bf16_f32 v118, v44, v45
v_mfma_f32_16x16x32_bf16 v[24:27], a[200:203], v[184:187], v[24:27]
v_exp_f32 v47, v47
v_mfma_f32_16x16x32_bf16 v[24:27], a[204:207], v[188:191], v[24:27]
ds_read_b64_tr_b16 a[254:255], v227 offset:57344
v_mfma_f32_16x16x32_bf16 v[28:31], a[208:211], v[176:179], v[76:79]
v_exp_f32 v48, v48
v_smfmac_f32_16x16x64_bf16 v[80:83], v[232:235], v[96:103], v88
v_cvt_pk_bf16_f32 v119, v46, v47
v_mfma_f32_16x16x32_bf16 v[28:31], a[212:215], v[180:183], v[28:31]
v_exp_f32 v49, v49
v_mfma_f32_16x16x32_bf16 v[28:31], a[216:219], v[184:187], v[28:31]
s_mov_b32 exec_lo, 0xffff
s_mov_b32 exec_hi, 0x0
buffer_load_dword v215, v196, s[16:19], s47 offen offset:0 sc1
s_mov_b64 exec, -1
v_mfma_f32_16x16x32_bf16 v[28:31], a[220:223], v[188:191], v[28:31]
v_exp_f32 v50, v50
v_smfmac_f32_16x16x64_bf16 v[84:87], v[232:235], v[104:111], v88
s_waitcnt lgkmcnt(0)
v_cvt_pk_bf16_f32 v120, v48, v49
v_mfma_f32_16x16x32_bf16 a[0:3], a[224:227], v[96:99], a[0:3]
v_exp_f32 v51, v51
v_mfma_f32_16x16x32_bf16 a[4:7], a[224:227], v[100:103], a[4:7]
v_exp_f32 v52, v52
v_mfma_f32_16x16x32_bf16 a[8:11], a[224:227], v[104:107], a[8:11]
ds_read_b128 a[192:195], v216 offset:49152
v_cvt_pk_bf16_f32 v121, v50, v51
v_mfma_f32_16x16x32_bf16 a[12:15], a[224:227], v[108:111], a[12:15]
v_exp_f32 v53, v53
v_mfma_f32_16x16x32_bf16 a[16:19], a[228:231], v[96:99], a[16:19]
ds_read_b128 a[196:199], v217 offset:49152
ds_read_b128 a[200:203], v218 offset:49152
v_mfma_f32_16x16x32_bf16 a[20:23], a[228:231], v[100:103], a[20:23]
v_exp_f32 v54, v54
v_mfma_f32_16x16x32_bf16 a[24:27], a[228:231], v[104:107], a[24:27]
ds_read_b128 a[204:207], v219 offset:49152
v_cvt_pk_bf16_f32 v122, v52, v53
v_mfma_f32_16x16x32_bf16 a[28:31], a[228:231], v[108:111], a[28:31]
v_exp_f32 v55, v55
v_mfma_f32_16x16x32_bf16 a[32:35], a[232:235], v[96:99], a[32:35]
buffer_load_dwordx4 v231, s[8:11], s24 offen offset:3072  lds
v_mfma_f32_16x16x32_bf16 a[36:39], a[232:235], v[100:103], a[36:39]
s_add_u32 s24, s24, 8192
v_exp_f32 v56, v56
v_mfma_f32_16x16x32_bf16 a[40:43], a[232:235], v[104:107], a[40:43]
ds_read_b128 a[208:211], v216 offset:57344
v_cvt_pk_bf16_f32 v123, v54, v55
v_mfma_f32_16x16x32_bf16 a[44:47], a[232:235], v[108:111], a[44:47]
v_exp_f32 v57, v57
v_mfma_f32_16x16x32_bf16 a[48:51], a[236:239], v[96:99], a[48:51]
ds_read_b128 a[212:215], v217 offset:57344
ds_read_b128 a[216:219], v218 offset:57344
v_mfma_f32_16x16x32_bf16 a[52:55], a[236:239], v[100:103], a[52:55]
v_exp_f32 v58, v58
v_mfma_f32_16x16x32_bf16 a[56:59], a[236:239], v[104:107], a[56:59]
ds_read_b128 a[220:223], v219 offset:57344
v_cvt_pk_bf16_f32 v124, v56, v57
v_mfma_f32_16x16x32_bf16 a[60:63], a[236:239], v[108:111], a[60:63]
v_exp_f32 v59, v59
v_mfma_f32_16x16x32_bf16 a[64:67], a[240:243], v[96:99], a[64:67]
v_mfma_f32_16x16x32_bf16 a[68:71], a[240:243], v[100:103], a[68:71]
v_exp_f32 v60, v60
v_mfma_f32_16x16x32_bf16 a[72:75], a[240:243], v[104:107], a[72:75]
v_cvt_pk_bf16_f32 v125, v58, v59
v_mfma_f32_16x16x32_bf16 a[76:79], a[240:243], v[108:111], a[76:79]
v_exp_f32 v61, v61
v_mfma_f32_16x16x32_bf16 a[80:83], a[244:247], v[96:99], a[80:83]
s_lshl1_add_u32 m0, s26, 49152
v_mfma_f32_16x16x32_bf16 a[84:87], a[244:247], v[100:103], a[84:87]
s_waitcnt vmcnt(10) lgkmcnt(0)
s_barrier
v_mfma_f32_16x16x32_bf16 a[88:91], a[244:247], v[104:107], a[88:91]
buffer_load_dwordx4 v228, s[12:15], s24 offen  lds
v_mfma_f32_16x16x32_bf16 a[92:95], a[244:247], v[108:111], a[92:95]
v_mfma_f32_16x16x32_bf16 a[96:99], a[248:251], v[96:99], a[96:99]
v_exp_f32 v62, v62
v_mfma_f32_16x16x32_bf16 a[100:103], a[248:251], v[100:103], a[100:103]
v_cvt_pk_bf16_f32 v126, v60, v61
v_mfma_f32_16x16x32_bf16 a[104:107], a[248:251], v[104:107], a[104:107]
v_exp_f32 v63, v63
v_mfma_f32_16x16x32_bf16 a[108:111], a[248:251], v[108:111], a[108:111]
v_mfma_f32_16x16x32_bf16 a[112:115], a[252:255], v[96:99], a[112:115]
v_exp_f32 v0, v0
v_mfma_f32_16x16x32_bf16 a[116:119], a[252:255], v[100:103], a[116:119]
v_cvt_pk_bf16_f32 v127, v62, v63
v_mfma_f32_16x16x32_bf16 a[120:123], a[252:255], v[104:107], a[120:123]
v_exp_f32 v1, v1
v_mfma_f32_16x16x32_bf16 a[124:127], a[252:255], v[108:111], a[124:127]
v_mfma_f32_16x16x32_bf16 v[32:35], a[192:195], v[128:131], v[64:67]
v_exp_f32 v2, v2
v_mfma_f32_16x16x32_bf16 v[32:35], a[196:199], v[132:135], v[32:35]
ds_read_b64_tr_b16 a[224:225], v220 offset:0
v_cvt_pk_bf16_f32 v96, v0, v1
v_mfma_f32_16x16x32_bf16 v[32:35], a[200:203], v[136:139], v[32:35]
v_exp_f32 v3, v3
v_mfma_f32_16x16x32_bf16 v[32:35], a[204:207], v[140:143], v[32:35]
ds_read_b64_tr_b16 a[226:227], v220 offset:8192
ds_read_b64_tr_b16 a[228:229], v221 offset:0
v_mfma_f32_16x16x32_bf16 v[36:39], a[208:211], v[128:131], v[64:67]
v_exp_f32 v4, v4
v_mfma_f32_16x16x32_bf16 v[36:39], a[212:215], v[132:135], v[36:39]
ds_read_b64_tr_b16 a[230:231], v221 offset:8192
v_cvt_pk_bf16_f32 v97, v2, v3
v_mfma_f32_16x16x32_bf16 v[36:39], a[216:219], v[136:139], v[36:39]
v_exp_f32 v5, v5
v_mfma_f32_16x16x32_bf16 v[36:39], a[220:223], v[140:143], v[36:39]
buffer_load_dwordx4 v229, s[12:15], s24 offen offset:1024  lds
v_mfma_f32_16x16x32_bf16 v[40:43], a[192:195], v[144:147], v[68:71]
v_exp_f32 v6, v6
v_mfma_f32_16x16x32_bf16 v[40:43], a[196:199], v[148:151], v[40:43]
ds_read_b64_tr_b16 a[232:233], v222 offset:0
v_cvt_pk_bf16_f32 v98, v4, v5
v_mfma_f32_16x16x32_bf16 v[40:43], a[200:203], v[152:155], v[40:43]
v_exp_f32 v7, v7
v_mfma_f32_16x16x32_bf16 v[40:43], a[204:207], v[156:159], v[40:43]
ds_read_b64_tr_b16 a[234:235], v222 offset:8192
ds_read_b64_tr_b16 a[236:237], v223 offset:0
v_mfma_f32_16x16x32_bf16 v[44:47], a[208:211], v[144:147], v[68:71]
v_exp_f32 v8, v8
v_mfma_f32_16x16x32_bf16 v[44:47], a[212:215], v[148:151], v[44:47]
ds_read_b64_tr_b16 a[238:239], v223 offset:8192
v_cvt_pk_bf16_f32 v99, v6, v7
v_mfma_f32_16x16x32_bf16 v[44:47], a[216:219], v[152:155], v[44:47]
v_exp_f32 v9, v9
v_mfma_f32_16x16x32_bf16 v[44:47], a[220:223], v[156:159], v[44:47]
ds_read_b64_tr_b16 a[240:241], v224 offset:0
ds_read_b64_tr_b16 a[242:243], v224 offset:8192
v_mfma_f32_16x16x32_bf16 v[48:51], a[192:195], v[160:163], v[72:75]
v_exp_f32 v10, v10
v_mfma_f32_16x16x32_bf16 v[48:51], a[196:199], v[164:167], v[48:51]
ds_read_b64_tr_b16 a[244:245], v225 offset:0
v_cvt_pk_bf16_f32 v100, v8, v9
v_mfma_f32_16x16x32_bf16 v[48:51], a[200:203], v[168:171], v[48:51]
v_exp_f32 v11, v11
v_mfma_f32_16x16x32_bf16 v[48:51], a[204:207], v[172:175], v[48:51]
ds_read_b64_tr_b16 a[246:247], v225 offset:8192
ds_read_b64_tr_b16 a[248:249], v226 offset:0
v_mfma_f32_16x16x32_bf16 v[52:55], a[208:211], v[160:163], v[72:75]
v_exp_f32 v12, v12
v_mfma_f32_16x16x32_bf16 v[52:55], a[212:215], v[164:167], v[52:55]
ds_read_b64_tr_b16 a[250:251], v226 offset:8192
v_cvt_pk_bf16_f32 v101, v10, v11
v_mfma_f32_16x16x32_bf16 v[52:55], a[216:219], v[168:171], v[52:55]
v_exp_f32 v13, v13
v_mfma_f32_16x16x32_bf16 v[52:55], a[220:223], v[172:175], v[52:55]
buffer_load_dwordx4 v230, s[8:11], s24 offen offset:2048  lds
v_mfma_f32_16x16x32_bf16 v[56:59], a[192:195], v[176:179], v[76:79]
v_exp_f32 v14, v14
v_mfma_f32_16x16x32_bf16 v[56:59], a[196:199], v[180:183], v[56:59]
ds_read_b64_tr_b16 a[252:253], v227 offset:0
v_cvt_pk_bf16_f32 v102, v12, v13
v_mfma_f32_16x16x32_bf16 v[56:59], a[200:203], v[184:187], v[56:59]
v_exp_f32 v15, v15
v_mfma_f32_16x16x32_bf16 v[56:59], a[204:207], v[188:191], v[56:59]
ds_read_b64_tr_b16 a[254:255], v227 offset:8192
v_mfma_f32_16x16x32_bf16 v[60:63], a[208:211], v[176:179], v[76:79]
v_exp_f32 v16, v16
v_smfmac_f32_16x16x64_bf16 v[80:83], v[232:235], v[112:119], v88
v_cvt_pk_bf16_f32 v103, v14, v15
v_mfma_f32_16x16x32_bf16 v[60:63], a[212:215], v[180:183], v[60:63]
v_exp_f32 v17, v17
v_mfma_f32_16x16x32_bf16 v[60:63], a[216:219], v[184:187], v[60:63]
s_mov_b32 exec_lo, 0xffff
s_mov_b32 exec_hi, 0x0
buffer_load_dword v215, v196, s[16:19], s47 offen offset:2048 sc1
s_mov_b64 exec, -1
v_mfma_f32_16x16x32_bf16 v[60:63], a[220:223], v[188:191], v[60:63]
v_exp_f32 v18, v18
v_smfmac_f32_16x16x64_bf16 v[84:87], v[232:235], v[120:127], v88
s_waitcnt lgkmcnt(0)
v_cvt_pk_bf16_f32 v104, v16, v17
v_mfma_f32_16x16x32_bf16 a[0:3], a[224:227], v[112:115], a[0:3]
v_exp_f32 v19, v19
v_mfma_f32_16x16x32_bf16 a[4:7], a[224:227], v[116:119], a[4:7]
v_exp_f32 v20, v20
v_mfma_f32_16x16x32_bf16 a[8:11], a[224:227], v[120:123], a[8:11]
ds_read_b128 a[192:195], v216 offset:0
v_cvt_pk_bf16_f32 v105, v18, v19
v_mfma_f32_16x16x32_bf16 a[12:15], a[224:227], v[124:127], a[12:15]
v_exp_f32 v21, v21
v_mfma_f32_16x16x32_bf16 a[16:19], a[228:231], v[112:115], a[16:19]
ds_read_b128 a[196:199], v217 offset:0
ds_read_b128 a[200:203], v218 offset:0
v_mfma_f32_16x16x32_bf16 a[20:23], a[228:231], v[116:119], a[20:23]
v_exp_f32 v22, v22
v_mfma_f32_16x16x32_bf16 a[24:27], a[228:231], v[120:123], a[24:27]
ds_read_b128 a[204:207], v219 offset:0
v_cvt_pk_bf16_f32 v106, v20, v21
v_mfma_f32_16x16x32_bf16 a[28:31], a[228:231], v[124:127], a[28:31]
v_exp_f32 v23, v23
v_mfma_f32_16x16x32_bf16 a[32:35], a[232:235], v[112:115], a[32:35]
buffer_load_dwordx4 v231, s[8:11], s24 offen offset:3072  lds
v_mfma_f32_16x16x32_bf16 a[36:39], a[232:235], v[116:119], a[36:39]
s_add_u32 s24, s24, 8192
v_exp_f32 v24, v24
v_mfma_f32_16x16x32_bf16 a[40:43], a[232:235], v[120:123], a[40:43]
ds_read_b128 a[208:211], v216 offset:8192
v_cvt_pk_bf16_f32 v107, v22, v23
v_mfma_f32_16x16x32_bf16 a[44:47], a[232:235], v[124:127], a[44:47]
v_exp_f32 v25, v25
v_mfma_f32_16x16x32_bf16 a[48:51], a[236:239], v[112:115], a[48:51]
ds_read_b128 a[212:215], v217 offset:8192
ds_read_b128 a[216:219], v218 offset:8192
v_mfma_f32_16x16x32_bf16 a[52:55], a[236:239], v[116:119], a[52:55]
v_exp_f32 v26, v26
v_mfma_f32_16x16x32_bf16 a[56:59], a[236:239], v[120:123], a[56:59]
ds_read_b128 a[220:223], v219 offset:8192
v_cvt_pk_bf16_f32 v108, v24, v25
v_mfma_f32_16x16x32_bf16 a[60:63], a[236:239], v[124:127], a[60:63]
v_exp_f32 v27, v27
v_mfma_f32_16x16x32_bf16 a[64:67], a[240:243], v[112:115], a[64:67]
v_mfma_f32_16x16x32_bf16 a[68:71], a[240:243], v[116:119], a[68:71]
v_exp_f32 v28, v28
v_mfma_f32_16x16x32_bf16 a[72:75], a[240:243], v[120:123], a[72:75]
v_cvt_pk_bf16_f32 v109, v26, v27
v_mfma_f32_16x16x32_bf16 a[76:79], a[240:243], v[124:127], a[76:79]
v_exp_f32 v29, v29
v_mfma_f32_16x16x32_bf16 a[80:83], a[244:247], v[112:115], a[80:83]
s_lshl1_add_u32 m0, s26, 0
v_mfma_f32_16x16x32_bf16 a[84:87], a[244:247], v[116:119], a[84:87]
s_waitcnt vmcnt(10) lgkmcnt(0)
s_barrier
v_mfma_f32_16x16x32_bf16 a[88:91], a[244:247], v[120:123], a[88:91]
buffer_load_dwordx4 v228, s[12:15], s24 offen  lds
v_mfma_f32_16x16x32_bf16 a[92:95], a[244:247], v[124:127], a[92:95]
v_mfma_f32_16x16x32_bf16 a[96:99], a[248:251], v[112:115], a[96:99]
v_exp_f32 v30, v30
v_mfma_f32_16x16x32_bf16 a[100:103], a[248:251], v[116:119], a[100:103]
v_cvt_pk_bf16_f32 v110, v28, v29
v_mfma_f32_16x16x32_bf16 a[104:107], a[248:251], v[120:123], a[104:107]
v_exp_f32 v31, v31
v_mfma_f32_16x16x32_bf16 a[108:111], a[248:251], v[124:127], a[108:111]
v_mfma_f32_16x16x32_bf16 a[112:115], a[252:255], v[112:115], a[112:115]
v_exp_f32 v32, v32
v_mfma_f32_16x16x32_bf16 a[116:119], a[252:255], v[116:119], a[116:119]
v_cvt_pk_bf16_f32 v111, v30, v31
v_mfma_f32_16x16x32_bf16 a[120:123], a[252:255], v[120:123], a[120:123]
v_exp_f32 v33, v33
v_mfma_f32_16x16x32_bf16 a[124:127], a[252:255], v[124:127], a[124:127]
v_mfma_f32_16x16x32_bf16 v[0:3], a[192:195], v[128:131], v[64:67]
v_exp_f32 v34, v34
v_mfma_f32_16x16x32_bf16 v[0:3], a[196:199], v[132:135], v[0:3]
ds_read_b64_tr_b16 a[224:225], v220 offset:16384
v_cvt_pk_bf16_f32 v112, v32, v33
v_mfma_f32_16x16x32_bf16 v[0:3], a[200:203], v[136:139], v[0:3]
v_exp_f32 v35, v35
v_mfma_f32_16x16x32_bf16 v[0:3], a[204:207], v[140:143], v[0:3]
ds_read_b64_tr_b16 a[226:227], v220 offset:24576
ds_read_b64_tr_b16 a[228:229], v221 offset:16384
v_mfma_f32_16x16x32_bf16 v[4:7], a[208:211], v[128:131], v[64:67]
v_exp_f32 v36, v36
v_mfma_f32_16x16x32_bf16 v[4:7], a[212:215], v[132:135], v[4:7]
ds_read_b64_tr_b16 a[230:231], v221 offset:24576
v_cvt_pk_bf16_f32 v113, v34, v35
v_mfma_f32_16x16x32_bf16 v[4:7], a[216:219], v[136:139], v[4:7]
v_exp_f32 v37, v37
v_mfma_f32_16x16x32_bf16 v[4:7], a[220:223], v[140:143], v[4:7]
buffer_load_dwordx4 v229, s[12:15], s24 offen offset:1024  lds
v_mfma_f32_16x16x32_bf16 v[8:11], a[192:195], v[144:147], v[68:71]
v_exp_f32 v38, v38
v_mfma_f32_16x16x32_bf16 v[8:11], a[196:199], v[148:151], v[8:11]
ds_read_b64_tr_b16 a[232:233], v222 offset:16384
v_cvt_pk_bf16_f32 v114, v36, v37
v_mfma_f32_16x16x32_bf16 v[8:11], a[200:203], v[152:155], v[8:11]
v_exp_f32 v39, v39
v_mfma_f32_16x16x32_bf16 v[8:11], a[204:207], v[156:159], v[8:11]
ds_read_b64_tr_b16 a[234:235], v222 offset:24576
ds_read_b64_tr_b16 a[236:237], v223 offset:16384
v_mfma_f32_16x16x32_bf16 v[12:15], a[208:211], v[144:147], v[68:71]
v_exp_f32 v40, v40
v_mfma_f32_16x16x32_bf16 v[12:15], a[212:215], v[148:151], v[12:15]
ds_read_b64_tr_b16 a[238:239], v223 offset:24576
v_cvt_pk_bf16_f32 v115, v38, v39
v_mfma_f32_16x16x32_bf16 v[12:15], a[216:219], v[152:155], v[12:15]
v_exp_f32 v41, v41
v_mfma_f32_16x16x32_bf16 v[12:15], a[220:223], v[156:159], v[12:15]
ds_read_b64_tr_b16 a[240:241], v224 offset:16384
ds_read_b64_tr_b16 a[242:243], v224 offset:24576
v_mfma_f32_16x16x32_bf16 v[16:19], a[192:195], v[160:163], v[72:75]
v_exp_f32 v42, v42
v_mfma_f32_16x16x32_bf16 v[16:19], a[196:199], v[164:167], v[16:19]
ds_read_b64_tr_b16 a[244:245], v225 offset:16384
v_cvt_pk_bf16_f32 v116, v40, v41
v_mfma_f32_16x16x32_bf16 v[16:19], a[200:203], v[168:171], v[16:19]
v_exp_f32 v43, v43
v_mfma_f32_16x16x32_bf16 v[16:19], a[204:207], v[172:175], v[16:19]
ds_read_b64_tr_b16 a[246:247], v225 offset:24576
ds_read_b64_tr_b16 a[248:249], v226 offset:16384
v_mfma_f32_16x16x32_bf16 v[20:23], a[208:211], v[160:163], v[72:75]
v_exp_f32 v44, v44
v_mfma_f32_16x16x32_bf16 v[20:23], a[212:215], v[164:167], v[20:23]
ds_read_b64_tr_b16 a[250:251], v226 offset:24576
v_cvt_pk_bf16_f32 v117, v42, v43
v_mfma_f32_16x16x32_bf16 v[20:23], a[216:219], v[168:171], v[20:23]
s_add_u32 s36, s42, 0
v_exp_f32 v45, v45
v_mfma_f32_16x16x32_bf16 v[20:23], a[220:223], v[172:175], v[20:23]
buffer_load_dwordx4 v249, s[16:19], s36 offen offset:2048 sc1 lds
v_mfma_f32_16x16x32_bf16 v[24:27], a[192:195], v[176:179], v[76:79]
v_exp_f32 v46, v46
v_mfma_f32_16x16x32_bf16 v[24:27], a[196:199], v[180:183], v[24:27]
ds_read_b64_tr_b16 a[252:253], v227 offset:16384
v_cvt_pk_bf16_f32 v118, v44, v45
v_mfma_f32_16x16x32_bf16 v[24:27], a[200:203], v[184:187], v[24:27]
v_exp_f32 v47, v47
v_mfma_f32_16x16x32_bf16 v[24:27], a[204:207], v[188:191], v[24:27]
ds_read_b64_tr_b16 a[254:255], v227 offset:24576
v_mfma_f32_16x16x32_bf16 v[28:31], a[208:211], v[176:179], v[76:79]
v_exp_f32 v48, v48
v_smfmac_f32_16x16x64_bf16 v[80:83], v[232:235], v[96:103], v88
v_cvt_pk_bf16_f32 v119, v46, v47
v_mfma_f32_16x16x32_bf16 v[28:31], a[212:215], v[180:183], v[28:31]
v_exp_f32 v49, v49
v_mfma_f32_16x16x32_bf16 v[28:31], a[216:219], v[184:187], v[28:31]
v_mfma_f32_16x16x32_bf16 v[28:31], a[220:223], v[188:191], v[28:31]
v_exp_f32 v50, v50
v_smfmac_f32_16x16x64_bf16 v[84:87], v[232:235], v[104:111], v88
s_waitcnt lgkmcnt(0)
v_cvt_pk_bf16_f32 v120, v48, v49
v_mfma_f32_16x16x32_bf16 a[0:3], a[224:227], v[96:99], a[0:3]
v_exp_f32 v51, v51
v_mfma_f32_16x16x32_bf16 a[4:7], a[224:227], v[100:103], a[4:7]
v_exp_f32 v52, v52
v_mfma_f32_16x16x32_bf16 a[8:11], a[224:227], v[104:107], a[8:11]
ds_read_b128 a[192:195], v216 offset:16384
v_cvt_pk_bf16_f32 v121, v50, v51
v_mfma_f32_16x16x32_bf16 a[12:15], a[224:227], v[108:111], a[12:15]
v_exp_f32 v53, v53
v_mfma_f32_16x16x32_bf16 a[16:19], a[228:231], v[96:99], a[16:19]
ds_read_b128 a[196:199], v217 offset:16384
ds_read_b128 a[200:203], v218 offset:16384
v_mfma_f32_16x16x32_bf16 a[20:23], a[228:231], v[100:103], a[20:23]
v_exp_f32 v54, v54
v_mfma_f32_16x16x32_bf16 a[24:27], a[228:231], v[104:107], a[24:27]
ds_read_b128 a[204:207], v219 offset:16384
v_cvt_pk_bf16_f32 v122, v52, v53
v_mfma_f32_16x16x32_bf16 a[28:31], a[228:231], v[108:111], a[28:31]
v_exp_f32 v55, v55
v_mfma_f32_16x16x32_bf16 a[32:35], a[232:235], v[96:99], a[32:35]
buffer_load_dwordx4 v249, s[16:19], s36 offen offset:3072 sc1 lds
v_mfma_f32_16x16x32_bf16 a[36:39], a[232:235], v[100:103], a[36:39]
s_add_u32 s24, s24, 8192
v_exp_f32 v56, v56
v_mfma_f32_16x16x32_bf16 a[40:43], a[232:235], v[104:107], a[40:43]
ds_read_b128 a[208:211], v216 offset:24576
v_cvt_pk_bf16_f32 v123, v54, v55
v_mfma_f32_16x16x32_bf16 a[44:47], a[232:235], v[108:111], a[44:47]
v_exp_f32 v57, v57
v_mfma_f32_16x16x32_bf16 a[48:51], a[236:239], v[96:99], a[48:51]
ds_read_b128 a[212:215], v217 offset:24576
ds_read_b128 a[216:219], v218 offset:24576
v_mfma_f32_16x16x32_bf16 a[52:55], a[236:239], v[100:103], a[52:55]
v_exp_f32 v58, v58
v_mfma_f32_16x16x32_bf16 a[56:59], a[236:239], v[104:107], a[56:59]
ds_read_b128 a[220:223], v219 offset:24576
v_cvt_pk_bf16_f32 v124, v56, v57
v_mfma_f32_16x16x32_bf16 a[60:63], a[236:239], v[108:111], a[60:63]
v_exp_f32 v59, v59
v_mfma_f32_16x16x32_bf16 a[64:67], a[240:243], v[96:99], a[64:67]
v_mfma_f32_16x16x32_bf16 a[68:71], a[240:243], v[100:103], a[68:71]
v_exp_f32 v60, v60
v_mfma_f32_16x16x32_bf16 a[72:75], a[240:243], v[104:107], a[72:75]
v_cvt_pk_bf16_f32 v125, v58, v59
v_mfma_f32_16x16x32_bf16 a[76:79], a[240:243], v[108:111], a[76:79]
v_exp_f32 v61, v61
v_mfma_f32_16x16x32_bf16 a[80:83], a[244:247], v[96:99], a[80:83]
s_lshl1_add_u32 m0, s26, 16384
v_mfma_f32_16x16x32_bf16 a[84:87], a[244:247], v[100:103], a[84:87]
s_waitcnt vmcnt(9) lgkmcnt(0)
s_barrier
v_mfma_f32_16x16x32_bf16 a[88:91], a[244:247], v[104:107], a[88:91]
buffer_load_dwordx4 v228, s[12:15], s24 offen  lds
v_mfma_f32_16x16x32_bf16 a[92:95], a[244:247], v[108:111], a[92:95]
v_mfma_f32_16x16x32_bf16 a[96:99], a[248:251], v[96:99], a[96:99]
v_exp_f32 v62, v62
v_mfma_f32_16x16x32_bf16 a[100:103], a[248:251], v[100:103], a[100:103]
v_cvt_pk_bf16_f32 v126, v60, v61
v_mfma_f32_16x16x32_bf16 a[104:107], a[248:251], v[104:107], a[104:107]
v_exp_f32 v63, v63
v_mfma_f32_16x16x32_bf16 a[108:111], a[248:251], v[108:111], a[108:111]
v_mfma_f32_16x16x32_bf16 a[112:115], a[252:255], v[96:99], a[112:115]
v_exp_f32 v0, v0
v_mfma_f32_16x16x32_bf16 a[116:119], a[252:255], v[100:103], a[116:119]
v_cvt_pk_bf16_f32 v127, v62, v63
v_mfma_f32_16x16x32_bf16 a[120:123], a[252:255], v[104:107], a[120:123]
v_exp_f32 v1, v1
v_mfma_f32_16x16x32_bf16 a[124:127], a[252:255], v[108:111], a[124:127]
v_mfma_f32_16x16x32_bf16 v[32:35], a[192:195], v[128:131], v[64:67]
v_exp_f32 v2, v2
v_mfma_f32_16x16x32_bf16 v[32:35], a[196:199], v[132:135], v[32:35]
ds_read_b64_tr_b16 a[224:225], v220 offset:32768
v_cvt_pk_bf16_f32 v96, v0, v1
v_mfma_f32_16x16x32_bf16 v[32:35], a[200:203], v[136:139], v[32:35]
Lpad20:
s_cbranch_execz Lwalk1
v_exp_f32 v3, v3
v_mfma_f32_16x16x32_bf16 v[32:35], a[204:207], v[140:143], v[32:35]
ds_read_b64_tr_b16 a[226:227], v220 offset:40960
ds_read_b64_tr_b16 a[228:229], v221 offset:32768
v_mfma_f32_16x16x32_bf16 v[36:39], a[208:211], v[128:131], v[64:67]
v_exp_f32 v4, v4
v_mfma_f32_16x16x32_bf16 v[36:39], a[212:215], v[132:135], v[36:39]
ds_read_b64_tr_b16 a[230:231], v221 offset:40960
v_cvt_pk_bf16_f32 v97, v2, v3
v_mfma_f32_16x16x32_bf16 v[36:39], a[216:219], v[136:139], v[36:39]
v_exp_f32 v5, v5
v_mfma_f32_16x16x32_bf16 v[36:39], a[220:223], v[140:143], v[36:39]
buffer_load_dwordx4 v229, s[12:15], s24 offen offset:1024  lds
v_mfma_f32_16x16x32_bf16 v[40:43], a[192:195], v[144:147], v[68:71]
v_exp_f32 v6, v6
v_mfma_f32_16x16x32_bf16 v[40:43], a[196:199], v[148:151], v[40:43]
ds_read_b64_tr_b16 a[232:233], v222 offset:32768
v_cvt_pk_bf16_f32 v98, v4, v5
v_mfma_f32_16x16x32_bf16 v[40:43], a[200:203], v[152:155], v[40:43]
v_exp_f32 v7, v7
v_mfma_f32_16x16x32_bf16 v[40:43], a[204:207], v[156:159], v[40:43]
ds_read_b64_tr_b16 a[234:235], v222 offset:40960
ds_read_b64_tr_b16 a[236:237], v223 offset:32768
v_mfma_f32_16x16x32_bf16 v[44:47], a[208:211], v[144:147], v[68:71]
v_exp_f32 v8, v8
v_mfma_f32_16x16x32_bf16 v[44:47], a[212:215], v[148:151], v[44:47]
ds_read_b64_tr_b16 a[238:239], v223 offset:40960
v_cvt_pk_bf16_f32 v99, v6, v7
v_mfma_f32_16x16x32_bf16 v[44:47], a[216:219], v[152:155], v[44:47]
v_exp_f32 v9, v9
v_mfma_f32_16x16x32_bf16 v[44:47], a[220:223], v[156:159], v[44:47]
ds_read_b64_tr_b16 a[240:241], v224 offset:32768
ds_read_b64_tr_b16 a[242:243], v224 offset:40960
v_mfma_f32_16x16x32_bf16 v[48:51], a[192:195], v[160:163], v[72:75]
v_exp_f32 v10, v10
v_mfma_f32_16x16x32_bf16 v[48:51], a[196:199], v[164:167], v[48:51]
ds_read_b64_tr_b16 a[244:245], v225 offset:32768
v_cvt_pk_bf16_f32 v100, v8, v9
v_mfma_f32_16x16x32_bf16 v[48:51], a[200:203], v[168:171], v[48:51]
v_exp_f32 v11, v11
v_mfma_f32_16x16x32_bf16 v[48:51], a[204:207], v[172:175], v[48:51]
ds_read_b64_tr_b16 a[246:247], v225 offset:40960
ds_read_b64_tr_b16 a[248:249], v226 offset:32768
v_mfma_f32_16x16x32_bf16 v[52:55], a[208:211], v[160:163], v[72:75]
v_exp_f32 v12, v12
v_mfma_f32_16x16x32_bf16 v[52:55], a[212:215], v[164:167], v[52:55]
ds_read_b64_tr_b16 a[250:251], v226 offset:40960
v_cvt_pk_bf16_f32 v101, v10, v11
v_mfma_f32_16x16x32_bf16 v[52:55], a[216:219], v[168:171], v[52:55]
s_add_u32 s36, s42, 4096
v_exp_f32 v13, v13
v_mfma_f32_16x16x32_bf16 v[52:55], a[220:223], v[172:175], v[52:55]
buffer_load_dwordx4 v249, s[16:19], s36 offen offset:2048 sc1 lds
v_mfma_f32_16x16x32_bf16 v[56:59], a[192:195], v[176:179], v[76:79]
v_exp_f32 v14, v14
v_mfma_f32_16x16x32_bf16 v[56:59], a[196:199], v[180:183], v[56:59]
ds_read_b64_tr_b16 a[252:253], v227 offset:32768
v_cvt_pk_bf16_f32 v102, v12, v13
v_mfma_f32_16x16x32_bf16 v[56:59], a[200:203], v[184:187], v[56:59]
v_exp_f32 v15, v15
v_mfma_f32_16x16x32_bf16 v[56:59], a[204:207], v[188:191], v[56:59]
ds_read_b64_tr_b16 a[254:255], v227 offset:40960
v_mfma_f32_16x16x32_bf16 v[60:63], a[208:211], v[176:179], v[76:79]
v_exp_f32 v16, v16
v_smfmac_f32_16x16x64_bf16 v[80:83], v[232:235], v[112:119], v88
v_cvt_pk_bf16_f32 v103, v14, v15
v_mfma_f32_16x16x32_bf16 v[60:63], a[212:215], v[180:183], v[60:63]
v_exp_f32 v17, v17
v_mfma_f32_16x16x32_bf16 v[60:63], a[216:219], v[184:187], v[60:63]
v_mfma_f32_16x16x32_bf16 v[60:63], a[220:223], v[188:191], v[60:63]
v_exp_f32 v18, v18
v_smfmac_f32_16x16x64_bf16 v[84:87], v[232:235], v[120:127], v88
s_waitcnt lgkmcnt(0)
v_cvt_pk_bf16_f32 v104, v16, v17
v_mfma_f32_16x16x32_bf16 a[0:3], a[224:227], v[112:115], a[0:3]
v_exp_f32 v19, v19
v_mfma_f32_16x16x32_bf16 a[4:7], a[224:227], v[116:119], a[4:7]
v_exp_f32 v20, v20
v_mfma_f32_16x16x32_bf16 a[8:11], a[224:227], v[120:123], a[8:11]
ds_read_b128 a[192:195], v216 offset:32768
v_cvt_pk_bf16_f32 v105, v18, v19
v_mfma_f32_16x16x32_bf16 a[12:15], a[224:227], v[124:127], a[12:15]
v_exp_f32 v21, v21
v_mfma_f32_16x16x32_bf16 a[16:19], a[228:231], v[112:115], a[16:19]
ds_read_b128 a[196:199], v217 offset:32768
ds_read_b128 a[200:203], v218 offset:32768
v_mfma_f32_16x16x32_bf16 a[20:23], a[228:231], v[116:119], a[20:23]
v_exp_f32 v22, v22
v_mfma_f32_16x16x32_bf16 a[24:27], a[228:231], v[120:123], a[24:27]
ds_read_b128 a[204:207], v219 offset:32768
v_cvt_pk_bf16_f32 v106, v20, v21
v_mfma_f32_16x16x32_bf16 a[28:31], a[228:231], v[124:127], a[28:31]
v_exp_f32 v23, v23
v_mfma_f32_16x16x32_bf16 a[32:35], a[232:235], v[112:115], a[32:35]
buffer_load_dwordx4 v249, s[16:19], s36 offen offset:3072 sc1 lds
v_mfma_f32_16x16x32_bf16 a[36:39], a[232:235], v[116:119], a[36:39]
s_add_u32 s24, s24, 8192
v_exp_f32 v24, v24
v_mfma_f32_16x16x32_bf16 a[40:43], a[232:235], v[120:123], a[40:43]
ds_read_b128 a[208:211], v216 offset:40960
v_cvt_pk_bf16_f32 v107, v22, v23
v_mfma_f32_16x16x32_bf16 a[44:47], a[232:235], v[124:127], a[44:47]
v_exp_f32 v25, v25
v_mfma_f32_16x16x32_bf16 a[48:51], a[236:239], v[112:115], a[48:51]
ds_read_b128 a[212:215], v217 offset:40960
ds_read_b128 a[216:219], v218 offset:40960
v_mfma_f32_16x16x32_bf16 a[52:55], a[236:239], v[116:119], a[52:55]
v_exp_f32 v26, v26
v_mfma_f32_16x16x32_bf16 a[56:59], a[236:239], v[120:123], a[56:59]
ds_read_b128 a[220:223], v219 offset:40960
v_cvt_pk_bf16_f32 v108, v24, v25
v_mfma_f32_16x16x32_bf16 a[60:63], a[236:239], v[124:127], a[60:63]
v_exp_f32 v27, v27
v_mfma_f32_16x16x32_bf16 a[64:67], a[240:243], v[112:115], a[64:67]
v_mfma_f32_16x16x32_bf16 a[68:71], a[240:243], v[116:119], a[68:71]
v_exp_f32 v28, v28
v_mfma_f32_16x16x32_bf16 a[72:75], a[240:243], v[120:123], a[72:75]
v_cvt_pk_bf16_f32 v109, v26, v27
v_mfma_f32_16x16x32_bf16 a[76:79], a[240:243], v[124:127], a[76:79]
v_exp_f32 v29, v29
v_mfma_f32_16x16x32_bf16 a[80:83], a[244:247], v[112:115], a[80:83]
s_lshl1_add_u32 m0, s26, 32768
v_mfma_f32_16x16x32_bf16 a[84:87], a[244:247], v[116:119], a[84:87]
s_waitcnt vmcnt(8) lgkmcnt(0)
s_barrier
v_mfma_f32_16x16x32_bf16 a[88:91], a[244:247], v[120:123], a[88:91]
buffer_load_dwordx4 v228, s[12:15], s24 offen  lds
v_mfma_f32_16x16x32_bf16 a[92:95], a[244:247], v[124:127], a[92:95]
v_mfma_f32_16x16x32_bf16 a[96:99], a[248:251], v[112:115], a[96:99]
v_exp_f32 v30, v30
v_mfma_f32_16x16x32_bf16 a[100:103], a[248:251], v[116:119], a[100:103]
v_cvt_pk_bf16_f32 v110, v28, v29
v_mfma_f32_16x16x32_bf16 a[104:107], a[248:251], v[120:123], a[104:107]
v_exp_f32 v31, v31
v_mfma_f32_16x16x32_bf16 a[108:111], a[248:251], v[124:127], a[108:111]
v_mfma_f32_16x16x32_bf16 a[112:115], a[252:255], v[112:115], a[112:115]
v_exp_f32 v32, v32
v_mfma_f32_16x16x32_bf16 a[116:119], a[252:255], v[116:119], a[116:119]
v_cvt_pk_bf16_f32 v111, v30, v31
v_mfma_f32_16x16x32_bf16 a[120:123], a[252:255], v[120:123], a[120:123]
v_exp_f32 v33, v33
v_mfma_f32_16x16x32_bf16 a[124:127], a[252:255], v[124:127], a[124:127]
v_mfma_f32_16x16x32_bf16 v[0:3], a[192:195], v[128:131], v[64:67]
v_exp_f32 v34, v34
v_mfma_f32_16x16x32_bf16 v[0:3], a[196:199], v[132:135], v[0:3]
ds_read_b64_tr_b16 a[224:225], v220 offset:49152
v_cvt_pk_bf16_f32 v112, v32, v33
v_mfma_f32_16x16x32_bf16 v[0:3], a[200:203], v[136:139], v[0:3]
v_exp_f32 v35, v35
v_mfma_f32_16x16x32_bf16 v[0:3], a[204:207], v[140:143], v[0:3]
ds_read_b64_tr_b16 a[226:227], v220 offset:57344
ds_read_b64_tr_b16 a[228:229], v221 offset:49152
v_mfma_f32_16x16x32_bf16 v[4:7], a[208:211], v[128:131], v[64:67]
v_exp_f32 v36, v36
v_mfma_f32_16x16x32_bf16 v[4:7], a[212:215], v[132:135], v[4:7]
ds_read_b64_tr_b16 a[230:231], v221 offset:57344
v_cvt_pk_bf16_f32 v113, v34, v35
v_mfma_f32_16x16x32_bf16 v[4:7], a[216:219], v[136:139], v[4:7]
v_exp_f32 v37, v37
v_mfma_f32_16x16x32_bf16 v[4:7], a[220:223], v[140:143], v[4:7]
buffer_load_dwordx4 v229, s[12:15], s24 offen offset:1024  lds
v_mfma_f32_16x16x32_bf16 v[8:11], a[192:195], v[144:147], v[68:71]
v_exp_f32 v38, v38
v_mfma_f32_16x16x32_bf16 v[8:11], a[196:199], v[148:151], v[8:11]
ds_read_b64_tr_b16 a[232:233], v222 offset:49152
v_cvt_pk_bf16_f32 v114, v36, v37
v_mfma_f32_16x16x32_bf16 v[8:11], a[200:203], v[152:155], v[8:11]
v_exp_f32 v39, v39
v_mfma_f32_16x16x32_bf16 v[8:11], a[204:207], v[156:159], v[8:11]
ds_read_b64_tr_b16 a[234:235], v222 offset:57344
ds_read_b64_tr_b16 a[236:237], v223 offset:49152
v_mfma_f32_16x16x32_bf16 v[12:15], a[208:211], v[144:147], v[68:71]
v_exp_f32 v40, v40
v_mfma_f32_16x16x32_bf16 v[12:15], a[212:215], v[148:151], v[12:15]
ds_read_b64_tr_b16 a[238:239], v223 offset:57344
v_cvt_pk_bf16_f32 v115, v38, v39
v_mfma_f32_16x16x32_bf16 v[12:15], a[216:219], v[152:155], v[12:15]
v_exp_f32 v41, v41
v_mfma_f32_16x16x32_bf16 v[12:15], a[220:223], v[156:159], v[12:15]
ds_read_b64_tr_b16 a[240:241], v224 offset:49152
ds_read_b64_tr_b16 a[242:243], v224 offset:57344
v_mfma_f32_16x16x32_bf16 v[16:19], a[192:195], v[160:163], v[72:75]
v_exp_f32 v42, v42
v_mfma_f32_16x16x32_bf16 v[16:19], a[196:199], v[164:167], v[16:19]
ds_read_b64_tr_b16 a[244:245], v225 offset:49152
v_cvt_pk_bf16_f32 v116, v40, v41
v_mfma_f32_16x16x32_bf16 v[16:19], a[200:203], v[168:171], v[16:19]
v_exp_f32 v43, v43
v_mfma_f32_16x16x32_bf16 v[16:19], a[204:207], v[172:175], v[16:19]
ds_read_b64_tr_b16 a[246:247], v225 offset:57344
ds_read_b64_tr_b16 a[248:249], v226 offset:49152
v_mfma_f32_16x16x32_bf16 v[20:23], a[208:211], v[160:163], v[72:75]
v_exp_f32 v44, v44
v_mfma_f32_16x16x32_bf16 v[20:23], a[212:215], v[164:167], v[20:23]
ds_read_b64_tr_b16 a[250:251], v226 offset:57344
v_cvt_pk_bf16_f32 v117, v42, v43
v_mfma_f32_16x16x32_bf16 v[20:23], a[216:219], v[168:171], v[20:23]
s_add_u32 s36, s42, 8192
v_exp_f32 v45, v45
v_mfma_f32_16x16x32_bf16 v[20:23], a[220:223], v[172:175], v[20:23]
buffer_load_dwordx4 v249, s[16:19], s36 offen offset:2048 sc1 lds
v_mfma_f32_16x16x32_bf16 v[24:27], a[192:195], v[176:179], v[76:79]
v_exp_f32 v46, v46
v_mfma_f32_16x16x32_bf16 v[24:27], a[196:199], v[180:183], v[24:27]
ds_read_b64_tr_b16 a[252:253], v227 offset:49152
v_cvt_pk_bf16_f32 v118, v44, v45
v_mfma_f32_16x16x32_bf16 v[24:27], a[200:203], v[184:187], v[24:27]
v_exp_f32 v47, v47
v_mfma_f32_16x16x32_bf16 v[24:27], a[204:207], v[188:191], v[24:27]
ds_read_b64_tr_b16 a[254:255], v227 offset:57344
v_mfma_f32_16x16x32_bf16 v[28:31], a[208:211], v[176:179], v[76:79]
v_exp_f32 v48, v48
v_smfmac_f32_16x16x64_bf16 v[80:83], v[232:235], v[96:103], v88
v_cvt_pk_bf16_f32 v119, v46, v47
v_mfma_f32_16x16x32_bf16 v[28:31], a[212:215], v[180:183], v[28:31]
v_exp_f32 v49, v49
v_mfma_f32_16x16x32_bf16 v[28:31], a[216:219], v[184:187], v[28:31]
v_mfma_f32_16x16x32_bf16 v[28:31], a[220:223], v[188:191], v[28:31]
v_exp_f32 v50, v50
v_smfmac_f32_16x16x64_bf16 v[84:87], v[232:235], v[104:111], v88
s_waitcnt lgkmcnt(0)
v_cvt_pk_bf16_f32 v120, v48, v49
v_mfma_f32_16x16x32_bf16 a[0:3], a[224:227], v[96:99], a[0:3]
v_exp_f32 v51, v51
v_mfma_f32_16x16x32_bf16 a[4:7], a[224:227], v[100:103], a[4:7]
v_exp_f32 v52, v52
v_mfma_f32_16x16x32_bf16 a[8:11], a[224:227], v[104:107], a[8:11]
ds_read_b128 a[192:195], v216 offset:49152
v_cvt_pk_bf16_f32 v121, v50, v51
v_mfma_f32_16x16x32_bf16 a[12:15], a[224:227], v[108:111], a[12:15]
v_exp_f32 v53, v53
v_mfma_f32_16x16x32_bf16 a[16:19], a[228:231], v[96:99], a[16:19]
ds_read_b128 a[196:199], v217 offset:49152
ds_read_b128 a[200:203], v218 offset:49152
v_mfma_f32_16x16x32_bf16 a[20:23], a[228:231], v[100:103], a[20:23]
v_exp_f32 v54, v54
v_mfma_f32_16x16x32_bf16 a[24:27], a[228:231], v[104:107], a[24:27]
ds_read_b128 a[204:207], v219 offset:49152
v_cvt_pk_bf16_f32 v122, v52, v53
v_mfma_f32_16x16x32_bf16 a[28:31], a[228:231], v[108:111], a[28:31]
v_exp_f32 v55, v55
v_mfma_f32_16x16x32_bf16 a[32:35], a[232:235], v[96:99], a[32:35]
buffer_load_dwordx4 v249, s[16:19], s36 offen offset:3072 sc1 lds
v_mfma_f32_16x16x32_bf16 a[36:39], a[232:235], v[100:103], a[36:39]
s_add_u32 s24, s24, 8192
v_exp_f32 v56, v56
v_mfma_f32_16x16x32_bf16 a[40:43], a[232:235], v[104:107], a[40:43]
ds_read_b128 a[208:211], v216 offset:57344
v_cvt_pk_bf16_f32 v123, v54, v55
v_mfma_f32_16x16x32_bf16 a[44:47], a[232:235], v[108:111], a[44:47]
v_exp_f32 v57, v57
v_mfma_f32_16x16x32_bf16 a[48:51], a[236:239], v[96:99], a[48:51]
ds_read_b128 a[212:215], v217 offset:57344
ds_read_b128 a[216:219], v218 offset:57344
v_mfma_f32_16x16x32_bf16 a[52:55], a[236:239], v[100:103], a[52:55]
v_exp_f32 v58, v58
v_mfma_f32_16x16x32_bf16 a[56:59], a[236:239], v[104:107], a[56:59]
ds_read_b128 a[220:223], v219 offset:57344
v_cvt_pk_bf16_f32 v124, v56, v57
v_mfma_f32_16x16x32_bf16 a[60:63], a[236:239], v[108:111], a[60:63]
v_exp_f32 v59, v59
v_mfma_f32_16x16x32_bf16 a[64:67], a[240:243], v[96:99], a[64:67]
v_mfma_f32_16x16x32_bf16 a[68:71], a[240:243], v[100:103], a[68:71]
v_exp_f32 v60, v60
v_mfma_f32_16x16x32_bf16 a[72:75], a[240:243], v[104:107], a[72:75]
v_cvt_pk_bf16_f32 v125, v58, v59
v_mfma_f32_16x16x32_bf16 a[76:79], a[240:243], v[108:111], a[76:79]
v_exp_f32 v61, v61
v_mfma_f32_16x16x32_bf16 a[80:83], a[244:247], v[96:99], a[80:83]
s_lshl1_add_u32 m0, s26, 49152
v_mfma_f32_16x16x32_bf16 a[84:87], a[244:247], v[100:103], a[84:87]
s_waitcnt vmcnt(10) lgkmcnt(0)
s_barrier
v_mfma_f32_16x16x32_bf16 a[88:91], a[244:247], v[104:107], a[88:91]
s_add_u32 s36, s42, 12288
buffer_load_dwordx4 v249, s[16:19], s36 offen offset:0 sc1 lds
v_mfma_f32_16x16x32_bf16 a[92:95], a[244:247], v[108:111], a[92:95]
buffer_load_dwordx4 v249, s[16:19], s36 offen offset:1024 sc1 lds
v_mfma_f32_16x16x32_bf16 a[96:99], a[248:251], v[96:99], a[96:99]
v_exp_f32 v62, v62
v_mfma_f32_16x16x32_bf16 a[100:103], a[248:251], v[100:103], a[100:103]
v_cvt_pk_bf16_f32 v126, v60, v61
v_mfma_f32_16x16x32_bf16 a[104:107], a[248:251], v[104:107], a[104:107]
v_exp_f32 v63, v63
v_mfma_f32_16x16x32_bf16 a[108:111], a[248:251], v[108:111], a[108:111]
buffer_load_dwordx4 v249, s[16:19], s36 offen offset:2048 sc1 lds
v_mfma_f32_16x16x32_bf16 a[112:115], a[252:255], v[96:99], a[112:115]
v_exp_f32 v0, v0
v_mfma_f32_16x16x32_bf16 a[116:119], a[252:255], v[100:103], a[116:119]
v_cvt_pk_bf16_f32 v127, v62, v63
v_mfma_f32_16x16x32_bf16 a[120:123], a[252:255], v[104:107], a[120:123]
v_exp_f32 v1, v1
v_mfma_f32_16x16x32_bf16 a[124:127], a[252:255], v[108:111], a[124:127]
buffer_load_dwordx4 v249, s[16:19], s36 offen offset:3072 sc1 lds
v_mfma_f32_16x16x32_bf16 v[32:35], a[192:195], v[128:131], v[64:67]
ds_read_b64_tr_b16 a[224:225], v220 offset:0
ds_read_b64_tr_b16 a[226:227], v220 offset:8192
v_mfma_f32_16x16x32_bf16 v[32:35], a[196:199], v[132:135], v[32:35]
v_exp_f32 v2, v2
v_mfma_f32_16x16x32_bf16 v[32:35], a[200:203], v[136:139], v[32:35]
ds_read_b64_tr_b16 a[228:229], v221 offset:0
v_cvt_pk_bf16_f32 v96, v0, v1
v_mfma_f32_16x16x32_bf16 v[32:35], a[204:207], v[140:143], v[32:35]
v_exp_f32 v3, v3
v_mfma_f32_16x16x32_bf16 v[36:39], a[208:211], v[128:131], v[64:67]
v_exp_f32 v4, v4
v_mfma_f32_16x16x32_bf16 v[36:39], a[212:215], v[132:135], v[36:39]
ds_read_b64_tr_b16 a[230:231], v221 offset:8192
v_cvt_pk_bf16_f32 v97, v2, v3
v_mfma_f32_16x16x32_bf16 v[36:39], a[216:219], v[136:139], v[36:39]
v_exp_f32 v5, v5
v_mfma_f32_16x16x32_bf16 v[36:39], a[220:223], v[140:143], v[36:39]
v_exp_f32 v6, v6
v_mfma_f32_16x16x32_bf16 v[40:43], a[192:195], v[144:147], v[68:71]
ds_read_b64_tr_b16 a[232:233], v222 offset:0
v_cvt_pk_bf16_f32 v98, v4, v5
v_mfma_f32_16x16x32_bf16 v[40:43], a[196:199], v[148:151], v[40:43]
v_exp_f32 v7, v7
v_mfma_f32_16x16x32_bf16 v[40:43], a[200:203], v[152:155], v[40:43]
ds_read_b64_tr_b16 a[234:235], v222 offset:8192
ds_read_b64_tr_b16 a[236:237], v223 offset:0
v_mfma_f32_16x16x32_bf16 v[40:43], a[204:207], v[156:159], v[40:43]
v_exp_f32 v8, v8
v_mfma_f32_16x16x32_bf16 v[44:47], a[208:211], v[144:147], v[68:71]
ds_read_b64_tr_b16 a[238:239], v223 offset:8192
v_cvt_pk_bf16_f32 v99, v6, v7
v_mfma_f32_16x16x32_bf16 v[44:47], a[212:215], v[148:151], v[44:47]
v_exp_f32 v9, v9
v_mfma_f32_16x16x32_bf16 v[44:47], a[216:219], v[152:155], v[44:47]
v_exp_f32 v10, v10
v_mfma_f32_16x16x32_bf16 v[44:47], a[220:223], v[156:159], v[44:47]
ds_read_b64_tr_b16 a[240:241], v224 offset:0
v_cvt_pk_bf16_f32 v100, v8, v9
v_mfma_f32_16x16x32_bf16 v[48:51], a[192:195], v[160:163], v[72:75]
v_exp_f32 v11, v11
v_mfma_f32_16x16x32_bf16 v[48:51], a[196:199], v[164:167], v[48:51]
ds_read_b64_tr_b16 a[242:243], v224 offset:8192
ds_read_b64_tr_b16 a[244:245], v225 offset:0
v_mfma_f32_16x16x32_bf16 v[48:51], a[200:203], v[168:171], v[48:51]
v_exp_f32 v12, v12
v_mfma_f32_16x16x32_bf16 v[48:51], a[204:207], v[172:175], v[48:51]
ds_read_b64_tr_b16 a[246:247], v225 offset:8192
v_cvt_pk_bf16_f32 v101, v10, v11
v_mfma_f32_16x16x32_bf16 v[52:55], a[208:211], v[160:163], v[72:75]
v_exp_f32 v13, v13
v_mfma_f32_16x16x32_bf16 v[52:55], a[212:215], v[164:167], v[52:55]
v_exp_f32 v14, v14
v_mfma_f32_16x16x32_bf16 v[52:55], a[216:219], v[168:171], v[52:55]
ds_read_b64_tr_b16 a[248:249], v226 offset:0
v_cvt_pk_bf16_f32 v102, v12, v13
v_mfma_f32_16x16x32_bf16 v[52:55], a[220:223], v[172:175], v[52:55]
v_exp_f32 v15, v15
v_mfma_f32_16x16x32_bf16 v[56:59], a[192:195], v[176:179], v[76:79]
ds_read_b64_tr_b16 a[250:251], v226 offset:8192
ds_read_b64_tr_b16 a[252:253], v227 offset:0
v_mfma_f32_16x16x32_bf16 v[56:59], a[196:199], v[180:183], v[56:59]
v_exp_f32 v16, v16
v_mfma_f32_16x16x32_bf16 v[56:59], a[200:203], v[184:187], v[56:59]
ds_read_b64_tr_b16 a[254:255], v227 offset:8192
v_cvt_pk_bf16_f32 v103, v14, v15
v_mfma_f32_16x16x32_bf16 v[56:59], a[204:207], v[188:191], v[56:59]
v_exp_f32 v17, v17
v_mfma_f32_16x16x32_bf16 v[60:63], a[208:211], v[176:179], v[76:79]
v_exp_f32 v18, v18
v_mfma_f32_16x16x32_bf16 v[60:63], a[212:215], v[180:183], v[60:63]
v_cvt_pk_bf16_f32 v104, v16, v17
v_mfma_f32_16x16x32_bf16 v[60:63], a[216:219], v[184:187], v[60:63]
v_exp_f32 v19, v19
v_mfma_f32_16x16x32_bf16 v[60:63], a[220:223], v[188:191], v[60:63]
v_smfmac_f32_16x16x64_bf16 v[80:83], v[232:235], v[112:119], v88
v_smfmac_f32_16x16x64_bf16 v[84:87], v[232:235], v[120:127], v88
v_exp_f32 v20, v20
s_waitcnt vmcnt(6) lgkmcnt(0)
s_barrier
v_cvt_pk_bf16_f32 v105, v18, v19
v_mfma_f32_16x16x32_bf16 a[0:3], a[224:227], v[112:115], a[0:3]
s_lshl1_add_u32 m0, s26, 0
v_exp_f32 v21, v21
v_mfma_f32_16x16x32_bf16 a[4:7], a[224:227], v[116:119], a[4:7]
ds_read_b64_tr_b16 a[192:193], v220 offset:16384
v_exp_f32 v22, v22
v_mfma_f32_16x16x32_bf16 a[8:11], a[224:227], v[120:123], a[8:11]
s_add_u32 s36, s42, 0
ds_read_b64_tr_b16 a[194:195], v220 offset:24576
v_cvt_pk_bf16_f32 v106, v20, v21
v_mfma_f32_16x16x32_bf16 a[12:15], a[224:227], v[124:127], a[12:15]
v_exp_f32 v23, v23
v_mfma_f32_16x16x32_bf16 a[16:19], a[228:231], v[112:115], a[16:19]
v_exp_f32 v24, v24
v_mfma_f32_16x16x32_bf16 a[20:23], a[228:231], v[116:119], a[20:23]
ds_read_b64_tr_b16 a[196:197], v221 offset:16384
v_cvt_pk_bf16_f32 v107, v22, v23
v_mfma_f32_16x16x32_bf16 a[24:27], a[228:231], v[120:123], a[24:27]
buffer_load_dwordx4 v249, s[16:19], s36 offen offset:0 sc1 lds
v_mfma_f32_16x16x32_bf16 a[28:31], a[228:231], v[124:127], a[28:31]
ds_read_b64_tr_b16 a[198:199], v221 offset:24576
v_exp_f32 v25, v25
v_mfma_f32_16x16x32_bf16 a[32:35], a[232:235], v[112:115], a[32:35]
buffer_load_dwordx4 v249, s[16:19], s36 offen offset:1024 sc1 lds
v_exp_f32 v26, v26
v_mfma_f32_16x16x32_bf16 a[36:39], a[232:235], v[116:119], a[36:39]
s_add_u32 s36, s44, 0
ds_read_b64_tr_b16 a[200:201], v222 offset:16384
v_cvt_pk_bf16_f32 v108, v24, v25
v_mfma_f32_16x16x32_bf16 a[40:43], a[232:235], v[120:123], a[40:43]
v_exp_f32 v27, v27
v_mfma_f32_16x16x32_bf16 a[44:47], a[232:235], v[124:127], a[44:47]
ds_read_b64_tr_b16 a[202:203], v222 offset:24576
ds_read_b64_tr_b16 a[204:205], v223 offset:16384
v_mfma_f32_16x16x32_bf16 a[48:51], a[236:239], v[112:115], a[48:51]
v_exp_f32 v28, v28
v_mfma_f32_16x16x32_bf16 a[52:55], a[236:239], v[116:119], a[52:55]
buffer_load_dwordx4 v[64:67], v249, s[16:19], s36 offen offset:0 sc1
v_cvt_pk_bf16_f32 v109, v26, v27
v_mfma_f32_16x16x32_bf16 a[56:59], a[236:239], v[120:123], a[56:59]
v_exp_f32 v29, v29
v_mfma_f32_16x16x32_bf16 a[60:63], a[236:239], v[124:127], a[60:63]
ds_read_b64_tr_b16 a[206:207], v223 offset:24576
ds_read_b64_tr_b16 a[208:209], v224 offset:16384
v_mfma_f32_16x16x32_bf16 a[64:67], a[240:243], v[112:115], a[64:67]
buffer_load_dwordx4 v[68:71], v249, s[16:19], s36 offen offset:1024 sc1
v_exp_f32 v30, v30
v_mfma_f32_16x16x32_bf16 a[68:71], a[240:243], v[116:119], a[68:71]
ds_read_b64_tr_b16 a[210:211], v224 offset:24576
v_cvt_pk_bf16_f32 v110, v28, v29
v_mfma_f32_16x16x32_bf16 a[72:75], a[240:243], v[120:123], a[72:75]
v_exp_f32 v31, v31
v_mfma_f32_16x16x32_bf16 a[76:79], a[240:243], v[124:127], a[76:79]
s_nop 0
buffer_load_dwordx4 v[72:75], v249, s[16:19], s36 offen offset:2048 sc1
v_mfma_f32_16x16x32_bf16 a[80:83], a[244:247], v[112:115], a[80:83]
ds_read_b64_tr_b16 a[212:213], v225 offset:16384
v_cvt_pk_bf16_f32 v111, v30, v31
v_mfma_f32_16x16x32_bf16 a[84:87], a[244:247], v[116:119], a[84:87]
ds_read_b64_tr_b16 a[214:215], v225 offset:24576
ds_read_b64_tr_b16 a[216:217], v226 offset:16384
v_mfma_f32_16x16x32_bf16 a[88:91], a[244:247], v[120:123], a[88:91]
buffer_load_dwordx4 v[76:79], v249, s[16:19], s36 offen offset:3072 sc1
v_mfma_f32_16x16x32_bf16 a[92:95], a[244:247], v[124:127], a[92:95]
v_exp_f32 v32, v32
v_exp_f32 v33, v33
v_mfma_f32_16x16x32_bf16 a[96:99], a[248:251], v[112:115], a[96:99]
s_add_u32 s36, s43, 0
v_exp_f32 v34, v34
v_mfma_f32_16x16x32_bf16 a[100:103], a[248:251], v[116:119], a[100:103]
v_exp_f32 v35, v35
v_mfma_f32_16x16x32_bf16 a[104:107], a[248:251], v[120:123], a[104:107]
ds_read_b64_tr_b16 a[218:219], v226 offset:24576
v_exp_f32 v36, v36
v_mfma_f32_16x16x32_bf16 a[108:111], a[248:251], v[124:127], a[108:111]
v_exp_f32 v37, v37
v_mfma_f32_16x16x32_bf16 a[112:115], a[252:255], v[112:115], a[112:115]
ds_read_b64_tr_b16 a[220:221], v227 offset:16384
v_exp_f32 v38, v38
v_mfma_f32_16x16x32_bf16 a[116:119], a[252:255], v[116:119], a[116:119]
v_exp_f32 v39, v39
v_mfma_f32_16x16x32_bf16 a[120:123], a[252:255], v[120:123], a[120:123]
ds_read_b64_tr_b16 a[222:223], v227 offset:24576
v_exp_f32 v40, v40
v_mfma_f32_16x16x32_bf16 a[124:127], a[252:255], v[124:127], a[124:127]
v_exp_f32 v41, v41
v_smfmac_f32_16x16x64_bf16 v[80:83], v[232:235], v[96:103], v88
buffer_load_dwordx4 v[0:3], v249, s[16:19], s36 offen offset:0 sc1
v_cvt_pk_bf16_f32 v112, v32, v33
v_cvt_pk_bf16_f32 v113, v34, v35
v_smfmac_f32_16x16x64_bf16 v[84:87], v[232:235], v[104:111], v88
v_cvt_pk_bf16_f32 v114, v36, v37
v_cvt_pk_bf16_f32 v115, v38, v39
s_waitcnt lgkmcnt(0)
v_exp_f32 v42, v42
v_mfma_f32_16x16x32_bf16 a[0:3], a[192:195], v[96:99], a[0:3]
buffer_load_dwordx4 v[4:7], v249, s[16:19], s36 offen offset:1024 sc1
v_cvt_pk_bf16_f32 v116, v40, v41
v_mfma_f32_16x16x32_bf16 a[4:7], a[192:195], v[100:103], a[4:7]
ds_read_b64_tr_b16 a[224:225], v220 offset:32768
v_exp_f32 v43, v43
v_mfma_f32_16x16x32_bf16 a[8:11], a[192:195], v[104:107], a[8:11]
v_exp_f32 v44, v44
v_mfma_f32_16x16x32_bf16 a[12:15], a[192:195], v[108:111], a[12:15]
ds_read_b64_tr_b16 a[226:227], v220 offset:40960
v_cvt_pk_bf16_f32 v117, v42, v43
v_mfma_f32_16x16x32_bf16 a[16:19], a[196:199], v[96:99], a[16:19]
buffer_load_dwordx4 v[8:11], v249, s[16:19], s36 offen offset:2048 sc1
v_exp_f32 v45, v45
v_mfma_f32_16x16x32_bf16 a[20:23], a[196:199], v[100:103], a[20:23]
ds_read_b64_tr_b16 a[228:229], v221 offset:32768
v_exp_f32 v46, v46
v_mfma_f32_16x16x32_bf16 a[24:27], a[196:199], v[104:107], a[24:27]
ds_read_b64_tr_b16 a[230:231], v221 offset:40960
v_cvt_pk_bf16_f32 v118, v44, v45
v_mfma_f32_16x16x32_bf16 a[28:31], a[196:199], v[108:111], a[28:31]
v_exp_f32 v47, v47
v_mfma_f32_16x16x32_bf16 a[32:35], a[200:203], v[96:99], a[32:35]
v_exp_f32 v48, v48
v_mfma_f32_16x16x32_bf16 a[36:39], a[200:203], v[100:103], a[36:39]
ds_read_b64_tr_b16 a[232:233], v222 offset:32768
buffer_load_dwordx4 v[12:15], v249, s[16:19], s36 offen offset:3072 sc1
v_cvt_pk_bf16_f32 v119, v46, v47
v_exp_f32 v49, v49
v_mfma_f32_16x16x32_bf16 a[40:43], a[200:203], v[104:107], a[40:43]
s_add_u32 s36, s43, 4096
v_exp_f32 v50, v50
v_mfma_f32_16x16x32_bf16 a[44:47], a[200:203], v[108:111], a[44:47]
ds_read_b64_tr_b16 a[234:235], v222 offset:40960
v_cvt_pk_bf16_f32 v120, v48, v49
v_mfma_f32_16x16x32_bf16 a[48:51], a[204:207], v[96:99], a[48:51]
v_exp_f32 v51, v51
v_mfma_f32_16x16x32_bf16 a[52:55], a[204:207], v[100:103], a[52:55]
ds_read_b64_tr_b16 a[236:237], v223 offset:32768
v_exp_f32 v52, v52
v_mfma_f32_16x16x32_bf16 a[56:59], a[204:207], v[104:107], a[56:59]
ds_read_b64_tr_b16 a[238:239], v223 offset:40960
v_cvt_pk_bf16_f32 v121, v50, v51
v_mfma_f32_16x16x32_bf16 a[60:63], a[204:207], v[108:111], a[60:63]
v_exp_f32 v53, v53
v_mfma_f32_16x16x32_bf16 a[64:67], a[208:211], v[96:99], a[64:67]
ds_read_b64_tr_b16 a[240:241], v224 offset:32768
v_exp_f32 v54, v54
v_mfma_f32_16x16x32_bf16 a[68:71], a[208:211], v[100:103], a[68:71]
buffer_load_dwordx4 v[16:19], v249, s[16:19], s36 offen offset:0 sc1
v_cvt_pk_bf16_f32 v122, v52, v53
v_mfma_f32_16x16x32_bf16 a[72:75], a[208:211], v[104:107], a[72:75]
ds_read_b64_tr_b16 a[242:243], v224 offset:40960
v_exp_f32 v55, v55
v_mfma_f32_16x16x32_bf16 a[76:79], a[208:211], v[108:111], a[76:79]
v_exp_f32 v56, v56
v_mfma_f32_16x16x32_bf16 a[80:83], a[212:215], v[96:99], a[80:83]
ds_read_b64_tr_b16 a[244:245], v225 offset:32768
v_cvt_pk_bf16_f32 v123, v54, v55
v_exp_f32 v57, v57
v_mfma_f32_16x16x32_bf16 a[84:87], a[212:215], v[100:103], a[84:87]
buffer_load_dwordx4 v[20:23], v249, s[16:19], s36 offen offset:1024 sc1
v_exp_f32 v58, v58
v_mfma_f32_16x16x32_bf16 a[88:91], a[212:215], v[104:107], a[88:91]
ds_read_b64_tr_b16 a[246:247], v225 offset:40960
v_cvt_pk_bf16_f32 v124, v56, v57
v_mfma_f32_16x16x32_bf16 a[92:95], a[212:215], v[108:111], a[92:95]
v_exp_f32 v59, v59
v_mfma_f32_16x16x32_bf16 a[96:99], a[216:219], v[96:99], a[96:99]
ds_read_b64_tr_b16 a[248:249], v226 offset:32768
v_exp_f32 v60, v60
v_mfma_f32_16x16x32_bf16 a[100:103], a[216:219], v[100:103], a[100:103]
buffer_load_dwordx4 v[24:27], v249, s[16:19], s36 offen offset:2048 sc1
v_cvt_pk_bf16_f32 v125, v58, v59
v_mfma_f32_16x16x32_bf16 a[104:107], a[216:219], v[104:107], a[104:107]
ds_read_b64_tr_b16 a[250:251], v226 offset:40960
v_exp_f32 v61, v61
v_mfma_f32_16x16x32_bf16 a[108:111], a[216:219], v[108:111], a[108:111]
v_exp_f32 v62, v62
v_mfma_f32_16x16x32_bf16 a[112:115], a[220:223], v[96:99], a[112:115]
ds_read_b64_tr_b16 a[252:253], v227 offset:32768
v_cvt_pk_bf16_f32 v126, v60, v61
v_mfma_f32_16x16x32_bf16 a[116:119], a[220:223], v[100:103], a[116:119]
v_exp_f32 v63, v63
v_mfma_f32_16x16x32_bf16 a[120:123], a[220:223], v[104:107], a[120:123]
s_nop 0
ds_read_b64_tr_b16 a[254:255], v227 offset:40960
buffer_load_dwordx4 v[28:31], v249, s[16:19], s36 offen offset:3072 sc1
v_cvt_pk_bf16_f32 v127, v62, v63
v_mfma_f32_16x16x32_bf16 a[124:127], a[220:223], v[108:111], a[124:127]
v_smfmac_f32_16x16x64_bf16 v[80:83], v[232:235], v[112:119], v88
s_add_u32 s36, s43, 8192
v_mov_b32 v207, 155904
v_smfmac_f32_16x16x64_bf16 v[84:87], v[232:235], v[120:127], v88
v_lshl_add_u32 v206, s27, 2, v207
s_waitcnt lgkmcnt(0)
v_mfma_f32_16x16x32_bf16 a[0:3], a[224:227], v[112:115], a[0:3]
buffer_load_dwordx4 v[32:35], v249, s[16:19], s36 offen offset:0 sc1
v_mfma_f32_16x16x32_bf16 a[4:7], a[224:227], v[116:119], a[4:7]
buffer_load_dwordx4 v[36:39], v249, s[16:19], s36 offen offset:1024 sc1
v_mfma_f32_16x16x32_bf16 a[8:11], a[224:227], v[120:123], a[8:11]
buffer_load_dwordx4 v[40:43], v249, s[16:19], s36 offen offset:2048 sc1
v_mfma_f32_16x16x32_bf16 a[12:15], a[224:227], v[124:127], a[12:15]
buffer_load_dwordx4 v[44:47], v249, s[16:19], s36 offen offset:3072 sc1
v_mfma_f32_16x16x32_bf16 a[16:19], a[228:231], v[112:115], a[16:19]
s_add_u32 s36, s43, 12288
buffer_load_dwordx4 v[48:51], v249, s[16:19], s36 offen offset:0 sc1
v_mfma_f32_16x16x32_bf16 a[20:23], a[228:231], v[116:119], a[20:23]
buffer_load_dwordx4 v[52:55], v249, s[16:19], s36 offen offset:1024 sc1
v_mfma_f32_16x16x32_bf16 a[24:27], a[228:231], v[120:123], a[24:27]
buffer_load_dwordx4 v[56:59], v249, s[16:19], s36 offen offset:2048 sc1
v_mfma_f32_16x16x32_bf16 a[28:31], a[228:231], v[124:127], a[28:31]
Lpad21:
s_cbranch_execz Lwalk1
v_add_f32 v192, v80, v81
v_add_f32 v194, v82, v83
v_mfma_f32_16x16x32_bf16 a[32:35], a[232:235], v[112:115], a[32:35]
v_add_f32 v196, v84, v85
v_add_f32 v198, v86, v87
v_mfma_f32_16x16x32_bf16 a[36:39], a[232:235], v[116:119], a[36:39]
v_mov_b32 v193, v192
v_mov_b32 v195, v194
v_mfma_f32_16x16x32_bf16 a[40:43], a[232:235], v[120:123], a[40:43]
v_mov_b32 v197, v196
v_mov_b32 v199, v198
v_mfma_f32_16x16x32_bf16 a[44:47], a[232:235], v[124:127], a[44:47]
v_permlane16_swap_b32 v192, v193
v_permlane16_swap_b32 v194, v195
v_mfma_f32_16x16x32_bf16 a[48:51], a[236:239], v[112:115], a[48:51]
v_permlane16_swap_b32 v196, v197
v_permlane16_swap_b32 v198, v199
v_mfma_f32_16x16x32_bf16 a[52:55], a[236:239], v[116:119], a[52:55]
v_add_f32 v192, v192, v193
v_add_f32 v194, v194, v195
v_mfma_f32_16x16x32_bf16 a[56:59], a[236:239], v[120:123], a[56:59]
v_add_f32 v196, v196, v197
v_add_f32 v198, v198, v199
v_mfma_f32_16x16x32_bf16 a[60:63], a[236:239], v[124:127], a[60:63]
v_mov_b32 v193, v192
v_mov_b32 v195, v194
v_mfma_f32_16x16x32_bf16 a[64:67], a[240:243], v[112:115], a[64:67]
v_mov_b32 v197, v196
v_mov_b32 v199, v198
v_mfma_f32_16x16x32_bf16 a[68:71], a[240:243], v[116:119], a[68:71]
v_permlane32_swap_b32 v192, v193
v_permlane32_swap_b32 v194, v195
v_mfma_f32_16x16x32_bf16 a[72:75], a[240:243], v[120:123], a[72:75]
v_permlane32_swap_b32 v196, v197
v_permlane32_swap_b32 v198, v199
v_mfma_f32_16x16x32_bf16 a[76:79], a[240:243], v[124:127], a[76:79]
v_add_f32 v192, v192, v193
v_add_f32 v194, v194, v195
v_mfma_f32_16x16x32_bf16 a[80:83], a[244:247], v[112:115], a[80:83]
buffer_load_dwordx4 v[60:63], v249, s[16:19], s36 offen offset:3072 sc1
v_mfma_f32_16x16x32_bf16 a[84:87], a[244:247], v[116:119], a[84:87]
s_add_u32 s36, s44, 4096
v_add_f32 v196, v196, v197
v_add_f32 v198, v198, v199
v_mfma_f32_16x16x32_bf16 a[88:91], a[244:247], v[120:123], a[88:91]
v_add_f32 v193, v192, v194
v_add_f32 v195, v196, v198
v_mfma_f32_16x16x32_bf16 a[92:95], a[244:247], v[124:127], a[92:95]
v_add_f32 v193, v193, v195
v_cmp_nge_f32 vcc, 0x53800000, v193
v_mfma_f32_16x16x32_bf16 a[96:99], a[248:251], v[112:115], a[96:99]
s_cmp_lg_u64 vcc, 0
s_cselect_b32 s34, 1, 0
buffer_load_dwordx4 v[80:83], v249, s[16:19], s36 offen offset:0 sc1
v_mfma_f32_16x16x32_bf16 a[100:103], a[248:251], v[116:119], a[100:103]
v_mov_b32 v195, s34
v_mfma_f32_16x16x32_bf16 a[104:107], a[248:251], v[120:123], a[104:107]
ds_write_b32 v206, v195
buffer_load_dwordx4 v[84:87], v249, s[16:19], s36 offen offset:1024 sc1
v_rcp_f32 v192, v192
v_rcp_f32 v194, v194
v_mfma_f32_16x16x32_bf16 a[108:111], a[248:251], v[124:127], a[108:111]
v_rcp_f32 v196, v196
v_mfma_f32_16x16x32_bf16 a[112:115], a[252:255], v[112:115], a[112:115]
buffer_load_dwordx4 v[88:91], v249, s[16:19], s36 offen offset:2048 sc1
v_rcp_f32 v198, v198
v_mfma_f32_16x16x32_bf16 a[116:119], a[252:255], v[116:119], a[116:119]
buffer_load_dwordx4 v[92:95], v249, s[16:19], s36 offen offset:3072 sc1
v_mfma_f32_16x16x32_bf16 a[120:123], a[252:255], v[120:123], a[120:123]
v_mfma_f32_16x16x32_bf16 a[124:127], a[252:255], v[124:127], a[124:127]
s_waitcnt lgkmcnt(0)
s_barrier
ds_read_b128 v[200:203], v207
s_lshl1_add_u32 m0, s26, 16384
s_add_u32 s36, s42, 4096
buffer_load_dwordx4 v249, s[16:19], s36 offen offset:0 sc1 lds
buffer_load_dwordx4 v249, s[16:19], s36 offen offset:1024 sc1 lds
s_lshl1_add_u32 m0, s26, 32768
s_add_u32 s36, s42, 8192
buffer_load_dwordx4 v249, s[16:19], s36 offen offset:0 sc1 lds
buffer_load_dwordx4 v249, s[16:19], s36 offen offset:1024 sc1 lds
s_waitcnt lgkmcnt(0)
v_or3_b32 v200, v200, v201, v202
v_or_b32 v200, v200, v203
s_nop 0
v_readfirstlane_b32 s34, v200
s_andn2_b32 s34, s34, s32
s_cbranch_scc1 La_slow
v_accvgpr_read_b32 v128, a0
v_accvgpr_read_b32 v129, a1
v_accvgpr_read_b32 v130, a2
v_accvgpr_read_b32 v131, a3
v_accvgpr_read_b32 v132, a16
v_accvgpr_read_b32 v133, a17
v_accvgpr_read_b32 v134, a18
v_accvgpr_read_b32 v135, a19
v_pk_mul_f32 v[128:129], v[128:129], v[192:193] op_sel_hi:[1,0]
v_pk_mul_f32 v[130:131], v[130:131], v[192:193] op_sel_hi:[1,0]
v_pk_mul_f32 v[132:133], v[132:133], v[192:193] op_sel_hi:[1,0]
v_pk_mul_f32 v[134:135], v[134:135], v[192:193] op_sel_hi:[1,0]
s_add_u32 s35, s4, 0
s_add_u32 s36, s45, 0
v_cvt_pk_bf16_f32 v160, v128, v129
v_cvt_pk_bf16_f32 v161, v130, v131
v_cvt_pk_bf16_f32 v162, v132, v133
v_cvt_pk_bf16_f32 v163, v134, v135
buffer_store_dwordx4 v[160:163], v255, s[16:19], s35 offen sc1
buffer_load_dwordx4 v[208:211], v249, s[16:19], s36 offen offset:0 sc1
buffer_load_dwordx4 v[212:215], v249, s[16:19], s36 offen offset:1024 sc1
v_accvgpr_read_b32 v136, a4
v_accvgpr_read_b32 v137, a5
v_accvgpr_read_b32 v138, a6
v_accvgpr_read_b32 v139, a7
v_accvgpr_read_b32 v140, a20
v_accvgpr_read_b32 v141, a21
v_accvgpr_read_b32 v142, a22
v_accvgpr_read_b32 v143, a23
v_pk_mul_f32 v[136:137], v[136:137], v[194:195] op_sel_hi:[1,0]
v_pk_mul_f32 v[138:139], v[138:139], v[194:195] op_sel_hi:[1,0]
v_pk_mul_f32 v[140:141], v[140:141], v[194:195] op_sel_hi:[1,0]
v_pk_mul_f32 v[142:143], v[142:143], v[194:195] op_sel_hi:[1,0]
s_add_u32 s35, s5, 0
v_cvt_pk_bf16_f32 v164, v136, v137
v_cvt_pk_bf16_f32 v165, v138, v139
v_cvt_pk_bf16_f32 v166, v140, v141
v_cvt_pk_bf16_f32 v167, v142, v143
buffer_store_dwordx4 v[164:167], v255, s[16:19], s35 offen sc1
buffer_load_dwordx4 v[216:219], v249, s[16:19], s36 offen offset:2048 sc1
buffer_load_dwordx4 v[220:223], v249, s[16:19], s36 offen offset:3072 sc1
v_accvgpr_read_b32 v144, a8
v_accvgpr_read_b32 v145, a9
v_accvgpr_read_b32 v146, a10
v_accvgpr_read_b32 v147, a11
v_accvgpr_read_b32 v148, a24
v_accvgpr_read_b32 v149, a25
v_accvgpr_read_b32 v150, a26
v_accvgpr_read_b32 v151, a27
v_pk_mul_f32 v[144:145], v[144:145], v[196:197] op_sel_hi:[1,0]
v_pk_mul_f32 v[146:147], v[146:147], v[196:197] op_sel_hi:[1,0]
v_pk_mul_f32 v[148:149], v[148:149], v[196:197] op_sel_hi:[1,0]
v_pk_mul_f32 v[150:151], v[150:151], v[196:197] op_sel_hi:[1,0]
s_add_u32 s35, s6, 0
s_add_u32 s36, s45, 4096
v_cvt_pk_bf16_f32 v168, v144, v145
v_cvt_pk_bf16_f32 v169, v146, v147
v_cvt_pk_bf16_f32 v170, v148, v149
v_cvt_pk_bf16_f32 v171, v150, v151
buffer_store_dwordx4 v[168:171], v255, s[16:19], s35 offen sc1
buffer_load_dwordx4 a[240:243], v249, s[16:19], s36 offen offset:0 sc1
buffer_load_dwordx4 a[244:247], v249, s[16:19], s36 offen offset:1024 sc1
v_accvgpr_read_b32 v152, a12
v_accvgpr_read_b32 v153, a13
v_accvgpr_read_b32 v154, a14
v_accvgpr_read_b32 v155, a15
v_accvgpr_read_b32 v156, a28
v_accvgpr_read_b32 v157, a29
v_accvgpr_read_b32 v158, a30
v_accvgpr_read_b32 v159, a31
v_pk_mul_f32 v[152:153], v[152:153], v[198:199] op_sel_hi:[1,0]
v_pk_mul_f32 v[154:155], v[154:155], v[198:199] op_sel_hi:[1,0]
v_pk_mul_f32 v[156:157], v[156:157], v[198:199] op_sel_hi:[1,0]
v_pk_mul_f32 v[158:159], v[158:159], v[198:199] op_sel_hi:[1,0]
s_add_u32 s35, s7, 0
v_cvt_pk_bf16_f32 v172, v152, v153
v_cvt_pk_bf16_f32 v173, v154, v155
v_cvt_pk_bf16_f32 v174, v156, v157
v_cvt_pk_bf16_f32 v175, v158, v159
buffer_store_dwordx4 v[172:175], v255, s[16:19], s35 offen sc1
buffer_load_dwordx4 a[248:251], v249, s[16:19], s36 offen offset:2048 sc1
buffer_load_dwordx4 a[252:255], v249, s[16:19], s36 offen offset:3072 sc1
v_accvgpr_read_b32 v128, a32
v_accvgpr_read_b32 v129, a33
v_accvgpr_read_b32 v130, a34
v_accvgpr_read_b32 v131, a35
v_accvgpr_read_b32 v132, a48
v_accvgpr_read_b32 v133, a49
v_accvgpr_read_b32 v134, a50
v_accvgpr_read_b32 v135, a51
v_pk_mul_f32 v[128:129], v[128:129], v[192:193] op_sel_hi:[1,0]
v_pk_mul_f32 v[130:131], v[130:131], v[192:193] op_sel_hi:[1,0]
v_pk_mul_f32 v[132:133], v[132:133], v[192:193] op_sel_hi:[1,0]
v_pk_mul_f32 v[134:135], v[134:135], v[192:193] op_sel_hi:[1,0]
s_add_u32 s35, s4, 4096
s_add_u32 s36, s45, 8192
v_cvt_pk_bf16_f32 v176, v128, v129
v_cvt_pk_bf16_f32 v177, v130, v131
v_cvt_pk_bf16_f32 v178, v132, v133
v_cvt_pk_bf16_f32 v179, v134, v135
buffer_store_dwordx4 v[176:179], v255, s[16:19], s35 offen sc1
buffer_load_dwordx4 a[0:3], v249, s[16:19], s36 offen offset:0 sc1
buffer_load_dwordx4 a[4:7], v249, s[16:19], s36 offen offset:1024 sc1
v_accvgpr_read_b32 v136, a36
v_accvgpr_read_b32 v137, a37
v_accvgpr_read_b32 v138, a38
v_accvgpr_read_b32 v139, a39
v_accvgpr_read_b32 v140, a52
v_accvgpr_read_b32 v141, a53
v_accvgpr_read_b32 v142, a54
v_accvgpr_read_b32 v143, a55
v_pk_mul_f32 v[136:137], v[136:137], v[194:195] op_sel_hi:[1,0]
v_pk_mul_f32 v[138:139], v[138:139], v[194:195] op_sel_hi:[1,0]
v_pk_mul_f32 v[140:141], v[140:141], v[194:195] op_sel_hi:[1,0]
v_pk_mul_f32 v[142:143], v[142:143], v[194:195] op_sel_hi:[1,0]
s_add_u32 s35, s5, 4096
v_cvt_pk_bf16_f32 v180, v136, v137
v_cvt_pk_bf16_f32 v181, v138, v139
v_cvt_pk_bf16_f32 v182, v140, v141
v_cvt_pk_bf16_f32 v183, v142, v143
buffer_store_dwordx4 v[180:183], v255, s[16:19], s35 offen sc1
buffer_load_dwordx4 a[8:11], v249, s[16:19], s36 offen offset:2048 sc1
buffer_load_dwordx4 a[12:15], v249, s[16:19], s36 offen offset:3072 sc1
v_accvgpr_read_b32 v144, a40
v_accvgpr_read_b32 v145, a41
v_accvgpr_read_b32 v146, a42
v_accvgpr_read_b32 v147, a43
v_accvgpr_read_b32 v148, a56
v_accvgpr_read_b32 v149, a57
v_accvgpr_read_b32 v150, a58
v_accvgpr_read_b32 v151, a59
v_pk_mul_f32 v[144:145], v[144:145], v[196:197] op_sel_hi:[1,0]
v_pk_mul_f32 v[146:147], v[146:147], v[196:197] op_sel_hi:[1,0]
v_pk_mul_f32 v[148:149], v[148:149], v[196:197] op_sel_hi:[1,0]
v_pk_mul_f32 v[150:151], v[150:151], v[196:197] op_sel_hi:[1,0]
s_add_u32 s35, s6, 4096
s_add_u32 s36, s45, 12288
v_cvt_pk_bf16_f32 v184, v144, v145
v_cvt_pk_bf16_f32 v185, v146, v147
v_cvt_pk_bf16_f32 v186, v148, v149
v_cvt_pk_bf16_f32 v187, v150, v151
buffer_store_dwordx4 v[184:187], v255, s[16:19], s35 offen sc1
buffer_load_dwordx4 a[16:19], v249, s[16:19], s36 offen offset:0 sc1
buffer_load_dwordx4 a[20:23], v249, s[16:19], s36 offen offset:1024 sc1
v_accvgpr_read_b32 v152, a44
v_accvgpr_read_b32 v153, a45
v_accvgpr_read_b32 v154, a46
v_accvgpr_read_b32 v155, a47
v_accvgpr_read_b32 v156, a60
v_accvgpr_read_b32 v157, a61
v_accvgpr_read_b32 v158, a62
v_accvgpr_read_b32 v159, a63
v_pk_mul_f32 v[152:153], v[152:153], v[198:199] op_sel_hi:[1,0]
v_pk_mul_f32 v[154:155], v[154:155], v[198:199] op_sel_hi:[1,0]
v_pk_mul_f32 v[156:157], v[156:157], v[198:199] op_sel_hi:[1,0]
v_pk_mul_f32 v[158:159], v[158:159], v[198:199] op_sel_hi:[1,0]
s_add_u32 s35, s7, 4096
v_cvt_pk_bf16_f32 v188, v152, v153
v_cvt_pk_bf16_f32 v189, v154, v155
v_cvt_pk_bf16_f32 v190, v156, v157
v_cvt_pk_bf16_f32 v191, v158, v159
buffer_store_dwordx4 v[188:191], v255, s[16:19], s35 offen sc1
buffer_load_dwordx4 a[24:27], v249, s[16:19], s36 offen offset:2048 sc1
buffer_load_dwordx4 a[28:31], v249, s[16:19], s36 offen offset:3072 sc1
v_accvgpr_read_b32 v128, a64
v_accvgpr_read_b32 v129, a65
v_accvgpr_read_b32 v130, a66
v_accvgpr_read_b32 v131, a67
v_accvgpr_read_b32 v132, a80
v_accvgpr_read_b32 v133, a81
v_accvgpr_read_b32 v134, a82
v_accvgpr_read_b32 v135, a83
v_pk_mul_f32 v[128:129], v[128:129], v[192:193] op_sel_hi:[1,0]
v_pk_mul_f32 v[130:131], v[130:131], v[192:193] op_sel_hi:[1,0]
v_pk_mul_f32 v[132:133], v[132:133], v[192:193] op_sel_hi:[1,0]
v_pk_mul_f32 v[134:135], v[134:135], v[192:193] op_sel_hi:[1,0]
s_add_u32 s35, s4, 8192
s_add_u32 s36, s46, 0
v_cvt_pk_bf16_f32 v160, v128, v129
v_cvt_pk_bf16_f32 v161, v130, v131
v_cvt_pk_bf16_f32 v162, v132, v133
v_cvt_pk_bf16_f32 v163, v134, v135
buffer_store_dwordx4 v[160:163], v255, s[16:19], s35 offen sc1
buffer_load_dwordx4 a[32:35], v249, s[16:19], s36 offen offset:0 sc1
buffer_load_dwordx4 a[36:39], v249, s[16:19], s36 offen offset:1024 sc1
v_accvgpr_read_b32 v136, a68
v_accvgpr_read_b32 v137, a69
v_accvgpr_read_b32 v138, a70
v_accvgpr_read_b32 v139, a71
v_accvgpr_read_b32 v140, a84
v_accvgpr_read_b32 v141, a85
v_accvgpr_read_b32 v142, a86
v_accvgpr_read_b32 v143, a87
v_pk_mul_f32 v[136:137], v[136:137], v[194:195] op_sel_hi:[1,0]
v_pk_mul_f32 v[138:139], v[138:139], v[194:195] op_sel_hi:[1,0]
v_pk_mul_f32 v[140:141], v[140:141], v[194:195] op_sel_hi:[1,0]
v_pk_mul_f32 v[142:143], v[142:143], v[194:195] op_sel_hi:[1,0]
s_add_u32 s35, s5, 8192
v_cvt_pk_bf16_f32 v164, v136, v137
v_cvt_pk_bf16_f32 v165, v138, v139
v_cvt_pk_bf16_f32 v166, v140, v141
v_cvt_pk_bf16_f32 v167, v142, v143
s_waitcnt vmcnt(59)
buffer_store_dwordx4 v[164:167], v255, s[16:19], s35 offen sc1
buffer_load_dwordx4 a[40:43], v249, s[16:19], s36 offen offset:2048 sc1
buffer_load_dwordx4 a[44:47], v249, s[16:19], s36 offen offset:3072 sc1
v_accvgpr_read_b32 v144, a72
v_accvgpr_read_b32 v145, a73
v_accvgpr_read_b32 v146, a74
v_accvgpr_read_b32 v147, a75
v_accvgpr_read_b32 v148, a88
v_accvgpr_read_b32 v149, a89
v_accvgpr_read_b32 v150, a90
v_accvgpr_read_b32 v151, a91
v_pk_mul_f32 v[144:145], v[144:145], v[196:197] op_sel_hi:[1,0]
v_pk_mul_f32 v[146:147], v[146:147], v[196:197] op_sel_hi:[1,0]
v_pk_mul_f32 v[148:149], v[148:149], v[196:197] op_sel_hi:[1,0]
v_pk_mul_f32 v[150:151], v[150:151], v[196:197] op_sel_hi:[1,0]
s_add_u32 s35, s6, 8192
s_add_u32 s36, s46, 4096
v_cvt_pk_bf16_f32 v168, v144, v145
v_cvt_pk_bf16_f32 v169, v146, v147
v_cvt_pk_bf16_f32 v170, v148, v149
v_cvt_pk_bf16_f32 v171, v150, v151
buffer_store_dwordx4 v[168:171], v255, s[16:19], s35 offen sc1
s_waitcnt vmcnt(59)
buffer_load_dwordx4 a[48:51], v249, s[16:19], s36 offen offset:0 sc1
buffer_load_dwordx4 a[52:55], v249, s[16:19], s36 offen offset:1024 sc1
v_accvgpr_read_b32 v152, a76
v_accvgpr_read_b32 v153, a77
v_accvgpr_read_b32 v154, a78
v_accvgpr_read_b32 v155, a79
v_accvgpr_read_b32 v156, a92
v_accvgpr_read_b32 v157, a93
v_accvgpr_read_b32 v158, a94
v_accvgpr_read_b32 v159, a95
v_pk_mul_f32 v[152:153], v[152:153], v[198:199] op_sel_hi:[1,0]
v_pk_mul_f32 v[154:155], v[154:155], v[198:199] op_sel_hi:[1,0]
v_pk_mul_f32 v[156:157], v[156:157], v[198:199] op_sel_hi:[1,0]
v_pk_mul_f32 v[158:159], v[158:159], v[198:199] op_sel_hi:[1,0]
s_add_u32 s35, s7, 8192
v_cvt_pk_bf16_f32 v172, v152, v153
v_cvt_pk_bf16_f32 v173, v154, v155
v_cvt_pk_bf16_f32 v174, v156, v157
v_cvt_pk_bf16_f32 v175, v158, v159
buffer_store_dwordx4 v[172:175], v255, s[16:19], s35 offen sc1
buffer_load_dwordx4 a[56:59], v249, s[16:19], s36 offen offset:2048 sc1
s_waitcnt vmcnt(59)
buffer_load_dwordx4 a[60:63], v249, s[16:19], s36 offen offset:3072 sc1
v_accvgpr_read_b32 v128, a96
v_accvgpr_read_b32 v129, a97
v_accvgpr_read_b32 v130, a98
v_accvgpr_read_b32 v131, a99
v_accvgpr_read_b32 v132, a112
v_accvgpr_read_b32 v133, a113
v_accvgpr_read_b32 v134, a114
v_accvgpr_read_b32 v135, a115
v_pk_mul_f32 v[128:129], v[128:129], v[192:193] op_sel_hi:[1,0]
v_pk_mul_f32 v[130:131], v[130:131], v[192:193] op_sel_hi:[1,0]
v_pk_mul_f32 v[132:133], v[132:133], v[192:193] op_sel_hi:[1,0]
v_pk_mul_f32 v[134:135], v[134:135], v[192:193] op_sel_hi:[1,0]
s_add_u32 s35, s4, 12288
s_add_u32 s36, s46, 8192
v_cvt_pk_bf16_f32 v176, v128, v129
v_cvt_pk_bf16_f32 v177, v130, v131
v_cvt_pk_bf16_f32 v178, v132, v133
v_cvt_pk_bf16_f32 v179, v134, v135
buffer_store_dwordx4 v[176:179], v255, s[16:19], s35 offen sc1
buffer_load_dwordx4 a[64:67], v249, s[16:19], s36 offen offset:0 sc1
buffer_load_dwordx4 a[68:71], v249, s[16:19], s36 offen offset:1024 sc1
v_accvgpr_read_b32 v136, a100
v_accvgpr_read_b32 v137, a101
v_accvgpr_read_b32 v138, a102
v_accvgpr_read_b32 v139, a103
v_accvgpr_read_b32 v140, a116
v_accvgpr_read_b32 v141, a117
v_accvgpr_read_b32 v142, a118
v_accvgpr_read_b32 v143, a119
v_pk_mul_f32 v[136:137], v[136:137], v[194:195] op_sel_hi:[1,0]
v_pk_mul_f32 v[138:139], v[138:139], v[194:195] op_sel_hi:[1,0]
v_pk_mul_f32 v[140:141], v[140:141], v[194:195] op_sel_hi:[1,0]
v_pk_mul_f32 v[142:143], v[142:143], v[194:195] op_sel_hi:[1,0]
s_add_u32 s35, s5, 12288
v_cvt_pk_bf16_f32 v180, v136, v137
v_cvt_pk_bf16_f32 v181, v138, v139
v_cvt_pk_bf16_f32 v182, v140, v141
v_cvt_pk_bf16_f32 v183, v142, v143
s_waitcnt vmcnt(59)
buffer_store_dwordx4 v[180:183], v255, s[16:19], s35 offen sc1
buffer_load_dwordx4 a[72:75], v249, s[16:19], s36 offen offset:2048 sc1
buffer_load_dwordx4 a[76:79], v249, s[16:19], s36 offen offset:3072 sc1
v_accvgpr_read_b32 v144, a104
v_accvgpr_read_b32 v145, a105
v_accvgpr_read_b32 v146, a106
v_accvgpr_read_b32 v147, a107
v_accvgpr_read_b32 v148, a120
v_accvgpr_read_b32 v149, a121
v_accvgpr_read_b32 v150, a122
v_accvgpr_read_b32 v151, a123
v_pk_mul_f32 v[144:145], v[144:145], v[196:197] op_sel_hi:[1,0]
v_pk_mul_f32 v[146:147], v[146:147], v[196:197] op_sel_hi:[1,0]
v_pk_mul_f32 v[148:149], v[148:149], v[196:197] op_sel_hi:[1,0]
v_pk_mul_f32 v[150:151], v[150:151], v[196:197] op_sel_hi:[1,0]
s_add_u32 s35, s6, 12288
s_add_u32 s36, s46, 12288
v_cvt_pk_bf16_f32 v184, v144, v145
v_cvt_pk_bf16_f32 v185, v146, v147
v_cvt_pk_bf16_f32 v186, v148, v149
v_cvt_pk_bf16_f32 v187, v150, v151
buffer_store_dwordx4 v[184:187], v255, s[16:19], s35 offen sc1
s_waitcnt vmcnt(59)
buffer_load_dwordx4 a[80:83], v249, s[16:19], s36 offen offset:0 sc1
buffer_load_dwordx4 a[84:87], v249, s[16:19], s36 offen offset:1024 sc1
v_accvgpr_read_b32 v152, a108
v_accvgpr_read_b32 v153, a109
v_accvgpr_read_b32 v154, a110
v_accvgpr_read_b32 v155, a111
v_accvgpr_read_b32 v156, a124
v_accvgpr_read_b32 v157, a125
v_accvgpr_read_b32 v158, a126
v_accvgpr_read_b32 v159, a127
v_pk_mul_f32 v[152:153], v[152:153], v[198:199] op_sel_hi:[1,0]
v_pk_mul_f32 v[154:155], v[154:155], v[198:199] op_sel_hi:[1,0]
v_pk_mul_f32 v[156:157], v[156:157], v[198:199] op_sel_hi:[1,0]
v_pk_mul_f32 v[158:159], v[158:159], v[198:199] op_sel_hi:[1,0]
s_add_u32 s35, s7, 12288
v_cvt_pk_bf16_f32 v188, v152, v153
v_cvt_pk_bf16_f32 v189, v154, v155
v_cvt_pk_bf16_f32 v190, v156, v157
v_cvt_pk_bf16_f32 v191, v158, v159
buffer_store_dwordx4 v[188:191], v255, s[16:19], s35 offen sc1
buffer_load_dwordx4 a[88:91], v249, s[16:19], s36 offen offset:2048 sc1
s_waitcnt vmcnt(59)
buffer_load_dwordx4 a[92:95], v249, s[16:19], s36 offen offset:3072 sc1
s_buffer_load_dwordx8 s[48:55], s[16:19], s25 glc
s_add_u32 s36, s44, 8192
buffer_load_dwordx4 v[160:163], v249, s[16:19], s36 offen offset:0 sc1
buffer_load_dwordx4 v[164:167], v249, s[16:19], s36 offen offset:1024 sc1
buffer_load_dwordx4 v[168:171], v249, s[16:19], s36 offen offset:2048 sc1
s_waitcnt vmcnt(59)
buffer_load_dwordx4 v[172:175], v249, s[16:19], s36 offen offset:3072 sc1
s_add_u32 s36, s44, 12288
buffer_load_dwordx4 v[176:179], v249, s[16:19], s36 offen offset:0 sc1
buffer_load_dwordx4 v[180:183], v249, s[16:19], s36 offen offset:1024 sc1
buffer_load_dwordx4 v[184:187], v249, s[16:19], s36 offen offset:2048 sc1
s_waitcnt vmcnt(59)
buffer_load_dwordx4 v[188:191], v249, s[16:19], s36 offen offset:3072 sc1
v_add_u32 v224, s39, v255
v_add_u32 v224, 65536, v224
v_lshl_add_u32 v225, s26, 1, v255
s_sub_u32 s34, s27, 1
s_and_b32 s34, s34, 3
s_lshl_b32 s34, s34, 14
s_add_u32 s34, s34, 65536
v_add_u32 v226, s34, v255
s_sub_u32 s34, s27, 2
s_and_b32 s34, s34, 3
s_lshl_b32 s34, s34, 14
s_add_u32 s34, s34, 69632
v_add_u32 v227, s34, v255
s_sub_u32 s34, s27, 3
s_and_b32 s34, s34, 3
s_lshl_b32 s34, s34, 14
s_add_u32 s34, s34, 73728
v_add_u32 v228, s34, v255
v_lshrrev_b32 v232, 4, v248
v_lshlrev_b32 v232, 4, v232
v_add_u32 v230, 157696, v232
v_lshlrev_b32 v232, 1, v232
v_add_u32 v229, 156672, v232
v_mov_b32 v232, 1
v_mov_b32 v233, 0
s_mov_b64 exec, 0
s_cmp_eq_u32 s27, 0
s_cbranch_scc1 Lpad23
s_cmp_eq_u32 s27, 1
s_cbranch_scc1 Lpad24
s_cmp_eq_u32 s27, 2
s_cbranch_scc1 Lpad25
s_branch Lwalk2
Lwalk2:
s_mov_b64 exec, -1
s_waitcnt vmcnt(10)
s_mov_b64 exec, 1
buffer_store_dword v232, v233, s[16:19], s30 offen sc1
s_mov_b64 exec, -1
s_add_u32 s36, s47, 0
buffer_load_dwordx4 a[96:99], v249, s[16:19], s36 offen offset:0 sc1
buffer_load_dwordx4 a[100:103], v249, s[16:19], s36 offen offset:1024 sc1
buffer_load_dwordx4 a[104:107], v249, s[16:19], s36 offen offset:2048 sc1
buffer_load_dwordx4 a[108:111], v249, s[16:19], s36 offen offset:3072 sc1
s_add_u32 s36, s47, 4096
buffer_load_dwordx4 a[112:115], v249, s[16:19], s36 offen offset:0 sc1
buffer_load_dwordx4 a[116:119], v249, s[16:19], s36 offen offset:1024 sc1
buffer_load_dwordx4 a[120:123], v249, s[16:19], s36 offen offset:2048 sc1
buffer_load_dwordx4 a[124:127], v249, s[16:19], s36 offen offset:3072 sc1
s_waitcnt lgkmcnt(0)
s_cmp_lg_u32 s48, -1
s_cbranch_scc0 Lm_poll0
Lm_ok0:
s_add_u32 s37, s40, 0
buffer_load_dwordx4 v[96:99], v250, s[16:19], s37 offen offset:0 sc1
buffer_load_dwordx4 v[100:103], v250, s[16:19], s37 offen offset:1024 sc1
buffer_load_dwordx4 v[104:107], v250, s[16:19], s37 offen offset:2048 sc1
buffer_load_dwordx4 v[108:111], v250, s[16:19], s37 offen offset:3072 sc1
s_add_u32 s37, s40, 4096
buffer_load_dwordx4 v[112:115], v250, s[16:19], s37 offen offset:0 sc1
buffer_load_dwordx4 v[116:119], v250, s[16:19], s37 offen offset:1024 sc1
buffer_load_dwordx4 v[120:123], v250, s[16:19], s37 offen offset:2048 sc1
buffer_load_dwordx4 v[124:127], v250, s[16:19], s37 offen offset:3072 sc1
s_add_u32 s37, s40, 8192
buffer_load_dwordx4 v[128:131], v250, s[16:19], s37 offen offset:0 sc1
buffer_load_dwordx4 v[132:135], v250, s[16:19], s37 offen offset:1024 sc1
buffer_load_dwordx4 v[136:139], v250, s[16:19], s37 offen offset:2048 sc1
buffer_load_dwordx4 v[140:143], v250, s[16:19], s37 offen offset:3072 sc1
s_add_u32 s37, s40, 12288
buffer_load_dwordx4 v[144:147], v250, s[16:19], s37 offen offset:0 sc1
buffer_load_dwordx4 v[148:151], v250, s[16:19], s37 offen offset:1024 sc1
buffer_load_dwordx4 v[152:155], v250, s[16:19], s37 offen offset:2048 sc1
buffer_load_dwordx4 v[156:159], v250, s[16:19], s37 offen offset:3072 sc1
s_waitcnt vmcnt(12)
s_waitcnt lgkmcnt(0)
s_cmp_lg_u32 s49, -1
s_cbranch_scc0 Lm_poll1
Lm_ok1:
s_cmp_lg_u32 s50, -1
s_cbranch_scc0 Lm_ap1
Lm_apr1:
s_add_u32 s37, s41, 0
v_mfma_f32_16x16x32_bf16 a[192:195], a[128:131], v[96:99], 0
v_mfma_f32_16x16x32_bf16 a[196:199], a[132:135], v[96:99], 0
v_mfma_f32_16x16x32_bf16 a[200:203], a[136:139], v[96:99], 0
v_mfma_f32_16x16x32_bf16 a[204:207], a[140:143], v[96:99], 0
buffer_load_dwordx4 v[96:99], v250, s[16:19], s37 offen offset:0 sc1
v_mfma_f32_16x16x32_bf16 a[208:211], a[128:131], v[100:103], 0
v_mfma_f32_16x16x32_bf16 a[212:215], a[132:135], v[100:103], 0
v_mfma_f32_16x16x32_bf16 a[216:219], a[136:139], v[100:103], 0
v_mfma_f32_16x16x32_bf16 a[220:223], a[140:143], v[100:103], 0
buffer_load_dwordx4 v[100:103], v250, s[16:19], s37 offen offset:1024 sc1
v_mfma_f32_16x16x32_bf16 a[224:227], a[128:131], v[104:107], 0
v_mfma_f32_16x16x32_bf16 a[228:231], a[132:135], v[104:107], 0
v_mfma_f32_16x16x32_bf16 a[232:235], a[136:139], v[104:107], 0
v_mfma_f32_16x16x32_bf16 a[236:239], a[140:143], v[104:107], 0
buffer_load_dwordx4 v[104:107], v250, s[16:19], s37 offen offset:2048 sc1
v_mfma_f32_16x16x32_bf16 v[192:195], a[128:131], v[108:111], 0
v_mfma_f32_16x16x32_bf16 v[196:199], a[132:135], v[108:111], 0
v_mfma_f32_16x16x32_bf16 v[200:203], a[136:139], v[108:111], 0
v_mfma_f32_16x16x32_bf16 v[204:207], a[140:143], v[108:111], 0
buffer_load_dwordx4 v[108:111], v250, s[16:19], s37 offen offset:3072 sc1
s_waitcnt vmcnt(12)
s_add_u32 s37, s41, 4096
v_mfma_f32_16x16x32_bf16 a[192:195], a[144:147], v[112:115], a[192:195]
ds_read_b128 a[128:131], v224 offset:0
ds_read_b128 a[132:135], v224 offset:1024
v_mfma_f32_16x16x32_bf16 a[196:199], a[148:151], v[112:115], a[196:199]
ds_read_b128 a[136:139], v224 offset:2048
ds_read_b128 a[140:143], v224 offset:3072
v_mfma_f32_16x16x32_bf16 a[200:203], a[152:155], v[112:115], a[200:203]
v_mfma_f32_16x16x32_bf16 a[204:207], a[156:159], v[112:115], a[204:207]
buffer_load_dwordx4 v[112:115], v250, s[16:19], s37 offen offset:0 sc1
v_mfma_f32_16x16x32_bf16 a[208:211], a[144:147], v[116:119], a[208:211]
v_mfma_f32_16x16x32_bf16 a[212:215], a[148:151], v[116:119], a[212:215]
v_mfma_f32_16x16x32_bf16 a[216:219], a[152:155], v[116:119], a[216:219]
v_mfma_f32_16x16x32_bf16 a[220:223], a[156:159], v[116:119], a[220:223]
buffer_load_dwordx4 v[116:119], v250, s[16:19], s37 offen offset:1024 sc1
v_mfma_f32_16x16x32_bf16 a[224:227], a[144:147], v[120:123], a[224:227]
v_mfma_f32_16x16x32_bf16 a[228:231], a[148:151], v[120:123], a[228:231]
v_mfma_f32_16x16x32_bf16 a[232:235], a[152:155], v[120:123], a[232:235]
v_mfma_f32_16x16x32_bf16 a[236:239], a[156:159], v[120:123], a[236:239]
buffer_load_dwordx4 v[120:123], v250, s[16:19], s37 offen offset:2048 sc1
v_mfma_f32_16x16x32_bf16 v[192:195], a[144:147], v[124:127], v[192:195]
v_mfma_f32_16x16x32_bf16 v[196:199], a[148:151], v[124:127], v[196:199]
v_mfma_f32_16x16x32_bf16 v[200:203], a[152:155], v[124:127], v[200:203]
v_mfma_f32_16x16x32_bf16 v[204:207], a[156:159], v[124:127], v[204:207]
buffer_load_dwordx4 v[124:127], v250, s[16:19], s37 offen offset:3072 sc1
s_waitcnt vmcnt(12)
s_add_u32 s37, s41, 8192
v_mfma_f32_16x16x32_bf16 a[192:195], a[160:163], v[128:131], a[192:195]
ds_read_b128 a[144:147], v224 offset:4096
ds_read_b128 a[148:151], v224 offset:5120
Lpad22:
s_cbranch_execz Lwalk1
v_mfma_f32_16x16x32_bf16 a[196:199], a[164:167], v[128:131], a[196:199]
ds_read_b128 a[152:155], v224 offset:6144
ds_read_b128 a[156:159], v224 offset:7168
v_mfma_f32_16x16x32_bf16 a[200:203], a[168:171], v[128:131], a[200:203]
v_mfma_f32_16x16x32_bf16 a[204:207], a[172:175], v[128:131], a[204:207]
buffer_load_dwordx4 v[128:131], v250, s[16:19], s37 offen offset:0 sc1
v_mfma_f32_16x16x32_bf16 a[208:211], a[160:163], v[132:135], a[208:211]
v_mfma_f32_16x16x32_bf16 a[212:215], a[164:167], v[132:135], a[212:215]
v_mfma_f32_16x16x32_bf16 a[216:219], a[168:171], v[132:135], a[216:219]
v_mfma_f32_16x16x32_bf16 a[220:223], a[172:175], v[132:135], a[220:223]
buffer_load_dwordx4 v[132:135], v250, s[16:19], s37 offen offset:1024 sc1
v_mfma_f32_16x16x32_bf16 a[224:227], a[160:163], v[136:139], a[224:227]
v_mfma_f32_16x16x32_bf16 a[228:231], a[164:167], v[136:139], a[228:231]
v_mfma_f32_16x16x32_bf16 a[232:235], a[168:171], v[136:139], a[232:235]
v_mfma_f32_16x16x32_bf16 a[236:239], a[172:175], v[136:139], a[236:239]
buffer_load_dwordx4 v[136:139], v250, s[16:19], s37 offen offset:2048 sc1
v_mfma_f32_16x16x32_bf16 v[192:195], a[160:163], v[140:143], v[192:195]
v_mfma_f32_16x16x32_bf16 v[196:199], a[164:167], v[140:143], v[196:199]
v_mfma_f32_16x16x32_bf16 v[200:203], a[168:171], v[140:143], v[200:203]
v_mfma_f32_16x16x32_bf16 v[204:207], a[172:175], v[140:143], v[204:207]
buffer_load_dwordx4 v[140:143], v250, s[16:19], s37 offen offset:3072 sc1
s_waitcnt vmcnt(12)
s_add_u32 s37, s41, 12288
v_mfma_f32_16x16x32_bf16 a[192:195], a[176:179], v[144:147], a[192:195]
ds_read_b128 a[160:163], v224 offset:8192
ds_read_b128 a[164:167], v224 offset:9216
v_mfma_f32_16x16x32_bf16 a[196:199], a[180:183], v[144:147], a[196:199]
ds_read_b128 a[168:171], v224 offset:10240
ds_read_b128 a[172:175], v224 offset:11264
v_mfma_f32_16x16x32_bf16 a[200:203], a[184:187], v[144:147], a[200:203]
v_mfma_f32_16x16x32_bf16 a[204:207], a[188:191], v[144:147], a[204:207]
buffer_load_dwordx4 v[144:147], v250, s[16:19], s37 offen offset:0 sc1
v_mfma_f32_16x16x32_bf16 a[208:211], a[176:179], v[148:151], a[208:211]
v_mfma_f32_16x16x32_bf16 a[212:215], a[180:183], v[148:151], a[212:215]
v_mfma_f32_16x16x32_bf16 a[216:219], a[184:187], v[148:151], a[216:219]
v_mfma_f32_16x16x32_bf16 a[220:223], a[188:191], v[148:151], a[220:223]
buffer_load_dwordx4 v[148:151], v250, s[16:19], s37 offen offset:1024 sc1
v_mfma_f32_16x16x32_bf16 a[224:227], a[176:179], v[152:155], a[224:227]
v_mfma_f32_16x16x32_bf16 a[228:231], a[180:183], v[152:155], a[228:231]
v_mfma_f32_16x16x32_bf16 a[232:235], a[184:187], v[152:155], a[232:235]
v_mfma_f32_16x16x32_bf16 a[236:239], a[188:191], v[152:155], a[236:239]
buffer_load_dwordx4 v[152:155], v250, s[16:19], s37 offen offset:2048 sc1
v_mfma_f32_16x16x32_bf16 v[192:195], a[176:179], v[156:159], v[192:195]
v_mfma_f32_16x16x32_bf16 v[196:199], a[180:183], v[156:159], v[196:199]
v_mfma_f32_16x16x32_bf16 v[200:203], a[184:187], v[156:159], v[200:203]
v_mfma_f32_16x16x32_bf16 v[204:207], a[188:191], v[156:159], v[204:207]
buffer_load_dwordx4 v[156:159], v250, s[16:19], s37 offen offset:3072 sc1
s_waitcnt vmcnt(12)
s_waitcnt lgkmcnt(0)
s_cmp_lg_u32 s50, -1
s_cbranch_scc0 Lm_poll2
Lm_ok2:
s_cmp_lg_u32 s51, -1
s_cbranch_scc0 Lm_ap2
Lm_apr2:
s_add_u32 s37, s42, 0
v_mfma_f32_16x16x32_bf16 a[192:195], a[128:131], v[96:99], a[192:195]
ds_read_b128 a[176:179], v224 offset:12288
ds_read_b128 a[180:183], v224 offset:13312
v_mfma_f32_16x16x32_bf16 a[196:199], a[132:135], v[96:99], a[196:199]
ds_read_b128 a[184:187], v224 offset:14336
ds_read_b128 a[188:191], v224 offset:15360
v_mfma_f32_16x16x32_bf16 a[200:203], a[136:139], v[96:99], a[200:203]
v_mfma_f32_16x16x32_bf16 a[204:207], a[140:143], v[96:99], a[204:207]
buffer_load_dwordx4 v[96:99], v250, s[16:19], s37 offen offset:0 sc1
v_mfma_f32_16x16x32_bf16 a[208:211], a[128:131], v[100:103], a[208:211]
v_mfma_f32_16x16x32_bf16 a[212:215], a[132:135], v[100:103], a[212:215]
v_mfma_f32_16x16x32_bf16 a[216:219], a[136:139], v[100:103], a[216:219]
v_mfma_f32_16x16x32_bf16 a[220:223], a[140:143], v[100:103], a[220:223]
buffer_load_dwordx4 v[100:103], v250, s[16:19], s37 offen offset:1024 sc1
v_mfma_f32_16x16x32_bf16 a[224:227], a[128:131], v[104:107], a[224:227]
v_mfma_f32_16x16x32_bf16 a[228:231], a[132:135], v[104:107], a[228:231]
v_mfma_f32_16x16x32_bf16 a[232:235], a[136:139], v[104:107], a[232:235]
v_mfma_f32_16x16x32_bf16 a[236:239], a[140:143], v[104:107], a[236:239]
buffer_load_dwordx4 v[104:107], v250, s[16:19], s37 offen offset:2048 sc1
v_mfma_f32_16x16x32_bf16 v[192:195], a[128:131], v[108:111], v[192:195]
v_mfma_f32_16x16x32_bf16 v[196:199], a[132:135], v[108:111], v[196:199]
v_mfma_f32_16x16x32_bf16 v[200:203], a[136:139], v[108:111], v[200:203]
v_mfma_f32_16x16x32_bf16 v[204:207], a[140:143], v[108:111], v[204:207]
buffer_load_dwordx4 v[108:111], v250, s[16:19], s37 offen offset:3072 sc1
s_waitcnt vmcnt(12)
s_add_u32 s37, s42, 4096
v_mfma_f32_16x16x32_bf16 a[192:195], a[144:147], v[112:115], a[192:195]
ds_read_b128 a[128:131], v225 offset:0
ds_read_b128 a[132:135], v225 offset:1024
v_mfma_f32_16x16x32_bf16 a[196:199], a[148:151], v[112:115], a[196:199]
ds_read_b128 a[136:139], v225 offset:2048
ds_read_b128 a[140:143], v225 offset:3072
v_mfma_f32_16x16x32_bf16 a[200:203], a[152:155], v[112:115], a[200:203]
v_mfma_f32_16x16x32_bf16 a[204:207], a[156:159], v[112:115], a[204:207]
buffer_load_dwordx4 v[112:115], v250, s[16:19], s37 offen offset:0 sc1
v_mfma_f32_16x16x32_bf16 a[208:211], a[144:147], v[116:119], a[208:211]
v_mfma_f32_16x16x32_bf16 a[212:215], a[148:151], v[116:119], a[212:215]
v_mfma_f32_16x16x32_bf16 a[216:219], a[152:155], v[116:119], a[216:219]
v_mfma_f32_16x16x32_bf16 a[220:223], a[156:159], v[116:119], a[220:223]
buffer_load_dwordx4 v[116:119], v250, s[16:19], s37 offen offset:1024 sc1
v_mfma_f32_16x16x32_bf16 a[224:227], a[144:147], v[120:123], a[224:227]
v_mfma_f32_16x16x32_bf16 a[228:231], a[148:151], v[120:123], a[228:231]
v_mfma_f32_16x16x32_bf16 a[232:235], a[152:155], v[120:123], a[232:235]
v_mfma_f32_16x16x32_bf16 a[236:239], a[156:159], v[120:123], a[236:239]
buffer_load_dwordx4 v[120:123], v250, s[16:19], s37 offen offset:2048 sc1
v_mfma_f32_16x16x32_bf16 v[192:195], a[144:147], v[124:127], v[192:195]
v_mfma_f32_16x16x32_bf16 v[196:199], a[148:151], v[124:127], v[196:199]
v_mfma_f32_16x16x32_bf16 v[200:203], a[152:155], v[124:127], v[200:203]
v_mfma_f32_16x16x32_bf16 v[204:207], a[156:159], v[124:127], v[204:207]
buffer_load_dwordx4 v[124:127], v250, s[16:19], s37 offen offset:3072 sc1
s_waitcnt vmcnt(12)
s_add_u32 s37, s42, 8192
v_mfma_f32_16x16x32_bf16 a[192:195], a[160:163], v[128:131], a[192:195]
ds_read_b128 a[144:147], v225 offset:16384
ds_read_b128 a[148:151], v225 offset:17408
v_mfma_f32_16x16x32_bf16 a[196:199], a[164:167], v[128:131], a[196:199]
ds_read_b128 a[152:155], v225 offset:18432
ds_read_b128 a[156:159], v225 offset:19456
v_mfma_f32_16x16x32_bf16 a[200:203], a[168:171], v[128:131], a[200:203]
v_mfma_f32_16x16x32_bf16 a[204:207], a[172:175], v[128:131], a[204:207]
buffer_load_dwordx4 v[128:131], v250, s[16:19], s37 offen offset:0 sc1
v_mfma_f32_16x16x32_bf16 a[208:211], a[160:163], v[132:135], a[208:211]
v_mfma_f32_16x16x32_bf16 a[212:215], a[164:167], v[132:135], a[212:215]
v_mfma_f32_16x16x32_bf16 a[216:219], a[168:171], v[132:135], a[216:219]
v_mfma_f32_16x16x32_bf16 a[220:223], a[172:175], v[132:135], a[220:223]
buffer_load_dwordx4 v[132:135], v250, s[16:19], s37 offen offset:1024 sc1
v_mfma_f32_16x16x32_bf16 a[224:227], a[160:163], v[136:139], a[224:227]
v_mfma_f32_16x16x32_bf16 a[228:231], a[164:167], v[136:139], a[228:231]
v_mfma_f32_16x16x32_bf16 a[232:235], a[168:171], v[136:139], a[232:235]
v_mfma_f32_16x16x32_bf16 a[236:239], a[172:175], v[136:139], a[236:239]
buffer_load_dwordx4 v[136:139], v250, s[16:19], s37 offen offset:2048 sc1
v_mfma_f32_16x16x32_bf16 v[192:195], a[160:163], v[140:143], v[192:195]
v_mfma_f32_16x16x32_bf16 v[196:199], a[164:167], v[140:143], v[196:199]
v_mfma_f32_16x16x32_bf16 v[200:203], a[168:171], v[140:143], v[200:203]
v_mfma_f32_16x16x32_bf16 v[204:207], a[172:175], v[140:143], v[204:207]
buffer_load_dwordx4 v[140:143], v250, s[16:19], s37 offen offset:3072 sc1
s_waitcnt vmcnt(12) lgkmcnt(0)
s_add_u32 s37, s42, 12288
v_mfma_f32_16x16x32_bf16 a[192:195], a[176:179], v[144:147], a[192:195]
ds_read_b128 a[160:163], v225 offset:32768
ds_read_b128 a[164:167], v225 offset:33792
v_mfma_f32_16x16x32_bf16 a[196:199], a[180:183], v[144:147], a[196:199]
ds_read_b128 a[168:171], v225 offset:34816
ds_read_b128 a[172:175], v225 offset:35840
v_mfma_f32_16x16x32_bf16 a[200:203], a[184:187], v[144:147], a[200:203]
v_mfma_f32_16x16x32_bf16 a[204:207], a[188:191], v[144:147], a[204:207]
buffer_load_dwordx4 v[144:147], v250, s[16:19], s37 offen offset:0 sc1
v_mfma_f32_16x16x32_bf16 a[208:211], a[176:179], v[148:151], a[208:211]
v_mfma_f32_16x16x32_bf16 a[212:215], a[180:183], v[148:151], a[212:215]
v_mfma_f32_16x16x32_bf16 a[216:219], a[184:187], v[148:151], a[216:219]
v_mfma_f32_16x16x32_bf16 a[220:223], a[188:191], v[148:151], a[220:223]
buffer_load_dwordx4 v[148:151], v250, s[16:19], s37 offen offset:1024 sc1
v_mfma_f32_16x16x32_bf16 a[224:227], a[176:179], v[152:155], a[224:227]
v_mfma_f32_16x16x32_bf16 a[228:231], a[180:183], v[152:155], a[228:231]
v_mfma_f32_16x16x32_bf16 a[232:235], a[184:187], v[152:155], a[232:235]
v_mfma_f32_16x16x32_bf16 a[236:239], a[188:191], v[152:155], a[236:239]
buffer_load_dwordx4 v[152:155], v250, s[16:19], s37 offen offset:2048 sc1
v_mfma_f32_16x16x32_bf16 v[192:195], a[176:179], v[156:159], v[192:195]
v_mfma_f32_16x16x32_bf16 v[196:199], a[180:183], v[156:159], v[196:199]
v_mfma_f32_16x16x32_bf16 v[200:203], a[184:187], v[156:159], v[200:203]
v_mfma_f32_16x16x32_bf16 v[204:207], a[188:191], v[156:159], v[204:207]
buffer_load_dwordx4 v[156:159], v250, s[16:19], s37 offen offset:3072 sc1
s_waitcnt vmcnt(12)
s_waitcnt lgkmcnt(0)
s_cmp_lg_u32 s51, -1
s_cbranch_scc0 Lm_poll3
Lm_ok3:
s_cmp_lg_u32 s52, -1
s_cbranch_scc0 Lm_ap3
Lm_apr3:
s_add_u32 s37, s43, 0
v_mfma_f32_16x16x32_bf16 a[192:195], a[128:131], v[96:99], a[192:195]
ds_read_b128 a[176:179], v225 offset:49152
ds_read_b128 a[180:183], v225 offset:50176
v_mfma_f32_16x16x32_bf16 a[196:199], a[132:135], v[96:99], a[196:199]
ds_read_b128 a[184:187], v225 offset:51200
ds_read_b128 a[188:191], v225 offset:52224
v_mfma_f32_16x16x32_bf16 a[200:203], a[136:139], v[96:99], a[200:203]
v_mfma_f32_16x16x32_bf16 a[204:207], a[140:143], v[96:99], a[204:207]
buffer_load_dwordx4 v[96:99], v250, s[16:19], s37 offen offset:0 sc1
v_mfma_f32_16x16x32_bf16 a[208:211], a[128:131], v[100:103], a[208:211]
v_mfma_f32_16x16x32_bf16 a[212:215], a[132:135], v[100:103], a[212:215]
v_mfma_f32_16x16x32_bf16 a[216:219], a[136:139], v[100:103], a[216:219]
v_mfma_f32_16x16x32_bf16 a[220:223], a[140:143], v[100:103], a[220:223]
buffer_load_dwordx4 v[100:103], v250, s[16:19], s37 offen offset:1024 sc1
v_mfma_f32_16x16x32_bf16 a[224:227], a[128:131], v[104:107], a[224:227]
v_mfma_f32_16x16x32_bf16 a[228:231], a[132:135], v[104:107], a[228:231]
v_mfma_f32_16x16x32_bf16 a[232:235], a[136:139], v[104:107], a[232:235]
v_mfma_f32_16x16x32_bf16 a[236:239], a[140:143], v[104:107], a[236:239]
buffer_load_dwordx4 v[104:107], v250, s[16:19], s37 offen offset:2048 sc1
v_mfma_f32_16x16x32_bf16 v[192:195], a[128:131], v[108:111], v[192:195]
v_mfma_f32_16x16x32_bf16 v[196:199], a[132:135], v[108:111], v[196:199]
v_mfma_f32_16x16x32_bf16 v[200:203], a[136:139], v[108:111], v[200:203]
v_mfma_f32_16x16x32_bf16 v[204:207], a[140:143], v[108:111], v[204:207]
buffer_load_dwordx4 v[108:111], v250, s[16:19], s37 offen offset:3072 sc1
s_waitcnt vmcnt(12)
s_add_u32 s37, s43, 4096
v_mfma_f32_16x16x32_bf16 a[192:195], a[144:147], v[112:115], a[192:195]
v_mfma_f32_16x16x32_bf16 a[196:199], a[148:151], v[112:115], a[196:199]
v_mfma_f32_16x16x32_bf16 a[200:203], a[152:155], v[112:115], a[200:203]
v_mfma_f32_16x16x32_bf16 a[204:207], a[156:159], v[112:115], a[204:207]
buffer_load_dwordx4 v[112:115], v250, s[16:19], s37 offen offset:0 sc1
v_mfma_f32_16x16x32_bf16 a[208:211], a[144:147], v[116:119], a[208:211]
v_mfma_f32_16x16x32_bf16 a[212:215], a[148:151], v[116:119], a[212:215]
v_mfma_f32_16x16x32_bf16 a[216:219], a[152:155], v[116:119], a[216:219]
v_mfma_f32_16x16x32_bf16 a[220:223], a[156:159], v[116:119], a[220:223]
buffer_load_dwordx4 v[116:119], v250, s[16:19], s37 offen offset:1024 sc1
v_mfma_f32_16x16x32_bf16 a[224:227], a[144:147], v[120:123], a[224:227]
v_mfma_f32_16x16x32_bf16 a[228:231], a[148:151], v[120:123], a[228:231]
v_mfma_f32_16x16x32_bf16 a[232:235], a[152:155], v[120:123], a[232:235]
v_mfma_f32_16x16x32_bf16 a[236:239], a[156:159], v[120:123], a[236:239]
buffer_load_dwordx4 v[120:123], v250, s[16:19], s37 offen offset:2048 sc1
v_mfma_f32_16x16x32_bf16 v[192:195], a[144:147], v[124:127], v[192:195]
v_mfma_f32_16x16x32_bf16 v[196:199], a[148:151], v[124:127], v[196:199]
v_mfma_f32_16x16x32_bf16 v[200:203], a[152:155], v[124:127], v[200:203]
v_mfma_f32_16x16x32_bf16 v[204:207], a[156:159], v[124:127], v[204:207]
buffer_load_dwordx4 v[124:127], v250, s[16:19], s37 offen offset:3072 sc1
s_waitcnt vmcnt(12)
s_add_u32 s37, s43, 8192
v_mfma_f32_16x16x32_bf16 a[192:195], a[160:163], v[128:131], a[192:195]
v_mfma_f32_16x16x32_bf16 a[196:199], a[164:167], v[128:131], a[196:199]
v_mfma_f32_16x16x32_bf16 a[200:203], a[168:171], v[128:131], a[200:203]
v_mfma_f32_16x16x32_bf16 a[204:207], a[172:175], v[128:131], a[204:207]
buffer_load_dwordx4 v[128:131], v250, s[16:19], s37 offen offset:0 sc1
v_mfma_f32_16x16x32_bf16 a[208:211], a[160:163], v[132:135], a[208:211]
v_mfma_f32_16x16x32_bf16 a[212:215], a[164:167], v[132:135], a[212:215]
v_mfma_f32_16x16x32_bf16 a[216:219], a[168:171], v[132:135], a[216:219]
v_mfma_f32_16x16x32_bf16 a[220:223], a[172:175], v[132:135], a[220:223]
buffer_load_dwordx4 v[132:135], v250, s[16:19], s37 offen offset:1024 sc1
v_mfma_f32_16x16x32_bf16 a[224:227], a[160:163], v[136:139], a[224:227]
v_mfma_f32_16x16x32_bf16 a[228:231], a[164:167], v[136:139], a[228:231]
v_mfma_f32_16x16x32_bf16 a[232:235], a[168:171], v[136:139], a[232:235]
v_mfma_f32_16x16x32_bf16 a[236:239], a[172:175], v[136:139], a[236:239]
buffer_load_dwordx4 v[136:139], v250, s[16:19], s37 offen offset:2048 sc1
v_mfma_f32_16x16x32_bf16 v[192:195], a[160:163], v[140:143], v[192:195]
v_mfma_f32_16x16x32_bf16 v[196:199], a[164:167], v[140:143], v[196:199]
v_mfma_f32_16x16x32_bf16 v[200:203], a[168:171], v[140:143], v[200:203]
v_mfma_f32_16x16x32_bf16 v[204:207], a[172:175], v[140:143], v[204:207]
buffer_load_dwordx4 v[140:143], v250, s[16:19], s37 offen offset:3072 sc1
s_waitcnt vmcnt(12) lgkmcnt(0)
s_add_u32 s37, s43, 12288
v_mfma_f32_16x16x32_bf16 a[192:195], a[176:179], v[144:147], a[192:195]
v_mfma_f32_16x16x32_bf16 a[196:199], a[180:183], v[144:147], a[196:199]
v_mfma_f32_16x16x32_bf16 a[200:203], a[184:187], v[144:147], a[200:203]
v_mfma_f32_16x16x32_bf16 a[204:207], a[188:191], v[144:147], a[204:207]
buffer_load_dwordx4 v[144:147], v250, s[16:19], s37 offen offset:0 sc1
v_mfma_f32_16x16x32_bf16 a[208:211], a[176:179], v[148:151], a[208:211]
v_mfma_f32_16x16x32_bf16 a[212:215], a[180:183], v[148:151], a[212:215]
v_mfma_f32_16x16x32_bf16 a[216:219], a[184:187], v[148:151], a[216:219]
v_mfma_f32_16x16x32_bf16 a[220:223], a[188:191], v[148:151], a[220:223]
buffer_load_dwordx4 v[148:151], v250, s[16:19], s37 offen offset:1024 sc1
v_mfma_f32_16x16x32_bf16 a[224:227], a[176:179], v[152:155], a[224:227]
v_mfma_f32_16x16x32_bf16 a[228:231], a[180:183], v[152:155], a[228:231]
v_mfma_f32_16x16x32_bf16 a[232:235], a[184:187], v[152:155], a[232:235]
v_mfma_f32_16x16x32_bf16 a[236:239], a[188:191], v[152:155], a[236:239]
buffer_load_dwordx4 v[152:155], v250, s[16:19], s37 offen offset:2048 sc1
v_mfma_f32_16x16x32_bf16 v[192:195], a[176:179], v[156:159], v[192:195]
v_mfma_f32_16x16x32_bf16 v[196:199], a[180:183], v[156:159], v[196:199]
v_mfma_f32_16x16x32_bf16 v[200:203], a[184:187], v[156:159], v[200:203]
v_mfma_f32_16x16x32_bf16 v[204:207], a[188:191], v[156:159], v[204:207]
buffer_load_dwordx4 v[156:159], v250, s[16:19], s37 offen offset:3072 sc1
s_waitcnt vmcnt(12)
s_waitcnt lgkmcnt(0)
s_cmp_lg_u32 s52, -1
s_cbranch_scc0 Lm_poll4
Lm_ok4:
s_cmp_lg_u32 s53, -1
s_cbranch_scc0 Lm_ap4
Lm_apr4:
s_add_u32 s37, s44, 0
v_mfma_f32_16x16x32_bf16 a[192:195], v[0:3], v[96:99], a[192:195]
s_add_u32 s36, s47, 8192
buffer_load_dwordx4 a[128:131], v249, s[16:19], s36 offen offset:0 sc1
v_mfma_f32_16x16x32_bf16 a[196:199], v[4:7], v[96:99], a[196:199]
buffer_load_dwordx4 a[132:135], v249, s[16:19], s36 offen offset:1024 sc1
v_mfma_f32_16x16x32_bf16 a[200:203], v[8:11], v[96:99], a[200:203]
buffer_load_dwordx4 a[136:139], v249, s[16:19], s36 offen offset:2048 sc1
v_mfma_f32_16x16x32_bf16 a[204:207], v[12:15], v[96:99], a[204:207]
buffer_load_dwordx4 v[96:99], v250, s[16:19], s37 offen offset:0 sc1
v_mfma_f32_16x16x32_bf16 a[208:211], v[0:3], v[100:103], a[208:211]
buffer_load_dwordx4 a[140:143], v249, s[16:19], s36 offen offset:3072 sc1
v_mfma_f32_16x16x32_bf16 a[212:215], v[4:7], v[100:103], a[212:215]
v_mfma_f32_16x16x32_bf16 a[216:219], v[8:11], v[100:103], a[216:219]
v_mfma_f32_16x16x32_bf16 a[220:223], v[12:15], v[100:103], a[220:223]
buffer_load_dwordx4 v[100:103], v250, s[16:19], s37 offen offset:1024 sc1
v_mfma_f32_16x16x32_bf16 a[224:227], v[0:3], v[104:107], a[224:227]
v_mfma_f32_16x16x32_bf16 a[228:231], v[4:7], v[104:107], a[228:231]
v_mfma_f32_16x16x32_bf16 a[232:235], v[8:11], v[104:107], a[232:235]
v_mfma_f32_16x16x32_bf16 a[236:239], v[12:15], v[104:107], a[236:239]
buffer_load_dwordx4 v[104:107], v250, s[16:19], s37 offen offset:2048 sc1
v_mfma_f32_16x16x32_bf16 v[192:195], v[0:3], v[108:111], v[192:195]
v_mfma_f32_16x16x32_bf16 v[196:199], v[4:7], v[108:111], v[196:199]
v_mfma_f32_16x16x32_bf16 v[200:203], v[8:11], v[108:111], v[200:203]
v_mfma_f32_16x16x32_bf16 v[204:207], v[12:15], v[108:111], v[204:207]
buffer_load_dwordx4 v[108:111], v250, s[16:19], s37 offen offset:3072 sc1
s_waitcnt vmcnt(16)
s_add_u32 s37, s44, 4096
v_mfma_f32_16x16x32_bf16 a[192:195], v[16:19], v[112:115], a[192:195]
v_mfma_f32_16x16x32_bf16 a[196:199], v[20:23], v[112:115], a[196:199]
v_mfma_f32_16x16x32_bf16 a[200:203], v[24:27], v[112:115], a[200:203]
v_mfma_f32_16x16x32_bf16 a[204:207], v[28:31], v[112:115], a[204:207]
buffer_load_dwordx4 v[112:115], v250, s[16:19], s37 offen offset:0 sc1
v_mfma_f32_16x16x32_bf16 a[208:211], v[16:19], v[116:119], a[208:211]
v_mfma_f32_16x16x32_bf16 a[212:215], v[20:23], v[116:119], a[212:215]
v_mfma_f32_16x16x32_bf16 a[216:219], v[24:27], v[116:119], a[216:219]
v_mfma_f32_16x16x32_bf16 a[220:223], v[28:31], v[116:119], a[220:223]
buffer_load_dwordx4 v[116:119], v250, s[16:19], s37 offen offset:1024 sc1
v_mfma_f32_16x16x32_bf16 a[224:227], v[16:19], v[120:123], a[224:227]
v_mfma_f32_16x16x32_bf16 a[228:231], v[20:23], v[120:123], a[228:231]
v_mfma_f32_16x16x32_bf16 a[232:235], v[24:27], v[120:123], a[232:235]
v_mfma_f32_16x16x32_bf16 a[236:239], v[28:31], v[120:123], a[236:239]
buffer_load_dwordx4 v[120:123], v250, s[16:19], s37 offen offset:2048 sc1
v_mfma_f32_16x16x32_bf16 v[192:195], v[16:19], v[124:127], v[192:195]
v_mfma_f32_16x16x32_bf16 v[196:199], v[20:23], v[124:127], v[196:199]
v_mfma_f32_16x16x32_bf16 v[200:203], v[24:27], v[124:127], v[200:203]
v_mfma_f32_16x16x32_bf16 v[204:207], v[28:31], v[124:127], v[204:207]
buffer_load_dwordx4 v[124:127], v250, s[16:19], s37 offen offset:3072 sc1
s_waitcnt vmcnt(16)
s_add_u32 s37, s44, 8192
v_mfma_f32_16x16x32_bf16 a[192:195], v[32:35], v[128:131], a[192:195]
s_add_u32 s36, s47, 12288
buffer_load_dwordx4 a[144:147], v249, s[16:19], s36 offen offset:0 sc1
v_mfma_f32_16x16x32_bf16 a[196:199], v[36:39], v[128:131], a[196:199]
buffer_load_dwordx4 a[148:151], v249, s[16:19], s36 offen offset:1024 sc1
v_mfma_f32_16x16x32_bf16 a[200:203], v[40:43], v[128:131], a[200:203]
buffer_load_dwordx4 a[152:155], v249, s[16:19], s36 offen offset:2048 sc1
v_mfma_f32_16x16x32_bf16 a[204:207], v[44:47], v[128:131], a[204:207]
buffer_load_dwordx4 v[128:131], v250, s[16:19], s37 offen offset:0 sc1
v_mfma_f32_16x16x32_bf16 a[208:211], v[32:35], v[132:135], a[208:211]
buffer_load_dwordx4 a[156:159], v249, s[16:19], s36 offen offset:3072 sc1
v_mfma_f32_16x16x32_bf16 a[212:215], v[36:39], v[132:135], a[212:215]
v_mfma_f32_16x16x32_bf16 a[216:219], v[40:43], v[132:135], a[216:219]
v_mfma_f32_16x16x32_bf16 a[220:223], v[44:47], v[132:135], a[220:223]
buffer_load_dwordx4 v[132:135], v250, s[16:19], s37 offen offset:1024 sc1
v_mfma_f32_16x16x32_bf16 a[224:227], v[32:35], v[136:139], a[224:227]
v_mfma_f32_16x16x32_bf16 a[228:231], v[36:39], v[136:139], a[228:231]
v_mfma_f32_16x16x32_bf16 a[232:235], v[40:43], v[136:139], a[232:235]
v_mfma_f32_16x16x32_bf16 a[236:239], v[44:47], v[136:139], a[236:239]
buffer_load_dwordx4 v[136:139], v250, s[16:19], s37 offen offset:2048 sc1
v_mfma_f32_16x16x32_bf16 v[192:195], v[32:35], v[140:143], v[192:195]
v_mfma_f32_16x16x32_bf16 v[196:199], v[36:39], v[140:143], v[196:199]
v_mfma_f32_16x16x32_bf16 v[200:203], v[40:43], v[140:143], v[200:203]
v_mfma_f32_16x16x32_bf16 v[204:207], v[44:47], v[140:143], v[204:207]
buffer_load_dwordx4 v[140:143], v250, s[16:19], s37 offen offset:3072 sc1
s_waitcnt vmcnt(20)
s_add_u32 s37, s44, 12288
v_mfma_f32_16x16x32_bf16 a[192:195], v[48:51], v[144:147], a[192:195]
v_mfma_f32_16x16x32_bf16 a[196:199], v[52:55], v[144:147], a[196:199]
v_mfma_f32_16x16x32_bf16 a[200:203], v[56:59], v[144:147], a[200:203]
v_mfma_f32_16x16x32_bf16 a[204:207], v[60:63], v[144:147], a[204:207]
buffer_load_dwordx4 v[144:147], v250, s[16:19], s37 offen offset:0 sc1
v_mfma_f32_16x16x32_bf16 a[208:211], v[48:51], v[148:151], a[208:211]
v_mfma_f32_16x16x32_bf16 a[212:215], v[52:55], v[148:151], a[212:215]
v_mfma_f32_16x16x32_bf16 a[216:219], v[56:59], v[148:151], a[216:219]
v_mfma_f32_16x16x32_bf16 a[220:223], v[60:63], v[148:151], a[220:223]
buffer_load_dwordx4 v[148:151], v250, s[16:19], s37 offen offset:1024 sc1
v_mfma_f32_16x16x32_bf16 a[224:227], v[48:51], v[152:155], a[224:227]
v_mfma_f32_16x16x32_bf16 a[228:231], v[52:55], v[152:155], a[228:231]
v_mfma_f32_16x16x32_bf16 a[232:235], v[56:59], v[152:155], a[232:235]
v_mfma_f32_16x16x32_bf16 a[236:239], v[60:63], v[152:155], a[236:239]
buffer_load_dwordx4 v[152:155], v250, s[16:19], s37 offen offset:2048 sc1
v_mfma_f32_16x16x32_bf16 v[192:195], v[48:51], v[156:159], v[192:195]
v_mfma_f32_16x16x32_bf16 v[196:199], v[52:55], v[156:159], v[196:199]
v_mfma_f32_16x16x32_bf16 v[200:203], v[56:59], v[156:159], v[200:203]
v_mfma_f32_16x16x32_bf16 v[204:207], v[60:63], v[156:159], v[204:207]
buffer_load_dwordx4 v[156:159], v250, s[16:19], s37 offen offset:3072 sc1
s_waitcnt vmcnt(16)
s_waitcnt lgkmcnt(0)
s_cmp_lg_u32 s53, -1
s_cbranch_scc0 Lm_poll5
Lm_ok5:
s_cmp_lg_u32 s54, -1
s_cbranch_scc0 Lm_ap5
Lm_apr5:
s_add_u32 s37, s45, 0
v_mfma_f32_16x16x32_bf16 a[192:195], v[64:67], v[96:99], a[192:195]
v_mfma_f32_16x16x32_bf16 a[196:199], v[68:71], v[96:99], a[196:199]
v_mfma_f32_16x16x32_bf16 a[200:203], v[72:75], v[96:99], a[200:203]
v_mfma_f32_16x16x32_bf16 a[204:207], v[76:79], v[96:99], a[204:207]
buffer_load_dwordx4 v[96:99], v250, s[16:19], s37 offen offset:0 sc1
v_mfma_f32_16x16x32_bf16 a[208:211], v[64:67], v[100:103], a[208:211]
v_mfma_f32_16x16x32_bf16 a[212:215], v[68:71], v[100:103], a[212:215]
v_mfma_f32_16x16x32_bf16 a[216:219], v[72:75], v[100:103], a[216:219]
v_mfma_f32_16x16x32_bf16 a[220:223], v[76:79], v[100:103], a[220:223]
buffer_load_dwordx4 v[100:103], v250, s[16:19], s37 offen offset:1024 sc1
v_mfma_f32_16x16x32_bf16 a[224:227], v[64:67], v[104:107], a[224:227]
v_mfma_f32_16x16x32_bf16 a[228:231], v[68:71], v[104:107], a[228:231]
v_mfma_f32_16x16x32_bf16 a[232:235], v[72:75], v[104:107], a[232:235]
v_mfma_f32_16x16x32_bf16 a[236:239], v[76:79], v[104:107], a[236:239]
buffer_load_dwordx4 v[104:107], v250, s[16:19], s37 offen offset:2048 sc1
v_mfma_f32_16x16x32_bf16 v[192:195], v[64:67], v[108:111], v[192:195]
v_mfma_f32_16x16x32_bf16 v[196:199], v[68:71], v[108:111], v[196:199]
v_mfma_f32_16x16x32_bf16 v[200:203], v[72:75], v[108:111], v[200:203]
v_mfma_f32_16x16x32_bf16 v[204:207], v[76:79], v[108:111], v[204:207]
buffer_load_dwordx4 v[108:111], v250, s[16:19], s37 offen offset:3072 sc1
s_waitcnt vmcnt(16)
s_add_u32 s37, s45, 4096
v_mfma_f32_16x16x32_bf16 a[192:195], v[80:83], v[112:115], a[192:195]
v_mfma_f32_16x16x32_bf16 a[196:199], v[84:87], v[112:115], a[196:199]
v_mfma_f32_16x16x32_bf16 a[200:203], v[88:91], v[112:115], a[200:203]
v_mfma_f32_16x16x32_bf16 a[204:207], v[92:95], v[112:115], a[204:207]
buffer_load_dwordx4 v[112:115], v250, s[16:19], s37 offen offset:0 sc1
v_mfma_f32_16x16x32_bf16 a[208:211], v[80:83], v[116:119], a[208:211]
v_mfma_f32_16x16x32_bf16 a[212:215], v[84:87], v[116:119], a[212:215]
v_mfma_f32_16x16x32_bf16 a[216:219], v[88:91], v[116:119], a[216:219]
v_mfma_f32_16x16x32_bf16 a[220:223], v[92:95], v[116:119], a[220:223]
buffer_load_dwordx4 v[116:119], v250, s[16:19], s37 offen offset:1024 sc1
v_mfma_f32_16x16x32_bf16 a[224:227], v[80:83], v[120:123], a[224:227]
v_mfma_f32_16x16x32_bf16 a[228:231], v[84:87], v[120:123], a[228:231]
v_mfma_f32_16x16x32_bf16 a[232:235], v[88:91], v[120:123], a[232:235]
v_mfma_f32_16x16x32_bf16 a[236:239], v[92:95], v[120:123], a[236:239]
buffer_load_dwordx4 v[120:123], v250, s[16:19], s37 offen offset:2048 sc1
v_mfma_f32_16x16x32_bf16 v[192:195], v[80:83], v[124:127], v[192:195]
v_mfma_f32_16x16x32_bf16 v[196:199], v[84:87], v[124:127], v[196:199]
v_mfma_f32_16x16x32_bf16 v[200:203], v[88:91], v[124:127], v[200:203]
v_mfma_f32_16x16x32_bf16 v[204:207], v[92:95], v[124:127], v[204:207]
buffer_load_dwordx4 v[124:127], v250, s[16:19], s37 offen offset:3072 sc1
s_waitcnt vmcnt(12)
s_add_u32 s37, s45, 8192
v_mfma_f32_16x16x32_bf16 a[192:195], v[160:163], v[128:131], a[192:195]
v_mfma_f32_16x16x32_bf16 a[196:199], v[164:167], v[128:131], a[196:199]
v_mfma_f32_16x16x32_bf16 a[200:203], v[168:171], v[128:131], a[200:203]
v_mfma_f32_16x16x32_bf16 a[204:207], v[172:175], v[128:131], a[204:207]
buffer_load_dwordx4 v[128:131], v250, s[16:19], s37 offen offset:0 sc1
v_mfma_f32_16x16x32_bf16 a[208:211], v[160:163], v[132:135], a[208:211]
v_mfma_f32_16x16x32_bf16 a[212:215], v[164:167], v[132:135], a[212:215]
v_mfma_f32_16x16x32_bf16 a[216:219], v[168:171], v[132:135], a[216:219]
v_mfma_f32_16x16x32_bf16 a[220:223], v[172:175], v[132:135], a[220:223]
buffer_load_dwordx4 v[132:135], v250, s[16:19], s37 offen offset:1024 sc1
v_mfma_f32_16x16x32_bf16 a[224:227], v[160:163], v[136:139], a[224:227]
v_mfma_f32_16x16x32_bf16 a[228:231], v[164:167], v[136:139], a[228:231]
v_mfma_f32_16x16x32_bf16 a[232:235], v[168:171], v[136:139], a[232:235]
v_mfma_f32_16x16x32_bf16 a[236:239], v[172:175], v[136:139], a[236:239]
buffer_load_dwordx4 v[136:139], v250, s[16:19], s37 offen offset:2048 sc1
v_mfma_f32_16x16x32_bf16 v[192:195], v[160:163], v[140:143], v[192:195]
v_mfma_f32_16x16x32_bf16 v[196:199], v[164:167], v[140:143], v[196:199]
v_mfma_f32_16x16x32_bf16 v[200:203], v[168:171], v[140:143], v[200:203]
v_mfma_f32_16x16x32_bf16 v[204:207], v[172:175], v[140:143], v[204:207]
buffer_load_dwordx4 v[140:143], v250, s[16:19], s37 offen offset:3072 sc1
s_waitcnt vmcnt(12)
s_add_u32 s37, s45, 12288
v_mfma_f32_16x16x32_bf16 a[192:195], v[176:179], v[144:147], a[192:195]
v_mfma_f32_16x16x32_bf16 a[196:199], v[180:183], v[144:147], a[196:199]
v_mfma_f32_16x16x32_bf16 a[200:203], v[184:187], v[144:147], a[200:203]
v_mfma_f32_16x16x32_bf16 a[204:207], v[188:191], v[144:147], a[204:207]
buffer_load_dwordx4 v[144:147], v250, s[16:19], s37 offen offset:0 sc1
v_mfma_f32_16x16x32_bf16 a[208:211], v[176:179], v[148:151], a[208:211]
v_mfma_f32_16x16x32_bf16 a[212:215], v[180:183], v[148:151], a[212:215]
v_mfma_f32_16x16x32_bf16 a[216:219], v[184:187], v[148:151], a[216:219]
v_mfma_f32_16x16x32_bf16 a[220:223], v[188:191], v[148:151], a[220:223]
buffer_load_dwordx4 v[148:151], v250, s[16:19], s37 offen offset:1024 sc1
v_mfma_f32_16x16x32_bf16 a[224:227], v[176:179], v[152:155], a[224:227]
v_mfma_f32_16x16x32_bf16 a[228:231], v[180:183], v[152:155], a[228:231]
v_mfma_f32_16x16x32_bf16 a[232:235], v[184:187], v[152:155], a[232:235]
v_mfma_f32_16x16x32_bf16 a[236:239], v[188:191], v[152:155], a[236:239]
buffer_load_dwordx4 v[152:155], v250, s[16:19], s37 offen offset:2048 sc1
v_mfma_f32_16x16x32_bf16 v[192:195], v[176:179], v[156:159], v[192:195]
v_mfma_f32_16x16x32_bf16 v[196:199], v[180:183], v[156:159], v[196:199]
v_mfma_f32_16x16x32_bf16 v[200:203], v[184:187], v[156:159], v[200:203]
v_mfma_f32_16x16x32_bf16 v[204:207], v[188:191], v[156:159], v[204:207]
buffer_load_dwordx4 v[156:159], v250, s[16:19], s37 offen offset:3072 sc1
s_waitcnt vmcnt(12)
s_waitcnt lgkmcnt(0)
s_cmp_lg_u32 s54, -1
s_cbranch_scc0 Lm_poll6
Lm_ok6:
s_cmp_lg_u32 s55, -1
s_cbranch_scc0 Lm_ap6
Lm_apr6:
s_add_u32 s37, s46, 0
v_mfma_f32_16x16x32_bf16 a[192:195], v[208:211], v[96:99], a[192:195]
v_mfma_f32_16x16x32_bf16 a[196:199], v[212:215], v[96:99], a[196:199]
v_mfma_f32_16x16x32_bf16 a[200:203], v[216:219], v[96:99], a[200:203]
v_mfma_f32_16x16x32_bf16 a[204:207], v[220:223], v[96:99], a[204:207]
buffer_load_dwordx4 v[96:99], v250, s[16:19], s37 offen offset:0 sc1
v_mfma_f32_16x16x32_bf16 a[208:211], v[208:211], v[100:103], a[208:211]
v_mfma_f32_16x16x32_bf16 a[212:215], v[212:215], v[100:103], a[212:215]
v_mfma_f32_16x16x32_bf16 a[216:219], v[216:219], v[100:103], a[216:219]
v_mfma_f32_16x16x32_bf16 a[220:223], v[220:223], v[100:103], a[220:223]
buffer_load_dwordx4 v[100:103], v250, s[16:19], s37 offen offset:1024 sc1
v_mfma_f32_16x16x32_bf16 a[224:227], v[208:211], v[104:107], a[224:227]
v_mfma_f32_16x16x32_bf16 a[228:231], v[212:215], v[104:107], a[228:231]
v_mfma_f32_16x16x32_bf16 a[232:235], v[216:219], v[104:107], a[232:235]
v_mfma_f32_16x16x32_bf16 a[236:239], v[220:223], v[104:107], a[236:239]
buffer_load_dwordx4 v[104:107], v250, s[16:19], s37 offen offset:2048 sc1
v_mfma_f32_16x16x32_bf16 v[192:195], v[208:211], v[108:111], v[192:195]
v_mfma_f32_16x16x32_bf16 v[196:199], v[212:215], v[108:111], v[196:199]
v_mfma_f32_16x16x32_bf16 v[200:203], v[216:219], v[108:111], v[200:203]
v_mfma_f32_16x16x32_bf16 v[204:207], v[220:223], v[108:111], v[204:207]
buffer_load_dwordx4 v[108:111], v250, s[16:19], s37 offen offset:3072 sc1
s_waitcnt vmcnt(12)
s_add_u32 s37, s46, 4096
v_mfma_f32_16x16x32_bf16 a[192:195], a[240:243], v[112:115], a[192:195]
ds_read_b128 v[160:163], v230 offset:0
ds_read_b128 v[164:167], v230 offset:64
v_mfma_f32_16x16x32_bf16 a[196:199], a[244:247], v[112:115], a[196:199]
ds_read_b128 v[48:51], v229 offset:512
ds_read_b128 v[52:55], v229 offset:528
v_mfma_f32_16x16x32_bf16 a[200:203], a[248:251], v[112:115], a[200:203]
ds_read_b128 v[56:59], v229 offset:640
ds_read_b128 v[60:63], v229 offset:656
v_mfma_f32_16x16x32_bf16 a[204:207], a[252:255], v[112:115], a[204:207]
buffer_load_dwordx4 v[112:115], v250, s[16:19], s37 offen offset:0 sc1
v_mfma_f32_16x16x32_bf16 a[208:211], a[240:243], v[116:119], a[208:211]
ds_read_b128 v[16:19], v229 offset:0
ds_read_b128 v[20:23], v229 offset:16
v_mfma_f32_16x16x32_bf16 a[212:215], a[244:247], v[116:119], a[212:215]
ds_read_b128 v[24:27], v229 offset:128
v_mfma_f32_16x16x32_bf16 a[216:219], a[248:251], v[116:119], a[216:219]
v_mfma_f32_16x16x32_bf16 a[220:223], a[252:255], v[116:119], a[220:223]
buffer_load_dwordx4 v[116:119], v250, s[16:19], s37 offen offset:1024 sc1
v_mfma_f32_16x16x32_bf16 a[224:227], a[240:243], v[120:123], a[224:227]
v_mfma_f32_16x16x32_bf16 a[228:231], a[244:247], v[120:123], a[228:231]
v_mfma_f32_16x16x32_bf16 a[232:235], a[248:251], v[120:123], a[232:235]
v_mfma_f32_16x16x32_bf16 a[236:239], a[252:255], v[120:123], a[236:239]
buffer_load_dwordx4 v[120:123], v250, s[16:19], s37 offen offset:2048 sc1
v_mfma_f32_16x16x32_bf16 v[192:195], a[240:243], v[124:127], v[192:195]
v_mfma_f32_16x16x32_bf16 v[196:199], a[244:247], v[124:127], v[196:199]
v_mfma_f32_16x16x32_bf16 v[200:203], a[248:251], v[124:127], v[200:203]
v_mfma_f32_16x16x32_bf16 v[204:207], a[252:255], v[124:127], v[204:207]
buffer_load_dwordx4 v[124:127], v250, s[16:19], s37 offen offset:3072 sc1
s_waitcnt vmcnt(12)
s_add_u32 s37, s46, 8192
v_mfma_f32_16x16x32_bf16 a[192:195], a[0:3], v[128:131], a[192:195]
ds_read_b128 v[28:31], v229 offset:144
ds_read_b128 v[64:67], v229 offset:256
v_mfma_f32_16x16x32_bf16 a[196:199], a[4:7], v[128:131], a[196:199]
ds_read_b128 v[68:71], v229 offset:272
ds_read_b128 v[72:75], v229 offset:384
v_mfma_f32_16x16x32_bf16 a[200:203], a[8:11], v[128:131], a[200:203]
ds_read_b128 v[76:79], v229 offset:400
ds_read_b128 v[80:83], v229 offset:768
v_mfma_f32_16x16x32_bf16 a[204:207], a[12:15], v[128:131], a[204:207]
buffer_load_dwordx4 v[128:131], v250, s[16:19], s37 offen offset:0 sc1
v_mfma_f32_16x16x32_bf16 a[208:211], a[0:3], v[132:135], a[208:211]
ds_read_b128 v[84:87], v229 offset:784
ds_read_b128 v[88:91], v229 offset:896
v_mfma_f32_16x16x32_bf16 a[212:215], a[4:7], v[132:135], a[212:215]
ds_read_b128 v[92:95], v229 offset:912
v_mfma_f32_16x16x32_bf16 a[216:219], a[8:11], v[132:135], a[216:219]
v_mfma_f32_16x16x32_bf16 a[220:223], a[12:15], v[132:135], a[220:223]
buffer_load_dwordx4 v[132:135], v250, s[16:19], s37 offen offset:1024 sc1
v_mfma_f32_16x16x32_bf16 a[224:227], a[0:3], v[136:139], a[224:227]
v_mfma_f32_16x16x32_bf16 a[228:231], a[4:7], v[136:139], a[228:231]
v_mfma_f32_16x16x32_bf16 a[232:235], a[8:11], v[136:139], a[232:235]
v_mfma_f32_16x16x32_bf16 a[236:239], a[12:15], v[136:139], a[236:239]
buffer_load_dwordx4 v[136:139], v250, s[16:19], s37 offen offset:2048 sc1
v_mfma_f32_16x16x32_bf16 v[192:195], a[0:3], v[140:143], v[192:195]
v_mfma_f32_16x16x32_bf16 v[196:199], a[4:7], v[140:143], v[196:199]
v_mfma_f32_16x16x32_bf16 v[200:203], a[8:11], v[140:143], v[200:203]
Lpad23:
s_cbranch_execz Lwalk2
v_mfma_f32_16x16x32_bf16 v[204:207], a[12:15], v[140:143], v[204:207]
buffer_load_dwordx4 v[140:143], v250, s[16:19], s37 offen offset:3072 sc1
s_waitcnt vmcnt(12)
s_add_u32 s37, s46, 12288
v_mfma_f32_16x16x32_bf16 a[192:195], a[16:19], v[144:147], a[192:195]
v_mfma_f32_16x16x32_bf16 a[196:199], a[20:23], v[144:147], a[196:199]
v_mfma_f32_16x16x32_bf16 a[200:203], a[24:27], v[144:147], a[200:203]
v_mfma_f32_16x16x32_bf16 a[204:207], a[28:31], v[144:147], a[204:207]
buffer_load_dwordx4 v[144:147], v250, s[16:19], s37 offen offset:0 sc1
v_mfma_f32_16x16x32_bf16 a[208:211], a[16:19], v[148:151], a[208:211]
v_mfma_f32_16x16x32_bf16 a[212:215], a[20:23], v[148:151], a[212:215]
v_mfma_f32_16x16x32_bf16 a[216:219], a[24:27], v[148:151], a[216:219]
v_mfma_f32_16x16x32_bf16 a[220:223], a[28:31], v[148:151], a[220:223]
buffer_load_dwordx4 v[148:151], v250, s[16:19], s37 offen offset:1024 sc1
v_mfma_f32_16x16x32_bf16 a[224:227], a[16:19], v[152:155], a[224:227]
v_mfma_f32_16x16x32_bf16 a[228:231], a[20:23], v[152:155], a[228:231]
v_mfma_f32_16x16x32_bf16 a[232:235], a[24:27], v[152:155], a[232:235]
v_mfma_f32_16x16x32_bf16 a[236:239], a[28:31], v[152:155], a[236:239]
buffer_load_dwordx4 v[152:155], v250, s[16:19], s37 offen offset:2048 sc1
v_mfma_f32_16x16x32_bf16 v[192:195], a[16:19], v[156:159], v[192:195]
v_mfma_f32_16x16x32_bf16 v[196:199], a[20:23], v[156:159], v[196:199]
v_mfma_f32_16x16x32_bf16 v[200:203], a[24:27], v[156:159], v[200:203]
v_mfma_f32_16x16x32_bf16 v[204:207], a[28:31], v[156:159], v[204:207]
buffer_load_dwordx4 v[156:159], v250, s[16:19], s37 offen offset:3072 sc1
s_waitcnt vmcnt(12)
s_waitcnt lgkmcnt(0)
s_cmp_lg_u32 s55, -1
s_cbranch_scc0 Lm_poll7
Lm_ok7:
s_add_u32 s37, s47, 0
v_mfma_f32_16x16x32_bf16 a[192:195], a[32:35], v[96:99], a[192:195]
v_lshlrev_b32 v0, 16, v240
v_and_b32 v1, 0xffff0000, v240
v_mfma_f32_16x16x32_bf16 a[196:199], a[36:39], v[96:99], a[196:199]
v_lshlrev_b32 v2, 16, v241
v_and_b32 v3, 0xffff0000, v241
v_mfma_f32_16x16x32_bf16 a[200:203], a[40:43], v[96:99], a[200:203]
v_lshlrev_b32 v4, 16, v242
v_and_b32 v5, 0xffff0000, v242
v_mfma_f32_16x16x32_bf16 a[204:207], a[44:47], v[96:99], a[204:207]
buffer_load_dwordx4 v[96:99], v250, s[16:19], s37 offen offset:0 sc1
v_mfma_f32_16x16x32_bf16 a[208:211], a[32:35], v[100:103], a[208:211]
v_lshlrev_b32 v6, 16, v243
v_and_b32 v7, 0xffff0000, v243
v_mfma_f32_16x16x32_bf16 a[212:215], a[36:39], v[100:103], a[212:215]
v_lshlrev_b32 v8, 16, v244
v_and_b32 v9, 0xffff0000, v244
v_mfma_f32_16x16x32_bf16 a[216:219], a[40:43], v[100:103], a[216:219]
v_lshlrev_b32 v10, 16, v245
v_and_b32 v11, 0xffff0000, v245
v_mfma_f32_16x16x32_bf16 a[220:223], a[44:47], v[100:103], a[220:223]
buffer_load_dwordx4 v[100:103], v250, s[16:19], s37 offen offset:1024 sc1
v_mfma_f32_16x16x32_bf16 a[224:227], a[32:35], v[104:107], a[224:227]
v_lshlrev_b32 v12, 16, v246
v_and_b32 v13, 0xffff0000, v246
v_mfma_f32_16x16x32_bf16 a[228:231], a[36:39], v[104:107], a[228:231]
v_mfma_f32_16x16x32_bf16 a[232:235], a[40:43], v[104:107], a[232:235]
v_mfma_f32_16x16x32_bf16 a[236:239], a[44:47], v[104:107], a[236:239]
buffer_load_dwordx4 v[104:107], v250, s[16:19], s37 offen offset:2048 sc1
v_mfma_f32_16x16x32_bf16 v[192:195], a[32:35], v[108:111], v[192:195]
v_mfma_f32_16x16x32_bf16 v[196:199], a[36:39], v[108:111], v[196:199]
v_mfma_f32_16x16x32_bf16 v[200:203], a[40:43], v[108:111], v[200:203]
v_mfma_f32_16x16x32_bf16 v[204:207], a[44:47], v[108:111], v[204:207]
buffer_load_dwordx4 v[108:111], v250, s[16:19], s37 offen offset:3072 sc1
s_waitcnt vmcnt(12)
s_add_u32 s37, s47, 4096
v_mfma_f32_16x16x32_bf16 a[192:195], a[48:51], v[112:115], a[192:195]
v_lshlrev_b32 v14, 16, v247
v_and_b32 v15, 0xffff0000, v247
v_mfma_f32_16x16x32_bf16 a[196:199], a[52:55], v[112:115], a[196:199]
v_lshlrev_b32 v32, 16, v160
v_and_b32 v33, 0xffff0000, v160
v_mfma_f32_16x16x32_bf16 a[200:203], a[56:59], v[112:115], a[200:203]
v_lshlrev_b32 v34, 16, v161
v_and_b32 v35, 0xffff0000, v161
v_mfma_f32_16x16x32_bf16 a[204:207], a[60:63], v[112:115], a[204:207]
buffer_load_dwordx4 v[112:115], v250, s[16:19], s37 offen offset:0 sc1
v_mfma_f32_16x16x32_bf16 a[208:211], a[48:51], v[116:119], a[208:211]
v_lshlrev_b32 v36, 16, v162
v_and_b32 v37, 0xffff0000, v162
v_mfma_f32_16x16x32_bf16 a[212:215], a[52:55], v[116:119], a[212:215]
v_lshlrev_b32 v38, 16, v163
v_and_b32 v39, 0xffff0000, v163
v_mfma_f32_16x16x32_bf16 a[216:219], a[56:59], v[116:119], a[216:219]
v_lshlrev_b32 v40, 16, v164
v_and_b32 v41, 0xffff0000, v164
v_mfma_f32_16x16x32_bf16 a[220:223], a[60:63], v[116:119], a[220:223]
buffer_load_dwordx4 v[116:119], v250, s[16:19], s37 offen offset:1024 sc1
v_mfma_f32_16x16x32_bf16 a[224:227], a[48:51], v[120:123], a[224:227]
v_lshlrev_b32 v42, 16, v165
v_and_b32 v43, 0xffff0000, v165
v_mfma_f32_16x16x32_bf16 a[228:231], a[52:55], v[120:123], a[228:231]
v_mfma_f32_16x16x32_bf16 a[232:235], a[56:59], v[120:123], a[232:235]
v_mfma_f32_16x16x32_bf16 a[236:239], a[60:63], v[120:123], a[236:239]
buffer_load_dwordx4 v[120:123], v250, s[16:19], s37 offen offset:2048 sc1
v_mfma_f32_16x16x32_bf16 v[192:195], a[48:51], v[124:127], v[192:195]
v_mfma_f32_16x16x32_bf16 v[196:199], a[52:55], v[124:127], v[196:199]
v_mfma_f32_16x16x32_bf16 v[200:203], a[56:59], v[124:127], v[200:203]
v_mfma_f32_16x16x32_bf16 v[204:207], a[60:63], v[124:127], v[204:207]
buffer_load_dwordx4 v[124:127], v250, s[16:19], s37 offen offset:3072 sc1
s_waitcnt vmcnt(12)
s_add_u32 s37, s47, 8192
v_mfma_f32_16x16x32_bf16 a[192:195], a[64:67], v[128:131], a[192:195]
v_lshlrev_b32 v44, 16, v166
v_and_b32 v45, 0xffff0000, v166
v_mfma_f32_16x16x32_bf16 a[196:199], a[68:71], v[128:131], a[196:199]
v_lshlrev_b32 v46, 16, v167
v_and_b32 v47, 0xffff0000, v167
v_mfma_f32_16x16x32_bf16 a[200:203], a[72:75], v[128:131], a[200:203]
v_mul_f32 v32, v48, v32
v_mul_f32 v33, v49, v33
v_mfma_f32_16x16x32_bf16 a[204:207], a[76:79], v[128:131], a[204:207]
buffer_load_dwordx4 v[128:131], v250, s[16:19], s37 offen offset:0 sc1
v_mfma_f32_16x16x32_bf16 a[208:211], a[64:67], v[132:135], a[208:211]
v_mul_f32 v34, v50, v34
v_mul_f32 v35, v51, v35
v_mfma_f32_16x16x32_bf16 a[212:215], a[68:71], v[132:135], a[212:215]
v_mul_f32 v36, v52, v36
v_mul_f32 v37, v53, v37
v_mfma_f32_16x16x32_bf16 a[216:219], a[72:75], v[132:135], a[216:219]
v_mul_f32 v38, v54, v38
v_mul_f32 v39, v55, v39
v_mfma_f32_16x16x32_bf16 a[220:223], a[76:79], v[132:135], a[220:223]
buffer_load_dwordx4 v[132:135], v250, s[16:19], s37 offen offset:1024 sc1
v_mfma_f32_16x16x32_bf16 a[224:227], a[64:67], v[136:139], a[224:227]
v_mul_f32 v40, v56, v40
v_mul_f32 v41, v57, v41
v_mfma_f32_16x16x32_bf16 a[228:231], a[68:71], v[136:139], a[228:231]
v_mfma_f32_16x16x32_bf16 a[232:235], a[72:75], v[136:139], a[232:235]
v_mfma_f32_16x16x32_bf16 a[236:239], a[76:79], v[136:139], a[236:239]
buffer_load_dwordx4 v[136:139], v250, s[16:19], s37 offen offset:2048 sc1
v_mfma_f32_16x16x32_bf16 v[192:195], a[64:67], v[140:143], v[192:195]
v_mfma_f32_16x16x32_bf16 v[196:199], a[68:71], v[140:143], v[196:199]
v_mfma_f32_16x16x32_bf16 v[200:203], a[72:75], v[140:143], v[200:203]
v_mfma_f32_16x16x32_bf16 v[204:207], a[76:79], v[140:143], v[204:207]
buffer_load_dwordx4 v[140:143], v250, s[16:19], s37 offen offset:3072 sc1
s_waitcnt vmcnt(12)
s_add_u32 s37, s47, 12288
v_mfma_f32_16x16x32_bf16 a[192:195], a[80:83], v[144:147], a[192:195]
v_mul_f32 v42, v58, v42
v_mul_f32 v43, v59, v43
v_mfma_f32_16x16x32_bf16 a[196:199], a[84:87], v[144:147], a[196:199]
v_mul_f32 v44, v60, v44
v_mul_f32 v45, v61, v45
v_mfma_f32_16x16x32_bf16 a[200:203], a[88:91], v[144:147], a[200:203]
v_mul_f32 v46, v62, v46
v_mul_f32 v47, v63, v47
v_mfma_f32_16x16x32_bf16 a[204:207], a[92:95], v[144:147], a[204:207]
buffer_load_dwordx4 v[144:147], v250, s[16:19], s37 offen offset:0 sc1
v_mfma_f32_16x16x32_bf16 a[208:211], a[80:83], v[148:151], a[208:211]
v_lshrrev_b32 v168, 4, v248
v_and_b32 v169, 15, v248
v_mfma_f32_16x16x32_bf16 a[212:215], a[84:87], v[148:151], a[212:215]
v_lshlrev_b32 v168, 8, v168
v_lshl_add_u32 v168, v169, 2, v168
v_mfma_f32_16x16x32_bf16 a[216:219], a[88:91], v[148:151], a[216:219]
v_lshl_add_u32 v169, s31, 4, v169
v_mov_b32 v171, 156160
v_mfma_f32_16x16x32_bf16 a[220:223], a[92:95], v[148:151], a[220:223]
buffer_load_dwordx4 v[148:151], v250, s[16:19], s37 offen offset:1024 sc1
v_mfma_f32_16x16x32_bf16 a[224:227], a[80:83], v[152:155], a[224:227]
v_lshl_add_u32 v170, s27, 2, v171
v_lshlrev_b32 v232, 2, v248
v_mfma_f32_16x16x32_bf16 a[228:231], a[84:87], v[152:155], a[228:231]
v_mfma_f32_16x16x32_bf16 a[232:235], a[88:91], v[152:155], a[232:235]
v_mfma_f32_16x16x32_bf16 a[236:239], a[92:95], v[152:155], a[236:239]
buffer_load_dwordx4 v[152:155], v250, s[16:19], s37 offen offset:2048 sc1
v_mfma_f32_16x16x32_bf16 v[192:195], a[80:83], v[156:159], v[192:195]
v_mfma_f32_16x16x32_bf16 v[196:199], a[84:87], v[156:159], v[196:199]
v_mfma_f32_16x16x32_bf16 v[200:203], a[88:91], v[156:159], v[200:203]
v_mfma_f32_16x16x32_bf16 v[204:207], a[92:95], v[156:159], v[204:207]
buffer_load_dwordx4 v[156:159], v250, s[16:19], s37 offen offset:3072 sc1
s_waitcnt vmcnt(12)
v_mfma_f32_16x16x32_bf16 a[192:195], a[96:99], v[96:99], a[192:195]
s_lshl_b32 s36, s31, 11
s_add_u32 s36, s36, 30474240
s_lshl_b32 s37, s101, 8
v_mfma_f32_16x16x32_bf16 a[196:199], a[100:103], v[96:99], a[196:199]
s_add_u32 s37, s37, s36
s_lshl_b32 s24, s100, 11
s_add_u32 s33, s24, 30801920
v_mfma_f32_16x16x32_bf16 a[200:203], a[104:107], v[96:99], a[200:203]
s_add_u32 s24, s24, 30736384
s_lshl_b32 s30, s100, 7
s_add_u32 s30, s30, 30425088
v_mfma_f32_16x16x32_bf16 a[204:207], a[108:111], v[96:99], a[204:207]
s_mov_b32 s38, 0x7f7ff800
s_mov_b32 s26, 0xfffff800
v_mfma_f32_16x16x32_bf16 a[208:211], a[96:99], v[100:103], a[208:211]
v_mfma_f32_16x16x32_bf16 a[212:215], a[100:103], v[100:103], a[212:215]
v_mfma_f32_16x16x32_bf16 a[216:219], a[104:107], v[100:103], a[216:219]
v_mfma_f32_16x16x32_bf16 a[220:223], a[108:111], v[100:103], a[220:223]
v_mfma_f32_16x16x32_bf16 a[224:227], a[96:99], v[104:107], a[224:227]
v_mfma_f32_16x16x32_bf16 a[228:231], a[100:103], v[104:107], a[228:231]
v_mfma_f32_16x16x32_bf16 a[232:235], a[104:107], v[104:107], a[232:235]
v_mfma_f32_16x16x32_bf16 a[236:239], a[108:111], v[104:107], a[236:239]
v_mfma_f32_16x16x32_bf16 v[192:195], a[96:99], v[108:111], v[192:195]
v_mfma_f32_16x16x32_bf16 v[196:199], a[100:103], v[108:111], v[196:199]
v_mfma_f32_16x16x32_bf16 v[200:203], a[104:107], v[108:111], v[200:203]
v_mfma_f32_16x16x32_bf16 v[204:207], a[108:111], v[108:111], v[204:207]
s_waitcnt vmcnt(8)
v_mfma_f32_16x16x32_bf16 a[192:195], a[112:115], v[112:115], a[192:195]
v_mfma_f32_16x16x32_bf16 a[196:199], a[116:119], v[112:115], a[196:199]
v_mfma_f32_16x16x32_bf16 a[200:203], a[120:123], v[112:115], a[200:203]
v_mfma_f32_16x16x32_bf16 a[204:207], a[124:127], v[112:115], a[204:207]
v_mfma_f32_16x16x32_bf16 a[208:211], a[112:115], v[116:119], a[208:211]
v_mfma_f32_16x16x32_bf16 a[212:215], a[116:119], v[116:119], a[212:215]
v_mfma_f32_16x16x32_bf16 a[216:219], a[120:123], v[116:119], a[216:219]
v_mfma_f32_16x16x32_bf16 a[220:223], a[124:127], v[116:119], a[220:223]
v_mfma_f32_16x16x32_bf16 a[224:227], a[112:115], v[120:123], a[224:227]
v_mfma_f32_16x16x32_bf16 a[228:231], a[116:119], v[120:123], a[228:231]
v_mfma_f32_16x16x32_bf16 a[232:235], a[120:123], v[120:123], a[232:235]
v_mfma_f32_16x16x32_bf16 a[236:239], a[124:127], v[120:123], a[236:239]
v_mfma_f32_16x16x32_bf16 v[192:195], a[112:115], v[124:127], v[192:195]
v_mfma_f32_16x16x32_bf16 v[196:199], a[116:119], v[124:127], v[196:199]
v_mfma_f32_16x16x32_bf16 v[200:203], a[120:123], v[124:127], v[200:203]
v_mfma_f32_16x16x32_bf16 v[204:207], a[124:127], v[124:127], v[204:207]
s_waitcnt vmcnt(0)
v_mfma_f32_16x16x32_bf16 a[192:195], a[128:131], v[128:131], a[192:195]
v_mfma_f32_16x16x32_bf16 a[192:195], a[144:147], v[144:147], a[192:195]
v_mfma_f32_16x16x32_bf16 a[196:199], a[132:135], v[128:131], a[196:199]
v_mfma_f32_16x16x32_bf16 a[196:199], a[148:151], v[144:147], a[196:199]
v_mfma_f32_16x16x32_bf16 a[200:203], a[136:139], v[128:131], a[200:203]
v_mfma_f32_16x16x32_bf16 a[200:203], a[152:155], v[144:147], a[200:203]
v_mfma_f32_16x16x32_bf16 a[204:207], a[140:143], v[128:131], a[204:207]
v_mfma_f32_16x16x32_bf16 a[204:207], a[156:159], v[144:147], a[204:207]
v_mfma_f32_16x16x32_bf16 a[208:211], a[128:131], v[132:135], a[208:211]
v_mfma_f32_16x16x32_bf16 a[208:211], a[144:147], v[148:151], a[208:211]
ds_write_b128 v224, a[192:195] offset:0
v_mfma_f32_16x16x32_bf16 a[212:215], a[132:135], v[132:135], a[212:215]
v_mfma_f32_16x16x32_bf16 a[212:215], a[148:151], v[148:151], a[212:215]
ds_write_b128 v224, a[196:199] offset:1024
v_mfma_f32_16x16x32_bf16 a[216:219], a[136:139], v[132:135], a[216:219]
v_mfma_f32_16x16x32_bf16 a[216:219], a[152:155], v[148:151], a[216:219]
ds_write_b128 v224, a[200:203] offset:2048
v_mfma_f32_16x16x32_bf16 a[220:223], a[140:143], v[132:135], a[220:223]
v_mfma_f32_16x16x32_bf16 a[220:223], a[156:159], v[148:151], a[220:223]
ds_write_b128 v224, a[204:207] offset:3072
v_mfma_f32_16x16x32_bf16 a[224:227], a[128:131], v[136:139], a[224:227]
v_mfma_f32_16x16x32_bf16 a[224:227], a[144:147], v[152:155], a[224:227]
ds_write_b128 v224, a[208:211] offset:4096
v_mfma_f32_16x16x32_bf16 a[228:231], a[132:135], v[136:139], a[228:231]
v_mfma_f32_16x16x32_bf16 a[228:231], a[148:151], v[152:155], a[228:231]
ds_write_b128 v224, a[212:215] offset:5120
v_mfma_f32_16x16x32_bf16 a[232:235], a[136:139], v[136:139], a[232:235]
v_mfma_f32_16x16x32_bf16 a[232:235], a[152:155], v[152:155], a[232:235]
ds_write_b128 v224, a[216:219] offset:6144
v_mfma_f32_16x16x32_bf16 a[236:239], a[140:143], v[136:139], a[236:239]
v_mfma_f32_16x16x32_bf16 a[236:239], a[156:159], v[152:155], a[236:239]
ds_write_b128 v224, a[220:223] offset:7168
v_mfma_f32_16x16x32_bf16 v[192:195], a[128:131], v[140:143], v[192:195]
v_mfma_f32_16x16x32_bf16 v[192:195], a[144:147], v[156:159], v[192:195]
ds_write_b128 v224, a[224:227] offset:8192
v_mfma_f32_16x16x32_bf16 v[196:199], a[132:135], v[140:143], v[196:199]
v_mfma_f32_16x16x32_bf16 v[196:199], a[148:151], v[156:159], v[196:199]
ds_write_b128 v224, a[228:231] offset:9216
v_mfma_f32_16x16x32_bf16 v[200:203], a[136:139], v[140:143], v[200:203]
v_mfma_f32_16x16x32_bf16 v[200:203], a[152:155], v[156:159], v[200:203]
ds_write_b128 v224, a[232:235] offset:10240
v_mfma_f32_16x16x32_bf16 v[204:207], a[140:143], v[140:143], v[204:207]
v_mfma_f32_16x16x32_bf16 v[204:207], a[156:159], v[156:159], v[204:207]
ds_write_b128 v224, a[236:239] offset:11264
s_waitcnt lgkmcnt(0)
s_barrier
ds_read_b128 v[96:99], v226 offset:0
ds_read_b128 v[112:115], v227 offset:0
ds_read_b128 v[128:131], v228 offset:0
ds_read_b128 v[100:103], v226 offset:1024
ds_read_b128 v[116:119], v227 offset:1024
ds_read_b128 v[132:135], v228 offset:1024
ds_read_b128 v[104:107], v226 offset:2048
ds_read_b128 v[120:123], v227 offset:2048
ds_read_b128 v[136:139], v228 offset:2048
ds_read_b128 v[108:111], v226 offset:3072
ds_read_b128 v[124:127], v227 offset:3072
ds_read_b128 v[140:143], v228 offset:3072
v_mov_b32 v155, 0
s_waitcnt lgkmcnt(9)
v_pk_add_f32 v[96:97], v[96:97], v[192:193]
v_pk_add_f32 v[112:113], v[112:113], v[128:129]
v_pk_add_f32 v[98:99], v[98:99], v[194:195]
v_pk_add_f32 v[114:115], v[114:115], v[130:131]
v_pk_add_f32 v[96:97], v[96:97], v[112:113]
v_pk_add_f32 v[98:99], v[98:99], v[114:115]
v_pk_fma_f32 v[0:1], v[16:17], v[96:97], v[0:1]
v_pk_fma_f32 v[2:3], v[18:19], v[98:99], v[2:3]
v_pk_mul_f32 v[146:147], v[0:1], v[0:1]
v_pk_mul_f32 v[148:149], v[0:1], v[32:33]
v_pk_add_f32 v[144:145], v[0:1], v[2:3]
v_pk_fma_f32 v[146:147], v[2:3], v[2:3], v[146:147]
v_pk_fma_f32 v[148:149], v[2:3], v[34:35], v[148:149]
s_waitcnt lgkmcnt(6)
v_pk_add_f32 v[100:101], v[100:101], v[196:197]
v_pk_add_f32 v[116:117], v[116:117], v[132:133]
v_pk_add_f32 v[102:103], v[102:103], v[198:199]
v_pk_add_f32 v[118:119], v[118:119], v[134:135]
v_pk_add_f32 v[100:101], v[100:101], v[116:117]
v_pk_add_f32 v[102:103], v[102:103], v[118:119]
v_pk_fma_f32 v[4:5], v[20:21], v[100:101], v[4:5]
v_pk_fma_f32 v[6:7], v[22:23], v[102:103], v[6:7]
v_pk_add_f32 v[144:145], v[144:145], v[4:5]
v_pk_fma_f32 v[146:147], v[4:5], v[4:5], v[146:147]
v_pk_fma_f32 v[148:149], v[4:5], v[36:37], v[148:149]
v_pk_add_f32 v[144:145], v[144:145], v[6:7]
v_pk_fma_f32 v[146:147], v[6:7], v[6:7], v[146:147]
v_pk_fma_f32 v[148:149], v[6:7], v[38:39], v[148:149]
s_waitcnt lgkmcnt(3)
v_pk_add_f32 v[104:105], v[104:105], v[200:201]
v_pk_add_f32 v[120:121], v[120:121], v[136:137]
v_pk_add_f32 v[106:107], v[106:107], v[202:203]
v_pk_add_f32 v[122:123], v[122:123], v[138:139]
v_pk_add_f32 v[104:105], v[104:105], v[120:121]
v_pk_add_f32 v[106:107], v[106:107], v[122:123]
v_pk_fma_f32 v[8:9], v[24:25], v[104:105], v[8:9]
v_pk_fma_f32 v[10:11], v[26:27], v[106:107], v[10:11]
v_pk_add_f32 v[144:145], v[144:145], v[8:9]
v_pk_fma_f32 v[146:147], v[8:9], v[8:9], v[146:147]
v_pk_fma_f32 v[148:149], v[8:9], v[40:41], v[148:149]
v_pk_add_f32 v[144:145], v[144:145], v[10:11]
v_pk_fma_f32 v[146:147], v[10:11], v[10:11], v[146:147]
v_pk_fma_f32 v[148:149], v[10:11], v[42:43], v[148:149]
s_waitcnt lgkmcnt(0)
v_pk_add_f32 v[108:109], v[108:109], v[204:205]
v_pk_add_f32 v[124:125], v[124:125], v[140:141]
v_pk_add_f32 v[110:111], v[110:111], v[206:207]
v_pk_add_f32 v[126:127], v[126:127], v[142:143]
v_pk_add_f32 v[108:109], v[108:109], v[124:125]
v_pk_add_f32 v[110:111], v[110:111], v[126:127]
v_pk_fma_f32 v[12:13], v[28:29], v[108:109], v[12:13]
v_pk_fma_f32 v[14:15], v[30:31], v[110:111], v[14:15]
v_pk_add_f32 v[144:145], v[144:145], v[12:13]
v_pk_fma_f32 v[146:147], v[12:13], v[12:13], v[146:147]
v_pk_fma_f32 v[148:149], v[12:13], v[44:45], v[148:149]
v_pk_add_f32 v[144:145], v[144:145], v[14:15]
v_pk_fma_f32 v[146:147], v[14:15], v[14:15], v[146:147]
v_pk_fma_f32 v[148:149], v[14:15], v[46:47], v[148:149]
v_add_f32 v152, v144, v145
v_add_f32 v153, v146, v147
v_add_f32 v154, v148, v149
s_nop 1
v_permlane32_swap_b32 v152, v154
v_permlane32_swap_b32 v153, v155
v_add_f32 v152, v152, v154
v_add_f32 v153, v153, v155
s_nop 1
v_permlane16_swap_b32 v152, v153
v_add_f32 v152, v152, v153
v_min_u32 v152, -2, v152
buffer_store_dword v152, v232, s[16:19], s37 offen sc1
s_or_b32 s34, s101, s27
s_cbranch_scc1 Lm_nohu
s_add_u32 s34, s30, 4096
s_mov_b64 exec, 1
buffer_store_dword v233, v233, s[16:19], s34 offen sc1
s_mov_b64 exec, -1
Lm_nohu:
s_waitcnt vmcnt(0)
Lm_h1:
buffer_load_dword v96, v168, s[16:19], s36 offen offset:0 sc1
buffer_load_dword v97, v168, s[16:19], s36 offen offset:64 sc1
buffer_load_dword v98, v168, s[16:19], s36 offen offset:128 sc1
buffer_load_dword v99, v168, s[16:19], s36 offen offset:1024 sc1
buffer_load_dword v100, v168, s[16:19], s36 offen offset:1088 sc1
buffer_load_dword v101, v168, s[16:19], s36 offen offset:1152 sc1
s_sub_u32 s60, s60, 1
s_cbranch_scc1 La_end
s_waitcnt vmcnt(0)
v_max3_u32 v102, v96, v97, v98
v_max3_u32 v103, v99, v100, v101
v_max_u32 v102, v102, v103
v_cmp_eq_u32 vcc, -1, v102
s_cbranch_vccnz Lm_h1
v_add_f32 v96, v96, v99
v_add_f32 v97, v97, v100
v_add_f32 v98, v98, v101
v_mov_b32 v99, v96
v_mov_b32 v100, v97
v_mov_b32 v101, v98
v_permlane16_swap_b32 v96, v99
v_permlane16_swap_b32 v97, v100
v_permlane16_swap_b32 v98, v101
v_add_f32 v96, v96, v99
v_add_f32 v97, v97, v100
v_add_f32 v98, v98, v101
v_mov_b32 v99, v96
v_mov_b32 v100, v97
v_mov_b32 v101, v98
v_permlane32_swap_b32 v96, v99
v_permlane32_swap_b32 v97, v100
v_permlane32_swap_b32 v98, v101
v_add_f32 v96, v96, v99
v_add_f32 v97, v97, v100
v_add_f32 v98, v98, v101
v_mul_f32 v96, 0x3b000000, v96
v_mul_f32 v97, 0x3b000000, v97
v_fma_f32 v97, -v96, v96, v97
v_max_f32 v97, 0, v97
v_cvt_pk_bf16_f32 v96, v96, v97
v_and_b32 v97, 0xffff0000, v96
v_add_f32 v97, 0x3727c5ac, v97
v_cvt_pk_bf16_f32 v97, v97, v97
v_lshlrev_b32 v97, 16, v97
v_sqrt_f32 v97, v97
v_lshlrev_b32 v96, 16, v96
v_cvt_pk_bf16_f32 v97, v97, v97
v_lshlrev_b32 v97, 16, v97
v_rcp_f32 v100, v97
v_fma_f32 v98, -v96, v251, v98
v_fma_f32 v98, v98, v100, v252
v_med3_f32 v98, v98, -s38, s38
v_and_or_b32 v104, v98, s26, v169
v_mul_f32 v102, v96, v100
v_pk_fma_f32 v[112:113], v[0:1], v[100:101], v[102:103] op_sel_hi:[1,0,0] neg_lo:[0,0,1] neg_hi:[0,0,1]
v_max_f32_dpp v104, v104, v104 quad_perm:[1,0,3,2] row_mask:0xf bank_mask:0xf
v_pk_fma_f32 v[114:115], v[2:3], v[100:101], v[102:103] op_sel_hi:[1,0,0] neg_lo:[0,0,1] neg_hi:[0,0,1]
v_pk_fma_f32 v[116:117], v[4:5], v[100:101], v[102:103] op_sel_hi:[1,0,0] neg_lo:[0,0,1] neg_hi:[0,0,1]
v_max_f32_dpp v104, v104, v104 quad_perm:[2,3,0,1] row_mask:0xf bank_mask:0xf
v_pk_fma_f32 v[118:119], v[6:7], v[100:101], v[102:103] op_sel_hi:[1,0,0] neg_lo:[0,0,1] neg_hi:[0,0,1]
v_pk_fma_f32 v[120:121], v[8:9], v[100:101], v[102:103] op_sel_hi:[1,0,0] neg_lo:[0,0,1] neg_hi:[0,0,1]
v_max_f32_dpp v104, v104, v104 row_half_mirror row_mask:0xf bank_mask:0xf
v_pk_fma_f32 v[122:123], v[10:11], v[100:101], v[102:103] op_sel_hi:[1,0,0] neg_lo:[0,0,1] neg_hi:[0,0,1]
v_pk_fma_f32 v[124:125], v[12:13], v[100:101], v[102:103] op_sel_hi:[1,0,0] neg_lo:[0,0,1] neg_hi:[0,0,1]
v_max_f32_dpp v104, v104, v104 row_mirror row_mask:0xf bank_mask:0xf
ds_write_b32 v170, v104
v_pk_fma_f32 v[126:127], v[14:15], v[100:101], v[102:103] op_sel_hi:[1,0,0] neg_lo:[0,0,1] neg_hi:[0,0,1]
v_pk_fma_f32 v[112:113], v[112:113], v[48:49], v[64:65]
v_pk_fma_f32 v[114:115], v[114:115], v[50:51], v[66:67]
v_pk_fma_f32 v[116:117], v[116:117], v[52:53], v[68:69]
v_pk_fma_f32 v[118:119], v[118:119], v[54:55], v[70:71]
v_pk_fma_f32 v[120:121], v[120:121], v[56:57], v[72:73]
v_pk_fma_f32 v[122:123], v[122:123], v[58:59], v[74:75]
v_pk_fma_f32 v[124:125], v[124:125], v[60:61], v[76:77]
v_pk_fma_f32 v[126:127], v[126:127], v[62:63], v[78:79]
s_waitcnt lgkmcnt(0)
s_barrier
ds_read_b128 v[104:107], v171
v_min_u32 v112, -2, v112
v_min_u32 v113, -2, v113
v_min_u32 v114, -2, v114
v_min_u32 v115, -2, v115
v_min_u32 v116, -2, v116
v_min_u32 v117, -2, v117
v_min_u32 v118, -2, v118
v_min_u32 v119, -2, v119
v_min_u32 v120, -2, v120
v_min_u32 v121, -2, v121
v_min_u32 v122, -2, v122
v_min_u32 v123, -2, v123
v_min_u32 v124, -2, v124
v_min_u32 v125, -2, v125
v_min_u32 v126, -2, v126
v_min_u32 v127, -2, v127
s_or_b32 s34, s101, s27
s_waitcnt lgkmcnt(0)
v_max3_f32 v104, v104, v105, v106
v_max_f32 v104, v104, v107
s_cbranch_scc1 Lm_nokey
s_mov_b64 exec, 1
buffer_store_dword v104, v233, s[16:19], s30 offen sc1
s_mov_b64 exec, -1
Lm_nokey:
v_and_b32 v105, 2047, v104
v_cmp_eq_u32 s[48:49], v105, v169
v_readfirstlane_b32 s34, v105
s_mov_b64 exec, s[48:49]
s_cbranch_execz Lm_noh2
buffer_store_dwordx4 v[112:115], v254, s[16:19], s24 offen offset:0 sc1
buffer_store_dwordx4 v[116:119], v254, s[16:19], s24 offen offset:16 sc1
buffer_store_dwordx4 v[120:123], v254, s[16:19], s24 offen offset:128 sc1
buffer_store_dwordx4 v[124:127], v254, s[16:19], s24 offen offset:144 sc1
Lm_noh2:
s_mov_b64 exec, -1
s_lshr_b32 s34, s34, 4
s_add_u32 s34, s34, 1
s_and_b32 s34, s34, 3
s_cmp_lg_u32 s34, s27
s_cselect_b32 s61, 0, s61
v_and_b32 v192, 31, v248
v_lshlrev_b32 v192, 7, v192
s_mov_b32 s30, 30429184
s_cmp_eq_u32 s61, 0
s_cbranch_scc1 Lm_nok
buffer_load_dword v194, v192, s[16:19], s30 offen sc1
Lm_nok:
v_pk_fma_f32 v[128:129], v[80:81], v[112:113], v[0:1]
v_pk_fma_f32 v[130:131], v[82:83], v[114:115], v[2:3]
v_pk_fma_f32 v[132:133], v[84:85], v[116:117], v[4:5]
v_pk_fma_f32 v[134:135], v[86:87], v[118:119], v[6:7]
v_pk_fma_f32 v[136:137], v[88:89], v[120:121], v[8:9]
v_pk_fma_f32 v[138:139], v[90:91], v[122:123], v[10:11]
v_pk_fma_f32 v[140:141], v[92:93], v[124:125], v[12:13]
v_pk_fma_f32 v[142:143], v[94:95], v[126:127], v[14:15]
v_cvt_pk_bf16_f32 v240, v128, v129
v_cvt_pk_bf16_f32 v241, v130, v131
v_cvt_pk_bf16_f32 v242, v132, v133
v_cvt_pk_bf16_f32 v243, v134, v135
v_cvt_pk_bf16_f32 v244, v136, v137
v_cvt_pk_bf16_f32 v245, v138, v139
v_cvt_pk_bf16_f32 v246, v140, v141
v_cvt_pk_bf16_f32 v247, v142, v143
s_cbranch_scc0 Lm_ffn
s_andn2_b64 exec, exec, s[48:49]
buffer_store_dwordx4 v[240:243], v253, s[84:87], 0 offen offset:0 sc1
buffer_store_dwordx4 v[244:247], v253, s[84:87], 0 offen offset:64 sc1
s_mov_b64 exec, s[48:49]
s_cbranch_execz Lm_noz
buffer_store_dwordx4 v[240:243], v253, s[84:87], 0 offen offset:0 sc1
buffer_store_dwordx4 v[244:247], v253, s[84:87], 0 offen offset:64 sc1
v_min_u32 v128, -2, v128
v_min_u32 v129, -2, v129
v_min_u32 v130, -2, v130
v_min_u32 v131, -2, v131
v_min_u32 v132, -2, v132
v_min_u32 v133, -2, v133
v_min_u32 v134, -2, v134
v_min_u32 v135, -2, v135
v_min_u32 v136, -2, v136
v_min_u32 v137, -2, v137
v_min_u32 v138, -2, v138
v_min_u32 v139, -2, v139
v_min_u32 v140, -2, v140
v_min_u32 v141, -2, v141
v_min_u32 v142, -2, v142
v_min_u32 v143, -2, v143
s_waitcnt vmcnt(0)
buffer_store_dwordx4 v[128:131], v254, s[16:19], s33 offen offset:0 sc1
buffer_store_dwordx4 v[132:135], v254, s[16:19], s33 offen offset:16 sc1
buffer_store_dwordx4 v[136:139], v254, s[16:19], s33 offen offset:128 sc1
buffer_store_dwordx4 v[140:143], v254, s[16:19], s33 offen offset:144 sc1
Lm_noz:
s_mov_b64 exec, -1
s_branch Lm_done
Lm_ffn:
v_add_u32 v193, 131072, v255
s_cmp_eq_u32 s61, 2
s_cbranch_scc1 Lm_st2
ds_read_b128 v[4:7], v193 offset:0
ds_read_b128 v[12:15], v193 offset:1024
ds_read_b128 v[20:23], v193 offset:2048
ds_read_b128 v[28:31], v193 offset:3072
ds_read_b128 v[36:39], v193 offset:4096
ds_read_b128 v[44:47], v193 offset:5120
ds_read_b128 v[52:55], v193 offset:6144
ds_read_b128 v[60:63], v193 offset:7168
s_waitcnt lgkmcnt(7)
v_lshlrev_b32 v0, 16, v4
v_and_b32 v1, 0xffff0000, v4
v_lshlrev_b32 v2, 16, v5
v_and_b32 v3, 0xffff0000, v5
v_lshlrev_b32 v4, 16, v6
v_and_b32 v5, 0xffff0000, v6
v_lshlrev_b32 v6, 16, v7
v_and_b32 v7, 0xffff0000, v7
s_waitcnt lgkmcnt(6)
v_lshlrev_b32 v8, 16, v12
v_and_b32 v9, 0xffff0000, v12
v_lshlrev_b32 v10, 16, v13
v_and_b32 v11, 0xffff0000, v13
v_lshlrev_b32 v12, 16, v14
v_and_b32 v13, 0xffff0000, v14
v_lshlrev_b32 v14, 16, v15
v_and_b32 v15, 0xffff0000, v15
s_waitcnt lgkmcnt(5)
v_lshlrev_b32 v16, 16, v20
v_and_b32 v17, 0xffff0000, v20
v_lshlrev_b32 v18, 16, v21
v_and_b32 v19, 0xffff0000, v21
v_lshlrev_b32 v20, 16, v22
v_and_b32 v21, 0xffff0000, v22
v_lshlrev_b32 v22, 16, v23
v_and_b32 v23, 0xffff0000, v23
s_waitcnt lgkmcnt(4)
v_lshlrev_b32 v24, 16, v28
v_and_b32 v25, 0xffff0000, v28
v_lshlrev_b32 v26, 16, v29
v_and_b32 v27, 0xffff0000, v29
v_lshlrev_b32 v28, 16, v30
v_and_b32 v29, 0xffff0000, v30
v_lshlrev_b32 v30, 16, v31
v_and_b32 v31, 0xffff0000, v31
s_waitcnt lgkmcnt(3)
v_lshlrev_b32 v32, 16, v36
v_and_b32 v33, 0xffff0000, v36
v_lshlrev_b32 v34, 16, v37
v_and_b32 v35, 0xffff0000, v37
v_lshlrev_b32 v36, 16, v38
v_and_b32 v37, 0xffff0000, v38
v_lshlrev_b32 v38, 16, v39
v_and_b32 v39, 0xffff0000, v39
s_waitcnt lgkmcnt(2)
v_lshlrev_b32 v40, 16, v44
v_and_b32 v41, 0xffff0000, v44
v_lshlrev_b32 v42, 16, v45
v_and_b32 v43, 0xffff0000, v45
v_lshlrev_b32 v44, 16, v46
v_and_b32 v45, 0xffff0000, v46
v_lshlrev_b32 v46, 16, v47
v_and_b32 v47, 0xffff0000, v47
s_waitcnt lgkmcnt(1)
v_lshlrev_b32 v48, 16, v52
v_and_b32 v49, 0xffff0000, v52
v_lshlrev_b32 v50, 16, v53
v_and_b32 v51, 0xffff0000, v53
v_lshlrev_b32 v52, 16, v54
v_and_b32 v53, 0xffff0000, v54
v_lshlrev_b32 v54, 16, v55
v_and_b32 v55, 0xffff0000, v55
s_waitcnt lgkmcnt(0)
v_lshlrev_b32 v56, 16, v60
v_and_b32 v57, 0xffff0000, v60
v_lshlrev_b32 v58, 16, v61
v_and_b32 v59, 0xffff0000, v61
v_lshlrev_b32 v60, 16, v62
v_and_b32 v61, 0xffff0000, v62
v_lshlrev_b32 v62, 16, v63
v_and_b32 v63, 0xffff0000, v63
ds_read_b128 v[68:71], v193 offset:8192
ds_read_b128 v[76:79], v193 offset:9216
ds_read_b128 v[84:87], v193 offset:10240
ds_read_b128 v[92:95], v193 offset:11264
ds_read_b128 v[100:103], v193 offset:12288
ds_read_b128 v[108:111], v193 offset:13312
ds_read_b128 v[116:119], v193 offset:14336
ds_read_b128 v[124:127], v193 offset:15360
s_waitcnt lgkmcnt(7)
v_lshlrev_b32 v64, 16, v68
v_and_b32 v65, 0xffff0000, v68
Lpad24:
s_cbranch_execz Lwalk2
v_lshlrev_b32 v66, 16, v69
v_and_b32 v67, 0xffff0000, v69
v_lshlrev_b32 v68, 16, v70
v_and_b32 v69, 0xffff0000, v70
v_lshlrev_b32 v70, 16, v71
v_and_b32 v71, 0xffff0000, v71
s_waitcnt lgkmcnt(6)
v_lshlrev_b32 v72, 16, v76
v_and_b32 v73, 0xffff0000, v76
v_lshlrev_b32 v74, 16, v77
v_and_b32 v75, 0xffff0000, v77
v_lshlrev_b32 v76, 16, v78
v_and_b32 v77, 0xffff0000, v78
v_lshlrev_b32 v78, 16, v79
v_and_b32 v79, 0xffff0000, v79
s_waitcnt lgkmcnt(5)
v_lshlrev_b32 v80, 16, v84
v_and_b32 v81, 0xffff0000, v84
v_lshlrev_b32 v82, 16, v85
v_and_b32 v83, 0xffff0000, v85
v_lshlrev_b32 v84, 16, v86
v_and_b32 v85, 0xffff0000, v86
v_lshlrev_b32 v86, 16, v87
v_and_b32 v87, 0xffff0000, v87
s_waitcnt lgkmcnt(4)
v_lshlrev_b32 v88, 16, v92
v_and_b32 v89, 0xffff0000, v92
v_lshlrev_b32 v90, 16, v93
v_and_b32 v91, 0xffff0000, v93
v_lshlrev_b32 v92, 16, v94
v_and_b32 v93, 0xffff0000, v94
v_lshlrev_b32 v94, 16, v95
v_and_b32 v95, 0xffff0000, v95
s_waitcnt lgkmcnt(3)
v_lshlrev_b32 v96, 16, v100
v_and_b32 v97, 0xffff0000, v100
v_lshlrev_b32 v98, 16, v101
v_and_b32 v99, 0xffff0000, v101
v_lshlrev_b32 v100, 16, v102
v_and_b32 v101, 0xffff0000, v102
v_lshlrev_b32 v102, 16, v103
v_and_b32 v103, 0xffff0000, v103
s_waitcnt lgkmcnt(2)
v_lshlrev_b32 v104, 16, v108
v_and_b32 v105, 0xffff0000, v108
v_lshlrev_b32 v106, 16, v109
v_and_b32 v107, 0xffff0000, v109
v_lshlrev_b32 v108, 16, v110
v_and_b32 v109, 0xffff0000, v110
v_lshlrev_b32 v110, 16, v111
v_and_b32 v111, 0xffff0000, v111
s_waitcnt lgkmcnt(1)
v_lshlrev_b32 v112, 16, v116
v_and_b32 v113, 0xffff0000, v116
v_lshlrev_b32 v114, 16, v117
v_and_b32 v115, 0xffff0000, v117
v_lshlrev_b32 v116, 16, v118
v_and_b32 v117, 0xffff0000, v118
v_lshlrev_b32 v118, 16, v119
v_and_b32 v119, 0xffff0000, v119
s_waitcnt lgkmcnt(0)
v_lshlrev_b32 v120, 16, v124
v_and_b32 v121, 0xffff0000, v124
v_lshlrev_b32 v122, 16, v125
v_and_b32 v123, 0xffff0000, v125
v_lshlrev_b32 v124, 16, v126
v_and_b32 v125, 0xffff0000, v126
v_lshlrev_b32 v126, 16, v127
v_and_b32 v127, 0xffff0000, v127
v_lshlrev_b32 v195, 1, v255
s_lshl_b32 s33, s63, 7
s_add_u32 s33, s33, 30441472
s_waitcnt vmcnt(0)
v_cmp_eq_u32 vcc, -1, v194
s_cbranch_vccz Lm_k1ok
Lm_k1:
buffer_load_dword v194, v192, s[16:19], s30 offen sc1
s_sub_u32 s60, s60, 1
s_cbranch_scc1 La_end
s_waitcnt vmcnt(0)
v_cmp_eq_u32 vcc, -1, v194
s_cbranch_vccnz Lm_k1
Lm_k1ok:
s_cmp_eq_u32 s30, 30425088
s_mov_b32 s30, 30425088
s_cbranch_scc0 Lm_k1
v_mov_b32 v196, v194
s_nop 1
v_max_f32_dpp v196, v196, v196 quad_perm:[1,0,3,2] row_mask:0xf bank_mask:0xf
s_nop 1
v_max_f32_dpp v196, v196, v196 quad_perm:[2,3,0,1] row_mask:0xf bank_mask:0xf
s_nop 1
v_max_f32_dpp v196, v196, v196 row_half_mirror row_mask:0xf bank_mask:0xf
s_nop 1
v_max_f32_dpp v196, v196, v196 row_mirror row_mask:0xf bank_mask:0xf
s_nop 1
v_mov_b32 v197, v196
s_nop 1
v_permlane16_swap_b32 v196, v197
v_max_f32 v196, v196, v197
s_nop 0
v_readfirstlane_b32 s34, v196
s_bfe_u32 s36, s34, 0x50006
s_lshl_b32 s36, s36, 11
s_add_u32 s36, s36, 30736384
Lm_h2b:
buffer_load_dwordx4 v[200:203], v195, s[16:19], s36 offen sc1
buffer_load_dwordx4 v[204:207], v195, s[16:19], s36 offen offset:16 sc1
s_sub_u32 s60, s60, 1
s_cbranch_scc1 La_end
s_waitcnt vmcnt(0)
v_max3_u32 v196, v200, v201, v202
v_max3_u32 v197, v203, v204, v205
v_max3_u32 v196, v196, v206, v207
v_max_u32 v196, v196, v197
v_cmp_eq_u32 vcc, -1, v196
s_cbranch_vccnz Lm_h2b
v_pk_mul_f32 v[128:129], v[0:1], v[200:201] op_sel_hi:[1,0]
v_pk_mul_f32 v[130:131], v[2:3], v[200:201] op_sel_hi:[1,0]
v_pk_mul_f32 v[132:133], v[4:5], v[200:201] op_sel_hi:[1,0]
v_pk_mul_f32 v[134:135], v[6:7], v[200:201] op_sel_hi:[1,0]
v_pk_mul_f32 v[136:137], v[8:9], v[200:201] op_sel_hi:[1,0]
v_pk_mul_f32 v[138:139], v[10:11], v[200:201] op_sel_hi:[1,0]
v_pk_mul_f32 v[140:141], v[12:13], v[200:201] op_sel_hi:[1,0]
v_pk_mul_f32 v[142:143], v[14:15], v[200:201] op_sel_hi:[1,0]
v_pk_fma_f32 v[128:129], v[16:17], v[200:201], v[128:129] op_sel:[0,1,0]
v_pk_fma_f32 v[130:131], v[18:19], v[200:201], v[130:131] op_sel:[0,1,0]
v_pk_fma_f32 v[132:133], v[20:21], v[200:201], v[132:133] op_sel:[0,1,0]
v_pk_fma_f32 v[134:135], v[22:23], v[200:201], v[134:135] op_sel:[0,1,0]
v_pk_fma_f32 v[136:137], v[24:25], v[200:201], v[136:137] op_sel:[0,1,0]
v_pk_fma_f32 v[138:139], v[26:27], v[200:201], v[138:139] op_sel:[0,1,0]
v_pk_fma_f32 v[140:141], v[28:29], v[200:201], v[140:141] op_sel:[0,1,0]
v_pk_fma_f32 v[142:143], v[30:31], v[200:201], v[142:143] op_sel:[0,1,0]
v_pk_fma_f32 v[128:129], v[32:33], v[202:203], v[128:129] op_sel_hi:[1,0,1]
v_pk_fma_f32 v[130:131], v[34:35], v[202:203], v[130:131] op_sel_hi:[1,0,1]
v_pk_fma_f32 v[132:133], v[36:37], v[202:203], v[132:133] op_sel_hi:[1,0,1]
v_pk_fma_f32 v[134:135], v[38:39], v[202:203], v[134:135] op_sel_hi:[1,0,1]
v_pk_fma_f32 v[136:137], v[40:41], v[202:203], v[136:137] op_sel_hi:[1,0,1]
v_pk_fma_f32 v[138:139], v[42:43], v[202:203], v[138:139] op_sel_hi:[1,0,1]
v_pk_fma_f32 v[140:141], v[44:45], v[202:203], v[140:141] op_sel_hi:[1,0,1]
v_pk_fma_f32 v[142:143], v[46:47], v[202:203], v[142:143] op_sel_hi:[1,0,1]
v_pk_fma_f32 v[128:129], v[48:49], v[202:203], v[128:129] op_sel:[0,1,0]
v_pk_fma_f32 v[130:131], v[50:51], v[202:203], v[130:131] op_sel:[0,1,0]
v_pk_fma_f32 v[132:133], v[52:53], v[202:203], v[132:133] op_sel:[0,1,0]
v_pk_fma_f32 v[134:135], v[54:55], v[202:203], v[134:135] op_sel:[0,1,0]
v_pk_fma_f32 v[136:137], v[56:57], v[202:203], v[136:137] op_sel:[0,1,0]
v_pk_fma_f32 v[138:139], v[58:59], v[202:203], v[138:139] op_sel:[0,1,0]
v_pk_fma_f32 v[140:141], v[60:61], v[202:203], v[140:141] op_sel:[0,1,0]
v_pk_fma_f32 v[142:143], v[62:63], v[202:203], v[142:143] op_sel:[0,1,0]
v_pk_fma_f32 v[128:129], v[64:65], v[204:205], v[128:129] op_sel_hi:[1,0,1]
v_pk_fma_f32 v[130:131], v[66:67], v[204:205], v[130:131] op_sel_hi:[1,0,1]
v_pk_fma_f32 v[132:133], v[68:69], v[204:205], v[132:133] op_sel_hi:[1,0,1]
v_pk_fma_f32 v[134:135], v[70:71], v[204:205], v[134:135] op_sel_hi:[1,0,1]
v_pk_fma_f32 v[136:137], v[72:73], v[204:205], v[136:137] op_sel_hi:[1,0,1]
v_pk_fma_f32 v[138:139], v[74:75], v[204:205], v[138:139] op_sel_hi:[1,0,1]
v_pk_fma_f32 v[140:141], v[76:77], v[204:205], v[140:141] op_sel_hi:[1,0,1]
v_pk_fma_f32 v[142:143], v[78:79], v[204:205], v[142:143] op_sel_hi:[1,0,1]
v_pk_fma_f32 v[128:129], v[80:81], v[204:205], v[128:129] op_sel:[0,1,0]
v_pk_fma_f32 v[130:131], v[82:83], v[204:205], v[130:131] op_sel:[0,1,0]
v_pk_fma_f32 v[132:133], v[84:85], v[204:205], v[132:133] op_sel:[0,1,0]
v_pk_fma_f32 v[134:135], v[86:87], v[204:205], v[134:135] op_sel:[0,1,0]
v_pk_fma_f32 v[136:137], v[88:89], v[204:205], v[136:137] op_sel:[0,1,0]
v_pk_fma_f32 v[138:139], v[90:91], v[204:205], v[138:139] op_sel:[0,1,0]
v_pk_fma_f32 v[140:141], v[92:93], v[204:205], v[140:141] op_sel:[0,1,0]
v_pk_fma_f32 v[142:143], v[94:95], v[204:205], v[142:143] op_sel:[0,1,0]
v_pk_fma_f32 v[128:129], v[96:97], v[206:207], v[128:129] op_sel_hi:[1,0,1]
v_pk_fma_f32 v[130:131], v[98:99], v[206:207], v[130:131] op_sel_hi:[1,0,1]
v_pk_fma_f32 v[132:133], v[100:101], v[206:207], v[132:133] op_sel_hi:[1,0,1]
v_pk_fma_f32 v[134:135], v[102:103], v[206:207], v[134:135] op_sel_hi:[1,0,1]
v_pk_fma_f32 v[136:137], v[104:105], v[206:207], v[136:137] op_sel_hi:[1,0,1]
v_pk_fma_f32 v[138:139], v[106:107], v[206:207], v[138:139] op_sel_hi:[1,0,1]
v_pk_fma_f32 v[140:141], v[108:109], v[206:207], v[140:141] op_sel_hi:[1,0,1]
v_pk_fma_f32 v[142:143], v[110:111], v[206:207], v[142:143] op_sel_hi:[1,0,1]
v_pk_fma_f32 v[128:129], v[112:113], v[206:207], v[128:129] op_sel:[0,1,0]
v_pk_fma_f32 v[130:131], v[114:115], v[206:207], v[130:131] op_sel:[0,1,0]
v_pk_fma_f32 v[132:133], v[116:117], v[206:207], v[132:133] op_sel:[0,1,0]
v_pk_fma_f32 v[134:135], v[118:119], v[206:207], v[134:135] op_sel:[0,1,0]
v_pk_fma_f32 v[136:137], v[120:121], v[206:207], v[136:137] op_sel:[0,1,0]
v_pk_fma_f32 v[138:139], v[122:123], v[206:207], v[138:139] op_sel:[0,1,0]
v_pk_fma_f32 v[140:141], v[124:125], v[206:207], v[140:141] op_sel:[0,1,0]
v_pk_fma_f32 v[142:143], v[126:127], v[206:207], v[142:143] op_sel:[0,1,0]
s_nop 1
v_permlane32_swap_b32 v128, v136
v_permlane32_swap_b32 v129, v137
v_permlane32_swap_b32 v130, v138
v_permlane32_swap_b32 v131, v139
v_permlane32_swap_b32 v132, v140
v_permlane32_swap_b32 v133, v141
v_permlane32_swap_b32 v134, v142
v_permlane32_swap_b32 v135, v143
v_add_f32 v128, v128, v136
v_add_f32 v129, v129, v137
v_add_f32 v130, v130, v138
v_add_f32 v131, v131, v139
v_add_f32 v132, v132, v140
v_add_f32 v133, v133, v141
v_add_f32 v134, v134, v142
v_add_f32 v135, v135, v143
s_nop 1
v_permlane16_swap_b32 v128, v132
v_permlane16_swap_b32 v129, v133
v_permlane16_swap_b32 v130, v134
v_permlane16_swap_b32 v131, v135
v_add_f32 v128, v128, v132
v_add_f32 v129, v129, v133
v_add_f32 v130, v130, v134
v_add_f32 v131, v131, v135
v_add_f32_dpp v128, v128, v128 quad_perm:[1,0,3,2] row_mask:0xf bank_mask:0xf
v_add_f32_dpp v129, v129, v129 quad_perm:[1,0,3,2] row_mask:0xf bank_mask:0xf
v_add_f32_dpp v130, v130, v130 quad_perm:[1,0,3,2] row_mask:0xf bank_mask:0xf
v_add_f32_dpp v131, v131, v131 quad_perm:[1,0,3,2] row_mask:0xf bank_mask:0xf
v_add_f32_dpp v128, v128, v128 quad_perm:[2,3,0,1] row_mask:0xf bank_mask:0xf
v_add_f32_dpp v129, v129, v129 quad_perm:[2,3,0,1] row_mask:0xf bank_mask:0xf
v_add_f32_dpp v130, v130, v130 quad_perm:[2,3,0,1] row_mask:0xf bank_mask:0xf
v_add_f32_dpp v131, v131, v131 quad_perm:[2,3,0,1] row_mask:0xf bank_mask:0xf
v_add_f32_dpp v128, v128, v128 row_half_mirror row_mask:0xf bank_mask:0xf
v_add_f32_dpp v129, v129, v129 row_half_mirror row_mask:0xf bank_mask:0xf
v_add_f32_dpp v130, v130, v130 row_half_mirror row_mask:0xf bank_mask:0xf
v_add_f32_dpp v131, v131, v131 row_half_mirror row_mask:0xf bank_mask:0xf
v_add_f32_dpp v128, v128, v128 row_mirror row_mask:0xf bank_mask:0xf
v_add_f32_dpp v129, v129, v129 row_mirror row_mask:0xf bank_mask:0xf
v_add_f32_dpp v130, v130, v130 row_mirror row_mask:0xf bank_mask:0xf
v_add_f32_dpp v131, v131, v131 row_mirror row_mask:0xf bank_mask:0xf
v_mov_b32 v132, v128
v_mov_b32 v133, v129
v_mov_b32 v134, v130
v_mov_b32 v135, v131
v_mul_f32 v136, 0xbfb8aa3b, v128
v_mul_f32 v137, 0xbfb8aa3b, v129
v_mul_f32 v138, 0xbfb8aa3b, v130
v_mul_f32 v139, 0xbfb8aa3b, v131
v_permlane32_swap_b32 v132, v140
v_permlane32_swap_b32 v133, v141
v_permlane32_swap_b32 v134, v142
v_permlane32_swap_b32 v135, v143
v_exp_f32 v136, v136
v_exp_f32 v137, v137
v_exp_f32 v138, v138
v_exp_f32 v139, v139
v_mul_f32 v128, v128, v140
v_mul_f32 v129, v129, v141
v_mul_f32 v130, v130, v142
v_mul_f32 v131, v131, v143
v_add_f32 v136, 1.0, v136
v_add_f32 v137, 1.0, v137
v_add_f32 v138, 1.0, v138
v_add_f32 v139, 1.0, v139
v_rcp_f32 v136, v136
v_rcp_f32 v137, v137
v_rcp_f32 v138, v138
v_rcp_f32 v139, v139
s_nop 0
v_mul_f32 v128, v128, v136
v_mul_f32 v129, v129, v137
v_mul_f32 v130, v130, v138
v_mul_f32 v131, v131, v139
v_min_u32 v128, -2, v128
v_min_u32 v129, -2, v129
v_min_u32 v130, -2, v130
v_min_u32 v131, -2, v131
s_mov_b64 exec, 0x10001
buffer_store_dwordx4 v[128:131], v248, s[16:19], s33 offen sc1
s_mov_b64 exec, -1
buffer_store_dwordx4 v[240:243], v253, s[84:87], 0 offen offset:0 sc1
buffer_store_dwordx4 v[244:247], v253, s[84:87], 0 offen offset:64 sc1
s_branch Lm_done
Lm_st2:
buffer_store_dwordx4 v[240:243], v253, s[84:87], 0 offen offset:0 sc1
buffer_store_dwordx4 v[244:247], v253, s[84:87], 0 offen offset:64 sc1
v_lshrrev_b32 v195, 4, v248
v_lshlrev_b32 v203, 2, v195
v_lshlrev_b32 v195, 3, v195
s_lshl_b32 s38, s63, 5
s_add_u32 s37, s38, 29370368
s_add_u32 s56, s16, 30441472
s_addc_u32 s57, s17, 0
s_mov_b32 s58, 22016
v_lshrrev_b32 v212, 1, v248
v_lshlrev_b32 v212, 7, v212
v_and_b32 v213, 1, v248
v_lshl_add_u32 v212, v213, 4, v212
s_mov_b32 s41, 4096
s_mov_b32 s42, 8192
s_mov_b32 s43, 12288
s_mov_b32 s44, 16384
s_mov_b32 s45, 20480
s_waitcnt vmcnt(0)
v_cmp_eq_u32 vcc, -1, v194
s_cbranch_vccz Lm_k2ok
Lm_k2:
buffer_load_dword v194, v192, s[16:19], s30 offen sc1
s_sub_u32 s60, s60, 1
s_cbranch_scc1 La_end
s_waitcnt vmcnt(0)
v_cmp_eq_u32 vcc, -1, v194
s_cbranch_vccnz Lm_k2
Lm_k2ok:
s_cmp_eq_u32 s30, 30425088
s_mov_b32 s30, 30425088
s_cbranch_scc0 Lm_k2
v_mov_b32 v196, v194
s_nop 1
v_max_f32_dpp v196, v196, v196 quad_perm:[1,0,3,2] row_mask:0xf bank_mask:0xf
s_nop 1
v_max_f32_dpp v196, v196, v196 quad_perm:[2,3,0,1] row_mask:0xf bank_mask:0xf
s_nop 1
v_max_f32_dpp v196, v196, v196 row_half_mirror row_mask:0xf bank_mask:0xf
s_nop 1
v_max_f32_dpp v196, v196, v196 row_mirror row_mask:0xf bank_mask:0xf
s_nop 1
v_mov_b32 v197, v196
s_nop 1
v_permlane16_swap_b32 v196, v197
v_max_f32 v196, v196, v197
s_nop 0
v_readfirstlane_b32 s34, v196
v_mul_f32 v196, 0xbfb8aa3b, v196
v_exp_f32 v196, v196
s_bfe_u32 s36, s34, 0x50006
s_lshl_b32 s36, s36, 11
s_add_u32 s36, s36, s38
s_add_u32 s36, s36, 30801920
v_add_f32 v196, 1.0, v196
v_rcp_f32 v196, v196
s_and_b32 s35, s34, 2047
s_lshl_b32 s35, s35, 10
s_lshl4_add_u32 s35, s63, s35
ds_read_b128 v[4:7], v193 offset:0
ds_read_b128 v[12:15], v193 offset:1024
ds_read_b128 v[20:23], v193 offset:2048
ds_read_b128 v[28:31], v193 offset:3072
ds_read_b128 v[36:39], v193 offset:4096
ds_read_b128 v[44:47], v193 offset:5120
ds_read_b128 v[52:55], v193 offset:6144
ds_read_b128 v[60:63], v193 offset:7168
ds_read_b128 v[68:71], v193 offset:8192
ds_read_b128 v[76:79], v193 offset:9216
ds_read_b128 v[84:87], v193 offset:10240
ds_read_b128 v[92:95], v193 offset:11264
s_waitcnt lgkmcnt(11)
v_lshlrev_b32 v0, 16, v4
v_and_b32 v1, 0xffff0000, v4
v_lshlrev_b32 v2, 16, v5
v_and_b32 v3, 0xffff0000, v5
v_lshlrev_b32 v4, 16, v6
v_and_b32 v5, 0xffff0000, v6
v_lshlrev_b32 v6, 16, v7
v_and_b32 v7, 0xffff0000, v7
s_waitcnt lgkmcnt(10)
v_lshlrev_b32 v8, 16, v12
v_and_b32 v9, 0xffff0000, v12
v_lshlrev_b32 v10, 16, v13
v_and_b32 v11, 0xffff0000, v13
v_lshlrev_b32 v12, 16, v14
v_and_b32 v13, 0xffff0000, v14
v_lshlrev_b32 v14, 16, v15
v_and_b32 v15, 0xffff0000, v15
s_waitcnt lgkmcnt(9)
v_lshlrev_b32 v16, 16, v20
v_and_b32 v17, 0xffff0000, v20
v_lshlrev_b32 v18, 16, v21
v_and_b32 v19, 0xffff0000, v21
v_lshlrev_b32 v20, 16, v22
v_and_b32 v21, 0xffff0000, v22
v_lshlrev_b32 v22, 16, v23
v_and_b32 v23, 0xffff0000, v23
s_waitcnt lgkmcnt(8)
v_lshlrev_b32 v24, 16, v28
v_and_b32 v25, 0xffff0000, v28
v_lshlrev_b32 v26, 16, v29
v_and_b32 v27, 0xffff0000, v29
v_lshlrev_b32 v28, 16, v30
v_and_b32 v29, 0xffff0000, v30
v_lshlrev_b32 v30, 16, v31
v_and_b32 v31, 0xffff0000, v31
s_waitcnt lgkmcnt(7)
v_lshlrev_b32 v32, 16, v36
v_and_b32 v33, 0xffff0000, v36
v_lshlrev_b32 v34, 16, v37
v_and_b32 v35, 0xffff0000, v37
v_lshlrev_b32 v36, 16, v38
v_and_b32 v37, 0xffff0000, v38
v_lshlrev_b32 v38, 16, v39
v_and_b32 v39, 0xffff0000, v39
s_waitcnt lgkmcnt(6)
v_lshlrev_b32 v40, 16, v44
v_and_b32 v41, 0xffff0000, v44
v_lshlrev_b32 v42, 16, v45
v_and_b32 v43, 0xffff0000, v45
v_lshlrev_b32 v44, 16, v46
v_and_b32 v45, 0xffff0000, v46
v_lshlrev_b32 v46, 16, v47
v_and_b32 v47, 0xffff0000, v47
s_waitcnt lgkmcnt(5)
v_lshlrev_b32 v48, 16, v52
v_and_b32 v49, 0xffff0000, v52
v_lshlrev_b32 v50, 16, v53
v_and_b32 v51, 0xffff0000, v53
v_lshlrev_b32 v52, 16, v54
v_and_b32 v53, 0xffff0000, v54
v_lshlrev_b32 v54, 16, v55
v_and_b32 v55, 0xffff0000, v55
s_waitcnt lgkmcnt(4)
v_lshlrev_b32 v56, 16, v60
v_and_b32 v57, 0xffff0000, v60
v_lshlrev_b32 v58, 16, v61
v_and_b32 v59, 0xffff0000, v61
v_lshlrev_b32 v60, 16, v62
v_and_b32 v61, 0xffff0000, v62
v_lshlrev_b32 v62, 16, v63
v_and_b32 v63, 0xffff0000, v63
s_waitcnt lgkmcnt(3)
v_lshlrev_b32 v64, 16, v68
v_and_b32 v65, 0xffff0000, v68
v_lshlrev_b32 v66, 16, v69
v_and_b32 v67, 0xffff0000, v69
v_lshlrev_b32 v68, 16, v70
v_and_b32 v69, 0xffff0000, v70
v_lshlrev_b32 v70, 16, v71
v_and_b32 v71, 0xffff0000, v71
s_waitcnt lgkmcnt(2)
v_lshlrev_b32 v72, 16, v76
v_and_b32 v73, 0xffff0000, v76
v_lshlrev_b32 v74, 16, v77
v_and_b32 v75, 0xffff0000, v77
v_lshlrev_b32 v76, 16, v78
v_and_b32 v77, 0xffff0000, v78
v_lshlrev_b32 v78, 16, v79
v_and_b32 v79, 0xffff0000, v79
s_waitcnt lgkmcnt(1)
v_lshlrev_b32 v80, 16, v84
v_and_b32 v81, 0xffff0000, v84
v_lshlrev_b32 v82, 16, v85
v_and_b32 v83, 0xffff0000, v85
v_lshlrev_b32 v84, 16, v86
v_and_b32 v85, 0xffff0000, v86
v_lshlrev_b32 v86, 16, v87
v_and_b32 v87, 0xffff0000, v87
s_waitcnt lgkmcnt(0)
v_lshlrev_b32 v88, 16, v92
v_and_b32 v89, 0xffff0000, v92
v_lshlrev_b32 v90, 16, v93
v_and_b32 v91, 0xffff0000, v93
v_lshlrev_b32 v92, 16, v94
v_and_b32 v93, 0xffff0000, v94
v_lshlrev_b32 v94, 16, v95
v_and_b32 v95, 0xffff0000, v95
ds_read_b128 v[100:103], v193 offset:12288
ds_read_b128 v[108:111], v193 offset:13312
ds_read_b128 v[116:119], v193 offset:14336
ds_read_b128 v[124:127], v193 offset:15360
ds_read_b128 v[132:135], v193 offset:16384
ds_read_b128 v[140:143], v193 offset:17408
ds_read_b128 v[148:151], v193 offset:18432
ds_read_b128 v[156:159], v193 offset:19456
ds_read_b128 v[164:167], v193 offset:20480
ds_read_b128 v[172:175], v193 offset:21504
ds_read_b128 v[180:183], v193 offset:22528
ds_read_b128 v[188:191], v193 offset:23552
s_waitcnt lgkmcnt(11)
v_lshlrev_b32 v96, 16, v100
v_and_b32 v97, 0xffff0000, v100
v_lshlrev_b32 v98, 16, v101
v_and_b32 v99, 0xffff0000, v101
v_lshlrev_b32 v100, 16, v102
v_and_b32 v101, 0xffff0000, v102
v_lshlrev_b32 v102, 16, v103
v_and_b32 v103, 0xffff0000, v103
s_waitcnt lgkmcnt(10)
v_lshlrev_b32 v104, 16, v108
v_and_b32 v105, 0xffff0000, v108
v_lshlrev_b32 v106, 16, v109
v_and_b32 v107, 0xffff0000, v109
v_lshlrev_b32 v108, 16, v110
v_and_b32 v109, 0xffff0000, v110
v_lshlrev_b32 v110, 16, v111
v_and_b32 v111, 0xffff0000, v111
s_waitcnt lgkmcnt(9)
v_lshlrev_b32 v112, 16, v116
v_and_b32 v113, 0xffff0000, v116
v_lshlrev_b32 v114, 16, v117
v_and_b32 v115, 0xffff0000, v117
v_lshlrev_b32 v116, 16, v118
v_and_b32 v117, 0xffff0000, v118
v_lshlrev_b32 v118, 16, v119
v_and_b32 v119, 0xffff0000, v119
s_waitcnt lgkmcnt(8)
v_lshlrev_b32 v120, 16, v124
v_and_b32 v121, 0xffff0000, v124
v_lshlrev_b32 v122, 16, v125
v_and_b32 v123, 0xffff0000, v125
v_lshlrev_b32 v124, 16, v126
v_and_b32 v125, 0xffff0000, v126
v_lshlrev_b32 v126, 16, v127
v_and_b32 v127, 0xffff0000, v127
s_waitcnt lgkmcnt(7)
v_lshlrev_b32 v128, 16, v132
v_and_b32 v129, 0xffff0000, v132
v_lshlrev_b32 v130, 16, v133
v_and_b32 v131, 0xffff0000, v133
v_lshlrev_b32 v132, 16, v134
v_and_b32 v133, 0xffff0000, v134
v_lshlrev_b32 v134, 16, v135
v_and_b32 v135, 0xffff0000, v135
s_waitcnt lgkmcnt(6)
v_lshlrev_b32 v136, 16, v140
v_and_b32 v137, 0xffff0000, v140
v_lshlrev_b32 v138, 16, v141
v_and_b32 v139, 0xffff0000, v141
v_lshlrev_b32 v140, 16, v142
v_and_b32 v141, 0xffff0000, v142
v_lshlrev_b32 v142, 16, v143
v_and_b32 v143, 0xffff0000, v143
s_waitcnt lgkmcnt(5)
v_lshlrev_b32 v144, 16, v148
v_and_b32 v145, 0xffff0000, v148
v_lshlrev_b32 v146, 16, v149
v_and_b32 v147, 0xffff0000, v149
v_lshlrev_b32 v148, 16, v150
v_and_b32 v149, 0xffff0000, v150
v_lshlrev_b32 v150, 16, v151
v_and_b32 v151, 0xffff0000, v151
s_waitcnt lgkmcnt(4)
v_lshlrev_b32 v152, 16, v156
v_and_b32 v153, 0xffff0000, v156
v_lshlrev_b32 v154, 16, v157
v_and_b32 v155, 0xffff0000, v157
v_lshlrev_b32 v156, 16, v158
v_and_b32 v157, 0xffff0000, v158
v_lshlrev_b32 v158, 16, v159
v_and_b32 v159, 0xffff0000, v159
s_waitcnt lgkmcnt(3)
v_lshlrev_b32 v160, 16, v164
v_and_b32 v161, 0xffff0000, v164
v_lshlrev_b32 v162, 16, v165
v_and_b32 v163, 0xffff0000, v165
v_lshlrev_b32 v164, 16, v166
v_and_b32 v165, 0xffff0000, v166
v_lshlrev_b32 v166, 16, v167
v_and_b32 v167, 0xffff0000, v167
s_waitcnt lgkmcnt(2)
v_lshlrev_b32 v168, 16, v172
v_and_b32 v169, 0xffff0000, v172
v_lshlrev_b32 v170, 16, v173
v_and_b32 v171, 0xffff0000, v173
v_lshlrev_b32 v172, 16, v174
v_and_b32 v173, 0xffff0000, v174
v_lshlrev_b32 v174, 16, v175
v_and_b32 v175, 0xffff0000, v175
s_waitcnt lgkmcnt(1)
v_lshlrev_b32 v176, 16, v180
v_and_b32 v177, 0xffff0000, v180
v_lshlrev_b32 v178, 16, v181
v_and_b32 v179, 0xffff0000, v181
v_lshlrev_b32 v180, 16, v182
v_and_b32 v181, 0xffff0000, v182
v_lshlrev_b32 v182, 16, v183
v_and_b32 v183, 0xffff0000, v183
s_waitcnt lgkmcnt(0)
v_lshlrev_b32 v184, 16, v188
v_and_b32 v185, 0xffff0000, v188
v_lshlrev_b32 v186, 16, v189
v_and_b32 v187, 0xffff0000, v189
v_lshlrev_b32 v188, 16, v190
v_and_b32 v189, 0xffff0000, v190
v_lshlrev_b32 v190, 16, v191
v_and_b32 v191, 0xffff0000, v191
buffer_load_dwordx2 v[198:199], v195, s[16:19], s37 offen sc1
s_waitcnt vmcnt(0)
v_mul_f32 v198, v196, v198
v_mul_f32 v199, v196, v199
Lm_hz:
buffer_load_dwordx2 v[200:201], v195, s[16:19], s36 offen sc1
s_sub_u32 s60, s60, 1
s_cbranch_scc1 La_end
s_waitcnt vmcnt(0)
v_max_u32 v197, v200, v201
v_cmp_eq_u32 vcc, -1, v197
s_cbranch_vccnz Lm_hz
Lm_h3:
buffer_load_dwordx4 v[216:219], v212, s[56:59], 0 offen sc1
buffer_load_dwordx4 v[220:223], v212, s[56:59], s41 offen sc1
buffer_load_dwordx4 v[224:227], v212, s[56:59], s42 offen sc1
buffer_load_dwordx4 v[228:231], v212, s[56:59], s43 offen sc1
buffer_load_dwordx4 v[232:235], v212, s[56:59], s44 offen sc1
buffer_load_dwordx4 v[236:239], v212, s[56:59], s45 offen sc1
s_sub_u32 s60, s60, 1
s_cbranch_scc1 La_end
s_waitcnt vmcnt(0)
v_max_u32 v197, v200, v201
v_max_u32 v202, v216, v217
v_max3_u32 v197, v197, v218, v219
v_max3_u32 v202, v202, v220, v221
v_max3_u32 v197, v197, v222, v223
v_max3_u32 v202, v202, v224, v225
v_max3_u32 v197, v197, v226, v227
v_max3_u32 v202, v202, v228, v229
v_max3_u32 v197, v197, v230, v231
v_max3_u32 v202, v202, v232, v233
v_max3_u32 v197, v197, v234, v235
v_max3_u32 v202, v202, v236, v237
v_max3_u32 v197, v197, v238, v239
v_max_u32 v197, v197, v202
v_cmp_eq_u32 vcc, -1, v197
s_cbranch_vccnz Lm_h3
v_pk_mul_f32 v[204:205], v[0:1], v[216:217] op_sel_hi:[1,0]
v_pk_mul_f32 v[206:207], v[2:3], v[216:217] op_sel_hi:[1,0]
v_pk_mul_f32 v[208:209], v[4:5], v[216:217] op_sel_hi:[1,0]
v_pk_mul_f32 v[210:211], v[6:7], v[216:217] op_sel_hi:[1,0]
v_pk_fma_f32 v[204:205], v[8:9], v[216:217], v[204:205] op_sel:[0,1,0]
v_pk_fma_f32 v[206:207], v[10:11], v[216:217], v[206:207] op_sel:[0,1,0]
v_pk_fma_f32 v[208:209], v[12:13], v[216:217], v[208:209] op_sel:[0,1,0]
v_pk_fma_f32 v[210:211], v[14:15], v[216:217], v[210:211] op_sel:[0,1,0]
v_pk_fma_f32 v[204:205], v[16:17], v[218:219], v[204:205] op_sel_hi:[1,0,1]
v_pk_fma_f32 v[206:207], v[18:19], v[218:219], v[206:207] op_sel_hi:[1,0,1]
v_pk_fma_f32 v[208:209], v[20:21], v[218:219], v[208:209] op_sel_hi:[1,0,1]
v_pk_fma_f32 v[210:211], v[22:23], v[218:219], v[210:211] op_sel_hi:[1,0,1]
v_pk_fma_f32 v[204:205], v[24:25], v[218:219], v[204:205] op_sel:[0,1,0]
v_pk_fma_f32 v[206:207], v[26:27], v[218:219], v[206:207] op_sel:[0,1,0]
v_pk_fma_f32 v[208:209], v[28:29], v[218:219], v[208:209] op_sel:[0,1,0]
v_pk_fma_f32 v[210:211], v[30:31], v[218:219], v[210:211] op_sel:[0,1,0]
v_pk_fma_f32 v[204:205], v[32:33], v[220:221], v[204:205] op_sel_hi:[1,0,1]
v_pk_fma_f32 v[206:207], v[34:35], v[220:221], v[206:207] op_sel_hi:[1,0,1]
v_pk_fma_f32 v[208:209], v[36:37], v[220:221], v[208:209] op_sel_hi:[1,0,1]
v_pk_fma_f32 v[210:211], v[38:39], v[220:221], v[210:211] op_sel_hi:[1,0,1]
v_pk_fma_f32 v[204:205], v[40:41], v[220:221], v[204:205] op_sel:[0,1,0]
v_pk_fma_f32 v[206:207], v[42:43], v[220:221], v[206:207] op_sel:[0,1,0]
v_pk_fma_f32 v[208:209], v[44:45], v[220:221], v[208:209] op_sel:[0,1,0]
v_pk_fma_f32 v[210:211], v[46:47], v[220:221], v[210:211] op_sel:[0,1,0]
v_pk_fma_f32 v[204:205], v[48:49], v[222:223], v[204:205] op_sel_hi:[1,0,1]
v_pk_fma_f32 v[206:207], v[50:51], v[222:223], v[206:207] op_sel_hi:[1,0,1]
v_pk_fma_f32 v[208:209], v[52:53], v[222:223], v[208:209] op_sel_hi:[1,0,1]
v_pk_fma_f32 v[210:211], v[54:55], v[222:223], v[210:211] op_sel_hi:[1,0,1]
v_pk_fma_f32 v[204:205], v[56:57], v[222:223], v[204:205] op_sel:[0,1,0]
v_pk_fma_f32 v[206:207], v[58:59], v[222:223], v[206:207] op_sel:[0,1,0]
v_pk_fma_f32 v[208:209], v[60:61], v[222:223], v[208:209] op_sel:[0,1,0]
v_pk_fma_f32 v[210:211], v[62:63], v[222:223], v[210:211] op_sel:[0,1,0]
v_pk_fma_f32 v[204:205], v[64:65], v[224:225], v[204:205] op_sel_hi:[1,0,1]
v_pk_fma_f32 v[206:207], v[66:67], v[224:225], v[206:207] op_sel_hi:[1,0,1]
v_pk_fma_f32 v[208:209], v[68:69], v[224:225], v[208:209] op_sel_hi:[1,0,1]
v_pk_fma_f32 v[210:211], v[70:71], v[224:225], v[210:211] op_sel_hi:[1,0,1]
v_pk_fma_f32 v[204:205], v[72:73], v[224:225], v[204:205] op_sel:[0,1,0]
v_pk_fma_f32 v[206:207], v[74:75], v[224:225], v[206:207] op_sel:[0,1,0]
v_pk_fma_f32 v[208:209], v[76:77], v[224:225], v[208:209] op_sel:[0,1,0]
v_pk_fma_f32 v[210:211], v[78:79], v[224:225], v[210:211] op_sel:[0,1,0]
v_pk_fma_f32 v[204:205], v[80:81], v[226:227], v[204:205] op_sel_hi:[1,0,1]
v_pk_fma_f32 v[206:207], v[82:83], v[226:227], v[206:207] op_sel_hi:[1,0,1]
v_pk_fma_f32 v[208:209], v[84:85], v[226:227], v[208:209] op_sel_hi:[1,0,1]
v_pk_fma_f32 v[210:211], v[86:87], v[226:227], v[210:211] op_sel_hi:[1,0,1]
v_pk_fma_f32 v[204:205], v[88:89], v[226:227], v[204:205] op_sel:[0,1,0]
v_pk_fma_f32 v[206:207], v[90:91], v[226:227], v[206:207] op_sel:[0,1,0]
v_pk_fma_f32 v[208:209], v[92:93], v[226:227], v[208:209] op_sel:[0,1,0]
v_pk_fma_f32 v[210:211], v[94:95], v[226:227], v[210:211] op_sel:[0,1,0]
v_pk_fma_f32 v[204:205], v[96:97], v[228:229], v[204:205] op_sel_hi:[1,0,1]
v_pk_fma_f32 v[206:207], v[98:99], v[228:229], v[206:207] op_sel_hi:[1,0,1]
v_pk_fma_f32 v[208:209], v[100:101], v[228:229], v[208:209] op_sel_hi:[1,0,1]
v_pk_fma_f32 v[210:211], v[102:103], v[228:229], v[210:211] op_sel_hi:[1,0,1]
v_pk_fma_f32 v[204:205], v[104:105], v[228:229], v[204:205] op_sel:[0,1,0]
v_pk_fma_f32 v[206:207], v[106:107], v[228:229], v[206:207] op_sel:[0,1,0]
v_pk_fma_f32 v[208:209], v[108:109], v[228:229], v[208:209] op_sel:[0,1,0]
v_pk_fma_f32 v[210:211], v[110:111], v[228:229], v[210:211] op_sel:[0,1,0]
v_pk_fma_f32 v[204:205], v[112:113], v[230:231], v[204:205] op_sel_hi:[1,0,1]
v_pk_fma_f32 v[206:207], v[114:115], v[230:231], v[206:207] op_sel_hi:[1,0,1]
v_pk_fma_f32 v[208:209], v[116:117], v[230:231], v[208:209] op_sel_hi:[1,0,1]
v_pk_fma_f32 v[210:211], v[118:119], v[230:231], v[210:211] op_sel_hi:[1,0,1]
v_pk_fma_f32 v[204:205], v[120:121], v[230:231], v[204:205] op_sel:[0,1,0]
v_pk_fma_f32 v[206:207], v[122:123], v[230:231], v[206:207] op_sel:[0,1,0]
v_pk_fma_f32 v[208:209], v[124:125], v[230:231], v[208:209] op_sel:[0,1,0]
v_pk_fma_f32 v[210:211], v[126:127], v[230:231], v[210:211] op_sel:[0,1,0]
v_pk_fma_f32 v[204:205], v[128:129], v[232:233], v[204:205] op_sel_hi:[1,0,1]
v_pk_fma_f32 v[206:207], v[130:131], v[232:233], v[206:207] op_sel_hi:[1,0,1]
Lpad25:
s_cbranch_execz Lwalk2
v_pk_fma_f32 v[208:209], v[132:133], v[232:233], v[208:209] op_sel_hi:[1,0,1]
v_pk_fma_f32 v[210:211], v[134:135], v[232:233], v[210:211] op_sel_hi:[1,0,1]
v_pk_fma_f32 v[204:205], v[136:137], v[232:233], v[204:205] op_sel:[0,1,0]
v_pk_fma_f32 v[206:207], v[138:139], v[232:233], v[206:207] op_sel:[0,1,0]
v_pk_fma_f32 v[208:209], v[140:141], v[232:233], v[208:209] op_sel:[0,1,0]
v_pk_fma_f32 v[210:211], v[142:143], v[232:233], v[210:211] op_sel:[0,1,0]
v_pk_fma_f32 v[204:205], v[144:145], v[234:235], v[204:205] op_sel_hi:[1,0,1]
v_pk_fma_f32 v[206:207], v[146:147], v[234:235], v[206:207] op_sel_hi:[1,0,1]
v_pk_fma_f32 v[208:209], v[148:149], v[234:235], v[208:209] op_sel_hi:[1,0,1]
v_pk_fma_f32 v[210:211], v[150:151], v[234:235], v[210:211] op_sel_hi:[1,0,1]
v_pk_fma_f32 v[204:205], v[152:153], v[234:235], v[204:205] op_sel:[0,1,0]
v_pk_fma_f32 v[206:207], v[154:155], v[234:235], v[206:207] op_sel:[0,1,0]
v_pk_fma_f32 v[208:209], v[156:157], v[234:235], v[208:209] op_sel:[0,1,0]
v_pk_fma_f32 v[210:211], v[158:159], v[234:235], v[210:211] op_sel:[0,1,0]
v_pk_fma_f32 v[204:205], v[160:161], v[236:237], v[204:205] op_sel_hi:[1,0,1]
v_pk_fma_f32 v[206:207], v[162:163], v[236:237], v[206:207] op_sel_hi:[1,0,1]
v_pk_fma_f32 v[208:209], v[164:165], v[236:237], v[208:209] op_sel_hi:[1,0,1]
v_pk_fma_f32 v[210:211], v[166:167], v[236:237], v[210:211] op_sel_hi:[1,0,1]
v_pk_fma_f32 v[204:205], v[168:169], v[236:237], v[204:205] op_sel:[0,1,0]
v_pk_fma_f32 v[206:207], v[170:171], v[236:237], v[206:207] op_sel:[0,1,0]
v_pk_fma_f32 v[208:209], v[172:173], v[236:237], v[208:209] op_sel:[0,1,0]
v_pk_fma_f32 v[210:211], v[174:175], v[236:237], v[210:211] op_sel:[0,1,0]
v_pk_fma_f32 v[204:205], v[176:177], v[238:239], v[204:205] op_sel_hi:[1,0,1]
v_pk_fma_f32 v[206:207], v[178:179], v[238:239], v[206:207] op_sel_hi:[1,0,1]
v_pk_fma_f32 v[208:209], v[180:181], v[238:239], v[208:209] op_sel_hi:[1,0,1]
v_pk_fma_f32 v[210:211], v[182:183], v[238:239], v[210:211] op_sel_hi:[1,0,1]
v_pk_fma_f32 v[204:205], v[184:185], v[238:239], v[204:205] op_sel:[0,1,0]
v_pk_fma_f32 v[206:207], v[186:187], v[238:239], v[206:207] op_sel:[0,1,0]
v_pk_fma_f32 v[208:209], v[188:189], v[238:239], v[208:209] op_sel:[0,1,0]
v_pk_fma_f32 v[210:211], v[190:191], v[238:239], v[210:211] op_sel:[0,1,0]
s_nop 1
v_permlane32_swap_b32 v204, v208
v_permlane32_swap_b32 v205, v209
v_permlane32_swap_b32 v206, v210
v_permlane32_swap_b32 v207, v211
v_add_f32 v204, v204, v208
v_add_f32 v205, v205, v209
v_add_f32 v206, v206, v210
v_add_f32 v207, v207, v211
s_nop 1
v_permlane16_swap_b32 v204, v206
v_permlane16_swap_b32 v205, v207
v_add_f32 v204, v204, v206
v_add_f32 v205, v205, v207
s_nop 0
v_add_f32_dpp v204, v204, v204 quad_perm:[1,0,3,2] row_mask:0xf bank_mask:0xf
v_add_f32_dpp v205, v205, v205 quad_perm:[1,0,3,2] row_mask:0xf bank_mask:0xf
s_nop 0
v_add_f32_dpp v204, v204, v204 quad_perm:[2,3,0,1] row_mask:0xf bank_mask:0xf
v_add_f32_dpp v205, v205, v205 quad_perm:[2,3,0,1] row_mask:0xf bank_mask:0xf
s_nop 0
v_add_f32_dpp v204, v204, v204 row_half_mirror row_mask:0xf bank_mask:0xf
v_add_f32_dpp v205, v205, v205 row_half_mirror row_mask:0xf bank_mask:0xf
s_nop 0
v_add_f32_dpp v204, v204, v204 row_mirror row_mask:0xf bank_mask:0xf
v_add_f32_dpp v205, v205, v205 row_mirror row_mask:0xf bank_mask:0xf
v_fma_f32 v204, v204, v198, v200
v_fma_f32 v205, v205, v199, v201
v_cvt_pk_bf16_f32 v204, v204, v205
s_mov_b32 exec_lo, 0x10001
s_mov_b32 exec_hi, 0x10001
buffer_store_dword v204, v203, s[84:87], s35 offen sc1
s_mov_b64 exec, -1
Lm_done:
La_end:
s_endpgm
Lm_poll0:
s_buffer_load_dwordx8 s[48:55], s[16:19], s25 glc
s_sub_u32 s60, s60, 1
s_cbranch_scc1 La_end
s_waitcnt lgkmcnt(0)
s_cmp_lg_u32 s48, -1
s_cbranch_scc0 Lm_poll0
s_branch Lm_ok0
Lm_poll1:
s_buffer_load_dwordx8 s[48:55], s[16:19], s25 glc
s_sub_u32 s60, s60, 1
s_cbranch_scc1 La_end
s_waitcnt lgkmcnt(0)
s_cmp_lg_u32 s49, -1
s_cbranch_scc0 Lm_poll1
s_branch Lm_ok1
Lm_ap1:
s_buffer_load_dwordx8 s[48:55], s[16:19], s25 glc
s_branch Lm_apr1
Lm_poll2:
s_buffer_load_dwordx8 s[48:55], s[16:19], s25 glc
s_sub_u32 s60, s60, 1
s_cbranch_scc1 La_end
s_waitcnt lgkmcnt(0)
s_cmp_lg_u32 s50, -1
s_cbranch_scc0 Lm_poll2
s_branch Lm_ok2
Lm_ap2:
s_buffer_load_dwordx8 s[48:55], s[16:19], s25 glc
s_branch Lm_apr2
Lm_poll3:
s_buffer_load_dwordx8 s[48:55], s[16:19], s25 glc
s_sub_u32 s60, s60, 1
s_cbranch_scc1 La_end
s_waitcnt lgkmcnt(0)
s_cmp_lg_u32 s51, -1
s_cbranch_scc0 Lm_poll3
s_branch Lm_ok3
Lm_ap3:
s_buffer_load_dwordx8 s[48:55], s[16:19], s25 glc
s_branch Lm_apr3
Lm_poll4:
s_buffer_load_dwordx8 s[48:55], s[16:19], s25 glc
s_sub_u32 s60, s60, 1
s_cbranch_scc1 La_end
s_waitcnt lgkmcnt(0)
s_cmp_lg_u32 s52, -1
s_cbranch_scc0 Lm_poll4
s_branch Lm_ok4
Lm_ap4:
s_buffer_load_dwordx8 s[48:55], s[16:19], s25 glc
s_branch Lm_apr4
Lm_poll5:
s_buffer_load_dwordx8 s[48:55], s[16:19], s25 glc
s_sub_u32 s60, s60, 1
s_cbranch_scc1 La_end
s_waitcnt lgkmcnt(0)
s_cmp_lg_u32 s53, -1
s_cbranch_scc0 Lm_poll5
s_branch Lm_ok5
Lm_ap5:
s_buffer_load_dwordx8 s[48:55], s[16:19], s25 glc
s_branch Lm_apr5
Lm_poll6:
s_buffer_load_dwordx8 s[48:55], s[16:19], s25 glc
s_sub_u32 s60, s60, 1
s_cbranch_scc1 La_end
s_waitcnt lgkmcnt(0)
s_cmp_lg_u32 s54, -1
s_cbranch_scc0 Lm_poll6
s_branch Lm_ok6
Lm_ap6:
s_buffer_load_dwordx8 s[48:55], s[16:19], s25 glc
s_branch Lm_apr6
Lm_poll7:
s_buffer_load_dwordx8 s[48:55], s[16:19], s25 glc
s_sub_u32 s60, s60, 1
s_cbranch_scc1 La_end
s_waitcnt lgkmcnt(0)
s_cmp_lg_u32 s55, -1
s_cbranch_scc0 Lm_poll7
s_branch Lm_ok7
La_xwait:
v_mov_b32 v192, 0
buffer_load_dword v192, v192, s[88:91], 0 offen offset:128 sc1
s_sub_u32 s60, s60, 1
s_cbranch_scc1 La_end
s_waitcnt vmcnt(0)
v_cmp_gt_u32 vcc, 256, v192
s_cbranch_vccnz La_xwait
s_branch La_xok
La_slow:
s_mov_b32 s32, 1
s_waitcnt vmcnt(0) lgkmcnt(0)
s_barrier
v_and_b32 v192, 15, v248
v_lshrrev_b32 v193, 4, v248
v_lshlrev_b32 v192, 8, v192
v_lshl_add_u32 v192, v193, 4, v192
s_mov_b32 s24, 0
La_slow_loop:
buffer_load_dwordx4 a[192:195], v192, s[8:11], s24 offen offset:0
buffer_load_dwordx4 a[196:199], v192, s[8:11], s24 offen offset:64
buffer_load_dwordx4 a[200:203], v192, s[8:11], s24 offen offset:128
buffer_load_dwordx4 a[204:207], v192, s[8:11], s24 offen offset:192
s_waitcnt vmcnt(0)
v_mfma_f32_16x16x32_bf16 v[0:3], a[192:195], v[128:131], 0
v_mfma_f32_16x16x32_bf16 v[0:3], a[196:199], v[132:135], v[0:3]
v_mfma_f32_16x16x32_bf16 v[0:3], a[200:203], v[136:139], v[0:3]
v_mfma_f32_16x16x32_bf16 v[0:3], a[204:207], v[140:143], v[0:3]
v_mfma_f32_16x16x32_bf16 v[4:7], a[192:195], v[144:147], 0
v_mfma_f32_16x16x32_bf16 v[4:7], a[196:199], v[148:151], v[4:7]
v_mfma_f32_16x16x32_bf16 v[4:7], a[200:203], v[152:155], v[4:7]
v_mfma_f32_16x16x32_bf16 v[4:7], a[204:207], v[156:159], v[4:7]
v_mfma_f32_16x16x32_bf16 v[8:11], a[192:195], v[160:163], 0
v_mfma_f32_16x16x32_bf16 v[8:11], a[196:199], v[164:167], v[8:11]
v_mfma_f32_16x16x32_bf16 v[8:11], a[200:203], v[168:171], v[8:11]
v_mfma_f32_16x16x32_bf16 v[8:11], a[204:207], v[172:175], v[8:11]
v_mfma_f32_16x16x32_bf16 v[12:15], a[192:195], v[176:179], 0
v_mfma_f32_16x16x32_bf16 v[12:15], a[196:199], v[180:183], v[12:15]
v_mfma_f32_16x16x32_bf16 v[12:15], a[200:203], v[184:187], v[12:15]
v_mfma_f32_16x16x32_bf16 v[12:15], a[204:207], v[188:191], v[12:15]
s_nop 7
v_max3_f32 v236, v236, v0, v1
v_max3_f32 v236, v236, v2, v3
v_max3_f32 v237, v237, v4, v5
v_max3_f32 v237, v237, v6, v7
v_max3_f32 v238, v238, v8, v9
v_max3_f32 v238, v238, v10, v11
v_max3_f32 v239, v239, v12, v13
v_max3_f32 v239, v239, v14, v15
s_add_u32 s24, s24, 4096
s_cmp_lt_u32 s24, 0x80000
s_cbranch_scc1 La_slow_loop
v_subrev_u32 v230, 22528, v230
v_subrev_u32 v231, 22528, v231
s_load_dwordx2 s[96:97], s[0:1], 88
s_load_dwordx2 s[4:5], s[0:1], 72
s_mov_b32 s6, 0x158000
s_mov_b32 s7, 0x20000
s_mov_b32 s98, 3145728
s_lshl1_add_u32 m0, s26, 2048
s_mov_b32 s31, 0
buffer_load_dwordx4 v230, s[8:11], s31 offen lds
buffer_load_dwordx4 v231, s[8:11], s31 offen offset:1024 lds
s_lshl1_add_u32 m0, s26, 18432
s_mov_b32 s31, 8192
buffer_load_dwordx4 v230, s[8:11], s31 offen lds
buffer_load_dwordx4 v231, s[8:11], s31 offen offset:1024 lds
s_lshl1_add_u32 m0, s26, 34816
s_mov_b32 s31, 16384
buffer_load_dwordx4 v230, s[8:11], s31 offen lds
buffer_load_dwordx4 v231, s[8:11], s31 offen offset:1024 lds
s_lshl1_add_u32 m0, s26, 51200
s_mov_b32 s31, 24576
buffer_load_dwordx4 v230, s[8:11], s31 offen lds
buffer_load_dwordx4 v231, s[8:11], s31 offen offset:1024 lds
s_lshl1_add_u32 m0, s26, 49152
s_nop 0
buffer_load_dwordx4 v228, s[12:15], 0 offen lds
buffer_load_dwordx4 v229, s[12:15], 0 offen offset:1024 lds
s_waitcnt vmcnt(0) lgkmcnt(0)
s_barrier
v_add_u32 v230, 22528, v230
v_add_u32 v231, 22528, v231
ds_read_b128 a[192:195], v216 offset:0
ds_read_b128 a[196:199], v217 offset:0
ds_read_b128 a[200:203], v218 offset:0
ds_read_b128 a[204:207], v219 offset:0
ds_read_b128 a[208:211], v216 offset:8192
ds_read_b128 a[212:215], v217 offset:8192
ds_read_b128 a[216:219], v218 offset:8192
ds_read_b128 a[220:223], v219 offset:8192
s_waitcnt lgkmcnt(0)
v_mfma_f32_16x16x32_bf16 v[0:3], a[192:195], v[128:131], 0
ds_read_b128 a[224:227], v216 offset:16384
ds_read_b128 a[228:231], v217 offset:16384
v_mfma_f32_16x16x32_bf16 v[0:3], a[196:199], v[132:135], v[0:3]
ds_read_b128 a[232:235], v218 offset:16384
ds_read_b128 a[236:239], v219 offset:16384
v_mfma_f32_16x16x32_bf16 v[0:3], a[200:203], v[136:139], v[0:3]
ds_read_b128 a[240:243], v216 offset:24576
ds_read_b128 a[244:247], v217 offset:24576
v_mfma_f32_16x16x32_bf16 v[0:3], a[204:207], v[140:143], v[0:3]
ds_read_b128 a[248:251], v218 offset:24576
ds_read_b128 a[252:255], v219 offset:24576
v_mfma_f32_16x16x32_bf16 v[4:7], a[208:211], v[128:131], 0
v_mfma_f32_16x16x32_bf16 v[4:7], a[212:215], v[132:135], v[4:7]
v_mfma_f32_16x16x32_bf16 v[4:7], a[216:219], v[136:139], v[4:7]
v_mfma_f32_16x16x32_bf16 v[4:7], a[220:223], v[140:143], v[4:7]
v_mfma_f32_16x16x32_bf16 v[8:11], a[192:195], v[144:147], 0
v_mfma_f32_16x16x32_bf16 v[8:11], a[196:199], v[148:151], v[8:11]
v_mfma_f32_16x16x32_bf16 v[8:11], a[200:203], v[152:155], v[8:11]
v_mfma_f32_16x16x32_bf16 v[8:11], a[204:207], v[156:159], v[8:11]
v_mfma_f32_16x16x32_bf16 v[12:15], a[208:211], v[144:147], 0
v_mfma_f32_16x16x32_bf16 v[12:15], a[212:215], v[148:151], v[12:15]
v_mfma_f32_16x16x32_bf16 v[12:15], a[216:219], v[152:155], v[12:15]
v_mfma_f32_16x16x32_bf16 v[12:15], a[220:223], v[156:159], v[12:15]
v_mfma_f32_16x16x32_bf16 v[16:19], a[192:195], v[160:163], 0
v_mfma_f32_16x16x32_bf16 v[16:19], a[196:199], v[164:167], v[16:19]
v_mfma_f32_16x16x32_bf16 v[16:19], a[200:203], v[168:171], v[16:19]
v_mfma_f32_16x16x32_bf16 v[16:19], a[204:207], v[172:175], v[16:19]
v_mfma_f32_16x16x32_bf16 v[20:23], a[208:211], v[160:163], 0
v_mfma_f32_16x16x32_bf16 v[20:23], a[212:215], v[164:167], v[20:23]
v_max3_f32 v208, v236, v0, v1
v_max3_f32 v209, v237, v8, v9
v_max3_f32 v208, v208, v2, v3
v_mfma_f32_16x16x32_bf16 v[20:23], a[216:219], v[168:171], v[20:23]
v_max3_f32 v209, v209, v10, v11
v_max3_f32 v208, v208, v4, v5
v_max3_f32 v209, v209, v12, v13
v_max3_f32 v208, v208, v6, v7
v_mfma_f32_16x16x32_bf16 v[20:23], a[220:223], v[172:175], v[20:23]
v_max3_f32 v209, v209, v14, v15
v_mfma_f32_16x16x32_bf16 v[24:27], a[192:195], v[176:179], 0
s_nop 0
v_mov_b32 v212, v208
v_mov_b32 v213, v209
v_mfma_f32_16x16x32_bf16 v[24:27], a[196:199], v[180:183], v[24:27]
s_nop 0
v_permlane16_swap_b32 v208, v212
v_permlane16_swap_b32 v209, v213
v_max_f32 v208, v208, v212
v_max_f32 v209, v209, v213
v_mfma_f32_16x16x32_bf16 v[24:27], a[200:203], v[184:187], v[24:27]
s_nop 0
v_mov_b32 v212, v208
v_mov_b32 v213, v209
v_mfma_f32_16x16x32_bf16 v[24:27], a[204:207], v[188:191], v[24:27]
s_nop 0
v_permlane32_swap_b32 v208, v212
v_permlane32_swap_b32 v209, v213
v_max_f32 v208, v208, v212
v_max_f32 v209, v209, v213
v_sub_f32 v64, 0, v208
v_sub_f32 v65, 0, v208
v_sub_f32 v66, 0, v208
v_mfma_f32_16x16x32_bf16 v[28:31], a[208:211], v[176:179], 0
v_sub_f32 v67, 0, v208
v_sub_f32 v68, 0, v209
v_sub_f32 v69, 0, v209
v_sub_f32 v70, 0, v209
v_mfma_f32_16x16x32_bf16 v[28:31], a[212:215], v[180:183], v[28:31]
v_sub_f32 v71, 0, v209
v_mfma_f32_16x16x32_bf16 v[28:31], a[216:219], v[184:187], v[28:31]
v_mfma_f32_16x16x32_bf16 v[28:31], a[220:223], v[188:191], v[28:31]
s_waitcnt lgkmcnt(0)
s_barrier
v_mfma_f32_16x16x32_bf16 v[32:35], a[224:227], v[128:131], v[64:67]
s_lshl1_add_u32 m0, s26, 0
ds_read_b128 a[192:195], v216 offset:32768
ds_read_b128 a[196:199], v217 offset:32768
v_mfma_f32_16x16x32_bf16 v[32:35], a[228:231], v[132:135], v[32:35]
s_mov_b32 s24, 8192
ds_read_b128 a[200:203], v218 offset:32768
ds_read_b128 a[204:207], v219 offset:32768
v_mfma_f32_16x16x32_bf16 v[32:35], a[232:235], v[136:139], v[32:35]
ds_read_b128 a[208:211], v216 offset:40960
ds_read_b128 a[212:215], v217 offset:40960
v_mfma_f32_16x16x32_bf16 v[32:35], a[236:239], v[140:143], v[32:35]
buffer_load_dwordx4 v228, s[12:15], s24 offen  lds
v_mfma_f32_16x16x32_bf16 v[36:39], a[240:243], v[128:131], v[64:67]
ds_read_b128 a[216:219], v218 offset:40960
ds_read_b128 a[220:223], v219 offset:40960
v_mfma_f32_16x16x32_bf16 v[36:39], a[244:247], v[132:135], v[36:39]
v_max3_f32 v208, v238, v16, v17
v_max3_f32 v209, v239, v24, v25
v_max3_f32 v208, v208, v18, v19
v_mfma_f32_16x16x32_bf16 v[36:39], a[248:251], v[136:139], v[36:39]
v_max3_f32 v209, v209, v26, v27
v_max3_f32 v208, v208, v20, v21
v_max3_f32 v209, v209, v28, v29
v_max3_f32 v208, v208, v22, v23
v_mfma_f32_16x16x32_bf16 v[36:39], a[252:255], v[140:143], v[36:39]
v_max3_f32 v209, v209, v30, v31
v_mfma_f32_16x16x32_bf16 v[40:43], a[224:227], v[144:147], v[68:71]
s_nop 0
v_mov_b32 v212, v208
v_mov_b32 v213, v209
v_mfma_f32_16x16x32_bf16 v[40:43], a[228:231], v[148:151], v[40:43]
s_nop 0
v_permlane16_swap_b32 v208, v212
v_permlane16_swap_b32 v209, v213
v_max_f32 v208, v208, v212
v_max_f32 v209, v209, v213
v_mfma_f32_16x16x32_bf16 v[40:43], a[232:235], v[152:155], v[40:43]
s_nop 0
buffer_load_dwordx4 v229, s[12:15], s24 offen offset:1024  lds
v_mov_b32 v212, v208
v_mov_b32 v213, v209
v_mfma_f32_16x16x32_bf16 v[40:43], a[236:239], v[156:159], v[40:43]
s_nop 0
v_permlane32_swap_b32 v208, v212
v_permlane32_swap_b32 v209, v213
v_max_f32 v208, v208, v212
v_max_f32 v209, v209, v213
v_sub_f32 v72, 0, v208
v_sub_f32 v73, 0, v208
v_sub_f32 v74, 0, v208
v_mfma_f32_16x16x32_bf16 v[44:47], a[240:243], v[144:147], v[68:71]
buffer_load_dwordx4 v230, s[8:11], s24 offen offset:2048  lds
v_sub_f32 v75, 0, v208
v_sub_f32 v76, 0, v209
v_sub_f32 v77, 0, v209
v_sub_f32 v78, 0, v209
v_mfma_f32_16x16x32_bf16 v[44:47], a[244:247], v[148:151], v[44:47]
v_sub_f32 v79, 0, v209
v_add_f32 v0, v0, v64
v_add_f32 v1, v1, v64
v_add_f32 v2, v2, v64
v_mfma_f32_16x16x32_bf16 v[44:47], a[248:251], v[152:155], v[44:47]
v_add_f32 v3, v3, v64
v_add_f32 v4, v4, v64
v_add_f32 v5, v5, v64
v_mfma_f32_16x16x32_bf16 v[44:47], a[252:255], v[156:159], v[44:47]
buffer_load_dwordx4 v231, s[8:11], s24 offen offset:3072  lds
v_add_f32 v6, v6, v64
v_add_f32 v7, v7, v64
v_add_f32 v8, v8, v68
v_mfma_f32_16x16x32_bf16 v[48:51], a[224:227], v[160:163], v[72:75]
v_add_f32 v9, v9, v68
v_add_f32 v10, v10, v68
v_add_f32 v11, v11, v68
v_mfma_f32_16x16x32_bf16 v[48:51], a[228:231], v[164:167], v[48:51]
s_lshl1_add_u32 m0, s26, 16384
v_add_f32 v12, v12, v68
v_add_f32 v13, v13, v68
v_add_f32 v14, v14, v68
v_mfma_f32_16x16x32_bf16 v[48:51], a[232:235], v[168:171], v[48:51]
v_add_f32 v15, v15, v68
v_exp_f32 v0, v0
v_mfma_f32_16x16x32_bf16 v[48:51], a[236:239], v[172:175], v[48:51]
s_mov_b32 s24, 16384
v_exp_f32 v1, v1
v_mfma_f32_16x16x32_bf16 v[52:55], a[240:243], v[160:163], v[72:75]
v_exp_f32 v2, v2
v_mfma_f32_16x16x32_bf16 v[52:55], a[244:247], v[164:167], v[52:55]
v_cvt_pk_bf16_f32 v96, v0, v1
v_exp_f32 v3, v3
v_mfma_f32_16x16x32_bf16 v[52:55], a[248:251], v[168:171], v[52:55]
buffer_load_dwordx4 v228, s[12:15], s24 offen  lds
v_exp_f32 v4, v4
v_mfma_f32_16x16x32_bf16 v[52:55], a[252:255], v[172:175], v[52:55]
v_cvt_pk_bf16_f32 v97, v2, v3
v_mfma_f32_16x16x32_bf16 v[56:59], a[224:227], v[176:179], v[76:79]
v_exp_f32 v5, v5
v_exp_f32 v6, v6
v_mfma_f32_16x16x32_bf16 v[56:59], a[228:231], v[180:183], v[56:59]
buffer_load_dwordx4 v229, s[12:15], s24 offen offset:1024  lds
v_cvt_pk_bf16_f32 v98, v4, v5
v_mfma_f32_16x16x32_bf16 v[56:59], a[232:235], v[184:187], v[56:59]
v_exp_f32 v7, v7
v_mfma_f32_16x16x32_bf16 v[56:59], a[236:239], v[188:191], v[56:59]
buffer_load_dwordx4 v230, s[8:11], s24 offen offset:2048  lds
v_exp_f32 v8, v8
v_mfma_f32_16x16x32_bf16 v[60:63], a[240:243], v[176:179], v[76:79]
v_cvt_pk_bf16_f32 v99, v6, v7
v_exp_f32 v9, v9
v_mfma_f32_16x16x32_bf16 v[60:63], a[244:247], v[180:183], v[60:63]
v_exp_f32 v10, v10
v_mfma_f32_16x16x32_bf16 v[60:63], a[248:251], v[184:187], v[60:63]
buffer_load_dwordx4 v231, s[8:11], s24 offen offset:3072  lds
v_cvt_pk_bf16_f32 v100, v8, v9
v_mfma_f32_16x16x32_bf16 v[60:63], a[252:255], v[188:191], v[60:63]
v_exp_f32 v11, v11
v_exp_f32 v12, v12
v_cvt_pk_bf16_f32 v101, v10, v11
v_exp_f32 v13, v13
v_exp_f32 v14, v14
v_cvt_pk_bf16_f32 v102, v12, v13
v_add_f32 v16, v16, v72
v_add_f32 v17, v17, v72
v_add_f32 v18, v18, v72
v_add_f32 v19, v19, v72
v_add_f32 v20, v20, v72
v_add_f32 v21, v21, v72
v_add_f32 v22, v22, v72
v_add_f32 v23, v23, v72
v_add_f32 v24, v24, v76
v_add_f32 v25, v25, v76
v_add_f32 v26, v26, v76
v_add_f32 v27, v27, v76
v_add_f32 v28, v28, v76
v_add_f32 v29, v29, v76
v_add_f32 v30, v30, v76
v_add_f32 v31, v31, v76
v_exp_f32 v15, v15
v_exp_f32 v16, v16
v_cvt_pk_bf16_f32 v103, v14, v15
v_exp_f32 v17, v17
v_exp_f32 v18, v18
v_cvt_pk_bf16_f32 v104, v16, v17
v_exp_f32 v19, v19
v_exp_f32 v20, v20
v_cvt_pk_bf16_f32 v105, v18, v19
v_exp_f32 v21, v21
v_exp_f32 v22, v22
v_cvt_pk_bf16_f32 v106, v20, v21
v_exp_f32 v23, v23
v_exp_f32 v24, v24
v_cvt_pk_bf16_f32 v107, v22, v23
v_exp_f32 v25, v25
v_exp_f32 v26, v26
v_cvt_pk_bf16_f32 v108, v24, v25
v_exp_f32 v27, v27
v_exp_f32 v28, v28
v_cvt_pk_bf16_f32 v109, v26, v27
v_exp_f32 v29, v29
v_exp_f32 v30, v30
v_cvt_pk_bf16_f32 v110, v28, v29
v_exp_f32 v31, v31
s_nop 0
v_cvt_pk_bf16_f32 v111, v30, v31
s_lshl_b32 s39, s27, 14
s_cmp_eq_u32 s61, 2
s_cselect_b32 s49, 262144, 0
s_mov_b32 s50, 2752
s_cselect_b32 s50, s49, s50
s_mov_b32 s52, 1024
s_cselect_b32 s52, 4096, s52
s_mov_b32 s51, 4096
s_cselect_b32 s51, 1024, s51
s_mov_b32 s48, 5504
s_cselect_b32 s48, 1024, s48
s_mov_b32 s36, 22016
s_cselect_b32 s36, 4096, s36
v_mul_u32_u24 v240, s36, v248
s_mul_i32 s51, s51, s27
s_add_u32 s51, s51, 131072
s_mul_i32 s48, s48, s27
s_lshl4_add_u32 s48, s63, s48
v_lshrrev_b32 v241, 3, v248
v_lshlrev_b32 v241, 10, v241
v_and_b32 v242, 7, v248
v_lshl_add_u32 v241, v242, 4, v241
s_lshr_b32 s53, s2, 1
s_and_b32 s36, s2, 1
s_lshl2_add_u32 s36, s36, s27
s_lshl_b32 s36, s36, 7
s_add_u32 s54, s36, s53
s_lshl_b32 s54, s54, 12
s_add_u32 s54, s54, 2097152
s_lshl_b32 s53, s53, 15
s_add_u32 s53, s53, s36
v_lshrrev_b32 v242, 2, v248
v_lshlrev_b32 v242, 7, v242
v_and_b32 v243, 3, v248
v_lshl_add_u32 v242, v243, 4, v242
s_add_u32 s36, s39, 65536
v_add_u32 v242, s36, v242
v_lshl_add_u32 v243, s27, 6, v248
v_mul_u32_u24 v243, 6144, v243
s_and_b32 s36, s2, 7
s_lshl_b32 s36, s36, 5
s_lshr_b32 s55, s2, 3
s_add_u32 s55, s55, s36
s_lshl_b32 s55, s55, 4
v_mov_b32 v80, 0
v_mov_b32 v81, 0
v_mov_b32 v82, 0
v_mov_b32 v83, 0
v_mov_b32 v84, 0
v_mov_b32 v85, 0
v_mov_b32 v86, 0
v_mov_b32 v87, 0
v_and_b32 v88, 1, v248
v_mul_u32_u24 v88, 0xaaaa, v88
v_or_b32 v88, 0x4444, v88
v_exp_f32 v32, v32
v_exp_f32 v33, v33
s_waitcnt lgkmcnt(0)
s_barrier
s_lshl1_add_u32 m0, s26, 32768
s_mov_b32 s24, 24576
buffer_load_dwordx4 v228, s[12:15], s24 offen  lds
s_waitcnt vmcnt(0)
La_last:
s_branch La_go
.section .rodata,"a"
.p2align 6
.amdhsa_kernel adaLN_cond__gqa_block_cached__moe_arch_mod__prompt_kernel
.amdhsa_next_free_vgpr 512
.amdhsa_next_free_sgpr 102
.amdhsa_accum_offset 256
.amdhsa_group_segment_fixed_size 0
.amdhsa_kernarg_size 120
.amdhsa_user_sgpr_count 2
.amdhsa_user_sgpr_kernarg_segment_ptr 1
.amdhsa_system_sgpr_workgroup_id_x 1
.amdhsa_float_denorm_mode_32 3
.end_amdhsa_kernel
```
